```python
import torch

def _softmax(x, axis=-1):
    return torch.softmax(x, dim=axis)

def _gelu(x):
    return torch.nn.functional.gelu(x, approximate='tanh')

def _silu(x):
    return torch.nn.functional.silu(x)

def _sigmoid(x):
    return torch.sigmoid(x)

def _layernorm(x, axis=-1, eps=1e-05):
    m = x.mean(dim=axis, keepdim=True)
    v = x.var(dim=axis, keepdim=True, unbiased=False)
    return (x - m) / torch.sqrt(v + eps)

def _scatter_add(tgt, idx, src, axis=0):
    return tgt.clone().index_add_(axis, idx, src)

def _segment_sum(src, seg, n):
    out = torch.zeros((n,) + src.shape[1:], dtype=src.dtype)
    return out.index_add_(0, seg, src)

def _pad(x, pw):
    flat = tuple((v for pair in reversed(pw) for v in pair))
    return torch.nn.functional.pad(x, flat)
kernel_name = 'sequential_preLN__memory_aug_recurrent_mem_tr__glu_gated_swiglu__prompt'

def setup_inputs():

    _w = lambda a: (lambda t: t.to(torch.bfloat16) if t.is_floating_point() else t)(torch.as_tensor(a))

    def _A_setup():
        B, S, Dm = (1, 2048, 576)
        H, Dh = (32, 128)
        M, seg = (8, 32)
        seg = min(seg, S)
        S = S // seg * seg
        return {'x': _w((lambda *s: torch.randn(*s, dtype=torch.bfloat16) * 0.05)(B, S, Dm)), 'mem0': _w((lambda *s: torch.randn(*s, dtype=torch.bfloat16) * 0.2)(B, M, Dm)), 'Wq': _w((lambda *s: torch.randn(*s, dtype=torch.bfloat16) * 1.6)(Dm, H, Dh) * Dm ** (-0.5)), 'Wk': _w((lambda *s: torch.randn(*s, dtype=torch.bfloat16) * 1.6)(Dm, H, Dh) * Dm ** (-0.5)), 'Wv': _w((lambda *s: torch.randn(*s, dtype=torch.bfloat16) * 0.2)(Dm, H, Dh) * Dm ** (-0.5)), 'Wo': _w((lambda *s: torch.randn(*s, dtype=torch.bfloat16) * 0.2)(H, Dh, Dm) * (H * Dh) ** (-0.5)), 'seg_len': seg}
    _A_in = _A_setup()

    def _B_setup():
        B, S, D, F = (1, 2048, 576, 4608)
        return {'x': _w((lambda *s: torch.randn(*s, dtype=torch.bfloat16) * 0.05)(B, S, D)), 'w1': _w((lambda *s: torch.randn(*s, dtype=torch.bfloat16) * 0.2)(D, F) * (2.0 / D) ** 0.5), 'w3': _w((lambda *s: torch.randn(*s, dtype=torch.bfloat16) * 0.2)(D, F) * (2.0 / D) ** 0.5), 'w2': _w((lambda *s: torch.randn(*s, dtype=torch.bfloat16) * 0.2)(F, D) * (2.0 / F) ** 0.5)}
    _B_in = _B_setup()
    return {'A_x': _A_in['x'], 'A_mem0': _A_in['mem0'], 'A_Wq': _A_in['Wq'], 'A_Wk': _A_in['Wk'], 'A_Wv': _A_in['Wv'], 'A_Wo': _A_in['Wo'], 'A_seg_len': _A_in['seg_len'], 'B_x': _B_in['x'], 'B_w1': _B_in['w1'], 'B_w3': _B_in['w3'], 'B_w2': _B_in['w2']}

def reference(A_x, A_mem0, A_Wq, A_Wk, A_Wv, A_Wo, A_seg_len, B_x, B_w1, B_w3, B_w2):

    def _A_ref(x, mem0, Wq, Wk, Wv, Wo, seg_len):
        B, S, Dm = x.shape
        H, Dh = (Wq.shape[1], Wq.shape[2])
        M = mem0.shape[1]
        scale = Dh ** (-0.5)
        n_seg = S // seg_len
        L = M + seg_len
        idx = torch.arange(L)
        mask = (idx[:, None] < M) | (idx[:, None] >= idx[None, :])
        mem = mem0
        outs = []
        for s in range(n_seg):
            xs = x[:, s * seg_len:(s + 1) * seg_len, :].clone()
            h = torch.concatenate([mem, xs], axis=1)
            q = torch.einsum('btd,dhe->bhte', h, Wq)
            k = torch.einsum('btd,dhe->bhte', h, Wk)
            v = torch.einsum('btd,dhe->bhte', h, Wv)
            scores = torch.einsum('bhqe,bhke->bhqk', q, k) * scale
            scores = torch.where(mask[None, None], scores, -1000000000.0)
            p = _softmax(scores, axis=-1)
            o = torch.einsum('bhqk,bhke->bhqe', p, v)
            o = torch.einsum('bhte,hed->btd', o, Wo)
            mem = o[:, :M, :].clone()
            outs.append(o[:, M:, :])
        return torch.concatenate(outs, axis=1)

    def _B_ref(x, w1, w3, w2):
        gate = torch.einsum('bsd,df->bsf', x, w1)
        up = torch.einsum('bsd,df->bsf', x, w3)
        h = _silu(gate) * up
        out = torch.einsum('bsf,fd->bsd', h, w2)
        return out
    x = A_x
    h = x + _A_ref(_layernorm(x, axis=-1), A_mem0, A_Wq, A_Wk, A_Wv, A_Wo, A_seg_len)
    h2 = h + _B_ref(_layernorm(h, axis=-1), B_w1, B_w3, B_w2)
    return h2
```

```asm
; @launch grid=(256,1,1) block=(256,1,1) lds=163840
.amdgcn_target "amdgcn-amd-amdhsa--gfx950"
.text
.globl sequential_preLN__memory_aug_recurrent_mem_tr__glu_gated_swiglu__prompt_kernel
.p2align 8
.type sequential_preLN__memory_aug_recurrent_mem_tr__glu_gated_swiglu__prompt_kernel,@function
sequential_preLN__memory_aug_recurrent_mem_tr__glu_gated_swiglu__prompt_kernel:
 s_cmp_ge_u32 s2, 256
 s_cbranch_scc1 L_EXIT
 s_load_dwordx16 s[16:31], s[0:1], 0
 s_load_dwordx8 s[32:39], s[0:1], 64
 s_load_dwordx4 s[40:43], s[0:1], 96
 s_getreg_b32 s45, hwreg(HW_REG_XCC_ID, 0, 4)
 v_lshrrev_b32 v1, 6, v0
 s_nop 0
 v_readfirstlane_b32 s44, v1
 s_waitcnt lgkmcnt(0)
 s_mov_b32 s4, s42
 s_mov_b32 s5, s43
 s_mov_b32 s6, 0x10000000
 s_mov_b32 s7, 0x20000
 s_mov_b32 s8, s40
 s_mov_b32 s9, s41
 s_mov_b32 s10, 256
 s_mov_b32 s11, 0x20000
 v_and_b32 v4, 63, v0
 v_lshlrev_b32 v4, 16, v4
 s_mov_b32 s48, s20
 s_mov_b32 s49, s21
 s_mov_b32 s50, 4718592
 s_mov_b32 s51, 0x20000
 buffer_load_dword v8, v4, s[48:51], 0 offen
 s_mov_b32 s48, s22
 s_mov_b32 s49, s23
 s_mov_b32 s50, 4718592
 s_mov_b32 s51, 0x20000
 buffer_load_dword v9, v4, s[48:51], 0 offen
 s_mov_b32 s48, s24
 s_mov_b32 s49, s25
 s_mov_b32 s50, 4718592
 s_mov_b32 s51, 0x20000
 buffer_load_dword v10, v4, s[48:51], 0 offen
 s_mov_b32 s48, s26
 s_mov_b32 s49, s27
 s_mov_b32 s50, 4718592
 s_mov_b32 s51, 0x20000
 buffer_load_dword v11, v4, s[48:51], 0 offen
 s_cmp_eq_u32 s44, 0
 s_cbranch_scc0 L_TK
 s_and_b32 s60, s45, 7
 s_lshl_b32 s60, s60, 2
 v_mov_b32 v2, s60
 v_mov_b32 v3, 1
 s_mov_b64 exec, 1
 buffer_atomic_add v3, v2, s[8:11], 0 offen offset:0 sc0
 s_waitcnt vmcnt(0)
 v_mov_b32 v2, 0
 ds_write_b32 v2, v3
 s_waitcnt lgkmcnt(0)
 s_mov_b64 exec, -1
L_TK:
 s_barrier
 v_mov_b32 v2, 0
 ds_read_b32 v3, v2
 s_waitcnt lgkmcnt(0)
 v_readfirstlane_b32 s46, v3
 s_barrier
 s_cmp_ge_u32 s45, 8
 s_cbranch_scc1 L_OVF
 s_cmp_ge_u32 s46, 32
 s_cbranch_scc1 L_OVF
 s_cmp_eq_u32 s45, 0
 s_cbranch_scc1 F_CHAIN
 s_cmp_lt_u32 s45, 2
 s_cbranch_scc1 F_T1
 s_cmp_lt_u32 s45, 5
 s_cbranch_scc1 F_T2
 s_sub_u32 s47, s45, 5
 v_and_b32 v68, 63, v0
 v_lshlrev_b32 v69, 4, v68
 s_lshl_b32 s72, s47, 8
 s_add_u32 s72, s72, 73437184
 s_lshl_b32 s71, s46, 2
 s_add_u32 s71, s71, s72
 s_mov_b32 s61, 0
 v_mov_b32 v6, 0
 v_mov_b32 v7, s61
 s_mov_b64 exec, 1
 buffer_store_dword v7, v6, s[4:7], s71 offen
 s_mov_b64 exec, -1
 s_add_u32 s60, s71, 128
 s_mov_b32 s61, 0
 v_mov_b32 v6, 0
 v_mov_b32 v7, s61
 s_mov_b64 exec, 1
 buffer_store_dword v7, v6, s[4:7], s60 offen
 s_mov_b64 exec, -1
 s_waitcnt vmcnt(0)
 s_barrier
 v_mov_b32 v6, 0
 s_cmp_eq_u32 s44, 0
 s_cbranch_scc0 L1
 s_lshl_b32 s60, s45, 2
 v_mov_b32 v6, s60
 v_mov_b32 v7, 1
 s_mov_b64 exec, 1
 buffer_atomic_add v7, v6, s[8:11], 0 offen offset:32 sc0
 s_mov_b64 exec, -1
 s_waitcnt vmcnt(0)
 s_mov_b64 exec, 1
 v_cmp_eq_u32 vcc, 31, v7
 s_and_b64 exec, exec, vcc
 v_mov_b32 v7, 1
 s_cbranch_execz L2
 buffer_store_dword v7, v6, s[8:11], 0 offen offset:64 sc1
L2:
 s_mov_b64 exec, -1
L1:
 s_mov_b32 s12, s32
 s_mov_b32 s13, s33
 s_mov_b32 s14, 5308416
 s_mov_b32 s15, 0x20000
 s_mov_b32 s48, s34
 s_mov_b32 s49, s35
 s_mov_b32 s50, 5308416
 s_mov_b32 s51, 0x20000
 s_mov_b32 s52, s36
 s_mov_b32 s53, s37
 s_mov_b32 s54, 5308416
 s_mov_b32 s55, 0x20000
 s_mov_b32 s56, s38
 s_mov_b32 s57, s39
 s_mov_b32 s58, 2359296
 s_mov_b32 s59, 0x20000
 s_mul_i32 s67, s44, 5
 s_cmp_eq_u32 s44, 3
 s_cselect_b32 s67, 14, s67
 s_lshl_b32 s68, s44, 2
 s_cmp_eq_u32 s44, 3
 s_cselect_b32 s68, 13, s68
 s_cmp_lt_u32 s44, 2
 s_cselect_b32 s69, 1, 0
 s_mul_i32 s66, s44, 13824
 v_mul_u32_u24 v6, 13108, v68
 v_lshrrev_b32 v6, 16, v6
 v_mul_u32_u24 v8, 5, v6
 v_sub_u32 v8, v68, v8
 v_mul_u32_u24 v6, 9216, v6
 v_lshlrev_b32 v8, 4, v8
 v_add_u32 v6, v6, v8
 s_mul_i32 s60, s46, 288
 s_lshl_b32 s61, s67, 4
 s_add_u32 s60, s60, s61
 v_add_u32 v0, s60, v6
 v_mul_u32_u24 v6, 3277, v68
 v_lshrrev_b32 v6, 16, v6
 v_mul_u32_u24 v8, 20, v6
 v_sub_u32 v8, v68, v8
 v_mul_u32_u24 v6, 1152, v6
 v_lshlrev_b32 v8, 4, v8
 v_add_u32 v6, v6, v8
 s_mul_i32 s60, s46, 165888
 s_lshl_b32 s61, s68, 6
 s_add_u32 s60, s60, s61
 v_add_u32 v2, s60, v6
 v_lshrrev_b32 v6, 4, v68
 v_lshlrev_b32 v6, 3, v6
 v_bfe_u32 v8, v68, 2, 2
 v_add_u32 v6, v6, v8
 v_mul_u32_u24 v6, 80, v6
 v_and_b32 v8, 1, v68
 v_mul_u32_u24 v8, 3840, v8
 v_add_u32 v6, v6, v8
 v_bfe_u32 v8, v68, 1, 1
 v_lshlrev_b32 v8, 3, v8
 v_add_u32 v6, v6, v8
 v_add_u32 v3, s66, v6
 v_lshrrev_b32 v6, 5, v68
 v_lshlrev_b32 v6, 3, v6
 v_bfe_u32 v8, v68, 2, 2
 v_add_u32 v6, v6, v8
 v_mul_u32_u24 v6, 320, v6
 v_bfe_u32 v8, v68, 4, 1
 v_lshlrev_b32 v8, 5, v8
 v_add_u32 v6, v6, v8
 v_and_b32 v8, 3, v68
 v_lshlrev_b32 v8, 3, v8
 v_add_u32 v6, v6, v8
 v_add_u32 v4, s66, v6
 s_and_b32 s60, s44, 1
 s_mul_i32 s61, s60, 18432
 s_add_u32 s61, s61, 55296
 s_mul_i32 s62, s60, 9216
 s_add_u32 s62, s62, 92160
 s_cmp_eq_u32 s69, 1
 s_cselect_b32 s61, s61, s62
 v_add_u32 v75, s61, v69
 s_mov_b32 exec_lo, -1
 s_mov_b32 exec_hi, 0x0fffffff
 s_add_u32 m0, s66, 0
 s_mov_b32 s60, 0
 buffer_load_dwordx4 v0, s[12:15], s60 offen lds
 s_add_u32 m0, s66, 960
 s_mov_b32 s60, 110592
 buffer_load_dwordx4 v0, s[12:15], s60 offen lds
 s_add_u32 m0, s66, 1920
 s_mov_b32 s60, 221184
 buffer_load_dwordx4 v0, s[12:15], s60 offen lds
 s_add_u32 m0, s66, 3840
 s_mov_b32 s60, 0
 buffer_load_dwordx4 v0, s[48:51], s60 offen lds
 s_add_u32 m0, s66, 4800
 s_mov_b32 s60, 110592
 buffer_load_dwordx4 v0, s[48:51], s60 offen lds
 s_add_u32 m0, s66, 5760
 s_mov_b32 s60, 221184
 buffer_load_dwordx4 v0, s[48:51], s60 offen lds
 s_mov_b64 exec, -1
 s_mov_b32 exec_lo, -1
 s_mov_b32 exec_hi, 0x0fffffff
 s_add_u32 m0, s66, 6720
 s_mov_b32 s60, 294912
 buffer_load_dwordx4 v0, s[12:15], s60 offen lds
 s_add_u32 m0, s66, 7680
 s_mov_b32 s60, 405504
 buffer_load_dwordx4 v0, s[12:15], s60 offen lds
 s_add_u32 m0, s66, 8640
 s_mov_b32 s60, 516096
 buffer_load_dwordx4 v0, s[12:15], s60 offen lds
 s_add_u32 m0, s66, 10560
 s_mov_b32 s60, 294912
 buffer_load_dwordx4 v0, s[48:51], s60 offen lds
 s_add_u32 m0, s66, 11520
 s_mov_b32 s60, 405504
 buffer_load_dwordx4 v0, s[48:51], s60 offen lds
 s_add_u32 m0, s66, 12480
 s_mov_b32 s60, 516096
 buffer_load_dwordx4 v0, s[48:51], s60 offen lds
 s_mov_b64 exec, -1
 s_waitcnt vmcnt(6)
 ds_read_b64_tr_b16 v[80:81], v3 offset:0
 ds_read_b64_tr_b16 v[82:83], v3 offset:320
 ds_read_b64_tr_b16 v[152:153], v3 offset:16
 ds_read_b64_tr_b16 v[154:155], v3 offset:336
 ds_read_b64_tr_b16 v[224:225], v3 offset:32
 ds_read_b64_tr_b16 v[226:227], v3 offset:352
 ds_read_b64_tr_b16 a[40:41], v3 offset:48
 ds_read_b64_tr_b16 a[42:43], v3 offset:368
 ds_read_b64_tr_b16 v[16:17], v3 offset:64
 ds_read_b64_tr_b16 v[18:19], v3 offset:384
 s_cmp_eq_u32 s69, 1
 s_cbranch_scc0 L3
 s_waitcnt lgkmcnt(0)
 ds_write_b128 v75, v[16:19] offset:0
L3:
 s_waitcnt lgkmcnt(0)
 s_mov_b32 exec_lo, -1
 s_mov_b32 exec_hi, 0x0fffffff
 s_add_u32 m0, s66, 0
 s_mov_b32 s60, 589824
 buffer_load_dwordx4 v0, s[12:15], s60 offen lds
 s_add_u32 m0, s66, 960
 s_mov_b32 s60, 700416
 buffer_load_dwordx4 v0, s[12:15], s60 offen lds
 s_add_u32 m0, s66, 1920
 s_mov_b32 s60, 811008
 buffer_load_dwordx4 v0, s[12:15], s60 offen lds
 s_add_u32 m0, s66, 3840
 s_mov_b32 s60, 589824
 buffer_load_dwordx4 v0, s[48:51], s60 offen lds
 s_add_u32 m0, s66, 4800
 s_mov_b32 s60, 700416
 buffer_load_dwordx4 v0, s[48:51], s60 offen lds
 s_add_u32 m0, s66, 5760
 s_mov_b32 s60, 811008
 buffer_load_dwordx4 v0, s[48:51], s60 offen lds
 s_mov_b64 exec, -1
 s_waitcnt vmcnt(6)
 ds_read_b64_tr_b16 v[84:85], v3 offset:6720
 ds_read_b64_tr_b16 v[86:87], v3 offset:7040
 ds_read_b64_tr_b16 v[156:157], v3 offset:6736
 ds_read_b64_tr_b16 v[158:159], v3 offset:7056
 ds_read_b64_tr_b16 v[228:229], v3 offset:6752
 ds_read_b64_tr_b16 v[230:231], v3 offset:7072
 ds_read_b64_tr_b16 a[44:45], v3 offset:6768
 ds_read_b64_tr_b16 a[46:47], v3 offset:7088
 ds_read_b64_tr_b16 v[16:17], v3 offset:6784
 ds_read_b64_tr_b16 v[18:19], v3 offset:7104
 s_cmp_eq_u32 s69, 1
 s_cbranch_scc0 L4
 s_waitcnt lgkmcnt(0)
 ds_write_b128 v75, v[16:19] offset:1024
L4:
 s_waitcnt lgkmcnt(0)
 s_mov_b32 exec_lo, -1
 s_mov_b32 exec_hi, 0x0fffffff
 s_add_u32 m0, s66, 6720
 s_mov_b32 s60, 884736
 buffer_load_dwordx4 v0, s[12:15], s60 offen lds
 s_add_u32 m0, s66, 7680
 s_mov_b32 s60, 995328
 buffer_load_dwordx4 v0, s[12:15], s60 offen lds
 s_add_u32 m0, s66, 8640
 s_mov_b32 s60, 1105920
 buffer_load_dwordx4 v0, s[12:15], s60 offen lds
 s_add_u32 m0, s66, 10560
 s_mov_b32 s60, 884736
 buffer_load_dwordx4 v0, s[48:51], s60 offen lds
 s_add_u32 m0, s66, 11520
 s_mov_b32 s60, 995328
 buffer_load_dwordx4 v0, s[48:51], s60 offen lds
 s_add_u32 m0, s66, 12480
 s_mov_b32 s60, 1105920
 buffer_load_dwordx4 v0, s[48:51], s60 offen lds
 s_mov_b64 exec, -1
 s_waitcnt vmcnt(6)
 ds_read_b64_tr_b16 v[88:89], v3 offset:0
 ds_read_b64_tr_b16 v[90:91], v3 offset:320
 ds_read_b64_tr_b16 v[160:161], v3 offset:16
 ds_read_b64_tr_b16 v[162:163], v3 offset:336
 ds_read_b64_tr_b16 v[232:233], v3 offset:32
 ds_read_b64_tr_b16 v[234:235], v3 offset:352
 ds_read_b64_tr_b16 a[48:49], v3 offset:48
 ds_read_b64_tr_b16 a[50:51], v3 offset:368
 ds_read_b64_tr_b16 v[16:17], v3 offset:64
 ds_read_b64_tr_b16 v[18:19], v3 offset:384
 s_cmp_eq_u32 s69, 1
 s_cbranch_scc0 L5
 s_waitcnt lgkmcnt(0)
 ds_write_b128 v75, v[16:19] offset:2048
L5:
 s_waitcnt lgkmcnt(0)
 s_mov_b32 exec_lo, -1
 s_mov_b32 exec_hi, 0x0fffffff
 s_add_u32 m0, s66, 0
 s_mov_b32 s60, 1179648
 buffer_load_dwordx4 v0, s[12:15], s60 offen lds
 s_add_u32 m0, s66, 960
 s_mov_b32 s60, 1290240
 buffer_load_dwordx4 v0, s[12:15], s60 offen lds
 s_add_u32 m0, s66, 1920
 s_mov_b32 s60, 1400832
 buffer_load_dwordx4 v0, s[12:15], s60 offen lds
 s_add_u32 m0, s66, 3840
 s_mov_b32 s60, 1179648
 buffer_load_dwordx4 v0, s[48:51], s60 offen lds
 s_add_u32 m0, s66, 4800
 s_mov_b32 s60, 1290240
 buffer_load_dwordx4 v0, s[48:51], s60 offen lds
 s_add_u32 m0, s66, 5760
 s_mov_b32 s60, 1400832
 buffer_load_dwordx4 v0, s[48:51], s60 offen lds
 s_mov_b64 exec, -1
 s_waitcnt vmcnt(6)
 ds_read_b64_tr_b16 v[92:93], v3 offset:6720
 ds_read_b64_tr_b16 v[94:95], v3 offset:7040
 ds_read_b64_tr_b16 v[164:165], v3 offset:6736
 ds_read_b64_tr_b16 v[166:167], v3 offset:7056
 ds_read_b64_tr_b16 v[236:237], v3 offset:6752
 ds_read_b64_tr_b16 v[238:239], v3 offset:7072
 ds_read_b64_tr_b16 a[52:53], v3 offset:6768
 ds_read_b64_tr_b16 a[54:55], v3 offset:7088
 ds_read_b64_tr_b16 v[16:17], v3 offset:6784
 ds_read_b64_tr_b16 v[18:19], v3 offset:7104
 s_cmp_eq_u32 s69, 1
 s_cbranch_scc0 L6
 s_waitcnt lgkmcnt(0)
 ds_write_b128 v75, v[16:19] offset:3072
L6:
 s_waitcnt lgkmcnt(0)
 s_mov_b32 exec_lo, -1
 s_mov_b32 exec_hi, 0x0fffffff
 s_add_u32 m0, s66, 6720
 s_mov_b32 s60, 1474560
 buffer_load_dwordx4 v0, s[12:15], s60 offen lds
 s_add_u32 m0, s66, 7680
 s_mov_b32 s60, 1585152
 buffer_load_dwordx4 v0, s[12:15], s60 offen lds
 s_add_u32 m0, s66, 8640
 s_mov_b32 s60, 1695744
 buffer_load_dwordx4 v0, s[12:15], s60 offen lds
 s_add_u32 m0, s66, 10560
 s_mov_b32 s60, 1474560
 buffer_load_dwordx4 v0, s[48:51], s60 offen lds
 s_add_u32 m0, s66, 11520
 s_mov_b32 s60, 1585152
 buffer_load_dwordx4 v0, s[48:51], s60 offen lds
 s_add_u32 m0, s66, 12480
 s_mov_b32 s60, 1695744
 buffer_load_dwordx4 v0, s[48:51], s60 offen lds
 s_mov_b64 exec, -1
 s_waitcnt vmcnt(6)
 ds_read_b64_tr_b16 v[96:97], v3 offset:0
 ds_read_b64_tr_b16 v[98:99], v3 offset:320
 ds_read_b64_tr_b16 v[168:169], v3 offset:16
 ds_read_b64_tr_b16 v[170:171], v3 offset:336
 ds_read_b64_tr_b16 v[240:241], v3 offset:32
 ds_read_b64_tr_b16 v[242:243], v3 offset:352
 ds_read_b64_tr_b16 a[56:57], v3 offset:48
 ds_read_b64_tr_b16 a[58:59], v3 offset:368
 ds_read_b64_tr_b16 v[16:17], v3 offset:64
 ds_read_b64_tr_b16 v[18:19], v3 offset:384
 s_cmp_eq_u32 s69, 1
 s_cbranch_scc0 L7
 s_waitcnt lgkmcnt(0)
 ds_write_b128 v75, v[16:19] offset:4096
L7:
 s_waitcnt lgkmcnt(0)
 s_mov_b32 exec_lo, -1
 s_mov_b32 exec_hi, 0x0fffffff
 s_add_u32 m0, s66, 0
 s_mov_b32 s60, 1769472
 buffer_load_dwordx4 v0, s[12:15], s60 offen lds
 s_add_u32 m0, s66, 960
 s_mov_b32 s60, 1880064
 buffer_load_dwordx4 v0, s[12:15], s60 offen lds
 s_add_u32 m0, s66, 1920
 s_mov_b32 s60, 1990656
 buffer_load_dwordx4 v0, s[12:15], s60 offen lds
 s_add_u32 m0, s66, 3840
 s_mov_b32 s60, 1769472
 buffer_load_dwordx4 v0, s[48:51], s60 offen lds
 s_add_u32 m0, s66, 4800
 s_mov_b32 s60, 1880064
 buffer_load_dwordx4 v0, s[48:51], s60 offen lds
 s_add_u32 m0, s66, 5760
 s_mov_b32 s60, 1990656
 buffer_load_dwordx4 v0, s[48:51], s60 offen lds
 s_mov_b64 exec, -1
 s_waitcnt vmcnt(6)
 ds_read_b64_tr_b16 v[100:101], v3 offset:6720
 ds_read_b64_tr_b16 v[102:103], v3 offset:7040
 ds_read_b64_tr_b16 v[172:173], v3 offset:6736
 ds_read_b64_tr_b16 v[174:175], v3 offset:7056
 ds_read_b64_tr_b16 v[244:245], v3 offset:6752
 ds_read_b64_tr_b16 v[246:247], v3 offset:7072
 ds_read_b64_tr_b16 a[60:61], v3 offset:6768
 ds_read_b64_tr_b16 a[62:63], v3 offset:7088
 ds_read_b64_tr_b16 v[16:17], v3 offset:6784
 ds_read_b64_tr_b16 v[18:19], v3 offset:7104
 s_cmp_eq_u32 s69, 1
 s_cbranch_scc0 L8
 s_waitcnt lgkmcnt(0)
 ds_write_b128 v75, v[16:19] offset:5120
L8:
 s_waitcnt lgkmcnt(0)
 s_mov_b32 exec_lo, -1
 s_mov_b32 exec_hi, 0x0fffffff
 s_add_u32 m0, s66, 6720
 s_mov_b32 s60, 2064384
 buffer_load_dwordx4 v0, s[12:15], s60 offen lds
 s_add_u32 m0, s66, 7680
 s_mov_b32 s60, 2174976
 buffer_load_dwordx4 v0, s[12:15], s60 offen lds
 s_add_u32 m0, s66, 8640
 s_mov_b32 s60, 2285568
 buffer_load_dwordx4 v0, s[12:15], s60 offen lds
 s_add_u32 m0, s66, 10560
 s_mov_b32 s60, 2064384
 buffer_load_dwordx4 v0, s[48:51], s60 offen lds
 s_add_u32 m0, s66, 11520
 s_mov_b32 s60, 2174976
 buffer_load_dwordx4 v0, s[48:51], s60 offen lds
 s_add_u32 m0, s66, 12480
 s_mov_b32 s60, 2285568
 buffer_load_dwordx4 v0, s[48:51], s60 offen lds
 s_mov_b64 exec, -1
 s_waitcnt vmcnt(6)
 ds_read_b64_tr_b16 v[104:105], v3 offset:0
 ds_read_b64_tr_b16 v[106:107], v3 offset:320
 ds_read_b64_tr_b16 v[176:177], v3 offset:16
 ds_read_b64_tr_b16 v[178:179], v3 offset:336
 ds_read_b64_tr_b16 v[248:249], v3 offset:32
 ds_read_b64_tr_b16 v[250:251], v3 offset:352
 ds_read_b64_tr_b16 a[64:65], v3 offset:48
 ds_read_b64_tr_b16 a[66:67], v3 offset:368
 ds_read_b64_tr_b16 v[16:17], v3 offset:64
 ds_read_b64_tr_b16 v[18:19], v3 offset:384
 s_cmp_eq_u32 s69, 1
 s_cbranch_scc0 L9
 s_waitcnt lgkmcnt(0)
 ds_write_b128 v75, v[16:19] offset:6144
L9:
 s_waitcnt lgkmcnt(0)
 s_mov_b32 exec_lo, -1
 s_mov_b32 exec_hi, 0x0fffffff
 s_add_u32 m0, s66, 0
 s_mov_b32 s60, 2359296
 buffer_load_dwordx4 v0, s[12:15], s60 offen lds
 s_add_u32 m0, s66, 960
 s_mov_b32 s60, 2469888
 buffer_load_dwordx4 v0, s[12:15], s60 offen lds
 s_add_u32 m0, s66, 1920
 s_mov_b32 s60, 2580480
 buffer_load_dwordx4 v0, s[12:15], s60 offen lds
 s_add_u32 m0, s66, 3840
 s_mov_b32 s60, 2359296
 buffer_load_dwordx4 v0, s[48:51], s60 offen lds
 s_add_u32 m0, s66, 4800
 s_mov_b32 s60, 2469888
 buffer_load_dwordx4 v0, s[48:51], s60 offen lds
 s_add_u32 m0, s66, 5760
 s_mov_b32 s60, 2580480
 buffer_load_dwordx4 v0, s[48:51], s60 offen lds
 s_mov_b64 exec, -1
 s_waitcnt vmcnt(6)
 ds_read_b64_tr_b16 v[108:109], v3 offset:6720
 ds_read_b64_tr_b16 v[110:111], v3 offset:7040
 ds_read_b64_tr_b16 v[180:181], v3 offset:6736
 ds_read_b64_tr_b16 v[182:183], v3 offset:7056
 ds_read_b64_tr_b16 v[252:253], v3 offset:6752
 ds_read_b64_tr_b16 v[254:255], v3 offset:7072
 ds_read_b64_tr_b16 a[68:69], v3 offset:6768
 ds_read_b64_tr_b16 a[70:71], v3 offset:7088
 ds_read_b64_tr_b16 v[16:17], v3 offset:6784
 ds_read_b64_tr_b16 v[18:19], v3 offset:7104
 s_cmp_eq_u32 s69, 1
 s_cbranch_scc0 L10
 s_waitcnt lgkmcnt(0)
 ds_write_b128 v75, v[16:19] offset:7168
L10:
 s_waitcnt lgkmcnt(0)
 s_mov_b32 exec_lo, -1
 s_mov_b32 exec_hi, 0x0fffffff
 s_add_u32 m0, s66, 6720
 s_mov_b32 s60, 2654208
 buffer_load_dwordx4 v0, s[12:15], s60 offen lds
 s_add_u32 m0, s66, 7680
 s_mov_b32 s60, 2764800
 buffer_load_dwordx4 v0, s[12:15], s60 offen lds
 s_add_u32 m0, s66, 8640
 s_mov_b32 s60, 2875392
 buffer_load_dwordx4 v0, s[12:15], s60 offen lds
 s_add_u32 m0, s66, 10560
 s_mov_b32 s60, 2654208
 buffer_load_dwordx4 v0, s[48:51], s60 offen lds
 s_add_u32 m0, s66, 11520
 s_mov_b32 s60, 2764800
 buffer_load_dwordx4 v0, s[48:51], s60 offen lds
 s_add_u32 m0, s66, 12480
 s_mov_b32 s60, 2875392
 buffer_load_dwordx4 v0, s[48:51], s60 offen lds
 s_mov_b64 exec, -1
 s_waitcnt vmcnt(6)
 ds_read_b64_tr_b16 v[112:113], v3 offset:0
 ds_read_b64_tr_b16 v[114:115], v3 offset:320
 ds_read_b64_tr_b16 v[184:185], v3 offset:16
 ds_read_b64_tr_b16 v[186:187], v3 offset:336
 ds_read_b64_tr_b16 a[0:1], v3 offset:32
 ds_read_b64_tr_b16 a[2:3], v3 offset:352
 ds_read_b64_tr_b16 a[72:73], v3 offset:48
 ds_read_b64_tr_b16 a[74:75], v3 offset:368
 ds_read_b64_tr_b16 v[16:17], v3 offset:64
 ds_read_b64_tr_b16 v[18:19], v3 offset:384
 s_cmp_eq_u32 s69, 1
 s_cbranch_scc0 L11
 s_waitcnt lgkmcnt(0)
 ds_write_b128 v75, v[16:19] offset:8192
L11:
 s_waitcnt lgkmcnt(0)
 s_mov_b32 exec_lo, -1
 s_mov_b32 exec_hi, 0x0fffffff
 s_add_u32 m0, s66, 0
 s_mov_b32 s60, 2949120
 buffer_load_dwordx4 v0, s[12:15], s60 offen lds
 s_add_u32 m0, s66, 960
 s_mov_b32 s60, 3059712
 buffer_load_dwordx4 v0, s[12:15], s60 offen lds
 s_add_u32 m0, s66, 1920
 s_mov_b32 s60, 3170304
 buffer_load_dwordx4 v0, s[12:15], s60 offen lds
 s_add_u32 m0, s66, 3840
 s_mov_b32 s60, 2949120
 buffer_load_dwordx4 v0, s[48:51], s60 offen lds
 s_add_u32 m0, s66, 4800
 s_mov_b32 s60, 3059712
 buffer_load_dwordx4 v0, s[48:51], s60 offen lds
 s_add_u32 m0, s66, 5760
 s_mov_b32 s60, 3170304
 buffer_load_dwordx4 v0, s[48:51], s60 offen lds
 s_mov_b64 exec, -1
 s_waitcnt vmcnt(6)
 ds_read_b64_tr_b16 v[116:117], v3 offset:6720
 ds_read_b64_tr_b16 v[118:119], v3 offset:7040
 ds_read_b64_tr_b16 v[188:189], v3 offset:6736
 ds_read_b64_tr_b16 v[190:191], v3 offset:7056
 ds_read_b64_tr_b16 a[4:5], v3 offset:6752
 ds_read_b64_tr_b16 a[6:7], v3 offset:7072
 ds_read_b64_tr_b16 a[76:77], v3 offset:6768
 ds_read_b64_tr_b16 a[78:79], v3 offset:7088
 ds_read_b64_tr_b16 v[16:17], v3 offset:6784
 ds_read_b64_tr_b16 v[18:19], v3 offset:7104
 s_cmp_eq_u32 s69, 1
 s_cbranch_scc0 L12
 s_waitcnt lgkmcnt(0)
 ds_write_b128 v75, v[16:19] offset:9216
L12:
 s_waitcnt lgkmcnt(0)
 s_mov_b32 exec_lo, -1
 s_mov_b32 exec_hi, 0x0fffffff
 s_add_u32 m0, s66, 6720
 s_mov_b32 s60, 3244032
 buffer_load_dwordx4 v0, s[12:15], s60 offen lds
 s_add_u32 m0, s66, 7680
 s_mov_b32 s60, 3354624
 buffer_load_dwordx4 v0, s[12:15], s60 offen lds
 s_add_u32 m0, s66, 8640
 s_mov_b32 s60, 3465216
 buffer_load_dwordx4 v0, s[12:15], s60 offen lds
 s_add_u32 m0, s66, 10560
 s_mov_b32 s60, 3244032
 buffer_load_dwordx4 v0, s[48:51], s60 offen lds
 s_add_u32 m0, s66, 11520
 s_mov_b32 s60, 3354624
 buffer_load_dwordx4 v0, s[48:51], s60 offen lds
 s_add_u32 m0, s66, 12480
 s_mov_b32 s60, 3465216
 buffer_load_dwordx4 v0, s[48:51], s60 offen lds
 s_mov_b64 exec, -1
 s_waitcnt vmcnt(6)
 ds_read_b64_tr_b16 v[120:121], v3 offset:0
 ds_read_b64_tr_b16 v[122:123], v3 offset:320
 ds_read_b64_tr_b16 v[192:193], v3 offset:16
 ds_read_b64_tr_b16 v[194:195], v3 offset:336
 ds_read_b64_tr_b16 a[8:9], v3 offset:32
 ds_read_b64_tr_b16 a[10:11], v3 offset:352
 ds_read_b64_tr_b16 a[80:81], v3 offset:48
 ds_read_b64_tr_b16 a[82:83], v3 offset:368
 ds_read_b64_tr_b16 v[16:17], v3 offset:64
 ds_read_b64_tr_b16 v[18:19], v3 offset:384
 s_cmp_eq_u32 s69, 1
 s_cbranch_scc0 L13
 s_waitcnt lgkmcnt(0)
 ds_write_b128 v75, v[16:19] offset:10240
L13:
 s_waitcnt lgkmcnt(0)
 s_mov_b32 exec_lo, -1
 s_mov_b32 exec_hi, 0x0fffffff
 s_add_u32 m0, s66, 0
 s_mov_b32 s60, 3538944
 buffer_load_dwordx4 v0, s[12:15], s60 offen lds
 s_add_u32 m0, s66, 960
 s_mov_b32 s60, 3649536
 buffer_load_dwordx4 v0, s[12:15], s60 offen lds
 s_add_u32 m0, s66, 1920
 s_mov_b32 s60, 3760128
 buffer_load_dwordx4 v0, s[12:15], s60 offen lds
 s_add_u32 m0, s66, 3840
 s_mov_b32 s60, 3538944
 buffer_load_dwordx4 v0, s[48:51], s60 offen lds
 s_add_u32 m0, s66, 4800
 s_mov_b32 s60, 3649536
 buffer_load_dwordx4 v0, s[48:51], s60 offen lds
 s_add_u32 m0, s66, 5760
 s_mov_b32 s60, 3760128
 buffer_load_dwordx4 v0, s[48:51], s60 offen lds
 s_mov_b64 exec, -1
 s_waitcnt vmcnt(6)
 ds_read_b64_tr_b16 v[124:125], v3 offset:6720
 ds_read_b64_tr_b16 v[126:127], v3 offset:7040
 ds_read_b64_tr_b16 v[196:197], v3 offset:6736
 ds_read_b64_tr_b16 v[198:199], v3 offset:7056
 ds_read_b64_tr_b16 a[12:13], v3 offset:6752
 ds_read_b64_tr_b16 a[14:15], v3 offset:7072
 ds_read_b64_tr_b16 a[84:85], v3 offset:6768
 ds_read_b64_tr_b16 a[86:87], v3 offset:7088
 ds_read_b64_tr_b16 v[16:17], v3 offset:6784
 ds_read_b64_tr_b16 v[18:19], v3 offset:7104
 s_cmp_eq_u32 s69, 1
 s_cbranch_scc0 L14
 s_waitcnt lgkmcnt(0)
 ds_write_b128 v75, v[16:19] offset:11264
L14:
 s_waitcnt lgkmcnt(0)
 s_mov_b32 exec_lo, -1
 s_mov_b32 exec_hi, 0x0fffffff
 s_add_u32 m0, s66, 6720
 s_mov_b32 s60, 3833856
 buffer_load_dwordx4 v0, s[12:15], s60 offen lds
 s_add_u32 m0, s66, 7680
 s_mov_b32 s60, 3944448
 buffer_load_dwordx4 v0, s[12:15], s60 offen lds
 s_add_u32 m0, s66, 8640
 s_mov_b32 s60, 4055040
 buffer_load_dwordx4 v0, s[12:15], s60 offen lds
 s_add_u32 m0, s66, 10560
 s_mov_b32 s60, 3833856
 buffer_load_dwordx4 v0, s[48:51], s60 offen lds
 s_add_u32 m0, s66, 11520
 s_mov_b32 s60, 3944448
 buffer_load_dwordx4 v0, s[48:51], s60 offen lds
 s_add_u32 m0, s66, 12480
 s_mov_b32 s60, 4055040
 buffer_load_dwordx4 v0, s[48:51], s60 offen lds
 s_mov_b64 exec, -1
 s_waitcnt vmcnt(6)
 ds_read_b64_tr_b16 v[128:129], v3 offset:0
 ds_read_b64_tr_b16 v[130:131], v3 offset:320
 ds_read_b64_tr_b16 v[200:201], v3 offset:16
 ds_read_b64_tr_b16 v[202:203], v3 offset:336
 ds_read_b64_tr_b16 a[16:17], v3 offset:32
 ds_read_b64_tr_b16 a[18:19], v3 offset:352
 ds_read_b64_tr_b16 a[88:89], v3 offset:48
 ds_read_b64_tr_b16 a[90:91], v3 offset:368
 ds_read_b64_tr_b16 v[16:17], v3 offset:64
 ds_read_b64_tr_b16 v[18:19], v3 offset:384
 s_cmp_eq_u32 s69, 1
 s_cbranch_scc0 L15
 s_waitcnt lgkmcnt(0)
 ds_write_b128 v75, v[16:19] offset:12288
L15:
 s_waitcnt lgkmcnt(0)
 s_mov_b32 exec_lo, -1
 s_mov_b32 exec_hi, 0x0fffffff
 s_add_u32 m0, s66, 0
 s_mov_b32 s60, 4128768
 buffer_load_dwordx4 v0, s[12:15], s60 offen lds
 s_add_u32 m0, s66, 960
 s_mov_b32 s60, 4239360
 buffer_load_dwordx4 v0, s[12:15], s60 offen lds
 s_add_u32 m0, s66, 1920
 s_mov_b32 s60, 4349952
 buffer_load_dwordx4 v0, s[12:15], s60 offen lds
 s_add_u32 m0, s66, 3840
 s_mov_b32 s60, 4128768
 buffer_load_dwordx4 v0, s[48:51], s60 offen lds
 s_add_u32 m0, s66, 4800
 s_mov_b32 s60, 4239360
 buffer_load_dwordx4 v0, s[48:51], s60 offen lds
 s_add_u32 m0, s66, 5760
 s_mov_b32 s60, 4349952
 buffer_load_dwordx4 v0, s[48:51], s60 offen lds
 s_mov_b64 exec, -1
 s_waitcnt vmcnt(6)
 ds_read_b64_tr_b16 v[132:133], v3 offset:6720
 ds_read_b64_tr_b16 v[134:135], v3 offset:7040
 ds_read_b64_tr_b16 v[204:205], v3 offset:6736
 ds_read_b64_tr_b16 v[206:207], v3 offset:7056
 ds_read_b64_tr_b16 a[20:21], v3 offset:6752
 ds_read_b64_tr_b16 a[22:23], v3 offset:7072
 ds_read_b64_tr_b16 a[92:93], v3 offset:6768
 ds_read_b64_tr_b16 a[94:95], v3 offset:7088
 ds_read_b64_tr_b16 v[16:17], v3 offset:6784
 ds_read_b64_tr_b16 v[18:19], v3 offset:7104
 s_cmp_eq_u32 s69, 1
 s_cbranch_scc0 L16
 s_waitcnt lgkmcnt(0)
 ds_write_b128 v75, v[16:19] offset:13312
L16:
 s_waitcnt lgkmcnt(0)
 s_mov_b32 exec_lo, -1
 s_mov_b32 exec_hi, 0x0fffffff
 s_add_u32 m0, s66, 6720
 s_mov_b32 s60, 4423680
 buffer_load_dwordx4 v0, s[12:15], s60 offen lds
 s_add_u32 m0, s66, 7680
 s_mov_b32 s60, 4534272
 buffer_load_dwordx4 v0, s[12:15], s60 offen lds
 s_add_u32 m0, s66, 8640
 s_mov_b32 s60, 4644864
 buffer_load_dwordx4 v0, s[12:15], s60 offen lds
 s_add_u32 m0, s66, 10560
 s_mov_b32 s60, 4423680
 buffer_load_dwordx4 v0, s[48:51], s60 offen lds
 s_add_u32 m0, s66, 11520
 s_mov_b32 s60, 4534272
 buffer_load_dwordx4 v0, s[48:51], s60 offen lds
 s_add_u32 m0, s66, 12480
 s_mov_b32 s60, 4644864
 buffer_load_dwordx4 v0, s[48:51], s60 offen lds
 s_mov_b64 exec, -1
 s_waitcnt vmcnt(6)
 ds_read_b64_tr_b16 v[136:137], v3 offset:0
 ds_read_b64_tr_b16 v[138:139], v3 offset:320
 ds_read_b64_tr_b16 v[208:209], v3 offset:16
 ds_read_b64_tr_b16 v[210:211], v3 offset:336
 ds_read_b64_tr_b16 a[24:25], v3 offset:32
 ds_read_b64_tr_b16 a[26:27], v3 offset:352
 ds_read_b64_tr_b16 a[96:97], v3 offset:48
 ds_read_b64_tr_b16 a[98:99], v3 offset:368
 ds_read_b64_tr_b16 v[16:17], v3 offset:64
 ds_read_b64_tr_b16 v[18:19], v3 offset:384
 s_cmp_eq_u32 s69, 1
 s_cbranch_scc0 L17
 s_waitcnt lgkmcnt(0)
 ds_write_b128 v75, v[16:19] offset:14336
L17:
 s_waitcnt lgkmcnt(0)
 s_mov_b32 exec_lo, -1
 s_mov_b32 exec_hi, 0x0fffffff
 s_add_u32 m0, s66, 0
 s_mov_b32 s60, 4718592
 buffer_load_dwordx4 v0, s[12:15], s60 offen lds
 s_add_u32 m0, s66, 960
 s_mov_b32 s60, 4829184
 buffer_load_dwordx4 v0, s[12:15], s60 offen lds
 s_add_u32 m0, s66, 1920
 s_mov_b32 s60, 4939776
 buffer_load_dwordx4 v0, s[12:15], s60 offen lds
 s_add_u32 m0, s66, 3840
 s_mov_b32 s60, 4718592
 buffer_load_dwordx4 v0, s[48:51], s60 offen lds
 s_add_u32 m0, s66, 4800
 s_mov_b32 s60, 4829184
 buffer_load_dwordx4 v0, s[48:51], s60 offen lds
 s_add_u32 m0, s66, 5760
 s_mov_b32 s60, 4939776
 buffer_load_dwordx4 v0, s[48:51], s60 offen lds
 s_mov_b64 exec, -1
 s_waitcnt vmcnt(6)
 ds_read_b64_tr_b16 v[140:141], v3 offset:6720
 ds_read_b64_tr_b16 v[142:143], v3 offset:7040
 ds_read_b64_tr_b16 v[212:213], v3 offset:6736
 ds_read_b64_tr_b16 v[214:215], v3 offset:7056
 ds_read_b64_tr_b16 a[28:29], v3 offset:6752
 ds_read_b64_tr_b16 a[30:31], v3 offset:7072
 ds_read_b64_tr_b16 a[100:101], v3 offset:6768
 ds_read_b64_tr_b16 a[102:103], v3 offset:7088
 ds_read_b64_tr_b16 v[16:17], v3 offset:6784
 ds_read_b64_tr_b16 v[18:19], v3 offset:7104
 s_cmp_eq_u32 s69, 1
 s_cbranch_scc0 L18
 s_waitcnt lgkmcnt(0)
 ds_write_b128 v75, v[16:19] offset:15360
L18:
 s_waitcnt lgkmcnt(0)
 s_mov_b32 exec_lo, -1
 s_mov_b32 exec_hi, 0x0fffffff
 s_add_u32 m0, s66, 6720
 s_mov_b32 s60, 5013504
 buffer_load_dwordx4 v0, s[12:15], s60 offen lds
 s_add_u32 m0, s66, 7680
 s_mov_b32 s60, 5124096
 buffer_load_dwordx4 v0, s[12:15], s60 offen lds
 s_add_u32 m0, s66, 8640
 s_mov_b32 s60, 5234688
 buffer_load_dwordx4 v0, s[12:15], s60 offen lds
 s_add_u32 m0, s66, 10560
 s_mov_b32 s60, 5013504
 buffer_load_dwordx4 v0, s[48:51], s60 offen lds
 s_add_u32 m0, s66, 11520
 s_mov_b32 s60, 5124096
 buffer_load_dwordx4 v0, s[48:51], s60 offen lds
 s_add_u32 m0, s66, 12480
 s_mov_b32 s60, 5234688
 buffer_load_dwordx4 v0, s[48:51], s60 offen lds
 s_mov_b64 exec, -1
 s_waitcnt vmcnt(6)
 ds_read_b64_tr_b16 v[144:145], v3 offset:0
 ds_read_b64_tr_b16 v[146:147], v3 offset:320
 ds_read_b64_tr_b16 v[216:217], v3 offset:16
 ds_read_b64_tr_b16 v[218:219], v3 offset:336
 ds_read_b64_tr_b16 a[32:33], v3 offset:32
 ds_read_b64_tr_b16 a[34:35], v3 offset:352
 ds_read_b64_tr_b16 a[104:105], v3 offset:48
 ds_read_b64_tr_b16 a[106:107], v3 offset:368
 ds_read_b64_tr_b16 v[16:17], v3 offset:64
 ds_read_b64_tr_b16 v[18:19], v3 offset:384
 s_cmp_eq_u32 s69, 1
 s_cbranch_scc0 L19
 s_waitcnt lgkmcnt(0)
 ds_write_b128 v75, v[16:19] offset:16384
L19:
 s_waitcnt lgkmcnt(0)
 s_mov_b32 exec_lo, -1
 s_mov_b32 exec_hi, 0x0fffffff
 s_add_u32 m0, s66, 0
 s_mov_b32 s60, 0
 buffer_load_dwordx4 v2, s[52:55], s60 offen lds
 s_add_u32 m0, s66, 960
 s_mov_b32 s60, 3456
 buffer_load_dwordx4 v2, s[52:55], s60 offen lds
 s_add_u32 m0, s66, 1920
 s_mov_b32 s60, 6912
 buffer_load_dwordx4 v2, s[52:55], s60 offen lds
 s_add_u32 m0, s66, 2880
 s_mov_b32 s60, 10368
 buffer_load_dwordx4 v2, s[52:55], s60 offen lds
 s_add_u32 m0, s66, 3840
 s_mov_b32 s60, 13824
 buffer_load_dwordx4 v2, s[52:55], s60 offen lds
 s_add_u32 m0, s66, 4800
 s_mov_b32 s60, 17280
 buffer_load_dwordx4 v2, s[52:55], s60 offen lds
 s_mov_b64 exec, -1
 s_waitcnt vmcnt(6)
 ds_read_b64_tr_b16 v[148:149], v3 offset:6720
 ds_read_b64_tr_b16 v[150:151], v3 offset:7040
 ds_read_b64_tr_b16 v[220:221], v3 offset:6736
 ds_read_b64_tr_b16 v[222:223], v3 offset:7056
 ds_read_b64_tr_b16 a[36:37], v3 offset:6752
 ds_read_b64_tr_b16 a[38:39], v3 offset:7072
 ds_read_b64_tr_b16 a[108:109], v3 offset:6768
 ds_read_b64_tr_b16 a[110:111], v3 offset:7088
 ds_read_b64_tr_b16 v[16:17], v3 offset:6784
 ds_read_b64_tr_b16 v[18:19], v3 offset:7104
 s_cmp_eq_u32 s69, 1
 s_cbranch_scc0 L20
 s_waitcnt lgkmcnt(0)
 ds_write_b128 v75, v[16:19] offset:17408
L20:
 s_waitcnt lgkmcnt(0)
 s_mov_b32 exec_lo, -1
 s_mov_b32 exec_hi, 0x0fffffff
 s_add_u32 m0, s66, 5760
 s_mov_b32 s60, 18432
 buffer_load_dwordx4 v2, s[52:55], s60 offen lds
 s_add_u32 m0, s66, 6720
 s_mov_b32 s60, 21888
 buffer_load_dwordx4 v2, s[52:55], s60 offen lds
 s_add_u32 m0, s66, 7680
 s_mov_b32 s60, 25344
 buffer_load_dwordx4 v2, s[52:55], s60 offen lds
 s_add_u32 m0, s66, 8640
 s_mov_b32 s60, 28800
 buffer_load_dwordx4 v2, s[52:55], s60 offen lds
 s_add_u32 m0, s66, 9600
 s_mov_b32 s60, 32256
 buffer_load_dwordx4 v2, s[52:55], s60 offen lds
 s_add_u32 m0, s66, 10560
 s_mov_b32 s60, 35712
 buffer_load_dwordx4 v2, s[52:55], s60 offen lds
 s_mov_b64 exec, -1
 s_waitcnt vmcnt(6)
 ds_read_b64_tr_b16 a[112:113], v4 offset:0
 ds_read_b64_tr_b16 a[114:115], v4 offset:1280
 ds_read_b64_tr_b16 a[148:149], v4 offset:64
 ds_read_b64_tr_b16 a[150:151], v4 offset:1344
 ds_read_b64_tr_b16 a[184:185], v4 offset:128
 ds_read_b64_tr_b16 a[186:187], v4 offset:1408
 ds_read_b64_tr_b16 a[220:221], v4 offset:192
 ds_read_b64_tr_b16 a[222:223], v4 offset:1472
 ds_read_b64_tr_b16 v[16:17], v4 offset:256
 ds_read_b64_tr_b16 v[18:19], v4 offset:1536
 s_cmp_eq_u32 s69, 0
 s_cbranch_scc0 L21
 s_waitcnt lgkmcnt(0)
 ds_write_b128 v75, v[16:19] offset:0
L21:
 s_waitcnt lgkmcnt(0)
 s_mov_b32 exec_lo, -1
 s_mov_b32 exec_hi, 0x0fffffff
 s_add_u32 m0, s66, 0
 s_mov_b32 s60, 36864
 buffer_load_dwordx4 v2, s[52:55], s60 offen lds
 s_add_u32 m0, s66, 960
 s_mov_b32 s60, 40320
 buffer_load_dwordx4 v2, s[52:55], s60 offen lds
 s_add_u32 m0, s66, 1920
 s_mov_b32 s60, 43776
 buffer_load_dwordx4 v2, s[52:55], s60 offen lds
 s_add_u32 m0, s66, 2880
 s_mov_b32 s60, 47232
 buffer_load_dwordx4 v2, s[52:55], s60 offen lds
 s_add_u32 m0, s66, 3840
 s_mov_b32 s60, 50688
 buffer_load_dwordx4 v2, s[52:55], s60 offen lds
 s_add_u32 m0, s66, 4800
 s_mov_b32 s60, 54144
 buffer_load_dwordx4 v2, s[52:55], s60 offen lds
 s_mov_b64 exec, -1
 s_waitcnt vmcnt(6)
 ds_read_b64_tr_b16 a[116:117], v4 offset:5760
 ds_read_b64_tr_b16 a[118:119], v4 offset:7040
 ds_read_b64_tr_b16 a[152:153], v4 offset:5824
 ds_read_b64_tr_b16 a[154:155], v4 offset:7104
 ds_read_b64_tr_b16 a[188:189], v4 offset:5888
 ds_read_b64_tr_b16 a[190:191], v4 offset:7168
 ds_read_b64_tr_b16 a[224:225], v4 offset:5952
 ds_read_b64_tr_b16 a[226:227], v4 offset:7232
 ds_read_b64_tr_b16 v[16:17], v4 offset:6016
 ds_read_b64_tr_b16 v[18:19], v4 offset:7296
 s_cmp_eq_u32 s69, 0
 s_cbranch_scc0 L22
 s_waitcnt lgkmcnt(0)
 ds_write_b128 v75, v[16:19] offset:1024
L22:
 s_waitcnt lgkmcnt(0)
 s_mov_b32 exec_lo, -1
 s_mov_b32 exec_hi, 0x0fffffff
 s_add_u32 m0, s66, 5760
 s_mov_b32 s60, 55296
 buffer_load_dwordx4 v2, s[52:55], s60 offen lds
 s_add_u32 m0, s66, 6720
 s_mov_b32 s60, 58752
 buffer_load_dwordx4 v2, s[52:55], s60 offen lds
 s_add_u32 m0, s66, 7680
 s_mov_b32 s60, 62208
 buffer_load_dwordx4 v2, s[52:55], s60 offen lds
 s_add_u32 m0, s66, 8640
 s_mov_b32 s60, 65664
 buffer_load_dwordx4 v2, s[52:55], s60 offen lds
 s_add_u32 m0, s66, 9600
 s_mov_b32 s60, 69120
 buffer_load_dwordx4 v2, s[52:55], s60 offen lds
 s_add_u32 m0, s66, 10560
 s_mov_b32 s60, 72576
 buffer_load_dwordx4 v2, s[52:55], s60 offen lds
 s_mov_b64 exec, -1
 s_waitcnt vmcnt(6)
 ds_read_b64_tr_b16 a[120:121], v4 offset:0
 ds_read_b64_tr_b16 a[122:123], v4 offset:1280
 ds_read_b64_tr_b16 a[156:157], v4 offset:64
 ds_read_b64_tr_b16 a[158:159], v4 offset:1344
 ds_read_b64_tr_b16 a[192:193], v4 offset:128
 ds_read_b64_tr_b16 a[194:195], v4 offset:1408
 ds_read_b64_tr_b16 a[228:229], v4 offset:192
 ds_read_b64_tr_b16 a[230:231], v4 offset:1472
 ds_read_b64_tr_b16 v[16:17], v4 offset:256
 ds_read_b64_tr_b16 v[18:19], v4 offset:1536
 s_cmp_eq_u32 s69, 0
 s_cbranch_scc0 L23
 s_waitcnt lgkmcnt(0)
 ds_write_b128 v75, v[16:19] offset:2048
L23:
 s_waitcnt lgkmcnt(0)
 s_mov_b32 exec_lo, -1
 s_mov_b32 exec_hi, 0x0fffffff
 s_add_u32 m0, s66, 0
 s_mov_b32 s60, 73728
 buffer_load_dwordx4 v2, s[52:55], s60 offen lds
 s_add_u32 m0, s66, 960
 s_mov_b32 s60, 77184
 buffer_load_dwordx4 v2, s[52:55], s60 offen lds
 s_add_u32 m0, s66, 1920
 s_mov_b32 s60, 80640
 buffer_load_dwordx4 v2, s[52:55], s60 offen lds
 s_add_u32 m0, s66, 2880
 s_mov_b32 s60, 84096
 buffer_load_dwordx4 v2, s[52:55], s60 offen lds
 s_add_u32 m0, s66, 3840
 s_mov_b32 s60, 87552
 buffer_load_dwordx4 v2, s[52:55], s60 offen lds
 s_add_u32 m0, s66, 4800
 s_mov_b32 s60, 91008
 buffer_load_dwordx4 v2, s[52:55], s60 offen lds
 s_mov_b64 exec, -1
 s_waitcnt vmcnt(6)
 ds_read_b64_tr_b16 a[124:125], v4 offset:5760
 ds_read_b64_tr_b16 a[126:127], v4 offset:7040
 ds_read_b64_tr_b16 a[160:161], v4 offset:5824
 ds_read_b64_tr_b16 a[162:163], v4 offset:7104
 ds_read_b64_tr_b16 a[196:197], v4 offset:5888
 ds_read_b64_tr_b16 a[198:199], v4 offset:7168
 ds_read_b64_tr_b16 a[232:233], v4 offset:5952
 ds_read_b64_tr_b16 a[234:235], v4 offset:7232
 ds_read_b64_tr_b16 v[16:17], v4 offset:6016
 ds_read_b64_tr_b16 v[18:19], v4 offset:7296
 s_cmp_eq_u32 s69, 0
 s_cbranch_scc0 L24
 s_waitcnt lgkmcnt(0)
 ds_write_b128 v75, v[16:19] offset:3072
L24:
 s_waitcnt lgkmcnt(0)
 s_mov_b32 exec_lo, -1
 s_mov_b32 exec_hi, 0x0fffffff
 s_add_u32 m0, s66, 5760
 s_mov_b32 s60, 92160
 buffer_load_dwordx4 v2, s[52:55], s60 offen lds
 s_add_u32 m0, s66, 6720
 s_mov_b32 s60, 95616
 buffer_load_dwordx4 v2, s[52:55], s60 offen lds
 s_add_u32 m0, s66, 7680
 s_mov_b32 s60, 99072
 buffer_load_dwordx4 v2, s[52:55], s60 offen lds
 s_add_u32 m0, s66, 8640
 s_mov_b32 s60, 102528
 buffer_load_dwordx4 v2, s[52:55], s60 offen lds
 s_add_u32 m0, s66, 9600
 s_mov_b32 s60, 105984
 buffer_load_dwordx4 v2, s[52:55], s60 offen lds
 s_add_u32 m0, s66, 10560
 s_mov_b32 s60, 109440
 buffer_load_dwordx4 v2, s[52:55], s60 offen lds
 s_mov_b64 exec, -1
 s_waitcnt vmcnt(6)
 ds_read_b64_tr_b16 a[128:129], v4 offset:0
 ds_read_b64_tr_b16 a[130:131], v4 offset:1280
 ds_read_b64_tr_b16 a[164:165], v4 offset:64
 ds_read_b64_tr_b16 a[166:167], v4 offset:1344
 ds_read_b64_tr_b16 a[200:201], v4 offset:128
 ds_read_b64_tr_b16 a[202:203], v4 offset:1408
 ds_read_b64_tr_b16 a[236:237], v4 offset:192
 ds_read_b64_tr_b16 a[238:239], v4 offset:1472
 ds_read_b64_tr_b16 v[16:17], v4 offset:256
 ds_read_b64_tr_b16 v[18:19], v4 offset:1536
 s_cmp_eq_u32 s69, 0
 s_cbranch_scc0 L25
 s_waitcnt lgkmcnt(0)
 ds_write_b128 v75, v[16:19] offset:4096
L25:
 s_waitcnt lgkmcnt(0)
 s_mov_b32 exec_lo, -1
 s_mov_b32 exec_hi, 0x0fffffff
 s_add_u32 m0, s66, 0
 s_mov_b32 s60, 110592
 buffer_load_dwordx4 v2, s[52:55], s60 offen lds
 s_add_u32 m0, s66, 960
 s_mov_b32 s60, 114048
 buffer_load_dwordx4 v2, s[52:55], s60 offen lds
 s_add_u32 m0, s66, 1920
 s_mov_b32 s60, 117504
 buffer_load_dwordx4 v2, s[52:55], s60 offen lds
 s_add_u32 m0, s66, 2880
 s_mov_b32 s60, 120960
 buffer_load_dwordx4 v2, s[52:55], s60 offen lds
 s_add_u32 m0, s66, 3840
 s_mov_b32 s60, 124416
 buffer_load_dwordx4 v2, s[52:55], s60 offen lds
 s_add_u32 m0, s66, 4800
 s_mov_b32 s60, 127872
 buffer_load_dwordx4 v2, s[52:55], s60 offen lds
 s_mov_b64 exec, -1
 s_waitcnt vmcnt(6)
 ds_read_b64_tr_b16 a[132:133], v4 offset:5760
 ds_read_b64_tr_b16 a[134:135], v4 offset:7040
 ds_read_b64_tr_b16 a[168:169], v4 offset:5824
 ds_read_b64_tr_b16 a[170:171], v4 offset:7104
 ds_read_b64_tr_b16 a[204:205], v4 offset:5888
 ds_read_b64_tr_b16 a[206:207], v4 offset:7168
 ds_read_b64_tr_b16 a[240:241], v4 offset:5952
 ds_read_b64_tr_b16 a[242:243], v4 offset:7232
 ds_read_b64_tr_b16 v[16:17], v4 offset:6016
 ds_read_b64_tr_b16 v[18:19], v4 offset:7296
 s_cmp_eq_u32 s69, 0
 s_cbranch_scc0 L26
 s_waitcnt lgkmcnt(0)
 ds_write_b128 v75, v[16:19] offset:5120
L26:
 s_waitcnt lgkmcnt(0)
 s_mov_b32 exec_lo, -1
 s_mov_b32 exec_hi, 0x0fffffff
 s_add_u32 m0, s66, 5760
 s_mov_b32 s60, 129024
 buffer_load_dwordx4 v2, s[52:55], s60 offen lds
 s_add_u32 m0, s66, 6720
 s_mov_b32 s60, 132480
 buffer_load_dwordx4 v2, s[52:55], s60 offen lds
 s_add_u32 m0, s66, 7680
 s_mov_b32 s60, 135936
 buffer_load_dwordx4 v2, s[52:55], s60 offen lds
 s_add_u32 m0, s66, 8640
 s_mov_b32 s60, 139392
 buffer_load_dwordx4 v2, s[52:55], s60 offen lds
 s_add_u32 m0, s66, 9600
 s_mov_b32 s60, 142848
 buffer_load_dwordx4 v2, s[52:55], s60 offen lds
 s_add_u32 m0, s66, 10560
 s_mov_b32 s60, 146304
 buffer_load_dwordx4 v2, s[52:55], s60 offen lds
 s_mov_b64 exec, -1
 s_waitcnt vmcnt(6)
 ds_read_b64_tr_b16 a[136:137], v4 offset:0
 ds_read_b64_tr_b16 a[138:139], v4 offset:1280
 ds_read_b64_tr_b16 a[172:173], v4 offset:64
 ds_read_b64_tr_b16 a[174:175], v4 offset:1344
 ds_read_b64_tr_b16 a[208:209], v4 offset:128
 ds_read_b64_tr_b16 a[210:211], v4 offset:1408
 ds_read_b64_tr_b16 a[244:245], v4 offset:192
 ds_read_b64_tr_b16 a[246:247], v4 offset:1472
 ds_read_b64_tr_b16 v[16:17], v4 offset:256
 ds_read_b64_tr_b16 v[18:19], v4 offset:1536
 s_cmp_eq_u32 s69, 0
 s_cbranch_scc0 L27
 s_waitcnt lgkmcnt(0)
 ds_write_b128 v75, v[16:19] offset:6144
L27:
 s_waitcnt lgkmcnt(0)
 s_mov_b32 exec_lo, -1
 s_mov_b32 exec_hi, 0x0fffffff
 s_add_u32 m0, s66, 0
 s_mov_b32 s60, 147456
 buffer_load_dwordx4 v2, s[52:55], s60 offen lds
 s_add_u32 m0, s66, 960
 s_mov_b32 s60, 150912
 buffer_load_dwordx4 v2, s[52:55], s60 offen lds
 s_add_u32 m0, s66, 1920
 s_mov_b32 s60, 154368
 buffer_load_dwordx4 v2, s[52:55], s60 offen lds
 s_add_u32 m0, s66, 2880
 s_mov_b32 s60, 157824
 buffer_load_dwordx4 v2, s[52:55], s60 offen lds
 s_add_u32 m0, s66, 3840
 s_mov_b32 s60, 161280
 buffer_load_dwordx4 v2, s[52:55], s60 offen lds
 s_add_u32 m0, s66, 4800
 s_mov_b32 s60, 164736
 buffer_load_dwordx4 v2, s[52:55], s60 offen lds
 s_mov_b64 exec, -1
 s_waitcnt vmcnt(6)
 ds_read_b64_tr_b16 a[140:141], v4 offset:5760
 ds_read_b64_tr_b16 a[142:143], v4 offset:7040
 ds_read_b64_tr_b16 a[176:177], v4 offset:5824
 ds_read_b64_tr_b16 a[178:179], v4 offset:7104
 ds_read_b64_tr_b16 a[212:213], v4 offset:5888
 ds_read_b64_tr_b16 a[214:215], v4 offset:7168
 ds_read_b64_tr_b16 a[248:249], v4 offset:5952
 ds_read_b64_tr_b16 a[250:251], v4 offset:7232
 ds_read_b64_tr_b16 v[16:17], v4 offset:6016
 ds_read_b64_tr_b16 v[18:19], v4 offset:7296
 s_cmp_eq_u32 s69, 0
 s_cbranch_scc0 L28
 s_waitcnt lgkmcnt(0)
 ds_write_b128 v75, v[16:19] offset:7168
L28:
 s_waitcnt lgkmcnt(0)
 s_waitcnt vmcnt(0)
 ds_read_b64_tr_b16 a[144:145], v4 offset:0
 ds_read_b64_tr_b16 a[146:147], v4 offset:1280
 ds_read_b64_tr_b16 a[180:181], v4 offset:64
 ds_read_b64_tr_b16 a[182:183], v4 offset:1344
 ds_read_b64_tr_b16 a[216:217], v4 offset:128
 ds_read_b64_tr_b16 a[218:219], v4 offset:1408
 ds_read_b64_tr_b16 a[252:253], v4 offset:192
 ds_read_b64_tr_b16 a[254:255], v4 offset:1472
 ds_read_b64_tr_b16 v[16:17], v4 offset:256
 ds_read_b64_tr_b16 v[18:19], v4 offset:1536
 s_cmp_eq_u32 s69, 0
 s_cbranch_scc0 L29
 s_waitcnt lgkmcnt(0)
 ds_write_b128 v75, v[16:19] offset:8192
L29:
 s_waitcnt lgkmcnt(0)
 s_barrier
 v_min_u32 v6, 8, v68
 v_lshlrev_b32 v6, 2, v6
L30:
 buffer_load_dword v7, v6, s[8:11], 0 offen offset:64 sc1
 s_waitcnt vmcnt(0)
 v_cmp_eq_u32 vcc, 1, v7
 s_nop 3
 s_and_b32 s60, vcc_lo, 0x1ff
 s_cmp_ge_u32 s60, 0x100
 s_cbranch_scc1 L_FALLBACK
 s_cmp_eq_u32 s60, 0xff
 s_cbranch_scc0 L30
 v_and_b32 v6, 31, v68
 v_mul_u32_u24 v6, 1168, v6
 v_lshrrev_b32 v70, 5, v68
 v_lshlrev_b32 v70, 4, v70
 v_add_u32 v70, v70, v6
 v_add_u32 v70, 112640, v70
 v_lshrrev_b32 v6, 4, v68
 s_lshl_b32 s60, s44, 3
 v_add_u32 v6, s60, v6
 v_mul_u32_u24 v6, 1152, v6
 v_and_b32 v71, 15, v68
 v_lshlrev_b32 v71, 4, v71
 v_add_u32 v71, v71, v6
 s_mul_i32 s60, s46, 36864
 v_add_u32 v71, s60, v71
 v_lshrrev_b32 v6, 4, v68
 v_lshlrev_b32 v6, 7, v6
 v_bfe_u32 v72, v68, 2, 1
 v_lshlrev_b32 v72, 5, v72
 v_add_u32 v72, v72, v6
 v_and_b32 v6, 3, v68
 v_lshlrev_b32 v6, 2, v6
 v_add_u32 v72, v72, v6
 s_mul_i32 s60, s44, 2304
 v_add_u32 v72, s60, v72
 v_lshlrev_b32 v73, 5, v68
 v_and_b32 v6, 15, v68
 v_mov_b32 v9, 0x3f80
 v_subrev_u32 v7, 0, v6
 v_lshlrev_b32 v8, 4, v7
 v_cmp_gt_u32 vcc, 2, v7
 v_lshlrev_b32 v8, v8, v9
 s_nop 0
 v_cndmask_b32 v76, 0, v8, vcc
 v_subrev_u32 v7, 2, v6
 v_lshlrev_b32 v8, 4, v7
 v_cmp_gt_u32 vcc, 2, v7
 v_lshlrev_b32 v8, v8, v9
 s_nop 0
 v_cndmask_b32 v77, 0, v8, vcc
 v_subrev_u32 v7, 4, v6
 v_lshlrev_b32 v8, 4, v7
 v_cmp_gt_u32 vcc, 2, v7
 v_lshlrev_b32 v8, v8, v9
 s_nop 0
 v_cndmask_b32 v78, 0, v8, vcc
 v_subrev_u32 v7, 6, v6
 v_lshlrev_b32 v8, 4, v7
 v_cmp_gt_u32 vcc, 2, v7
 v_lshlrev_b32 v8, v8, v9
 s_nop 0
 v_cndmask_b32 v79, 0, v8, vcc
 v_and_b32 v6, 31, v68
 v_lshlrev_b32 v6, 4, v6
 v_lshrrev_b32 v7, 5, v68
 v_lshlrev_b32 v7, 3, v7
 v_add_u32 v6, v6, v7
 s_lshl_b32 s60, s67, 9
 s_add_u32 s60, s60, 36864
 v_add_u32 v74, s60, v6
 s_mov_b32 s75, 0xffff0000
 s_mov_b32 s76, 0xbfb8aa3b
 s_mov_b32 s64, s47
 s_mov_b32 s65, 0
FF_LOOP31:
 s_lshl_b32 s60, s64, 7
 s_add_u32 s60, s60, 73416704
 s_mov_b32 s61, 1
 v_and_b32 v0, 31, v68
 v_lshlrev_b32 v0, 2, v0
L32:
 buffer_load_dword v1, v0, s[4:7], s60 offen sc1
 s_waitcnt vmcnt(0)
 v_cmp_gt_u32 vcc, s61, v1
 s_cbranch_vccnz L32
 s_mul_i32 s60, s64, 36864
 s_mul_i32 s61, s44, 9216
 s_add_u32 s60, s60, s61
 s_add_u32 s60, s60, 79691776
 s_add_u32 m0, s61, 0
 s_add_u32 s62, s60, 0
 buffer_load_dwordx4 v69, s[4:7], s62 offen offset:0 sc1 lds
 buffer_load_dwordx4 v69, s[4:7], s62 offen offset:1024 sc1 lds
 buffer_load_dwordx4 v69, s[4:7], s62 offen offset:2048 sc1 lds
 s_add_u32 m0, s61, 3072
 s_add_u32 s62, s60, 3072
 buffer_load_dwordx4 v69, s[4:7], s62 offen offset:0 sc1 lds
 buffer_load_dwordx4 v69, s[4:7], s62 offen offset:1024 sc1 lds
 buffer_load_dwordx4 v69, s[4:7], s62 offen offset:2048 sc1 lds
 s_add_u32 m0, s61, 6144
 s_add_u32 s62, s60, 6144
 buffer_load_dwordx4 v69, s[4:7], s62 offen offset:0 sc1 lds
 buffer_load_dwordx4 v69, s[4:7], s62 offen offset:1024 sc1 lds
 buffer_load_dwordx4 v69, s[4:7], s62 offen offset:2048 sc1 lds
 s_cmp_eq_u32 s44, 0
 s_cbranch_scc0 L33
 s_lshl_b32 s60, s64, 5
 s_add_u32 s60, s60, s46
 s_mul_i32 s60, s60, 1152
 s_add_u32 s60, s60, 75497472
 s_mov_b32 m0, 151552
 s_nop 0
 buffer_load_dwordx4 v69, s[4:7], s60 offen sc1 lds
 s_mov_b64 exec, 0xff
 buffer_load_dwordx4 v69, s[4:7], s60 offen offset:1024 sc1 lds
 s_mov_b64 exec, -1
L33:
 v_and_b32 v0, 31, v68
 v_lshlrev_b32 v0, 2, v0
 s_add_u32 s63, s72, 128
 buffer_load_dword v1, v0, s[4:7], s63 offen sc1
 s_waitcnt vmcnt(0)
 v_cmp_gt_u32 vcc, s65, v1
 s_cbranch_vccz L34e
L34:
 buffer_load_dword v1, v0, s[4:7], s63 offen sc1
 s_waitcnt vmcnt(0)
 v_cmp_gt_u32 vcc, s65, v1
 s_cbranch_vccnz L34
L34e:
 s_barrier
 ds_read_b128 v[40:43], v69 offset:0
 ds_read_b128 v[44:47], v69 offset:1024
 ds_read_b128 v[48:51], v69 offset:2048
 ds_read_b128 v[52:55], v69 offset:3072
 s_waitcnt lgkmcnt(2)
 v_mfma_f32_16x16x32_bf16 v[0:3], v[80:83], v[40:43], 0
 v_mfma_f32_16x16x32_bf16 v[4:7], v[80:83], v[44:47], 0
 v_mfma_f32_16x16x32_bf16 v[8:11], v[152:155], v[40:43], 0
 v_mfma_f32_16x16x32_bf16 v[12:15], v[152:155], v[44:47], 0
 v_mfma_f32_16x16x32_bf16 v[16:19], v[224:227], v[40:43], 0
 v_mfma_f32_16x16x32_bf16 v[20:23], v[224:227], v[44:47], 0
 ds_read_b128 v[40:43], v69 offset:4096
 ds_read_b128 v[44:47], v69 offset:5120
 s_waitcnt lgkmcnt(2)
 v_mfma_f32_16x16x32_bf16 v[0:3], v[84:87], v[48:51], v[0:3]
 v_mfma_f32_16x16x32_bf16 v[4:7], v[84:87], v[52:55], v[4:7]
 v_mfma_f32_16x16x32_bf16 v[8:11], v[156:159], v[48:51], v[8:11]
 v_mfma_f32_16x16x32_bf16 v[12:15], v[156:159], v[52:55], v[12:15]
 v_mfma_f32_16x16x32_bf16 v[16:19], v[228:231], v[48:51], v[16:19]
 v_mfma_f32_16x16x32_bf16 v[20:23], v[228:231], v[52:55], v[20:23]
 ds_read_b128 v[48:51], v69 offset:6144
 ds_read_b128 v[52:55], v69 offset:7168
 s_waitcnt lgkmcnt(2)
 v_mfma_f32_16x16x32_bf16 v[0:3], v[88:91], v[40:43], v[0:3]
 v_mfma_f32_16x16x32_bf16 v[4:7], v[88:91], v[44:47], v[4:7]
 v_mfma_f32_16x16x32_bf16 v[8:11], v[160:163], v[40:43], v[8:11]
 v_mfma_f32_16x16x32_bf16 v[12:15], v[160:163], v[44:47], v[12:15]
 v_mfma_f32_16x16x32_bf16 v[16:19], v[232:235], v[40:43], v[16:19]
 v_mfma_f32_16x16x32_bf16 v[20:23], v[232:235], v[44:47], v[20:23]
 ds_read_b128 v[40:43], v69 offset:8192
 ds_read_b128 v[44:47], v69 offset:9216
 s_waitcnt lgkmcnt(2)
 v_mfma_f32_16x16x32_bf16 v[0:3], v[92:95], v[48:51], v[0:3]
 v_mfma_f32_16x16x32_bf16 v[4:7], v[92:95], v[52:55], v[4:7]
 v_mfma_f32_16x16x32_bf16 v[8:11], v[164:167], v[48:51], v[8:11]
 v_mfma_f32_16x16x32_bf16 v[12:15], v[164:167], v[52:55], v[12:15]
 v_mfma_f32_16x16x32_bf16 v[16:19], v[236:239], v[48:51], v[16:19]
 v_mfma_f32_16x16x32_bf16 v[20:23], v[236:239], v[52:55], v[20:23]
 ds_read_b128 v[48:51], v69 offset:10240
 ds_read_b128 v[52:55], v69 offset:11264
 s_waitcnt lgkmcnt(2)
 v_mfma_f32_16x16x32_bf16 v[0:3], v[96:99], v[40:43], v[0:3]
 v_mfma_f32_16x16x32_bf16 v[4:7], v[96:99], v[44:47], v[4:7]
 v_mfma_f32_16x16x32_bf16 v[8:11], v[168:171], v[40:43], v[8:11]
 v_mfma_f32_16x16x32_bf16 v[12:15], v[168:171], v[44:47], v[12:15]
 v_mfma_f32_16x16x32_bf16 v[16:19], v[240:243], v[40:43], v[16:19]
 v_mfma_f32_16x16x32_bf16 v[20:23], v[240:243], v[44:47], v[20:23]
 ds_read_b128 v[40:43], v69 offset:12288
 ds_read_b128 v[44:47], v69 offset:13312
 s_waitcnt lgkmcnt(2)
 v_mfma_f32_16x16x32_bf16 v[0:3], v[100:103], v[48:51], v[0:3]
 v_mfma_f32_16x16x32_bf16 v[4:7], v[100:103], v[52:55], v[4:7]
 v_mfma_f32_16x16x32_bf16 v[8:11], v[172:175], v[48:51], v[8:11]
 v_mfma_f32_16x16x32_bf16 v[12:15], v[172:175], v[52:55], v[12:15]
 v_mfma_f32_16x16x32_bf16 v[16:19], v[244:247], v[48:51], v[16:19]
 v_mfma_f32_16x16x32_bf16 v[20:23], v[244:247], v[52:55], v[20:23]
 ds_read_b128 v[48:51], v69 offset:14336
 ds_read_b128 v[52:55], v69 offset:15360
 s_waitcnt lgkmcnt(2)
 v_mfma_f32_16x16x32_bf16 v[0:3], v[104:107], v[40:43], v[0:3]
 v_mfma_f32_16x16x32_bf16 v[4:7], v[104:107], v[44:47], v[4:7]
 v_mfma_f32_16x16x32_bf16 v[8:11], v[176:179], v[40:43], v[8:11]
 v_mfma_f32_16x16x32_bf16 v[12:15], v[176:179], v[44:47], v[12:15]
 v_mfma_f32_16x16x32_bf16 v[16:19], v[248:251], v[40:43], v[16:19]
 v_mfma_f32_16x16x32_bf16 v[20:23], v[248:251], v[44:47], v[20:23]
 ds_read_b128 v[40:43], v69 offset:16384
 ds_read_b128 v[44:47], v69 offset:17408
 s_waitcnt lgkmcnt(2)
 v_mfma_f32_16x16x32_bf16 v[0:3], v[108:111], v[48:51], v[0:3]
 v_mfma_f32_16x16x32_bf16 v[4:7], v[108:111], v[52:55], v[4:7]
 v_mfma_f32_16x16x32_bf16 v[8:11], v[180:183], v[48:51], v[8:11]
 v_mfma_f32_16x16x32_bf16 v[12:15], v[180:183], v[52:55], v[12:15]
 v_mfma_f32_16x16x32_bf16 v[16:19], v[252:255], v[48:51], v[16:19]
 v_mfma_f32_16x16x32_bf16 v[20:23], v[252:255], v[52:55], v[20:23]
 ds_read_b128 v[48:51], v69 offset:18432
 ds_read_b128 v[52:55], v69 offset:19456
 s_waitcnt lgkmcnt(2)
 v_mfma_f32_16x16x32_bf16 v[0:3], v[112:115], v[40:43], v[0:3]
 v_mfma_f32_16x16x32_bf16 v[4:7], v[112:115], v[44:47], v[4:7]
 v_mfma_f32_16x16x32_bf16 v[8:11], v[184:187], v[40:43], v[8:11]
 v_mfma_f32_16x16x32_bf16 v[12:15], v[184:187], v[44:47], v[12:15]
 v_mfma_f32_16x16x32_bf16 v[16:19], a[0:3], v[40:43], v[16:19]
 v_mfma_f32_16x16x32_bf16 v[20:23], a[0:3], v[44:47], v[20:23]
 ds_read_b128 v[40:43], v69 offset:20480
 ds_read_b128 v[44:47], v69 offset:21504
 s_waitcnt lgkmcnt(2)
 v_mfma_f32_16x16x32_bf16 v[0:3], v[116:119], v[48:51], v[0:3]
 v_mfma_f32_16x16x32_bf16 v[4:7], v[116:119], v[52:55], v[4:7]
 v_mfma_f32_16x16x32_bf16 v[8:11], v[188:191], v[48:51], v[8:11]
 v_mfma_f32_16x16x32_bf16 v[12:15], v[188:191], v[52:55], v[12:15]
 v_mfma_f32_16x16x32_bf16 v[16:19], a[4:7], v[48:51], v[16:19]
 v_mfma_f32_16x16x32_bf16 v[20:23], a[4:7], v[52:55], v[20:23]
 ds_read_b128 v[48:51], v69 offset:22528
 ds_read_b128 v[52:55], v69 offset:23552
 s_waitcnt lgkmcnt(2)
 v_mfma_f32_16x16x32_bf16 v[0:3], v[120:123], v[40:43], v[0:3]
 v_mfma_f32_16x16x32_bf16 v[4:7], v[120:123], v[44:47], v[4:7]
 v_mfma_f32_16x16x32_bf16 v[8:11], v[192:195], v[40:43], v[8:11]
 v_mfma_f32_16x16x32_bf16 v[12:15], v[192:195], v[44:47], v[12:15]
 v_mfma_f32_16x16x32_bf16 v[16:19], a[8:11], v[40:43], v[16:19]
 v_mfma_f32_16x16x32_bf16 v[20:23], a[8:11], v[44:47], v[20:23]
 ds_read_b128 v[40:43], v69 offset:24576
 ds_read_b128 v[44:47], v69 offset:25600
 s_waitcnt lgkmcnt(2)
 v_mfma_f32_16x16x32_bf16 v[0:3], v[124:127], v[48:51], v[0:3]
 v_mfma_f32_16x16x32_bf16 v[4:7], v[124:127], v[52:55], v[4:7]
 v_mfma_f32_16x16x32_bf16 v[8:11], v[196:199], v[48:51], v[8:11]
 v_mfma_f32_16x16x32_bf16 v[12:15], v[196:199], v[52:55], v[12:15]
 v_mfma_f32_16x16x32_bf16 v[16:19], a[12:15], v[48:51], v[16:19]
 v_mfma_f32_16x16x32_bf16 v[20:23], a[12:15], v[52:55], v[20:23]
 ds_read_b128 v[48:51], v69 offset:26624
 ds_read_b128 v[52:55], v69 offset:27648
 s_waitcnt lgkmcnt(2)
 v_mfma_f32_16x16x32_bf16 v[0:3], v[128:131], v[40:43], v[0:3]
 v_mfma_f32_16x16x32_bf16 v[4:7], v[128:131], v[44:47], v[4:7]
 v_mfma_f32_16x16x32_bf16 v[8:11], v[200:203], v[40:43], v[8:11]
 v_mfma_f32_16x16x32_bf16 v[12:15], v[200:203], v[44:47], v[12:15]
 v_mfma_f32_16x16x32_bf16 v[16:19], a[16:19], v[40:43], v[16:19]
 v_mfma_f32_16x16x32_bf16 v[20:23], a[16:19], v[44:47], v[20:23]
 ds_read_b128 v[40:43], v69 offset:28672
 ds_read_b128 v[44:47], v69 offset:29696
 s_waitcnt lgkmcnt(2)
 v_mfma_f32_16x16x32_bf16 v[0:3], v[132:135], v[48:51], v[0:3]
 v_mfma_f32_16x16x32_bf16 v[4:7], v[132:135], v[52:55], v[4:7]
 v_mfma_f32_16x16x32_bf16 v[8:11], v[204:207], v[48:51], v[8:11]
 v_mfma_f32_16x16x32_bf16 v[12:15], v[204:207], v[52:55], v[12:15]
 v_mfma_f32_16x16x32_bf16 v[16:19], a[20:23], v[48:51], v[16:19]
 v_mfma_f32_16x16x32_bf16 v[20:23], a[20:23], v[52:55], v[20:23]
 ds_read_b128 v[48:51], v69 offset:30720
 ds_read_b128 v[52:55], v69 offset:31744
 s_waitcnt lgkmcnt(2)
 v_mfma_f32_16x16x32_bf16 v[0:3], v[136:139], v[40:43], v[0:3]
 v_mfma_f32_16x16x32_bf16 v[4:7], v[136:139], v[44:47], v[4:7]
 v_mfma_f32_16x16x32_bf16 v[8:11], v[208:211], v[40:43], v[8:11]
 v_mfma_f32_16x16x32_bf16 v[12:15], v[208:211], v[44:47], v[12:15]
 v_mfma_f32_16x16x32_bf16 v[16:19], a[24:27], v[40:43], v[16:19]
 v_mfma_f32_16x16x32_bf16 v[20:23], a[24:27], v[44:47], v[20:23]
 ds_read_b128 v[40:43], v69 offset:32768
 ds_read_b128 v[44:47], v69 offset:33792
 s_waitcnt lgkmcnt(2)
 v_mfma_f32_16x16x32_bf16 v[0:3], v[140:143], v[48:51], v[0:3]
 v_mfma_f32_16x16x32_bf16 v[4:7], v[140:143], v[52:55], v[4:7]
 v_mfma_f32_16x16x32_bf16 v[8:11], v[212:215], v[48:51], v[8:11]
 v_mfma_f32_16x16x32_bf16 v[12:15], v[212:215], v[52:55], v[12:15]
 v_mfma_f32_16x16x32_bf16 v[16:19], a[28:31], v[48:51], v[16:19]
 v_mfma_f32_16x16x32_bf16 v[20:23], a[28:31], v[52:55], v[20:23]
 ds_read_b128 v[48:51], v69 offset:34816
 ds_read_b128 v[52:55], v69 offset:35840
 s_waitcnt lgkmcnt(2)
 v_mfma_f32_16x16x32_bf16 v[0:3], v[144:147], v[40:43], v[0:3]
 v_mfma_f32_16x16x32_bf16 v[4:7], v[144:147], v[44:47], v[4:7]
 v_mfma_f32_16x16x32_bf16 v[8:11], v[216:219], v[40:43], v[8:11]
 v_mfma_f32_16x16x32_bf16 v[12:15], v[216:219], v[44:47], v[12:15]
 v_mfma_f32_16x16x32_bf16 v[16:19], a[32:35], v[40:43], v[16:19]
 v_mfma_f32_16x16x32_bf16 v[20:23], a[32:35], v[44:47], v[20:23]
 s_waitcnt lgkmcnt(0)
 v_mfma_f32_16x16x32_bf16 v[0:3], v[148:151], v[48:51], v[0:3]
 v_mfma_f32_16x16x32_bf16 v[4:7], v[148:151], v[52:55], v[4:7]
 v_mfma_f32_16x16x32_bf16 v[8:11], v[220:223], v[48:51], v[8:11]
 v_mfma_f32_16x16x32_bf16 v[12:15], v[220:223], v[52:55], v[12:15]
 v_mfma_f32_16x16x32_bf16 v[16:19], a[36:39], v[48:51], v[16:19]
 v_mfma_f32_16x16x32_bf16 v[20:23], a[36:39], v[52:55], v[20:23]
 ds_read_b128 v[40:43], v69 offset:0
 ds_read_b128 v[44:47], v69 offset:1024
 ds_read_b128 v[56:59], v75 offset:0
 ds_read_b128 v[48:51], v69 offset:2048
 ds_read_b128 v[52:55], v69 offset:3072
 ds_read_b128 v[60:63], v75 offset:1024
 s_waitcnt lgkmcnt(3)
 v_mfma_f32_16x16x32_bf16 v[24:27], a[40:43], v[40:43], 0
 s_nop 0
 s_nop 0
 v_mfma_f32_16x16x32_bf16 v[28:31], a[40:43], v[44:47], 0
 s_nop 0
 s_nop 0
 v_mfma_f32_16x16x32_bf16 v[32:35], v[56:59], v[40:43], 0
 s_nop 0
 s_nop 0
 v_mfma_f32_16x16x32_bf16 v[36:39], v[56:59], v[44:47], 0
 v_permlane16_swap_b32 v0, v4
 v_permlane16_swap_b32 v1, v5
 ds_read_b128 v[40:43], v69 offset:4096
 ds_read_b128 v[44:47], v69 offset:5120
 ds_read_b128 v[56:59], v75 offset:2048
 s_waitcnt lgkmcnt(3)
 v_mfma_f32_16x16x32_bf16 v[24:27], a[44:47], v[48:51], v[24:27]
 v_permlane16_swap_b32 v2, v6
 v_permlane16_swap_b32 v3, v7
 v_mfma_f32_16x16x32_bf16 v[28:31], a[44:47], v[52:55], v[28:31]
 v_cvt_pk_bf16_f32 v64, v0, v1
 v_lshlrev_b32 v0, 16, v64
 v_mfma_f32_16x16x32_bf16 v[32:35], v[60:63], v[48:51], v[32:35]
 v_and_b32 v1, s75, v64
 v_mul_f32 v65, s76, v0
 v_mfma_f32_16x16x32_bf16 v[36:39], v[60:63], v[52:55], v[36:39]
 v_mul_f32 v66, s76, v1
 v_exp_f32 v65, v65
 ds_read_b128 v[48:51], v69 offset:6144
 ds_read_b128 v[52:55], v69 offset:7168
 ds_read_b128 v[60:63], v75 offset:3072
 s_waitcnt lgkmcnt(3)
 v_mfma_f32_16x16x32_bf16 v[24:27], a[48:51], v[40:43], v[24:27]
 v_exp_f32 v66, v66
 v_cvt_pk_bf16_f32 v64, v4, v5
 v_mfma_f32_16x16x32_bf16 v[28:31], a[48:51], v[44:47], v[28:31]
 v_add_f32 v65, 1.0, v65
 v_add_f32 v66, 1.0, v66
 v_mfma_f32_16x16x32_bf16 v[32:35], v[56:59], v[40:43], v[32:35]
 v_rcp_f32 v65, v65
 v_rcp_f32 v66, v66
 v_mfma_f32_16x16x32_bf16 v[36:39], v[56:59], v[44:47], v[36:39]
 v_lshlrev_b32 v4, 16, v64
 v_and_b32 v5, s75, v64
 ds_read_b128 v[40:43], v69 offset:8192
 ds_read_b128 v[44:47], v69 offset:9216
 ds_read_b128 v[56:59], v75 offset:4096
 s_waitcnt lgkmcnt(3)
 v_mfma_f32_16x16x32_bf16 v[24:27], a[52:55], v[48:51], v[24:27]
 v_mul_f32 v0, v0, v65
 v_mul_f32 v1, v1, v66
 v_mfma_f32_16x16x32_bf16 v[28:31], a[52:55], v[52:55], v[28:31]
 v_cvt_pk_bf16_f32 v64, v0, v1
 v_lshlrev_b32 v0, 16, v64
 v_mfma_f32_16x16x32_bf16 v[32:35], v[60:63], v[48:51], v[32:35]
 v_and_b32 v1, s75, v64
 v_mul_f32 v0, v0, v4
 v_mfma_f32_16x16x32_bf16 v[36:39], v[60:63], v[52:55], v[36:39]
 v_mul_f32 v1, v1, v5
 v_cvt_pk_bf16_f32 v4, v0, v1
 ds_read_b128 v[48:51], v69 offset:10240
 ds_read_b128 v[52:55], v69 offset:11264
 ds_read_b128 v[60:63], v75 offset:5120
 s_waitcnt lgkmcnt(3)
 v_mfma_f32_16x16x32_bf16 v[24:27], a[56:59], v[40:43], v[24:27]
 v_cvt_pk_bf16_f32 v64, v2, v3
 v_lshlrev_b32 v2, 16, v64
 v_mfma_f32_16x16x32_bf16 v[28:31], a[56:59], v[44:47], v[28:31]
 v_and_b32 v3, s75, v64
 v_mul_f32 v65, s76, v2
 v_mfma_f32_16x16x32_bf16 v[32:35], v[56:59], v[40:43], v[32:35]
 v_mul_f32 v66, s76, v3
 v_exp_f32 v65, v65
 v_mfma_f32_16x16x32_bf16 v[36:39], v[56:59], v[44:47], v[36:39]
 v_exp_f32 v66, v66
 v_cvt_pk_bf16_f32 v64, v6, v7
 ds_read_b128 v[40:43], v69 offset:12288
 ds_read_b128 v[44:47], v69 offset:13312
 ds_read_b128 v[56:59], v75 offset:6144
 s_waitcnt lgkmcnt(3)
 v_mfma_f32_16x16x32_bf16 v[24:27], a[60:63], v[48:51], v[24:27]
 v_add_f32 v65, 1.0, v65
 v_add_f32 v66, 1.0, v66
 v_mfma_f32_16x16x32_bf16 v[28:31], a[60:63], v[52:55], v[28:31]
 v_rcp_f32 v65, v65
 v_rcp_f32 v66, v66
 v_mfma_f32_16x16x32_bf16 v[32:35], v[60:63], v[48:51], v[32:35]
 v_lshlrev_b32 v6, 16, v64
 v_and_b32 v7, s75, v64
 v_mfma_f32_16x16x32_bf16 v[36:39], v[60:63], v[52:55], v[36:39]
 v_mul_f32 v2, v2, v65
 v_mul_f32 v3, v3, v66
 ds_read_b128 v[48:51], v69 offset:14336
 ds_read_b128 v[52:55], v69 offset:15360
 ds_read_b128 v[60:63], v75 offset:7168
 s_waitcnt lgkmcnt(3)
 v_mfma_f32_16x16x32_bf16 v[24:27], a[64:67], v[40:43], v[24:27]
 v_cvt_pk_bf16_f32 v64, v2, v3
 v_lshlrev_b32 v2, 16, v64
 v_mfma_f32_16x16x32_bf16 v[28:31], a[64:67], v[44:47], v[28:31]
 v_and_b32 v3, s75, v64
 v_mul_f32 v2, v2, v6
 v_mfma_f32_16x16x32_bf16 v[32:35], v[56:59], v[40:43], v[32:35]
 v_mul_f32 v3, v3, v7
 v_cvt_pk_bf16_f32 v5, v2, v3
 v_mfma_f32_16x16x32_bf16 v[36:39], v[56:59], v[44:47], v[36:39]
 ds_write_b64 v74, v[4:5] offset:0
 ds_read_b128 v[40:43], v69 offset:16384
 ds_read_b128 v[44:47], v69 offset:17408
 ds_read_b128 v[56:59], v75 offset:8192
 s_waitcnt lgkmcnt(3)
 v_mfma_f32_16x16x32_bf16 v[24:27], a[68:71], v[48:51], v[24:27]
 v_permlane16_swap_b32 v8, v12
 v_permlane16_swap_b32 v9, v13
 v_mfma_f32_16x16x32_bf16 v[28:31], a[68:71], v[52:55], v[28:31]
 v_permlane16_swap_b32 v10, v14
 v_permlane16_swap_b32 v11, v15
 v_mfma_f32_16x16x32_bf16 v[32:35], v[60:63], v[48:51], v[32:35]
 v_cvt_pk_bf16_f32 v64, v8, v9
 v_lshlrev_b32 v8, 16, v64
 v_mfma_f32_16x16x32_bf16 v[36:39], v[60:63], v[52:55], v[36:39]
 v_and_b32 v9, s75, v64
 v_mul_f32 v65, s76, v8
 ds_read_b128 v[48:51], v69 offset:18432
 ds_read_b128 v[52:55], v69 offset:19456
 ds_read_b128 v[60:63], v75 offset:9216
 s_waitcnt lgkmcnt(3)
 v_mfma_f32_16x16x32_bf16 v[24:27], a[72:75], v[40:43], v[24:27]
 v_mul_f32 v66, s76, v9
 v_exp_f32 v65, v65
 v_mfma_f32_16x16x32_bf16 v[28:31], a[72:75], v[44:47], v[28:31]
 v_exp_f32 v66, v66
 v_cvt_pk_bf16_f32 v64, v12, v13
 v_mfma_f32_16x16x32_bf16 v[32:35], v[56:59], v[40:43], v[32:35]
 v_add_f32 v65, 1.0, v65
 v_add_f32 v66, 1.0, v66
 v_mfma_f32_16x16x32_bf16 v[36:39], v[56:59], v[44:47], v[36:39]
 v_rcp_f32 v65, v65
 v_rcp_f32 v66, v66
 ds_read_b128 v[40:43], v69 offset:20480
 ds_read_b128 v[44:47], v69 offset:21504
 ds_read_b128 v[56:59], v75 offset:10240
 s_waitcnt lgkmcnt(3)
 v_mfma_f32_16x16x32_bf16 v[24:27], a[76:79], v[48:51], v[24:27]
 v_lshlrev_b32 v12, 16, v64
 v_and_b32 v13, s75, v64
 v_mfma_f32_16x16x32_bf16 v[28:31], a[76:79], v[52:55], v[28:31]
 v_mul_f32 v8, v8, v65
 v_mul_f32 v9, v9, v66
 v_mfma_f32_16x16x32_bf16 v[32:35], v[60:63], v[48:51], v[32:35]
 v_cvt_pk_bf16_f32 v64, v8, v9
 v_lshlrev_b32 v8, 16, v64
 v_mfma_f32_16x16x32_bf16 v[36:39], v[60:63], v[52:55], v[36:39]
 v_and_b32 v9, s75, v64
 v_mul_f32 v8, v8, v12
 ds_read_b128 v[48:51], v69 offset:22528
 ds_read_b128 v[52:55], v69 offset:23552
 ds_read_b128 v[60:63], v75 offset:11264
 s_waitcnt lgkmcnt(3)
 v_mfma_f32_16x16x32_bf16 v[24:27], a[80:83], v[40:43], v[24:27]
 v_mul_f32 v9, v9, v13
 v_cvt_pk_bf16_f32 v12, v8, v9
 v_mfma_f32_16x16x32_bf16 v[28:31], a[80:83], v[44:47], v[28:31]
 v_cvt_pk_bf16_f32 v64, v10, v11
 v_lshlrev_b32 v10, 16, v64
 v_mfma_f32_16x16x32_bf16 v[32:35], v[56:59], v[40:43], v[32:35]
 v_and_b32 v11, s75, v64
 v_mul_f32 v65, s76, v10
 v_mfma_f32_16x16x32_bf16 v[36:39], v[56:59], v[44:47], v[36:39]
 v_mul_f32 v66, s76, v11
 v_exp_f32 v65, v65
 ds_read_b128 v[40:43], v69 offset:24576
 ds_read_b128 v[44:47], v69 offset:25600
 ds_read_b128 v[56:59], v75 offset:12288
 s_waitcnt lgkmcnt(3)
 v_mfma_f32_16x16x32_bf16 v[24:27], a[84:87], v[48:51], v[24:27]
 v_exp_f32 v66, v66
 v_cvt_pk_bf16_f32 v64, v14, v15
 v_mfma_f32_16x16x32_bf16 v[28:31], a[84:87], v[52:55], v[28:31]
 v_add_f32 v65, 1.0, v65
 v_add_f32 v66, 1.0, v66
 v_mfma_f32_16x16x32_bf16 v[32:35], v[60:63], v[48:51], v[32:35]
 v_rcp_f32 v65, v65
 v_rcp_f32 v66, v66
 v_mfma_f32_16x16x32_bf16 v[36:39], v[60:63], v[52:55], v[36:39]
 v_lshlrev_b32 v14, 16, v64
 v_and_b32 v15, s75, v64
 ds_read_b128 v[48:51], v69 offset:26624
 ds_read_b128 v[52:55], v69 offset:27648
 ds_read_b128 v[60:63], v75 offset:13312
 s_waitcnt lgkmcnt(3)
 v_mfma_f32_16x16x32_bf16 v[24:27], a[88:91], v[40:43], v[24:27]
 v_mul_f32 v10, v10, v65
 v_mul_f32 v11, v11, v66
 v_mfma_f32_16x16x32_bf16 v[28:31], a[88:91], v[44:47], v[28:31]
 v_cvt_pk_bf16_f32 v64, v10, v11
 v_lshlrev_b32 v10, 16, v64
 v_mfma_f32_16x16x32_bf16 v[32:35], v[56:59], v[40:43], v[32:35]
 v_and_b32 v11, s75, v64
 v_mul_f32 v10, v10, v14
 v_mfma_f32_16x16x32_bf16 v[36:39], v[56:59], v[44:47], v[36:39]
 v_mul_f32 v11, v11, v15
 v_cvt_pk_bf16_f32 v13, v10, v11
 ds_write_b64 v74, v[12:13] offset:512
 ds_read_b128 v[40:43], v69 offset:28672
 ds_read_b128 v[44:47], v69 offset:29696
 ds_read_b128 v[56:59], v75 offset:14336
 s_waitcnt lgkmcnt(3)
 v_mfma_f32_16x16x32_bf16 v[24:27], a[92:95], v[48:51], v[24:27]
 v_permlane16_swap_b32 v16, v20
 v_permlane16_swap_b32 v17, v21
 v_mfma_f32_16x16x32_bf16 v[28:31], a[92:95], v[52:55], v[28:31]
 v_permlane16_swap_b32 v18, v22
 v_permlane16_swap_b32 v19, v23
 v_mfma_f32_16x16x32_bf16 v[32:35], v[60:63], v[48:51], v[32:35]
 v_cvt_pk_bf16_f32 v64, v16, v17
 v_lshlrev_b32 v16, 16, v64
 v_mfma_f32_16x16x32_bf16 v[36:39], v[60:63], v[52:55], v[36:39]
 v_and_b32 v17, s75, v64
 v_mul_f32 v65, s76, v16
 ds_read_b128 v[48:51], v69 offset:30720
 ds_read_b128 v[52:55], v69 offset:31744
 ds_read_b128 v[60:63], v75 offset:15360
 s_waitcnt lgkmcnt(3)
 v_mfma_f32_16x16x32_bf16 v[24:27], a[96:99], v[40:43], v[24:27]
 v_mul_f32 v66, s76, v17
 v_exp_f32 v65, v65
 v_mfma_f32_16x16x32_bf16 v[28:31], a[96:99], v[44:47], v[28:31]
 v_exp_f32 v66, v66
 v_cvt_pk_bf16_f32 v64, v20, v21
 v_mfma_f32_16x16x32_bf16 v[32:35], v[56:59], v[40:43], v[32:35]
 v_add_f32 v65, 1.0, v65
 v_add_f32 v66, 1.0, v66
 v_mfma_f32_16x16x32_bf16 v[36:39], v[56:59], v[44:47], v[36:39]
 v_rcp_f32 v65, v65
 v_rcp_f32 v66, v66
 ds_read_b128 v[40:43], v69 offset:32768
 ds_read_b128 v[44:47], v69 offset:33792
 ds_read_b128 v[56:59], v75 offset:16384
 s_waitcnt lgkmcnt(3)
 v_mfma_f32_16x16x32_bf16 v[24:27], a[100:103], v[48:51], v[24:27]
 v_lshlrev_b32 v20, 16, v64
 v_and_b32 v21, s75, v64
 v_mfma_f32_16x16x32_bf16 v[28:31], a[100:103], v[52:55], v[28:31]
 v_mul_f32 v16, v16, v65
 v_mul_f32 v17, v17, v66
 v_mfma_f32_16x16x32_bf16 v[32:35], v[60:63], v[48:51], v[32:35]
 v_cvt_pk_bf16_f32 v64, v16, v17
 v_lshlrev_b32 v16, 16, v64
 v_mfma_f32_16x16x32_bf16 v[36:39], v[60:63], v[52:55], v[36:39]
 v_and_b32 v17, s75, v64
 v_mul_f32 v16, v16, v20
 ds_read_b128 v[48:51], v69 offset:34816
 ds_read_b128 v[52:55], v69 offset:35840
 ds_read_b128 v[60:63], v75 offset:17408
 s_waitcnt lgkmcnt(3)
 v_mfma_f32_16x16x32_bf16 v[24:27], a[104:107], v[40:43], v[24:27]
 v_mul_f32 v17, v17, v21
 v_cvt_pk_bf16_f32 v20, v16, v17
 v_mfma_f32_16x16x32_bf16 v[28:31], a[104:107], v[44:47], v[28:31]
 v_cvt_pk_bf16_f32 v64, v18, v19
 v_lshlrev_b32 v18, 16, v64
 v_mfma_f32_16x16x32_bf16 v[32:35], v[56:59], v[40:43], v[32:35]
 v_and_b32 v19, s75, v64
 v_mul_f32 v65, s76, v18
 v_mfma_f32_16x16x32_bf16 v[36:39], v[56:59], v[44:47], v[36:39]
 v_mul_f32 v66, s76, v19
 v_exp_f32 v65, v65
 s_waitcnt lgkmcnt(0)
 v_mfma_f32_16x16x32_bf16 v[24:27], a[108:111], v[48:51], v[24:27]
 v_exp_f32 v66, v66
 v_cvt_pk_bf16_f32 v64, v22, v23
 v_mfma_f32_16x16x32_bf16 v[28:31], a[108:111], v[52:55], v[28:31]
 v_add_f32 v65, 1.0, v65
 v_add_f32 v66, 1.0, v66
 v_mfma_f32_16x16x32_bf16 v[32:35], v[60:63], v[48:51], v[32:35]
 v_rcp_f32 v65, v65
 v_rcp_f32 v66, v66
 v_mfma_f32_16x16x32_bf16 v[36:39], v[60:63], v[52:55], v[36:39]
 v_lshlrev_b32 v22, 16, v64
 v_and_b32 v23, s75, v64
 v_mul_f32 v18, v18, v65
 v_mul_f32 v19, v19, v66
 v_cvt_pk_bf16_f32 v64, v18, v19
 v_lshlrev_b32 v18, 16, v64
 v_and_b32 v19, s75, v64
 v_mul_f32 v18, v18, v22
 v_mul_f32 v19, v19, v23
 v_cvt_pk_bf16_f32 v21, v18, v19
 ds_write_b64 v74, v[20:21] offset:1024
 s_nop 7
 v_permlane16_swap_b32 v24, v28
 v_permlane16_swap_b32 v25, v29
 v_permlane16_swap_b32 v26, v30
 v_permlane16_swap_b32 v27, v31
 v_cvt_pk_bf16_f32 v64, v24, v25
 v_lshlrev_b32 v24, 16, v64
 v_and_b32 v25, s75, v64
 v_mul_f32 v65, s76, v24
 v_mul_f32 v66, s76, v25
 v_exp_f32 v65, v65
 v_exp_f32 v66, v66
 v_cvt_pk_bf16_f32 v64, v28, v29
 v_add_f32 v65, 1.0, v65
 v_add_f32 v66, 1.0, v66
 v_rcp_f32 v65, v65
 v_rcp_f32 v66, v66
 v_lshlrev_b32 v28, 16, v64
 v_and_b32 v29, s75, v64
 v_mul_f32 v24, v24, v65
 v_mul_f32 v25, v25, v66
 v_cvt_pk_bf16_f32 v64, v24, v25
 v_lshlrev_b32 v24, 16, v64
 v_and_b32 v25, s75, v64
 v_mul_f32 v24, v24, v28
 v_mul_f32 v25, v25, v29
 v_cvt_pk_bf16_f32 v28, v24, v25
 v_cvt_pk_bf16_f32 v64, v26, v27
 v_lshlrev_b32 v26, 16, v64
 v_and_b32 v27, s75, v64
 v_mul_f32 v65, s76, v26
 v_mul_f32 v66, s76, v27
 v_exp_f32 v65, v65
 v_exp_f32 v66, v66
 v_cvt_pk_bf16_f32 v64, v30, v31
 v_add_f32 v65, 1.0, v65
 v_add_f32 v66, 1.0, v66
 v_rcp_f32 v65, v65
 v_rcp_f32 v66, v66
 v_lshlrev_b32 v30, 16, v64
 v_and_b32 v31, s75, v64
 v_mul_f32 v26, v26, v65
 v_mul_f32 v27, v27, v66
 v_cvt_pk_bf16_f32 v64, v26, v27
 v_lshlrev_b32 v26, 16, v64
 v_and_b32 v27, s75, v64
 v_mul_f32 v26, v26, v30
 v_mul_f32 v27, v27, v31
 v_cvt_pk_bf16_f32 v29, v26, v27
 ds_write_b64 v74, v[28:29] offset:1536
 s_cmp_eq_u32 s69, 0
 s_cbranch_scc1 L35
 v_permlane16_swap_b32 v32, v36
 v_permlane16_swap_b32 v33, v37
 v_permlane16_swap_b32 v34, v38
 v_permlane16_swap_b32 v35, v39
 v_cvt_pk_bf16_f32 v64, v32, v33
 v_lshlrev_b32 v32, 16, v64
 v_and_b32 v33, s75, v64
 v_mul_f32 v65, s76, v32
 v_mul_f32 v66, s76, v33
 v_exp_f32 v65, v65
 v_exp_f32 v66, v66
 v_cvt_pk_bf16_f32 v64, v36, v37
 v_add_f32 v65, 1.0, v65
 v_add_f32 v66, 1.0, v66
 v_rcp_f32 v65, v65
 v_rcp_f32 v66, v66
 v_lshlrev_b32 v36, 16, v64
 v_and_b32 v37, s75, v64
 v_mul_f32 v32, v32, v65
 v_mul_f32 v33, v33, v66
 v_cvt_pk_bf16_f32 v64, v32, v33
 v_lshlrev_b32 v32, 16, v64
 v_and_b32 v33, s75, v64
 v_mul_f32 v32, v32, v36
 v_mul_f32 v33, v33, v37
 v_cvt_pk_bf16_f32 v36, v32, v33
 v_cvt_pk_bf16_f32 v64, v34, v35
 v_lshlrev_b32 v34, 16, v64
 v_and_b32 v35, s75, v64
 v_mul_f32 v65, s76, v34
 v_mul_f32 v66, s76, v35
 v_exp_f32 v65, v65
 v_exp_f32 v66, v66
 v_cvt_pk_bf16_f32 v64, v38, v39
 v_add_f32 v65, 1.0, v65
 v_add_f32 v66, 1.0, v66
 v_rcp_f32 v65, v65
 v_rcp_f32 v66, v66
 v_lshlrev_b32 v38, 16, v64
 v_and_b32 v39, s75, v64
 v_mul_f32 v34, v34, v65
 v_mul_f32 v35, v35, v66
 v_cvt_pk_bf16_f32 v64, v34, v35
 v_lshlrev_b32 v34, 16, v64
 v_and_b32 v35, s75, v64
 v_mul_f32 v34, v34, v38
 v_mul_f32 v35, v35, v39
 v_cvt_pk_bf16_f32 v37, v34, v35
 ds_write_b64 v74, v[36:37] offset:2048
L35:
 s_waitcnt lgkmcnt(0)
 s_barrier
 s_mul_i32 s60, s65, 1
 s_and_b32 s60, s60, 0
 s_lshl_b32 s61, s47, 1
 s_add_u32 s60, s60, s61
 s_mul_i32 s70, s60, 1179648
 s_add_u32 s70, s70, 94371840
 s_lshl_b32 s63, s68, 6
 ds_read_b128 v[0:3], v69 offset:36864
 ds_read_b128 v[4:7], v69 offset:37888
 ds_read_b128 v[8:11], v69 offset:38912
 ds_read_b128 v[12:15], v69 offset:39936
 ds_read_b128 v[16:19], v69 offset:40960
 ds_read_b128 v[20:23], v69 offset:41984
 ds_read_b128 v[24:27], v69 offset:43008
 ds_read_b128 v[28:31], v69 offset:44032
 ds_read_b128 v[32:35], v69 offset:45056
 s_waitcnt lgkmcnt(8)
 v_mfma_f32_32x32x16_bf16 v[36:51], a[112:115], v[0:3], 0
 s_waitcnt lgkmcnt(7)
 v_mfma_f32_32x32x16_bf16 v[36:51], a[116:119], v[4:7], v[36:51]
 s_waitcnt lgkmcnt(6)
 v_mfma_f32_32x32x16_bf16 v[36:51], a[120:123], v[8:11], v[36:51]
 s_waitcnt lgkmcnt(5)
 v_mfma_f32_32x32x16_bf16 v[36:51], a[124:127], v[12:15], v[36:51]
 s_waitcnt lgkmcnt(4)
 v_mfma_f32_32x32x16_bf16 v[36:51], a[128:131], v[16:19], v[36:51]
 s_waitcnt lgkmcnt(3)
 v_mfma_f32_32x32x16_bf16 v[36:51], a[132:135], v[20:23], v[36:51]
 s_waitcnt lgkmcnt(2)
 v_mfma_f32_32x32x16_bf16 v[36:51], a[136:139], v[24:27], v[36:51]
 s_waitcnt lgkmcnt(1)
 v_mfma_f32_32x32x16_bf16 v[36:51], a[140:143], v[28:31], v[36:51]
 s_waitcnt lgkmcnt(0)
 v_mfma_f32_32x32x16_bf16 v[36:51], a[144:147], v[32:35], v[36:51]
 v_mfma_f32_32x32x16_bf16 v[52:67], a[148:151], v[0:3], 0
 v_mfma_f32_32x32x16_bf16 v[52:67], a[152:155], v[4:7], v[52:67]
 v_cvt_pk_bf16_f32 v36, v36, v37
 v_cvt_pk_bf16_f32 v37, v38, v39
 v_cvt_pk_bf16_f32 v38, v40, v41
 v_cvt_pk_bf16_f32 v39, v42, v43
 v_cvt_pk_bf16_f32 v40, v44, v45
 v_cvt_pk_bf16_f32 v41, v46, v47
 v_cvt_pk_bf16_f32 v42, v48, v49
 v_cvt_pk_bf16_f32 v43, v50, v51
 s_add_u32 s60, s63, 0
 v_add_u32 v44, s60, v70
 ds_write_b128 v44, v[36:39] offset:0
 ds_write_b128 v44, v[40:43] offset:32
 v_mfma_f32_32x32x16_bf16 v[52:67], a[156:159], v[8:11], v[52:67]
 v_mfma_f32_32x32x16_bf16 v[52:67], a[160:163], v[12:15], v[52:67]
 v_mfma_f32_32x32x16_bf16 v[52:67], a[164:167], v[16:19], v[52:67]
 v_mfma_f32_32x32x16_bf16 v[52:67], a[168:171], v[20:23], v[52:67]
 v_mfma_f32_32x32x16_bf16 v[52:67], a[172:175], v[24:27], v[52:67]
 v_mfma_f32_32x32x16_bf16 v[52:67], a[176:179], v[28:31], v[52:67]
 v_mfma_f32_32x32x16_bf16 v[52:67], a[180:183], v[32:35], v[52:67]
 v_mfma_f32_32x32x16_bf16 v[36:51], a[184:187], v[0:3], 0
 v_mfma_f32_32x32x16_bf16 v[36:51], a[188:191], v[4:7], v[36:51]
 v_cvt_pk_bf16_f32 v52, v52, v53
 v_cvt_pk_bf16_f32 v53, v54, v55
 v_cvt_pk_bf16_f32 v54, v56, v57
 v_cvt_pk_bf16_f32 v55, v58, v59
 v_cvt_pk_bf16_f32 v56, v60, v61
 v_cvt_pk_bf16_f32 v57, v62, v63
 v_cvt_pk_bf16_f32 v58, v64, v65
 v_cvt_pk_bf16_f32 v59, v66, v67
 s_add_u32 s60, s63, 64
 v_add_u32 v60, s60, v70
 ds_write_b128 v60, v[52:55] offset:0
 ds_write_b128 v60, v[56:59] offset:32
 v_mfma_f32_32x32x16_bf16 v[36:51], a[192:195], v[8:11], v[36:51]
 v_mfma_f32_32x32x16_bf16 v[36:51], a[196:199], v[12:15], v[36:51]
 v_mfma_f32_32x32x16_bf16 v[36:51], a[200:203], v[16:19], v[36:51]
 v_mfma_f32_32x32x16_bf16 v[36:51], a[204:207], v[20:23], v[36:51]
 v_mfma_f32_32x32x16_bf16 v[36:51], a[208:211], v[24:27], v[36:51]
 v_mfma_f32_32x32x16_bf16 v[36:51], a[212:215], v[28:31], v[36:51]
 v_mfma_f32_32x32x16_bf16 v[36:51], a[216:219], v[32:35], v[36:51]
 v_mfma_f32_32x32x16_bf16 v[52:67], a[220:223], v[0:3], 0
 v_mfma_f32_32x32x16_bf16 v[52:67], a[224:227], v[4:7], v[52:67]
 v_cvt_pk_bf16_f32 v36, v36, v37
 v_cvt_pk_bf16_f32 v37, v38, v39
 v_cvt_pk_bf16_f32 v38, v40, v41
 v_cvt_pk_bf16_f32 v39, v42, v43
 v_cvt_pk_bf16_f32 v40, v44, v45
 v_cvt_pk_bf16_f32 v41, v46, v47
 v_cvt_pk_bf16_f32 v42, v48, v49
 v_cvt_pk_bf16_f32 v43, v50, v51
 s_add_u32 s60, s63, 128
 v_add_u32 v44, s60, v70
 ds_write_b128 v44, v[36:39] offset:0
 ds_write_b128 v44, v[40:43] offset:32
 v_mfma_f32_32x32x16_bf16 v[52:67], a[228:231], v[8:11], v[52:67]
 v_mfma_f32_32x32x16_bf16 v[52:67], a[232:235], v[12:15], v[52:67]
 v_mfma_f32_32x32x16_bf16 v[52:67], a[236:239], v[16:19], v[52:67]
 v_mfma_f32_32x32x16_bf16 v[52:67], a[240:243], v[20:23], v[52:67]
 v_mfma_f32_32x32x16_bf16 v[52:67], a[244:247], v[24:27], v[52:67]
 v_mfma_f32_32x32x16_bf16 v[52:67], a[248:251], v[28:31], v[52:67]
 v_mfma_f32_32x32x16_bf16 v[52:67], a[252:255], v[32:35], v[52:67]
 s_cmp_eq_u32 s69, 1
 s_cbranch_scc1 L37
 s_nop 7
 s_nop 3
 v_cvt_pk_bf16_f32 v52, v52, v53
 v_cvt_pk_bf16_f32 v53, v54, v55
 v_cvt_pk_bf16_f32 v54, v56, v57
 v_cvt_pk_bf16_f32 v55, v58, v59
 v_cvt_pk_bf16_f32 v56, v60, v61
 v_cvt_pk_bf16_f32 v57, v62, v63
 v_cvt_pk_bf16_f32 v58, v64, v65
 v_cvt_pk_bf16_f32 v59, v66, v67
 s_add_u32 s60, s63, 192
 v_add_u32 v60, s60, v70
 ds_write_b128 v60, v[52:55] offset:0
 ds_write_b128 v60, v[56:59] offset:32
 ds_read_b128 v[60:63], v75
 ds_read_b128 v[64:67], v75 offset:1024
 s_waitcnt lgkmcnt(1)
 v_mfma_f32_32x32x16_bf16 v[36:51], v[60:63], v[0:3], 0
 ds_read_b128 v[60:63], v75 offset:2048
 s_waitcnt lgkmcnt(1)
 v_mfma_f32_32x32x16_bf16 v[36:51], v[64:67], v[4:7], v[36:51]
 ds_read_b128 v[64:67], v75 offset:3072
 s_waitcnt lgkmcnt(1)
 v_mfma_f32_32x32x16_bf16 v[36:51], v[60:63], v[8:11], v[36:51]
 ds_read_b128 v[60:63], v75 offset:4096
 s_waitcnt lgkmcnt(1)
 v_mfma_f32_32x32x16_bf16 v[36:51], v[64:67], v[12:15], v[36:51]
 ds_read_b128 v[64:67], v75 offset:5120
 s_waitcnt lgkmcnt(1)
 v_mfma_f32_32x32x16_bf16 v[36:51], v[60:63], v[16:19], v[36:51]
 ds_read_b128 v[60:63], v75 offset:6144
 s_waitcnt lgkmcnt(1)
 v_mfma_f32_32x32x16_bf16 v[36:51], v[64:67], v[20:23], v[36:51]
 ds_read_b128 v[64:67], v75 offset:7168
 s_waitcnt lgkmcnt(1)
 v_mfma_f32_32x32x16_bf16 v[36:51], v[60:63], v[24:27], v[36:51]
 ds_read_b128 v[60:63], v75 offset:8192
 s_waitcnt lgkmcnt(1)
 v_mfma_f32_32x32x16_bf16 v[36:51], v[64:67], v[28:31], v[36:51]
 s_waitcnt lgkmcnt(0)
 v_mfma_f32_32x32x16_bf16 v[36:51], v[60:63], v[32:35], v[36:51]
 s_nop 7
 s_nop 3
 v_cvt_pk_bf16_f32 v36, v36, v37
 v_cvt_pk_bf16_f32 v37, v38, v39
 v_cvt_pk_bf16_f32 v38, v40, v41
 v_cvt_pk_bf16_f32 v39, v42, v43
 v_cvt_pk_bf16_f32 v40, v44, v45
 v_cvt_pk_bf16_f32 v41, v46, v47
 v_cvt_pk_bf16_f32 v42, v48, v49
 v_cvt_pk_bf16_f32 v43, v50, v51
 s_add_u32 s60, s63, 256
 v_add_u32 v44, s60, v70
 ds_write_b128 v44, v[36:39] offset:0
 ds_write_b128 v44, v[40:43] offset:32
 s_branch L36
L37:
 s_nop 7
 s_nop 3
 v_cvt_pk_bf16_f32 v52, v52, v53
 v_cvt_pk_bf16_f32 v53, v54, v55
 v_cvt_pk_bf16_f32 v54, v56, v57
 v_cvt_pk_bf16_f32 v55, v58, v59
 v_cvt_pk_bf16_f32 v56, v60, v61
 v_cvt_pk_bf16_f32 v57, v62, v63
 v_cvt_pk_bf16_f32 v58, v64, v65
 v_cvt_pk_bf16_f32 v59, v66, v67
 s_add_u32 s60, s63, 192
 v_add_u32 v60, s60, v70
 ds_write_b128 v60, v[52:55] offset:0
 ds_write_b128 v60, v[56:59] offset:32
L36:
 s_waitcnt lgkmcnt(0)
 s_barrier
 s_mul_i32 s60, s44, 9344
 s_add_u32 s60, s60, 112640
 v_add_u32 v36, s60, v69
 ds_read_b128 v[0:3], v36 offset:0
 ds_read_b128 v[4:7], v36 offset:1168
 ds_read_b128 v[8:11], v36 offset:2336
 ds_read_b128 v[12:15], v36 offset:3504
 ds_read_b128 v[16:19], v36 offset:4672
 ds_read_b128 v[20:23], v36 offset:5840
 ds_read_b128 v[24:27], v36 offset:7008
 ds_read_b128 v[28:31], v36 offset:8176
 v_lshrrev_b32 v37, 3, v68
 s_lshl_b32 s61, s44, 3
 v_add_u32 v37, s61, v37
 v_and_b32 v38, 7, v68
 v_lshlrev_b32 v38, 4, v38
 v_add_u32 v38, 1024, v38
 v_mul_u32_u24 v39, 1168, v37
 v_add_u32 v39, v39, v38
 v_add_u32 v39, 112640, v39
 ds_read_b128 v[32:35], v39
 v_mul_u32_u24 v37, 36864, v37
 v_add_u32 v38, v38, v37
 s_mul_i32 s60, s44, 294912
 s_mul_i32 s61, s46, 1152
 s_add_u32 s60, s60, s61
 s_add_u32 s60, s60, s70
 s_add_u32 s61, s61, s70
 s_waitcnt lgkmcnt(8)
 buffer_store_dwordx4 v[0:3], v69, s[4:7], s60 offen
 s_add_u32 s60, s60, 36864
 s_waitcnt lgkmcnt(7)
 buffer_store_dwordx4 v[4:7], v69, s[4:7], s60 offen
 s_add_u32 s60, s60, 36864
 s_waitcnt lgkmcnt(6)
 buffer_store_dwordx4 v[8:11], v69, s[4:7], s60 offen
 s_add_u32 s60, s60, 36864
 s_waitcnt lgkmcnt(5)
 buffer_store_dwordx4 v[12:15], v69, s[4:7], s60 offen
 s_add_u32 s60, s60, 36864
 s_waitcnt lgkmcnt(4)
 buffer_store_dwordx4 v[16:19], v69, s[4:7], s60 offen
 s_add_u32 s60, s60, 36864
 s_waitcnt lgkmcnt(3)
 buffer_store_dwordx4 v[20:23], v69, s[4:7], s60 offen
 s_add_u32 s60, s60, 36864
 s_waitcnt lgkmcnt(2)
 buffer_store_dwordx4 v[24:27], v69, s[4:7], s60 offen
 s_add_u32 s60, s60, 36864
 s_waitcnt lgkmcnt(1)
 buffer_store_dwordx4 v[28:31], v69, s[4:7], s60 offen
 s_waitcnt lgkmcnt(0)
 buffer_store_dwordx4 v[32:35], v38, s[4:7], s61 offen
 s_add_u32 s65, s65, 1
 s_waitcnt vmcnt(0)
 s_barrier
 s_cmp_eq_u32 s44, 0
 s_cbranch_scc0 L38
 v_mov_b32 v6, 0
 v_mov_b32 v7, s65
 s_mov_b64 exec, 1
 buffer_store_dword v7, v6, s[4:7], s71 offen
 s_mov_b64 exec, -1
L38:
 v_and_b32 v0, 31, v68
 v_lshlrev_b32 v0, 2, v0
L39:
 buffer_load_dword v1, v0, s[4:7], s72 offen sc1
 s_waitcnt vmcnt(0)
 v_cmp_gt_u32 vcc, s65, v1
 s_cbranch_vccnz L39
 s_mov_b32 s73, s70
 s_add_u32 s74, s70, 4608
 buffer_load_dwordx4 v[0:3], v71, s[4:7], s73 offen offset:0 sc1
 buffer_load_dwordx4 v[4:7], v71, s[4:7], s74 offen offset:0 sc1
 buffer_load_dwordx4 v[8:11], v71, s[4:7], s73 offen offset:256 sc1
 buffer_load_dwordx4 v[12:15], v71, s[4:7], s74 offen offset:256 sc1
 buffer_load_dwordx4 v[16:19], v71, s[4:7], s73 offen offset:512 sc1
 buffer_load_dwordx4 v[20:23], v71, s[4:7], s74 offen offset:512 sc1
 buffer_load_dwordx4 v[24:27], v71, s[4:7], s73 offen offset:768 sc1
 buffer_load_dwordx4 v[28:31], v71, s[4:7], s74 offen offset:768 sc1
 buffer_load_dwordx4 v[32:35], v71, s[4:7], s73 offen offset:1024 sc1
 buffer_load_dwordx4 v[36:39], v71, s[4:7], s74 offen offset:1024 sc1
 s_waitcnt vmcnt(9)
 v_mfma_f32_16x16x32_bf16 v[40:43], v[0:3], v[76:79], 0
 s_waitcnt vmcnt(8)
 v_mfma_f32_16x16x32_bf16 v[40:43], v[4:7], v[76:79], v[40:43]
 s_waitcnt vmcnt(7)
 v_mfma_f32_16x16x32_bf16 v[44:47], v[8:11], v[76:79], 0
 s_waitcnt vmcnt(6)
 v_mfma_f32_16x16x32_bf16 v[44:47], v[12:15], v[76:79], v[44:47]
 s_waitcnt vmcnt(5)
 v_mfma_f32_16x16x32_bf16 v[48:51], v[16:19], v[76:79], 0
 s_waitcnt vmcnt(4)
 v_mfma_f32_16x16x32_bf16 v[48:51], v[20:23], v[76:79], v[48:51]
 s_waitcnt vmcnt(3)
 v_mfma_f32_16x16x32_bf16 v[52:55], v[24:27], v[76:79], 0
 s_waitcnt vmcnt(2)
 v_mfma_f32_16x16x32_bf16 v[52:55], v[28:31], v[76:79], v[52:55]
 s_waitcnt vmcnt(1)
 v_mfma_f32_16x16x32_bf16 v[56:59], v[32:35], v[76:79], 0
 s_waitcnt vmcnt(0)
 v_mfma_f32_16x16x32_bf16 v[56:59], v[36:39], v[76:79], v[56:59]
 s_nop 7
 s_mov_b32 exec_lo, 0x00ff00ff
 s_mov_b32 exec_hi, 0x00ff00ff
 ds_write_b32 v72, v40 offset:46080
 ds_write_b32 v72, v41 offset:46096
 ds_write_b32 v72, v42 offset:46144
 ds_write_b32 v72, v43 offset:46160
 ds_write_b32 v72, v44 offset:46592
 ds_write_b32 v72, v45 offset:46608
 ds_write_b32 v72, v46 offset:46656
 ds_write_b32 v72, v47 offset:46672
 ds_write_b32 v72, v48 offset:47104
 ds_write_b32 v72, v49 offset:47120
 ds_write_b32 v72, v50 offset:47168
 ds_write_b32 v72, v51 offset:47184
 ds_write_b32 v72, v52 offset:47616
 ds_write_b32 v72, v53 offset:47632
 ds_write_b32 v72, v54 offset:47680
 ds_write_b32 v72, v55 offset:47696
 s_mov_b32 exec_hi, 0
 ds_write_b32 v72, v56 offset:48128
 ds_write_b32 v72, v57 offset:48144
 ds_write_b32 v72, v58 offset:48192
 ds_write_b32 v72, v59 offset:48208
 s_mov_b64 exec, -1
 s_waitcnt lgkmcnt(0)
 s_barrier
 s_cmp_eq_u32 s44, 1
 s_cbranch_scc0 L40
 s_add_u32 s60, s71, 128
 v_mov_b32 v60, 0
 v_mov_b32 v61, s65
 s_mov_b64 exec, 1
 buffer_store_dword v61, v60, s[4:7], s60 offen
 s_mov_b64 exec, -1
L40:
 s_cmp_eq_u32 s44, 0
 s_cbranch_scc0 L41
 s_lshl_b32 s60, s64, 5
 s_add_u32 s60, s60, s46
 s_mul_i32 s60, s60, 1152
 v_add_u32 v40, 151552, v69
 ds_read_b128 v[32:35], v40
 ds_read_b128 v[36:39], v40 offset:1024
 ds_read_b128 v[0:3], v73 offset:46080
 ds_read_b128 v[4:7], v73 offset:46096
 ds_read_b128 v[16:19], v73 offset:48384
 ds_read_b128 v[20:23], v73 offset:48400
 s_waitcnt lgkmcnt(0)
 v_pk_add_f32 v[0:1], v[0:1], v[16:17]
 v_pk_add_f32 v[2:3], v[2:3], v[18:19]
 v_pk_add_f32 v[4:5], v[4:5], v[20:21]
 v_pk_add_f32 v[6:7], v[6:7], v[22:23]
 ds_read_b128 v[16:19], v73 offset:50688
 ds_read_b128 v[20:23], v73 offset:50704
 s_waitcnt lgkmcnt(0)
 v_pk_add_f32 v[0:1], v[0:1], v[16:17]
 v_pk_add_f32 v[2:3], v[2:3], v[18:19]
 v_pk_add_f32 v[4:5], v[4:5], v[20:21]
 v_pk_add_f32 v[6:7], v[6:7], v[22:23]
 ds_read_b128 v[16:19], v73 offset:52992
 ds_read_b128 v[20:23], v73 offset:53008
 s_waitcnt lgkmcnt(0)
 v_pk_add_f32 v[0:1], v[0:1], v[16:17]
 v_pk_add_f32 v[2:3], v[2:3], v[18:19]
 v_pk_add_f32 v[4:5], v[4:5], v[20:21]
 v_pk_add_f32 v[6:7], v[6:7], v[22:23]
 v_mov_b32 v8, 0
 v_mov_b32 v9, 0
 v_mov_b32 v10, 0
 v_mov_b32 v11, 0
 v_mov_b32 v12, 0
 v_mov_b32 v13, 0
 v_mov_b32 v14, 0
 v_mov_b32 v15, 0
 s_mov_b64 exec, 0xff
 ds_read_b128 v[8:11], v73 offset:48128
 ds_read_b128 v[12:15], v73 offset:48144
 ds_read_b128 v[16:19], v73 offset:50432
 ds_read_b128 v[20:23], v73 offset:50448
 s_waitcnt lgkmcnt(0)
 v_pk_add_f32 v[8:9], v[8:9], v[16:17]
 v_pk_add_f32 v[10:11], v[10:11], v[18:19]
 v_pk_add_f32 v[12:13], v[12:13], v[20:21]
 v_pk_add_f32 v[14:15], v[14:15], v[22:23]
 ds_read_b128 v[16:19], v73 offset:52736
 ds_read_b128 v[20:23], v73 offset:52752
 s_waitcnt lgkmcnt(0)
 v_pk_add_f32 v[8:9], v[8:9], v[16:17]
 v_pk_add_f32 v[10:11], v[10:11], v[18:19]
 v_pk_add_f32 v[12:13], v[12:13], v[20:21]
 v_pk_add_f32 v[14:15], v[14:15], v[22:23]
 ds_read_b128 v[16:19], v73 offset:55040
 ds_read_b128 v[20:23], v73 offset:55056
 s_waitcnt lgkmcnt(0)
 v_pk_add_f32 v[8:9], v[8:9], v[16:17]
 v_pk_add_f32 v[10:11], v[10:11], v[18:19]
 v_pk_add_f32 v[12:13], v[12:13], v[20:21]
 v_pk_add_f32 v[14:15], v[14:15], v[22:23]
 s_mov_b64 exec, -1
 s_waitcnt lgkmcnt(0)
 v_cvt_pk_bf16_f32 v40, v0, v1
 v_lshlrev_b32 v0, 16, v40
 v_and_b32 v1, s75, v40
 v_lshlrev_b32 v41, 16, v32
 v_and_b32 v42, s75, v32
 v_add_f32 v0, v0, v41
 v_add_f32 v1, v1, v42
 v_cvt_pk_bf16_f32 v44, v0, v1
 v_cvt_pk_bf16_f32 v40, v2, v3
 v_lshlrev_b32 v2, 16, v40
 v_and_b32 v3, s75, v40
 v_lshlrev_b32 v41, 16, v33
 v_and_b32 v42, s75, v33
 v_add_f32 v2, v2, v41
 v_add_f32 v3, v3, v42
 v_cvt_pk_bf16_f32 v45, v2, v3
 v_cvt_pk_bf16_f32 v40, v4, v5
 v_lshlrev_b32 v4, 16, v40
 v_and_b32 v5, s75, v40
 v_lshlrev_b32 v41, 16, v34
 v_and_b32 v42, s75, v34
 v_add_f32 v4, v4, v41
 v_add_f32 v5, v5, v42
 v_cvt_pk_bf16_f32 v46, v4, v5
 v_cvt_pk_bf16_f32 v40, v6, v7
 v_lshlrev_b32 v6, 16, v40
 v_and_b32 v7, s75, v40
 v_lshlrev_b32 v41, 16, v35
 v_and_b32 v42, s75, v35
 v_add_f32 v6, v6, v41
 v_add_f32 v7, v7, v42
 v_cvt_pk_bf16_f32 v47, v6, v7
 v_cvt_pk_bf16_f32 v40, v8, v9
 v_lshlrev_b32 v8, 16, v40
 v_and_b32 v9, s75, v40
 v_lshlrev_b32 v41, 16, v36
 v_and_b32 v42, s75, v36
 v_add_f32 v8, v8, v41
 v_add_f32 v9, v9, v42
 v_cvt_pk_bf16_f32 v48, v8, v9
 v_cvt_pk_bf16_f32 v40, v10, v11
 v_lshlrev_b32 v10, 16, v40
 v_and_b32 v11, s75, v40
 v_lshlrev_b32 v41, 16, v37
 v_and_b32 v42, s75, v37
 v_add_f32 v10, v10, v41
 v_add_f32 v11, v11, v42
 v_cvt_pk_bf16_f32 v49, v10, v11
 v_cvt_pk_bf16_f32 v40, v12, v13
 v_lshlrev_b32 v12, 16, v40
 v_and_b32 v13, s75, v40
 v_lshlrev_b32 v41, 16, v38
 v_and_b32 v42, s75, v38
 v_add_f32 v12, v12, v41
 v_add_f32 v13, v13, v42
 v_cvt_pk_bf16_f32 v50, v12, v13
 v_cvt_pk_bf16_f32 v40, v14, v15
 v_lshlrev_b32 v14, 16, v40
 v_and_b32 v15, s75, v40
 v_lshlrev_b32 v41, 16, v39
 v_and_b32 v42, s75, v39
 v_add_f32 v14, v14, v41
 v_add_f32 v15, v15, v42
 v_cvt_pk_bf16_f32 v51, v14, v15
 buffer_store_dwordx4 v[44:47], v69, s[56:59], s60 offen
 s_mov_b64 exec, 0xff
 buffer_store_dwordx4 v[48:51], v69, s[56:59], s60 offen offset:1024
 s_mov_b64 exec, -1
L41:
 s_add_u32 s64, s64, 3
 s_cmp_lt_u32 s64, 64
 s_cbranch_scc1 FF_LOOP31
 s_waitcnt vmcnt(0)
 s_endpgm
F_T1:
 v_and_b32 v100, 63, v0
 v_lshlrev_b32 v102, 4, v100
 s_lshl_b32 s67, s46, 6
 s_add_u32 s67, s67, 73400320
 s_mov_b32 s65, 0
 v_mov_b32 v6, 0
 v_mov_b32 v7, s65
 s_mov_b64 exec, 1
 buffer_store_dword v7, v6, s[4:7], s67 offen sc1
 s_mov_b64 exec, -1
 s_waitcnt vmcnt(0)
 s_barrier
 v_mov_b32 v6, 0
 s_cmp_eq_u32 s44, 0
 s_cbranch_scc0 L42
 s_lshl_b32 s60, s45, 2
 v_mov_b32 v6, s60
 v_mov_b32 v7, 1
 s_mov_b64 exec, 1
 buffer_atomic_add v7, v6, s[8:11], 0 offen offset:32 sc0
 s_mov_b64 exec, -1
 s_waitcnt vmcnt(0)
 s_mov_b64 exec, 1
 v_cmp_eq_u32 vcc, 31, v7
 s_and_b64 exec, exec, vcc
 v_mov_b32 v7, 1
 s_cbranch_execz L43
 buffer_store_dword v7, v6, s[8:11], 0 offen offset:64 sc1
L43:
 s_mov_b64 exec, -1
L42:
 s_mov_b32 s48, s22
 s_mov_b32 s49, s23
 s_mov_b32 s50, 4718592
 s_mov_b32 s51, 0x20000
 s_mov_b32 s52, s24
 s_mov_b32 s53, s25
 s_mov_b32 s54, 4718592
 s_mov_b32 s55, 0x20000
 v_mov_b32 v1, v100
 v_lshrrev_b32 v6, 4, v1
 s_lshl_b32 s60, s44, 4
 v_add_u32 v6, s60, v6
 v_lshlrev_b32 v6, 13, v6
 v_and_b32 v7, 15, v1
 v_lshlrev_b32 v7, 4, v7
 v_add_u32 v6, v6, v7
 s_lshl_b32 s60, s46, 8
 v_add_u32 v0, s60, v6
 v_lshrrev_b32 v6, 5, v1
 v_lshlrev_b32 v6, 3, v6
 v_bfe_u32 v8, v1, 2, 2
 v_add_u32 v6, v6, v8
 v_lshlrev_b32 v6, 8, v6
 v_bfe_u32 v8, v1, 4, 1
 v_lshlrev_b32 v8, 5, v8
 v_add_u32 v6, v6, v8
 v_and_b32 v7, 3, v1
 v_lshlrev_b32 v7, 3, v7
 v_add_u32 v6, v6, v7
 s_lshl_b32 s60, s44, 6
 v_add_u32 v2, s60, v6
 s_lshl_b32 s64, s44, 12
 s_add_u32 m0, s64, 0
 s_mov_b32 s60, 0
 buffer_load_dwordx4 v0, s[48:51], s60 offen lds
 s_add_u32 m0, s64, 1024
 s_mov_b32 s60, 32768
 buffer_load_dwordx4 v0, s[48:51], s60 offen lds
 s_add_u32 m0, s64, 2048
 s_mov_b32 s60, 65536
 buffer_load_dwordx4 v0, s[48:51], s60 offen lds
 s_add_u32 m0, s64, 3072
 s_mov_b32 s60, 98304
 buffer_load_dwordx4 v0, s[48:51], s60 offen lds
 s_add_u32 m0, s64, 16384
 s_mov_b32 s60, 0
 buffer_load_dwordx4 v0, s[52:55], s60 offen lds
 s_add_u32 m0, s64, 17408
 s_mov_b32 s60, 32768
 buffer_load_dwordx4 v0, s[52:55], s60 offen lds
 s_add_u32 m0, s64, 18432
 s_mov_b32 s60, 65536
 buffer_load_dwordx4 v0, s[52:55], s60 offen lds
 s_add_u32 m0, s64, 19456
 s_mov_b32 s60, 98304
 buffer_load_dwordx4 v0, s[52:55], s60 offen lds
 s_add_u32 m0, s64, 32768
 s_mov_b32 s60, 524288
 buffer_load_dwordx4 v0, s[48:51], s60 offen lds
 s_add_u32 m0, s64, 33792
 s_mov_b32 s60, 557056
 buffer_load_dwordx4 v0, s[48:51], s60 offen lds
 s_add_u32 m0, s64, 34816
 s_mov_b32 s60, 589824
 buffer_load_dwordx4 v0, s[48:51], s60 offen lds
 s_add_u32 m0, s64, 35840
 s_mov_b32 s60, 622592
 buffer_load_dwordx4 v0, s[48:51], s60 offen lds
 s_add_u32 m0, s64, 49152
 s_mov_b32 s60, 524288
 buffer_load_dwordx4 v0, s[52:55], s60 offen lds
 s_add_u32 m0, s64, 50176
 s_mov_b32 s60, 557056
 buffer_load_dwordx4 v0, s[52:55], s60 offen lds
 s_add_u32 m0, s64, 51200
 s_mov_b32 s60, 589824
 buffer_load_dwordx4 v0, s[52:55], s60 offen lds
 s_add_u32 m0, s64, 52224
 s_mov_b32 s60, 622592
 buffer_load_dwordx4 v0, s[52:55], s60 offen lds
 s_add_u32 m0, s64, 65536
 s_mov_b32 s60, 1048576
 buffer_load_dwordx4 v0, s[48:51], s60 offen lds
 s_add_u32 m0, s64, 66560
 s_mov_b32 s60, 1081344
 buffer_load_dwordx4 v0, s[48:51], s60 offen lds
 s_add_u32 m0, s64, 67584
 s_mov_b32 s60, 1114112
 buffer_load_dwordx4 v0, s[48:51], s60 offen lds
 s_add_u32 m0, s64, 68608
 s_mov_b32 s60, 1146880
 buffer_load_dwordx4 v0, s[48:51], s60 offen lds
 s_add_u32 m0, s64, 81920
 s_mov_b32 s60, 1048576
 buffer_load_dwordx4 v0, s[52:55], s60 offen lds
 s_add_u32 m0, s64, 82944
 s_mov_b32 s60, 1081344
 buffer_load_dwordx4 v0, s[52:55], s60 offen lds
 s_add_u32 m0, s64, 83968
 s_mov_b32 s60, 1114112
 buffer_load_dwordx4 v0, s[52:55], s60 offen lds
 s_add_u32 m0, s64, 84992
 s_mov_b32 s60, 1146880
 buffer_load_dwordx4 v0, s[52:55], s60 offen lds
 s_add_u32 m0, s64, 98304
 s_mov_b32 s60, 1572864
 buffer_load_dwordx4 v0, s[48:51], s60 offen lds
 s_add_u32 m0, s64, 99328
 s_mov_b32 s60, 1605632
 buffer_load_dwordx4 v0, s[48:51], s60 offen lds
 s_add_u32 m0, s64, 100352
 s_mov_b32 s60, 1638400
 buffer_load_dwordx4 v0, s[48:51], s60 offen lds
 s_add_u32 m0, s64, 101376
 s_mov_b32 s60, 1671168
 buffer_load_dwordx4 v0, s[48:51], s60 offen lds
 s_add_u32 m0, s64, 114688
 s_mov_b32 s60, 1572864
 buffer_load_dwordx4 v0, s[52:55], s60 offen lds
 s_add_u32 m0, s64, 115712
 s_mov_b32 s60, 1605632
 buffer_load_dwordx4 v0, s[52:55], s60 offen lds
 s_add_u32 m0, s64, 116736
 s_mov_b32 s60, 1638400
 buffer_load_dwordx4 v0, s[52:55], s60 offen lds
 s_add_u32 m0, s64, 117760
 s_mov_b32 s60, 1671168
 buffer_load_dwordx4 v0, s[52:55], s60 offen lds
 s_add_u32 m0, s64, 131072
 s_mov_b32 s60, 2097152
 buffer_load_dwordx4 v0, s[48:51], s60 offen lds
 s_add_u32 m0, s64, 132096
 s_mov_b32 s60, 2129920
 buffer_load_dwordx4 v0, s[48:51], s60 offen lds
 s_add_u32 m0, s64, 133120
 s_mov_b32 s60, 2162688
 buffer_load_dwordx4 v0, s[48:51], s60 offen lds
 s_add_u32 m0, s64, 134144
 s_mov_b32 s60, 2195456
 buffer_load_dwordx4 v0, s[48:51], s60 offen lds
 s_waitcnt vmcnt(32)
 s_barrier
 v_add_u32 v3, 0, v2
 ds_read_b64_tr_b16 a[0:1], v3 offset:0
 ds_read_b64_tr_b16 a[2:3], v3 offset:1024
 ds_read_b64_tr_b16 a[4:5], v3 offset:4096
 ds_read_b64_tr_b16 a[6:7], v3 offset:5120
 ds_read_b64_tr_b16 a[8:9], v3 offset:8192
 ds_read_b64_tr_b16 a[10:11], v3 offset:9216
 ds_read_b64_tr_b16 a[12:13], v3 offset:12288
 ds_read_b64_tr_b16 a[14:15], v3 offset:13312
 s_waitcnt lgkmcnt(0)
 s_barrier
 s_add_u32 m0, s64, 0
 s_mov_b32 s60, 2097152
 buffer_load_dwordx4 v0, s[52:55], s60 offen lds
 s_add_u32 m0, s64, 1024
 s_mov_b32 s60, 2129920
 buffer_load_dwordx4 v0, s[52:55], s60 offen lds
 s_add_u32 m0, s64, 2048
 s_mov_b32 s60, 2162688
 buffer_load_dwordx4 v0, s[52:55], s60 offen lds
 s_add_u32 m0, s64, 3072
 s_mov_b32 s60, 2195456
 buffer_load_dwordx4 v0, s[52:55], s60 offen lds
 s_waitcnt vmcnt(32)
 s_barrier
 v_add_u32 v3, 16384, v2
 ds_read_b64_tr_b16 a[144:145], v3 offset:0
 ds_read_b64_tr_b16 a[146:147], v3 offset:1024
 ds_read_b64_tr_b16 a[148:149], v3 offset:4096
 ds_read_b64_tr_b16 a[150:151], v3 offset:5120
 ds_read_b64_tr_b16 a[152:153], v3 offset:8192
 ds_read_b64_tr_b16 a[154:155], v3 offset:9216
 ds_read_b64_tr_b16 a[156:157], v3 offset:12288
 ds_read_b64_tr_b16 a[158:159], v3 offset:13312
 s_waitcnt lgkmcnt(0)
 s_barrier
 s_add_u32 m0, s64, 16384
 s_mov_b32 s60, 2621440
 buffer_load_dwordx4 v0, s[48:51], s60 offen lds
 s_add_u32 m0, s64, 17408
 s_mov_b32 s60, 2654208
 buffer_load_dwordx4 v0, s[48:51], s60 offen lds
 s_add_u32 m0, s64, 18432
 s_mov_b32 s60, 2686976
 buffer_load_dwordx4 v0, s[48:51], s60 offen lds
 s_add_u32 m0, s64, 19456
 s_mov_b32 s60, 2719744
 buffer_load_dwordx4 v0, s[48:51], s60 offen lds
 s_waitcnt vmcnt(32)
 s_barrier
 v_add_u32 v3, 32768, v2
 ds_read_b64_tr_b16 a[16:17], v3 offset:0
 ds_read_b64_tr_b16 a[18:19], v3 offset:1024
 ds_read_b64_tr_b16 a[20:21], v3 offset:4096
 ds_read_b64_tr_b16 a[22:23], v3 offset:5120
 ds_read_b64_tr_b16 a[24:25], v3 offset:8192
 ds_read_b64_tr_b16 a[26:27], v3 offset:9216
 ds_read_b64_tr_b16 a[28:29], v3 offset:12288
 ds_read_b64_tr_b16 a[30:31], v3 offset:13312
 s_waitcnt lgkmcnt(0)
 s_barrier
 s_add_u32 m0, s64, 32768
 s_mov_b32 s60, 2621440
 buffer_load_dwordx4 v0, s[52:55], s60 offen lds
 s_add_u32 m0, s64, 33792
 s_mov_b32 s60, 2654208
 buffer_load_dwordx4 v0, s[52:55], s60 offen lds
 s_add_u32 m0, s64, 34816
 s_mov_b32 s60, 2686976
 buffer_load_dwordx4 v0, s[52:55], s60 offen lds
 s_add_u32 m0, s64, 35840
 s_mov_b32 s60, 2719744
 buffer_load_dwordx4 v0, s[52:55], s60 offen lds
 s_waitcnt vmcnt(32)
 s_barrier
 v_add_u32 v3, 49152, v2
 ds_read_b64_tr_b16 a[160:161], v3 offset:0
 ds_read_b64_tr_b16 a[162:163], v3 offset:1024
 ds_read_b64_tr_b16 a[164:165], v3 offset:4096
 ds_read_b64_tr_b16 a[166:167], v3 offset:5120
 ds_read_b64_tr_b16 a[168:169], v3 offset:8192
 ds_read_b64_tr_b16 a[170:171], v3 offset:9216
 ds_read_b64_tr_b16 a[172:173], v3 offset:12288
 ds_read_b64_tr_b16 a[174:175], v3 offset:13312
 s_waitcnt lgkmcnt(0)
 s_barrier
 s_add_u32 m0, s64, 49152
 s_mov_b32 s60, 3145728
 buffer_load_dwordx4 v0, s[48:51], s60 offen lds
 s_add_u32 m0, s64, 50176
 s_mov_b32 s60, 3178496
 buffer_load_dwordx4 v0, s[48:51], s60 offen lds
 s_add_u32 m0, s64, 51200
 s_mov_b32 s60, 3211264
 buffer_load_dwordx4 v0, s[48:51], s60 offen lds
 s_add_u32 m0, s64, 52224
 s_mov_b32 s60, 3244032
 buffer_load_dwordx4 v0, s[48:51], s60 offen lds
 s_waitcnt vmcnt(32)
 s_barrier
 v_add_u32 v3, 65536, v2
 ds_read_b64_tr_b16 a[32:33], v3 offset:0
 ds_read_b64_tr_b16 a[34:35], v3 offset:1024
 ds_read_b64_tr_b16 a[36:37], v3 offset:4096
 ds_read_b64_tr_b16 a[38:39], v3 offset:5120
 ds_read_b64_tr_b16 a[40:41], v3 offset:8192
 ds_read_b64_tr_b16 a[42:43], v3 offset:9216
 ds_read_b64_tr_b16 a[44:45], v3 offset:12288
 ds_read_b64_tr_b16 a[46:47], v3 offset:13312
 s_waitcnt lgkmcnt(0)
 s_barrier
 s_add_u32 m0, s64, 65536
 s_mov_b32 s60, 3145728
 buffer_load_dwordx4 v0, s[52:55], s60 offen lds
 s_add_u32 m0, s64, 66560
 s_mov_b32 s60, 3178496
 buffer_load_dwordx4 v0, s[52:55], s60 offen lds
 s_add_u32 m0, s64, 67584
 s_mov_b32 s60, 3211264
 buffer_load_dwordx4 v0, s[52:55], s60 offen lds
 s_add_u32 m0, s64, 68608
 s_mov_b32 s60, 3244032
 buffer_load_dwordx4 v0, s[52:55], s60 offen lds
 s_waitcnt vmcnt(32)
 s_barrier
 v_add_u32 v3, 81920, v2
 ds_read_b64_tr_b16 a[176:177], v3 offset:0
 ds_read_b64_tr_b16 a[178:179], v3 offset:1024
 ds_read_b64_tr_b16 a[180:181], v3 offset:4096
 ds_read_b64_tr_b16 a[182:183], v3 offset:5120
 ds_read_b64_tr_b16 a[184:185], v3 offset:8192
 ds_read_b64_tr_b16 a[186:187], v3 offset:9216
 ds_read_b64_tr_b16 a[188:189], v3 offset:12288
 ds_read_b64_tr_b16 a[190:191], v3 offset:13312
 s_waitcnt lgkmcnt(0)
 s_barrier
 s_add_u32 m0, s64, 81920
 s_mov_b32 s60, 3670016
 buffer_load_dwordx4 v0, s[48:51], s60 offen lds
 s_add_u32 m0, s64, 82944
 s_mov_b32 s60, 3702784
 buffer_load_dwordx4 v0, s[48:51], s60 offen lds
 s_add_u32 m0, s64, 83968
 s_mov_b32 s60, 3735552
 buffer_load_dwordx4 v0, s[48:51], s60 offen lds
 s_add_u32 m0, s64, 84992
 s_mov_b32 s60, 3768320
 buffer_load_dwordx4 v0, s[48:51], s60 offen lds
 s_waitcnt vmcnt(32)
 s_barrier
 v_add_u32 v3, 98304, v2
 ds_read_b64_tr_b16 a[48:49], v3 offset:0
 ds_read_b64_tr_b16 a[50:51], v3 offset:1024
 ds_read_b64_tr_b16 a[52:53], v3 offset:4096
 ds_read_b64_tr_b16 a[54:55], v3 offset:5120
 ds_read_b64_tr_b16 a[56:57], v3 offset:8192
 ds_read_b64_tr_b16 a[58:59], v3 offset:9216
 ds_read_b64_tr_b16 a[60:61], v3 offset:12288
 ds_read_b64_tr_b16 a[62:63], v3 offset:13312
 s_waitcnt lgkmcnt(0)
 s_barrier
 s_add_u32 m0, s64, 98304
 s_mov_b32 s60, 3670016
 buffer_load_dwordx4 v0, s[52:55], s60 offen lds
 s_add_u32 m0, s64, 99328
 s_mov_b32 s60, 3702784
 buffer_load_dwordx4 v0, s[52:55], s60 offen lds
 s_add_u32 m0, s64, 100352
 s_mov_b32 s60, 3735552
 buffer_load_dwordx4 v0, s[52:55], s60 offen lds
 s_add_u32 m0, s64, 101376
 s_mov_b32 s60, 3768320
 buffer_load_dwordx4 v0, s[52:55], s60 offen lds
 s_waitcnt vmcnt(32)
 s_barrier
 v_add_u32 v3, 114688, v2
 ds_read_b64_tr_b16 a[192:193], v3 offset:0
 ds_read_b64_tr_b16 a[194:195], v3 offset:1024
 ds_read_b64_tr_b16 a[196:197], v3 offset:4096
 ds_read_b64_tr_b16 a[198:199], v3 offset:5120
 ds_read_b64_tr_b16 a[200:201], v3 offset:8192
 ds_read_b64_tr_b16 a[202:203], v3 offset:9216
 ds_read_b64_tr_b16 a[204:205], v3 offset:12288
 ds_read_b64_tr_b16 a[206:207], v3 offset:13312
 s_waitcnt lgkmcnt(0)
 s_barrier
 s_add_u32 m0, s64, 114688
 s_mov_b32 s60, 4194304
 buffer_load_dwordx4 v0, s[48:51], s60 offen lds
 s_add_u32 m0, s64, 115712
 s_mov_b32 s60, 4227072
 buffer_load_dwordx4 v0, s[48:51], s60 offen lds
 s_add_u32 m0, s64, 116736
 s_mov_b32 s60, 4259840
 buffer_load_dwordx4 v0, s[48:51], s60 offen lds
 s_add_u32 m0, s64, 117760
 s_mov_b32 s60, 4292608
 buffer_load_dwordx4 v0, s[48:51], s60 offen lds
 s_waitcnt vmcnt(32)
 s_barrier
 v_add_u32 v3, 131072, v2
 ds_read_b64_tr_b16 a[64:65], v3 offset:0
 ds_read_b64_tr_b16 a[66:67], v3 offset:1024
 ds_read_b64_tr_b16 a[68:69], v3 offset:4096
 ds_read_b64_tr_b16 a[70:71], v3 offset:5120
 ds_read_b64_tr_b16 a[72:73], v3 offset:8192
 ds_read_b64_tr_b16 a[74:75], v3 offset:9216
 ds_read_b64_tr_b16 a[76:77], v3 offset:12288
 ds_read_b64_tr_b16 a[78:79], v3 offset:13312
 s_waitcnt lgkmcnt(0)
 s_barrier
 s_add_u32 m0, s64, 131072
 s_mov_b32 s60, 4194304
 buffer_load_dwordx4 v0, s[52:55], s60 offen lds
 s_add_u32 m0, s64, 132096
 s_mov_b32 s60, 4227072
 buffer_load_dwordx4 v0, s[52:55], s60 offen lds
 s_add_u32 m0, s64, 133120
 s_mov_b32 s60, 4259840
 buffer_load_dwordx4 v0, s[52:55], s60 offen lds
 s_add_u32 m0, s64, 134144
 s_mov_b32 s60, 4292608
 buffer_load_dwordx4 v0, s[52:55], s60 offen lds
 s_waitcnt vmcnt(32)
 s_barrier
 v_add_u32 v3, 0, v2
 ds_read_b64_tr_b16 a[208:209], v3 offset:0
 ds_read_b64_tr_b16 a[210:211], v3 offset:1024
 ds_read_b64_tr_b16 a[212:213], v3 offset:4096
 ds_read_b64_tr_b16 a[214:215], v3 offset:5120
 ds_read_b64_tr_b16 a[216:217], v3 offset:8192
 ds_read_b64_tr_b16 a[218:219], v3 offset:9216
 ds_read_b64_tr_b16 a[220:221], v3 offset:12288
 ds_read_b64_tr_b16 a[222:223], v3 offset:13312
 s_waitcnt lgkmcnt(0)
 s_barrier
 s_waitcnt vmcnt(28)
 s_barrier
 v_add_u32 v3, 16384, v2
 ds_read_b64_tr_b16 a[80:81], v3 offset:0
 ds_read_b64_tr_b16 a[82:83], v3 offset:1024
 ds_read_b64_tr_b16 a[84:85], v3 offset:4096
 ds_read_b64_tr_b16 a[86:87], v3 offset:5120
 ds_read_b64_tr_b16 a[88:89], v3 offset:8192
 ds_read_b64_tr_b16 a[90:91], v3 offset:9216
 ds_read_b64_tr_b16 a[92:93], v3 offset:12288
 ds_read_b64_tr_b16 a[94:95], v3 offset:13312
 s_waitcnt lgkmcnt(0)
 s_barrier
 s_waitcnt vmcnt(24)
 s_barrier
 v_add_u32 v3, 32768, v2
 ds_read_b64_tr_b16 a[224:225], v3 offset:0
 ds_read_b64_tr_b16 a[226:227], v3 offset:1024
 ds_read_b64_tr_b16 a[228:229], v3 offset:4096
 ds_read_b64_tr_b16 a[230:231], v3 offset:5120
 ds_read_b64_tr_b16 a[232:233], v3 offset:8192
 ds_read_b64_tr_b16 a[234:235], v3 offset:9216
 ds_read_b64_tr_b16 a[236:237], v3 offset:12288
 ds_read_b64_tr_b16 a[238:239], v3 offset:13312
 s_waitcnt lgkmcnt(0)
 s_barrier
 s_waitcnt vmcnt(20)
 s_barrier
 v_add_u32 v3, 49152, v2
 ds_read_b64_tr_b16 a[96:97], v3 offset:0
 ds_read_b64_tr_b16 a[98:99], v3 offset:1024
 ds_read_b64_tr_b16 a[100:101], v3 offset:4096
 ds_read_b64_tr_b16 a[102:103], v3 offset:5120
 ds_read_b64_tr_b16 a[104:105], v3 offset:8192
 ds_read_b64_tr_b16 a[106:107], v3 offset:9216
 ds_read_b64_tr_b16 a[108:109], v3 offset:12288
 ds_read_b64_tr_b16 a[110:111], v3 offset:13312
 s_waitcnt lgkmcnt(0)
 s_barrier
 s_waitcnt vmcnt(16)
 s_barrier
 v_add_u32 v3, 65536, v2
 ds_read_b64_tr_b16 a[240:241], v3 offset:0
 ds_read_b64_tr_b16 a[242:243], v3 offset:1024
 ds_read_b64_tr_b16 a[244:245], v3 offset:4096
 ds_read_b64_tr_b16 a[246:247], v3 offset:5120
 ds_read_b64_tr_b16 a[248:249], v3 offset:8192
 ds_read_b64_tr_b16 a[250:251], v3 offset:9216
 ds_read_b64_tr_b16 a[252:253], v3 offset:12288
 ds_read_b64_tr_b16 a[254:255], v3 offset:13312
 s_waitcnt lgkmcnt(0)
 s_barrier
 s_waitcnt vmcnt(12)
 s_barrier
 v_add_u32 v3, 81920, v2
 ds_read_b64_tr_b16 a[112:113], v3 offset:0
 ds_read_b64_tr_b16 a[114:115], v3 offset:1024
 ds_read_b64_tr_b16 a[116:117], v3 offset:4096
 ds_read_b64_tr_b16 a[118:119], v3 offset:5120
 ds_read_b64_tr_b16 a[120:121], v3 offset:8192
 ds_read_b64_tr_b16 a[122:123], v3 offset:9216
 ds_read_b64_tr_b16 a[124:125], v3 offset:12288
 ds_read_b64_tr_b16 a[126:127], v3 offset:13312
 s_waitcnt lgkmcnt(0)
 s_barrier
 s_waitcnt vmcnt(8)
 s_barrier
 v_add_u32 v3, 98304, v2
 ds_read_b64_tr_b16 v[224:225], v3 offset:0
 ds_read_b64_tr_b16 v[226:227], v3 offset:1024
 ds_read_b64_tr_b16 v[228:229], v3 offset:4096
 ds_read_b64_tr_b16 v[230:231], v3 offset:5120
 ds_read_b64_tr_b16 v[232:233], v3 offset:8192
 ds_read_b64_tr_b16 v[234:235], v3 offset:9216
 ds_read_b64_tr_b16 v[236:237], v3 offset:12288
 ds_read_b64_tr_b16 v[238:239], v3 offset:13312
 s_waitcnt lgkmcnt(0)
 s_barrier
 s_waitcnt vmcnt(4)
 s_barrier
 v_add_u32 v3, 114688, v2
 ds_read_b64_tr_b16 a[128:129], v3 offset:0
 ds_read_b64_tr_b16 a[130:131], v3 offset:1024
 ds_read_b64_tr_b16 a[132:133], v3 offset:4096
 ds_read_b64_tr_b16 a[134:135], v3 offset:5120
 ds_read_b64_tr_b16 a[136:137], v3 offset:8192
 ds_read_b64_tr_b16 a[138:139], v3 offset:9216
 ds_read_b64_tr_b16 a[140:141], v3 offset:12288
 ds_read_b64_tr_b16 a[142:143], v3 offset:13312
 s_waitcnt lgkmcnt(0)
 s_barrier
 s_waitcnt vmcnt(0)
 s_barrier
 v_add_u32 v3, 131072, v2
 ds_read_b64_tr_b16 v[240:241], v3 offset:0
 ds_read_b64_tr_b16 v[242:243], v3 offset:1024
 ds_read_b64_tr_b16 v[244:245], v3 offset:4096
 ds_read_b64_tr_b16 v[246:247], v3 offset:5120
 ds_read_b64_tr_b16 v[248:249], v3 offset:8192
 ds_read_b64_tr_b16 v[250:251], v3 offset:9216
 ds_read_b64_tr_b16 v[252:253], v3 offset:12288
 ds_read_b64_tr_b16 v[254:255], v3 offset:13312
 s_waitcnt lgkmcnt(0)
 s_barrier
 s_barrier
 v_min_u32 v6, 8, v100
 v_lshlrev_b32 v6, 2, v6
L44:
 buffer_load_dword v7, v6, s[8:11], 0 offen offset:64 sc1
 s_waitcnt vmcnt(0)
 v_cmp_eq_u32 vcc, 1, v7
 s_nop 3
 s_and_b32 s60, vcc_lo, 0x1ff
 s_cmp_ge_u32 s60, 0x100
 s_cbranch_scc1 L_FALLBACK
 s_cmp_eq_u32 s60, 0xff
 s_cbranch_scc0 L44
 v_lshlrev_b32 v6, 2, v100
 s_mov_b32 s60, 73408512
L45:
 buffer_load_dword v7, v6, s[4:7], s60 offen sc1
 s_waitcnt vmcnt(0)
 v_cmp_ne_u32 vcc, 1, v7
 s_cbranch_vccnz L45
 v_and_b32 v1, 15, v100
 v_lshlrev_b32 v1, 4, v1
 v_bfe_u32 v2, v100, 4, 1
 v_lshlrev_b32 v2, 12, v2
 v_add_u32 v1, v1, v2
 v_lshrrev_b32 v2, 5, v100
 v_lshlrev_b32 v3, 9, v2
 v_add_u32 v1, v1, v3
 s_lshl_b32 s60, s44, 10
 v_add_u32 v103, s60, v1
 v_and_b32 v1, 15, v100
 v_lshlrev_b32 v1, 4, v1
 v_bfe_u32 v3, v100, 4, 1
 v_lshlrev_b32 v3, 10, v3
 v_add_u32 v1, v1, v3
 v_lshlrev_b32 v3, 8, v2
 v_add_u32 v1, v1, v3
 s_lshl_b32 s60, s44, 11
 s_add_u32 s60, s60, 8192
 v_add_u32 v104, s60, v1
 s_mov_b32 s62, 0
 s_mov_b32 s66, 0
 s_mul_i32 s71, s62, 36864
 s_mul_i32 s72, s44, 9216
 s_add_u32 s71, s71, s72
 s_add_u32 s71, s71, 0
 s_add_u32 s72, s72, s66
 s_add_u32 m0, s72, 0
 s_add_u32 s63, s71, 0
 buffer_load_dwordx4 v102, s[4:7], s63 offen sc1 lds
 s_add_u32 m0, s72, 1024
 s_add_u32 s63, s71, 1024
 buffer_load_dwordx4 v102, s[4:7], s63 offen sc1 lds
 s_add_u32 m0, s72, 2048
 s_add_u32 s63, s71, 2048
 buffer_load_dwordx4 v102, s[4:7], s63 offen sc1 lds
 s_add_u32 m0, s72, 3072
 s_add_u32 s63, s71, 3072
 buffer_load_dwordx4 v102, s[4:7], s63 offen sc1 lds
 s_add_u32 m0, s72, 4096
 s_add_u32 s63, s71, 4096
 buffer_load_dwordx4 v102, s[4:7], s63 offen sc1 lds
 s_add_u32 m0, s72, 5120
 s_add_u32 s63, s71, 5120
 buffer_load_dwordx4 v102, s[4:7], s63 offen sc1 lds
 s_add_u32 m0, s72, 6144
 s_add_u32 s63, s71, 6144
 buffer_load_dwordx4 v102, s[4:7], s63 offen sc1 lds
 s_add_u32 m0, s72, 7168
 s_add_u32 s63, s71, 7168
 buffer_load_dwordx4 v102, s[4:7], s63 offen sc1 lds
 s_add_u32 m0, s72, 8192
 s_add_u32 s63, s71, 8192
 buffer_load_dwordx4 v102, s[4:7], s63 offen sc1 lds
 s_mov_b32 s70, 20971520
 s_lshl_b32 s60, s46, 14
 s_add_u32 s70, s70, s60
 s_add_u32 s70, s70, 33030144
T1_LOOP46:
 s_waitcnt vmcnt(0)
 s_barrier
 s_add_u32 s69, s62, 1
 s_min_u32 s69, s69, 63
 s_xor_b32 s68, s66, 36864
 s_mul_i32 s71, s69, 36864
 s_mul_i32 s72, s44, 9216
 s_add_u32 s71, s71, s72
 s_add_u32 s71, s71, 0
 s_add_u32 s72, s72, s68
 v_add_u32 v101, s66, v102
 ds_read_b128 v[80:83], v101 offset:0
 ds_read_b128 v[84:87], v101 offset:1024
 ds_read_b128 v[88:91], v101 offset:2048
 s_waitcnt lgkmcnt(2)
 v_mfma_f32_32x32x16_bf16 v[0:15], a[0:3], v[80:83], 0
 buffer_store_dwordx4 v[64:67], v103, s[4:7], s70 offen offset:0 sc1
 v_mfma_f32_32x32x16_bf16 v[16:31], v[80:83], a[144:147], 0
 ds_read_b128 v[80:83], v101 offset:3072
 s_waitcnt lgkmcnt(2)
 v_mfma_f32_32x32x16_bf16 v[0:15], a[4:7], v[84:87], v[0:15]
 buffer_store_dwordx4 v[68:71], v103, s[4:7], s70 offen offset:256 sc1
 v_mfma_f32_32x32x16_bf16 v[16:31], v[84:87], a[148:151], v[16:31]
 ds_read_b128 v[84:87], v101 offset:4096
 s_waitcnt lgkmcnt(2)
 v_mfma_f32_32x32x16_bf16 v[0:15], a[8:11], v[88:91], v[0:15]
 buffer_store_dwordx4 v[72:75], v104, s[4:7], s70 offen offset:0 sc1
 v_mfma_f32_32x32x16_bf16 v[16:31], v[88:91], a[152:155], v[16:31]
 ds_read_b128 v[88:91], v101 offset:5120
 s_waitcnt lgkmcnt(2)
 v_mfma_f32_32x32x16_bf16 v[0:15], a[12:15], v[80:83], v[0:15]
 buffer_store_dwordx4 v[76:79], v104, s[4:7], s70 offen offset:512 sc1
 v_mfma_f32_32x32x16_bf16 v[16:31], v[80:83], a[156:159], v[16:31]
 ds_read_b128 v[80:83], v101 offset:6144
 s_waitcnt lgkmcnt(2)
 v_mfma_f32_32x32x16_bf16 v[0:15], a[16:19], v[84:87], v[0:15]
 s_add_u32 m0, s72, 0
 s_add_u32 s63, s71, 0
 buffer_load_dwordx4 v102, s[4:7], s63 offen sc1 lds
 v_mfma_f32_32x32x16_bf16 v[16:31], v[84:87], a[160:163], v[16:31]
 ds_read_b128 v[84:87], v101 offset:7168
 s_waitcnt lgkmcnt(2)
 v_mfma_f32_32x32x16_bf16 v[0:15], a[20:23], v[88:91], v[0:15]
 v_mfma_f32_32x32x16_bf16 v[16:31], v[88:91], a[164:167], v[16:31]
 ds_read_b128 v[88:91], v101 offset:8192
 s_waitcnt lgkmcnt(2)
 v_mfma_f32_32x32x16_bf16 v[0:15], a[24:27], v[80:83], v[0:15]
 s_add_u32 m0, s72, 1024
 s_add_u32 s63, s71, 1024
 buffer_load_dwordx4 v102, s[4:7], s63 offen sc1 lds
 v_mfma_f32_32x32x16_bf16 v[16:31], v[80:83], a[168:171], v[16:31]
 ds_read_b128 v[80:83], v101 offset:9216
 s_waitcnt lgkmcnt(2)
 v_mfma_f32_32x32x16_bf16 v[0:15], a[28:31], v[84:87], v[0:15]
 v_mfma_f32_32x32x16_bf16 v[16:31], v[84:87], a[172:175], v[16:31]
 ds_read_b128 v[84:87], v101 offset:10240
 s_waitcnt lgkmcnt(2)
 v_mfma_f32_32x32x16_bf16 v[0:15], a[32:35], v[88:91], v[0:15]
 s_add_u32 m0, s72, 2048
 s_add_u32 s63, s71, 2048
 buffer_load_dwordx4 v102, s[4:7], s63 offen sc1 lds
 v_mfma_f32_32x32x16_bf16 v[16:31], v[88:91], a[176:179], v[16:31]
 ds_read_b128 v[88:91], v101 offset:11264
 s_waitcnt lgkmcnt(2)
 v_mfma_f32_32x32x16_bf16 v[0:15], a[36:39], v[80:83], v[0:15]
 v_mfma_f32_32x32x16_bf16 v[16:31], v[80:83], a[180:183], v[16:31]
 ds_read_b128 v[80:83], v101 offset:12288
 s_waitcnt lgkmcnt(2)
 v_mfma_f32_32x32x16_bf16 v[0:15], a[40:43], v[84:87], v[0:15]
 s_add_u32 m0, s72, 3072
 s_add_u32 s63, s71, 3072
 buffer_load_dwordx4 v102, s[4:7], s63 offen sc1 lds
 v_mfma_f32_32x32x16_bf16 v[16:31], v[84:87], a[184:187], v[16:31]
 ds_read_b128 v[84:87], v101 offset:13312
 s_waitcnt lgkmcnt(2)
 v_mfma_f32_32x32x16_bf16 v[0:15], a[44:47], v[88:91], v[0:15]
 v_mfma_f32_32x32x16_bf16 v[16:31], v[88:91], a[188:191], v[16:31]
 ds_read_b128 v[88:91], v101 offset:14336
 s_waitcnt lgkmcnt(2)
 v_mfma_f32_32x32x16_bf16 v[0:15], a[48:51], v[80:83], v[0:15]
 s_add_u32 m0, s72, 4096
 s_add_u32 s63, s71, 4096
 buffer_load_dwordx4 v102, s[4:7], s63 offen sc1 lds
 v_mfma_f32_32x32x16_bf16 v[16:31], v[80:83], a[192:195], v[16:31]
 ds_read_b128 v[80:83], v101 offset:15360
 s_waitcnt lgkmcnt(2)
 v_mfma_f32_32x32x16_bf16 v[0:15], a[52:55], v[84:87], v[0:15]
 v_mfma_f32_32x32x16_bf16 v[16:31], v[84:87], a[196:199], v[16:31]
 ds_read_b128 v[84:87], v101 offset:16384
 s_waitcnt lgkmcnt(2)
 v_mfma_f32_32x32x16_bf16 v[0:15], a[56:59], v[88:91], v[0:15]
 s_add_u32 m0, s72, 5120
 s_add_u32 s63, s71, 5120
 buffer_load_dwordx4 v102, s[4:7], s63 offen sc1 lds
 v_mfma_f32_32x32x16_bf16 v[16:31], v[88:91], a[200:203], v[16:31]
 ds_read_b128 v[88:91], v101 offset:17408
 s_waitcnt lgkmcnt(2)
 v_mfma_f32_32x32x16_bf16 v[0:15], a[60:63], v[80:83], v[0:15]
 v_mfma_f32_32x32x16_bf16 v[16:31], v[80:83], a[204:207], v[16:31]
 ds_read_b128 v[80:83], v101 offset:18432
 s_waitcnt lgkmcnt(2)
 v_mfma_f32_32x32x16_bf16 v[0:15], a[64:67], v[84:87], v[0:15]
 s_add_u32 m0, s72, 6144
 s_add_u32 s63, s71, 6144
 buffer_load_dwordx4 v102, s[4:7], s63 offen sc1 lds
 v_mfma_f32_32x32x16_bf16 v[16:31], v[84:87], a[208:211], v[16:31]
 ds_read_b128 v[84:87], v101 offset:19456
 s_waitcnt lgkmcnt(2)
 v_mfma_f32_32x32x16_bf16 v[0:15], a[68:71], v[88:91], v[0:15]
 v_mfma_f32_32x32x16_bf16 v[16:31], v[88:91], a[212:215], v[16:31]
 ds_read_b128 v[88:91], v101 offset:20480
 s_waitcnt lgkmcnt(2)
 v_mfma_f32_32x32x16_bf16 v[0:15], a[72:75], v[80:83], v[0:15]
 s_add_u32 m0, s72, 7168
 s_add_u32 s63, s71, 7168
 buffer_load_dwordx4 v102, s[4:7], s63 offen sc1 lds
 v_mfma_f32_32x32x16_bf16 v[16:31], v[80:83], a[216:219], v[16:31]
 ds_read_b128 v[80:83], v101 offset:21504
 s_waitcnt lgkmcnt(2)
 v_mfma_f32_32x32x16_bf16 v[0:15], a[76:79], v[84:87], v[0:15]
 v_mfma_f32_32x32x16_bf16 v[16:31], v[84:87], a[220:223], v[16:31]
 ds_read_b128 v[84:87], v101 offset:22528
 s_waitcnt lgkmcnt(2)
 v_mfma_f32_32x32x16_bf16 v[0:15], a[80:83], v[88:91], v[0:15]
 s_add_u32 m0, s72, 8192
 s_add_u32 s63, s71, 8192
 buffer_load_dwordx4 v102, s[4:7], s63 offen sc1 lds
 v_mfma_f32_32x32x16_bf16 v[16:31], v[88:91], a[224:227], v[16:31]
 ds_read_b128 v[88:91], v101 offset:23552
 s_waitcnt lgkmcnt(2)
 v_mfma_f32_32x32x16_bf16 v[0:15], a[84:87], v[80:83], v[0:15]
 v_mfma_f32_32x32x16_bf16 v[16:31], v[80:83], a[228:231], v[16:31]
 ds_read_b128 v[80:83], v101 offset:24576
 s_waitcnt lgkmcnt(2)
 v_mfma_f32_32x32x16_bf16 v[0:15], a[88:91], v[84:87], v[0:15]
 v_mfma_f32_32x32x16_bf16 v[16:31], v[84:87], a[232:235], v[16:31]
 ds_read_b128 v[84:87], v101 offset:25600
 s_waitcnt lgkmcnt(2)
 v_mfma_f32_32x32x16_bf16 v[0:15], a[92:95], v[88:91], v[0:15]
 v_mfma_f32_32x32x16_bf16 v[16:31], v[88:91], a[236:239], v[16:31]
 ds_read_b128 v[88:91], v101 offset:26624
 s_waitcnt lgkmcnt(2)
 v_mfma_f32_32x32x16_bf16 v[0:15], a[96:99], v[80:83], v[0:15]
 v_mfma_f32_32x32x16_bf16 v[16:31], v[80:83], a[240:243], v[16:31]
 ds_read_b128 v[80:83], v101 offset:27648
 s_waitcnt lgkmcnt(2)
 v_mfma_f32_32x32x16_bf16 v[0:15], a[100:103], v[84:87], v[0:15]
 v_mfma_f32_32x32x16_bf16 v[16:31], v[84:87], a[244:247], v[16:31]
 ds_read_b128 v[84:87], v101 offset:28672
 s_waitcnt lgkmcnt(2)
 v_mfma_f32_32x32x16_bf16 v[0:15], a[104:107], v[88:91], v[0:15]
 v_mfma_f32_32x32x16_bf16 v[16:31], v[88:91], a[248:251], v[16:31]
 ds_read_b128 v[88:91], v101 offset:29696
 s_waitcnt lgkmcnt(2)
 v_mfma_f32_32x32x16_bf16 v[0:15], a[108:111], v[80:83], v[0:15]
 v_mfma_f32_32x32x16_bf16 v[16:31], v[80:83], a[252:255], v[16:31]
 ds_read_b128 v[80:83], v101 offset:30720
 s_waitcnt lgkmcnt(2)
 v_mfma_f32_32x32x16_bf16 v[0:15], a[112:115], v[84:87], v[0:15]
 v_mfma_f32_32x32x16_bf16 v[16:31], v[84:87], v[224:227], v[16:31]
 s_waitcnt vmcnt(9)
 s_barrier
 s_cmp_eq_u32 s44, 0
 s_cbranch_scc0 L47
 v_mov_b32 v96, 0
 v_mov_b32 v97, s65
 s_mov_b64 exec, 1
 buffer_store_dword v97, v96, s[4:7], s67 offen sc1
 s_mov_b64 exec, -1
L47:
 ds_read_b128 v[84:87], v101 offset:31744
 s_waitcnt lgkmcnt(2)
 v_mfma_f32_32x32x16_bf16 v[0:15], a[116:119], v[88:91], v[0:15]
 v_mfma_f32_32x32x16_bf16 v[16:31], v[88:91], v[228:231], v[16:31]
 ds_read_b128 v[88:91], v101 offset:32768
 s_waitcnt lgkmcnt(2)
 v_mfma_f32_32x32x16_bf16 v[0:15], a[120:123], v[80:83], v[0:15]
 v_mfma_f32_32x32x16_bf16 v[16:31], v[80:83], v[232:235], v[16:31]
 ds_read_b128 v[80:83], v101 offset:33792
 s_waitcnt lgkmcnt(2)
 v_mfma_f32_32x32x16_bf16 v[0:15], a[124:127], v[84:87], v[0:15]
 v_mfma_f32_32x32x16_bf16 v[16:31], v[84:87], v[236:239], v[16:31]
 ds_read_b128 v[84:87], v101 offset:34816
 s_waitcnt lgkmcnt(2)
 v_mfma_f32_32x32x16_bf16 v[0:15], a[128:131], v[88:91], v[0:15]
 v_mfma_f32_32x32x16_bf16 v[16:31], v[88:91], v[240:243], v[16:31]
 ds_read_b128 v[88:91], v101 offset:35840
 s_waitcnt lgkmcnt(2)
 v_mfma_f32_32x32x16_bf16 v[0:15], a[132:135], v[80:83], v[0:15]
 v_mfma_f32_32x32x16_bf16 v[16:31], v[80:83], v[244:247], v[16:31]
 s_waitcnt lgkmcnt(1)
 v_mfma_f32_32x32x16_bf16 v[0:15], a[136:139], v[84:87], v[0:15]
 v_mfma_f32_32x32x16_bf16 v[16:31], v[84:87], v[248:251], v[16:31]
 s_waitcnt lgkmcnt(0)
 v_mfma_f32_32x32x16_bf16 v[0:15], a[140:143], v[88:91], v[0:15]
 v_mfma_f32_32x32x16_bf16 v[16:31], v[88:91], v[252:255], v[16:31]
 s_lshl_b32 s60, s62, 5
 s_add_u32 s60, s60, s46
 s_lshl_b32 s70, s60, 14
 s_add_u32 s70, s70, 20971520
 s_nop 7
 s_nop 1
 v_cvt_pk_bf16_f32 v64, v0, v1
 v_cvt_pk_bf16_f32 v65, v2, v3
 v_cvt_pk_bf16_f32 v66, v4, v5
 v_cvt_pk_bf16_f32 v67, v6, v7
 v_cvt_pk_bf16_f32 v68, v8, v9
 v_cvt_pk_bf16_f32 v69, v10, v11
 v_cvt_pk_bf16_f32 v70, v12, v13
 v_cvt_pk_bf16_f32 v71, v14, v15
 v_cvt_pk_bf16_f32 v72, v16, v17
 v_cvt_pk_bf16_f32 v73, v18, v19
 v_cvt_pk_bf16_f32 v74, v24, v25
 v_cvt_pk_bf16_f32 v75, v26, v27
 v_cvt_pk_bf16_f32 v76, v20, v21
 v_cvt_pk_bf16_f32 v77, v22, v23
 v_cvt_pk_bf16_f32 v78, v28, v29
 v_cvt_pk_bf16_f32 v79, v30, v31
 s_add_u32 s65, s65, 1
 s_cmp_gt_u32 s65, 1
 s_cbranch_scc1 L48
 buffer_store_dwordx4 v[64:67], v103, s[4:7], s70 offen offset:0 sc1
 buffer_store_dwordx4 v[68:71], v103, s[4:7], s70 offen offset:256 sc1
 buffer_store_dwordx4 v[72:75], v104, s[4:7], s70 offen offset:0 sc1
 buffer_store_dwordx4 v[76:79], v104, s[4:7], s70 offen offset:512 sc1
 s_waitcnt vmcnt(0)
 s_barrier
 s_cmp_eq_u32 s44, 0
 s_cbranch_scc0 L48
 v_mov_b32 v96, 0
 v_mov_b32 v97, s65
 s_mov_b64 exec, 1
 buffer_store_dword v97, v96, s[4:7], s67 offen sc1
 s_mov_b64 exec, -1
L48:
 s_add_u32 s62, s62, 1
 s_xor_b32 s66, s66, 36864
 s_cmp_lt_u32 s62, 64
 s_cbranch_scc1 T1_LOOP46
 buffer_store_dwordx4 v[64:67], v103, s[4:7], s70 offen offset:0 sc1
 buffer_store_dwordx4 v[68:71], v103, s[4:7], s70 offen offset:256 sc1
 buffer_store_dwordx4 v[72:75], v104, s[4:7], s70 offen offset:0 sc1
 buffer_store_dwordx4 v[76:79], v104, s[4:7], s70 offen offset:512 sc1
 s_waitcnt vmcnt(0)
 s_barrier
 s_cmp_eq_u32 s44, 0
 s_cbranch_scc0 L49
 v_mov_b32 v96, 0
 v_mov_b32 v97, s65
 s_mov_b64 exec, 1
 buffer_store_dword v97, v96, s[4:7], s67 offen sc1
 s_mov_b64 exec, -1
L49:
 s_waitcnt vmcnt(0)
 s_endpgm
F_T2:
 s_sub_u32 s47, s45, 2
 v_and_b32 v220, 63, v0
 v_lshlrev_b32 v221, 4, v220
 s_lshl_b32 s64, s46, 1
 s_add_u32 s64, s64, s47
 s_lshl_b32 s60, s64, 2
 s_add_u32 s60, s60, 73408512
 s_mov_b32 s61, 0
 s_lshl_b32 s72, s47, 8
 s_add_u32 s72, s72, 73433088
 s_lshl_b32 s71, s46, 2
 s_add_u32 s71, s71, s72
 s_cmp_ge_u32 s47, 2
 s_cbranch_scc1 L50
 v_mov_b32 v6, 0
 v_mov_b32 v7, s61
 s_mov_b64 exec, 1
 buffer_store_dword v7, v6, s[4:7], s60 offen sc1
 s_mov_b64 exec, -1
L50:
 v_mov_b32 v6, 0
 v_mov_b32 v7, s61
 s_mov_b64 exec, 1
 buffer_store_dword v7, v6, s[4:7], s71 offen
 s_mov_b64 exec, -1
 s_add_u32 s60, s71, 128
 s_mov_b32 s61, 0
 v_mov_b32 v6, 0
 v_mov_b32 v7, s61
 s_mov_b64 exec, 1
 buffer_store_dword v7, v6, s[4:7], s60 offen
 s_mov_b64 exec, -1
 v_mul_u32_u24 v6, 3, v220
 v_add_u32 v6, s47, v6
 v_cmp_gt_u32 vcc, 64, v6
 v_lshlrev_b32 v6, 7, v6
 s_lshl_b32 s62, s46, 2
 s_add_u32 s60, s62, 73416704
 v_mov_b32 v7, 0
 s_and_b64 exec, exec, vcc
 buffer_store_dword v7, v6, s[4:7], s60 offen sc1
 s_mov_b64 exec, -1
 s_waitcnt vmcnt(0)
 s_barrier
 v_mov_b32 v6, 0
 s_cmp_eq_u32 s44, 0
 s_cbranch_scc0 L51
 s_lshl_b32 s60, s45, 2
 v_mov_b32 v6, s60
 v_mov_b32 v7, 1
 s_mov_b64 exec, 1
 buffer_atomic_add v7, v6, s[8:11], 0 offen offset:32 sc0
 s_mov_b64 exec, -1
 s_waitcnt vmcnt(0)
 s_mov_b64 exec, 1
 v_cmp_eq_u32 vcc, 31, v7
 s_and_b64 exec, exec, vcc
 v_mov_b32 v7, 1
 s_cbranch_execz L52
 buffer_store_dword v7, v6, s[8:11], 0 offen offset:64 sc1
L52:
 s_mov_b64 exec, -1
L51:
 s_cmp_ge_u32 s47, 2
 s_cbranch_scc1 L53
 s_mov_b32 s12, s16
 s_mov_b32 s13, s17
 s_mov_b32 s14, 2359296
 s_mov_b32 s15, 0x20000
 v_lshrrev_b32 v120, 3, v220
 s_lshl_b32 s60, s44, 3
 v_add_u32 v120, s60, v120
 v_and_b32 v119, 7, v220
 v_mul_u32_u24 v118, 1152, v120
 v_lshlrev_b32 v117, 4, v119
 v_add_u32 v118, v118, v117
 s_mul_i32 s60, s64, 36864
 buffer_load_dwordx4 v[0:3], v118, s[12:15], s60 offen offset:0
 buffer_load_dwordx4 v[4:7], v118, s[12:15], s60 offen offset:128
 buffer_load_dwordx4 v[8:11], v118, s[12:15], s60 offen offset:256
 buffer_load_dwordx4 v[12:15], v118, s[12:15], s60 offen offset:384
 buffer_load_dwordx4 v[16:19], v118, s[12:15], s60 offen offset:512
 buffer_load_dwordx4 v[20:23], v118, s[12:15], s60 offen offset:640
 buffer_load_dwordx4 v[24:27], v118, s[12:15], s60 offen offset:768
 buffer_load_dwordx4 v[28:31], v118, s[12:15], s60 offen offset:896
 buffer_load_dwordx4 v[32:35], v118, s[12:15], s60 offen offset:1024
 v_lshrrev_b32 v117, 1, v119
 v_lshlrev_b32 v117, 10, v117
 v_and_b32 v116, 1, v119
 v_lshlrev_b32 v116, 9, v116
 v_add_u32 v117, v117, v116
 v_lshlrev_b32 v116, 4, v120
 v_add_u32 v117, v117, v116
 s_add_u32 s60, s60, 0
 s_mov_b32 s61, 0xffff0000
 s_waitcnt vmcnt(0)
 v_lshlrev_b32 v40, 16, v0
 v_and_b32 v41, s61, v0
 v_lshlrev_b32 v42, 16, v1
 v_and_b32 v43, s61, v1
 v_lshlrev_b32 v44, 16, v2
 v_and_b32 v45, s61, v2
 v_lshlrev_b32 v46, 16, v3
 v_and_b32 v47, s61, v3
 v_lshlrev_b32 v48, 16, v4
 v_and_b32 v49, s61, v4
 v_lshlrev_b32 v50, 16, v5
 v_and_b32 v51, s61, v5
 v_lshlrev_b32 v52, 16, v6
 v_and_b32 v53, s61, v6
 v_lshlrev_b32 v54, 16, v7
 v_and_b32 v55, s61, v7
 v_lshlrev_b32 v56, 16, v8
 v_and_b32 v57, s61, v8
 v_lshlrev_b32 v58, 16, v9
 v_and_b32 v59, s61, v9
 v_lshlrev_b32 v60, 16, v10
 v_and_b32 v61, s61, v10
 v_lshlrev_b32 v62, 16, v11
 v_and_b32 v63, s61, v11
 v_lshlrev_b32 v64, 16, v12
 v_and_b32 v65, s61, v12
 v_lshlrev_b32 v66, 16, v13
 v_and_b32 v67, s61, v13
 v_lshlrev_b32 v68, 16, v14
 v_and_b32 v69, s61, v14
 v_lshlrev_b32 v70, 16, v15
 v_and_b32 v71, s61, v15
 v_lshlrev_b32 v72, 16, v16
 v_and_b32 v73, s61, v16
 v_lshlrev_b32 v74, 16, v17
 v_and_b32 v75, s61, v17
 v_lshlrev_b32 v76, 16, v18
 v_and_b32 v77, s61, v18
 v_lshlrev_b32 v78, 16, v19
 v_and_b32 v79, s61, v19
 v_lshlrev_b32 v80, 16, v20
 v_and_b32 v81, s61, v20
 v_lshlrev_b32 v82, 16, v21
 v_and_b32 v83, s61, v21
 v_lshlrev_b32 v84, 16, v22
 v_and_b32 v85, s61, v22
 v_lshlrev_b32 v86, 16, v23
 v_and_b32 v87, s61, v23
 v_lshlrev_b32 v88, 16, v24
 v_and_b32 v89, s61, v24
 v_lshlrev_b32 v90, 16, v25
 v_and_b32 v91, s61, v25
 v_lshlrev_b32 v92, 16, v26
 v_and_b32 v93, s61, v26
 v_lshlrev_b32 v94, 16, v27
 v_and_b32 v95, s61, v27
 v_lshlrev_b32 v96, 16, v28
 v_and_b32 v97, s61, v28
 v_lshlrev_b32 v98, 16, v29
 v_and_b32 v99, s61, v29
 v_lshlrev_b32 v100, 16, v30
 v_and_b32 v101, s61, v30
 v_lshlrev_b32 v102, 16, v31
 v_and_b32 v103, s61, v31
 v_lshlrev_b32 v104, 16, v32
 v_and_b32 v105, s61, v32
 v_lshlrev_b32 v106, 16, v33
 v_and_b32 v107, s61, v33
 v_lshlrev_b32 v108, 16, v34
 v_and_b32 v109, s61, v34
 v_lshlrev_b32 v110, 16, v35
 v_and_b32 v111, s61, v35
 v_pk_add_f32 v[112:113], v[40:41], v[42:43]
 v_pk_add_f32 v[112:113], v[112:113], v[44:45]
 v_pk_add_f32 v[112:113], v[112:113], v[46:47]
 v_pk_add_f32 v[112:113], v[112:113], v[48:49]
 v_pk_add_f32 v[112:113], v[112:113], v[50:51]
 v_pk_add_f32 v[112:113], v[112:113], v[52:53]
 v_pk_add_f32 v[112:113], v[112:113], v[54:55]
 v_pk_add_f32 v[112:113], v[112:113], v[56:57]
 v_pk_add_f32 v[112:113], v[112:113], v[58:59]
 v_pk_add_f32 v[112:113], v[112:113], v[60:61]
 v_pk_add_f32 v[112:113], v[112:113], v[62:63]
 v_pk_add_f32 v[112:113], v[112:113], v[64:65]
 v_pk_add_f32 v[112:113], v[112:113], v[66:67]
 v_pk_add_f32 v[112:113], v[112:113], v[68:69]
 v_pk_add_f32 v[112:113], v[112:113], v[70:71]
 v_pk_add_f32 v[112:113], v[112:113], v[72:73]
 v_pk_add_f32 v[112:113], v[112:113], v[74:75]
 v_pk_add_f32 v[112:113], v[112:113], v[76:77]
 v_pk_add_f32 v[112:113], v[112:113], v[78:79]
 v_pk_add_f32 v[112:113], v[112:113], v[80:81]
 v_pk_add_f32 v[112:113], v[112:113], v[82:83]
 v_pk_add_f32 v[112:113], v[112:113], v[84:85]
 v_pk_add_f32 v[112:113], v[112:113], v[86:87]
 v_pk_add_f32 v[112:113], v[112:113], v[88:89]
 v_pk_add_f32 v[112:113], v[112:113], v[90:91]
 v_pk_add_f32 v[112:113], v[112:113], v[92:93]
 v_pk_add_f32 v[112:113], v[112:113], v[94:95]
 v_pk_add_f32 v[112:113], v[112:113], v[96:97]
 v_pk_add_f32 v[112:113], v[112:113], v[98:99]
 v_pk_add_f32 v[112:113], v[112:113], v[100:101]
 v_pk_add_f32 v[112:113], v[112:113], v[102:103]
 v_pk_add_f32 v[112:113], v[112:113], v[104:105]
 v_pk_add_f32 v[112:113], v[112:113], v[106:107]
 v_pk_add_f32 v[112:113], v[112:113], v[108:109]
 v_pk_add_f32 v[112:113], v[112:113], v[110:111]
 v_add_f32 v112, v112, v113
 s_nop 1
 v_add_f32_dpp v112, v112, v112 quad_perm:[1,0,3,2] row_mask:0xf bank_mask:0xf
 s_nop 1
 v_add_f32_dpp v112, v112, v112 quad_perm:[2,3,0,1] row_mask:0xf bank_mask:0xf
 s_nop 1
 v_add_f32_dpp v112, v112, v112 row_half_mirror row_mask:0xf bank_mask:0xf
 v_mul_f32 v112, 0x3ae38e39, v112
 v_mov_b32 v113, 0
 v_mov_b32 v114, 0
 v_sub_f32 v115, v40, v112
 v_sub_f32 v116, v41, v112
 v_fmac_f32 v113, v115, v115
 v_fmac_f32 v114, v116, v116
 v_sub_f32 v115, v42, v112
 v_sub_f32 v116, v43, v112
 v_fmac_f32 v113, v115, v115
 v_fmac_f32 v114, v116, v116
 v_sub_f32 v115, v44, v112
 v_sub_f32 v116, v45, v112
 v_fmac_f32 v113, v115, v115
 v_fmac_f32 v114, v116, v116
 v_sub_f32 v115, v46, v112
 v_sub_f32 v116, v47, v112
 v_fmac_f32 v113, v115, v115
 v_fmac_f32 v114, v116, v116
 v_sub_f32 v115, v48, v112
 v_sub_f32 v116, v49, v112
 v_fmac_f32 v113, v115, v115
 v_fmac_f32 v114, v116, v116
 v_sub_f32 v115, v50, v112
 v_sub_f32 v116, v51, v112
 v_fmac_f32 v113, v115, v115
 v_fmac_f32 v114, v116, v116
 v_sub_f32 v115, v52, v112
 v_sub_f32 v116, v53, v112
 v_fmac_f32 v113, v115, v115
 v_fmac_f32 v114, v116, v116
 v_sub_f32 v115, v54, v112
 v_sub_f32 v116, v55, v112
 v_fmac_f32 v113, v115, v115
 v_fmac_f32 v114, v116, v116
 v_sub_f32 v115, v56, v112
 v_sub_f32 v116, v57, v112
 v_fmac_f32 v113, v115, v115
 v_fmac_f32 v114, v116, v116
 v_sub_f32 v115, v58, v112
 v_sub_f32 v116, v59, v112
 v_fmac_f32 v113, v115, v115
 v_fmac_f32 v114, v116, v116
 v_sub_f32 v115, v60, v112
 v_sub_f32 v116, v61, v112
 v_fmac_f32 v113, v115, v115
 v_fmac_f32 v114, v116, v116
 v_sub_f32 v115, v62, v112
 v_sub_f32 v116, v63, v112
 v_fmac_f32 v113, v115, v115
 v_fmac_f32 v114, v116, v116
 v_sub_f32 v115, v64, v112
 v_sub_f32 v116, v65, v112
 v_fmac_f32 v113, v115, v115
 v_fmac_f32 v114, v116, v116
 v_sub_f32 v115, v66, v112
 v_sub_f32 v116, v67, v112
 v_fmac_f32 v113, v115, v115
 v_fmac_f32 v114, v116, v116
 v_sub_f32 v115, v68, v112
 v_sub_f32 v116, v69, v112
 v_fmac_f32 v113, v115, v115
 v_fmac_f32 v114, v116, v116
 v_sub_f32 v115, v70, v112
 v_sub_f32 v116, v71, v112
 v_fmac_f32 v113, v115, v115
 v_fmac_f32 v114, v116, v116
 v_sub_f32 v115, v72, v112
 v_sub_f32 v116, v73, v112
 v_fmac_f32 v113, v115, v115
 v_fmac_f32 v114, v116, v116
 v_sub_f32 v115, v74, v112
 v_sub_f32 v116, v75, v112
 v_fmac_f32 v113, v115, v115
 v_fmac_f32 v114, v116, v116
 v_sub_f32 v115, v76, v112
 v_sub_f32 v116, v77, v112
 v_fmac_f32 v113, v115, v115
 v_fmac_f32 v114, v116, v116
 v_sub_f32 v115, v78, v112
 v_sub_f32 v116, v79, v112
 v_fmac_f32 v113, v115, v115
 v_fmac_f32 v114, v116, v116
 v_sub_f32 v115, v80, v112
 v_sub_f32 v116, v81, v112
 v_fmac_f32 v113, v115, v115
 v_fmac_f32 v114, v116, v116
 v_sub_f32 v115, v82, v112
 v_sub_f32 v116, v83, v112
 v_fmac_f32 v113, v115, v115
 v_fmac_f32 v114, v116, v116
 v_sub_f32 v115, v84, v112
 v_sub_f32 v116, v85, v112
 v_fmac_f32 v113, v115, v115
 v_fmac_f32 v114, v116, v116
 v_sub_f32 v115, v86, v112
 v_sub_f32 v116, v87, v112
 v_fmac_f32 v113, v115, v115
 v_fmac_f32 v114, v116, v116
 v_sub_f32 v115, v88, v112
 v_sub_f32 v116, v89, v112
 v_fmac_f32 v113, v115, v115
 v_fmac_f32 v114, v116, v116
 v_sub_f32 v115, v90, v112
 v_sub_f32 v116, v91, v112
 v_fmac_f32 v113, v115, v115
 v_fmac_f32 v114, v116, v116
 v_sub_f32 v115, v92, v112
 v_sub_f32 v116, v93, v112
 v_fmac_f32 v113, v115, v115
 v_fmac_f32 v114, v116, v116
 v_sub_f32 v115, v94, v112
 v_sub_f32 v116, v95, v112
 v_fmac_f32 v113, v115, v115
 v_fmac_f32 v114, v116, v116
 v_sub_f32 v115, v96, v112
 v_sub_f32 v116, v97, v112
 v_fmac_f32 v113, v115, v115
 v_fmac_f32 v114, v116, v116
 v_sub_f32 v115, v98, v112
 v_sub_f32 v116, v99, v112
 v_fmac_f32 v113, v115, v115
 v_fmac_f32 v114, v116, v116
 v_sub_f32 v115, v100, v112
 v_sub_f32 v116, v101, v112
 v_fmac_f32 v113, v115, v115
 v_fmac_f32 v114, v116, v116
 v_sub_f32 v115, v102, v112
 v_sub_f32 v116, v103, v112
 v_fmac_f32 v113, v115, v115
 v_fmac_f32 v114, v116, v116
 v_sub_f32 v115, v104, v112
 v_sub_f32 v116, v105, v112
 v_fmac_f32 v113, v115, v115
 v_fmac_f32 v114, v116, v116
 v_sub_f32 v115, v106, v112
 v_sub_f32 v116, v107, v112
 v_fmac_f32 v113, v115, v115
 v_fmac_f32 v114, v116, v116
 v_sub_f32 v115, v108, v112
 v_sub_f32 v116, v109, v112
 v_fmac_f32 v113, v115, v115
 v_fmac_f32 v114, v116, v116
 v_sub_f32 v115, v110, v112
 v_sub_f32 v116, v111, v112
 v_fmac_f32 v113, v115, v115
 v_fmac_f32 v114, v116, v116
 v_add_f32 v113, v113, v114
 s_nop 1
 v_add_f32_dpp v113, v113, v113 quad_perm:[1,0,3,2] row_mask:0xf bank_mask:0xf
 s_nop 1
 v_add_f32_dpp v113, v113, v113 quad_perm:[2,3,0,1] row_mask:0xf bank_mask:0xf
 s_nop 1
 v_add_f32_dpp v113, v113, v113 row_half_mirror row_mask:0xf bank_mask:0xf
 v_mul_f32 v113, 0x3ae38e39, v113
 v_cvt_pk_bf16_f32 v114, v112, v112
 v_lshlrev_b32 v112, 16, v114
 v_cvt_pk_bf16_f32 v114, v113, v113
 v_lshlrev_b32 v113, 16, v114
 v_add_f32 v113, 0x3727c5ac, v113
 v_cvt_pk_bf16_f32 v114, v113, v113
 v_lshlrev_b32 v113, 16, v114
 v_sqrt_f32 v113, v113
 s_nop 0
 v_cvt_pk_bf16_f32 v114, v113, v113
 v_lshlrev_b32 v113, 16, v114
 v_rcp_f32 v113, v113
 s_nop 0
 v_sub_f32 v40, v40, v112
 v_sub_f32 v41, v41, v112
 v_cvt_pk_bf16_f32 v114, v40, v41
 v_lshlrev_b32 v40, 16, v114
 v_and_b32 v41, s61, v114
 v_mul_f32 v40, v40, v113
 v_mul_f32 v41, v41, v113
 v_cvt_pk_bf16_f32 v0, v40, v41
 v_sub_f32 v42, v42, v112
 v_sub_f32 v43, v43, v112
 v_cvt_pk_bf16_f32 v114, v42, v43
 v_lshlrev_b32 v42, 16, v114
 v_and_b32 v43, s61, v114
 v_mul_f32 v42, v42, v113
 v_mul_f32 v43, v43, v113
 v_cvt_pk_bf16_f32 v1, v42, v43
 v_sub_f32 v44, v44, v112
 v_sub_f32 v45, v45, v112
 v_cvt_pk_bf16_f32 v114, v44, v45
 v_lshlrev_b32 v44, 16, v114
 v_and_b32 v45, s61, v114
 v_mul_f32 v44, v44, v113
 v_mul_f32 v45, v45, v113
 v_cvt_pk_bf16_f32 v2, v44, v45
 v_sub_f32 v46, v46, v112
 v_sub_f32 v47, v47, v112
 v_cvt_pk_bf16_f32 v114, v46, v47
 v_lshlrev_b32 v46, 16, v114
 v_and_b32 v47, s61, v114
 v_mul_f32 v46, v46, v113
 v_mul_f32 v47, v47, v113
 v_cvt_pk_bf16_f32 v3, v46, v47
 v_sub_f32 v48, v48, v112
 v_sub_f32 v49, v49, v112
 v_cvt_pk_bf16_f32 v114, v48, v49
 v_lshlrev_b32 v48, 16, v114
 v_and_b32 v49, s61, v114
 v_mul_f32 v48, v48, v113
 v_mul_f32 v49, v49, v113
 v_cvt_pk_bf16_f32 v4, v48, v49
 v_sub_f32 v50, v50, v112
 v_sub_f32 v51, v51, v112
 v_cvt_pk_bf16_f32 v114, v50, v51
 v_lshlrev_b32 v50, 16, v114
 v_and_b32 v51, s61, v114
 v_mul_f32 v50, v50, v113
 v_mul_f32 v51, v51, v113
 v_cvt_pk_bf16_f32 v5, v50, v51
 v_sub_f32 v52, v52, v112
 v_sub_f32 v53, v53, v112
 v_cvt_pk_bf16_f32 v114, v52, v53
 v_lshlrev_b32 v52, 16, v114
 v_and_b32 v53, s61, v114
 v_mul_f32 v52, v52, v113
 v_mul_f32 v53, v53, v113
 v_cvt_pk_bf16_f32 v6, v52, v53
 v_sub_f32 v54, v54, v112
 v_sub_f32 v55, v55, v112
 v_cvt_pk_bf16_f32 v114, v54, v55
 v_lshlrev_b32 v54, 16, v114
 v_and_b32 v55, s61, v114
 v_mul_f32 v54, v54, v113
 v_mul_f32 v55, v55, v113
 v_cvt_pk_bf16_f32 v7, v54, v55
 v_sub_f32 v56, v56, v112
 v_sub_f32 v57, v57, v112
 v_cvt_pk_bf16_f32 v114, v56, v57
 v_lshlrev_b32 v56, 16, v114
 v_and_b32 v57, s61, v114
 v_mul_f32 v56, v56, v113
 v_mul_f32 v57, v57, v113
 v_cvt_pk_bf16_f32 v8, v56, v57
 v_sub_f32 v58, v58, v112
 v_sub_f32 v59, v59, v112
 v_cvt_pk_bf16_f32 v114, v58, v59
 v_lshlrev_b32 v58, 16, v114
 v_and_b32 v59, s61, v114
 v_mul_f32 v58, v58, v113
 v_mul_f32 v59, v59, v113
 v_cvt_pk_bf16_f32 v9, v58, v59
 v_sub_f32 v60, v60, v112
 v_sub_f32 v61, v61, v112
 v_cvt_pk_bf16_f32 v114, v60, v61
 v_lshlrev_b32 v60, 16, v114
 v_and_b32 v61, s61, v114
 v_mul_f32 v60, v60, v113
 v_mul_f32 v61, v61, v113
 v_cvt_pk_bf16_f32 v10, v60, v61
 v_sub_f32 v62, v62, v112
 v_sub_f32 v63, v63, v112
 v_cvt_pk_bf16_f32 v114, v62, v63
 v_lshlrev_b32 v62, 16, v114
 v_and_b32 v63, s61, v114
 v_mul_f32 v62, v62, v113
 v_mul_f32 v63, v63, v113
 v_cvt_pk_bf16_f32 v11, v62, v63
 v_sub_f32 v64, v64, v112
 v_sub_f32 v65, v65, v112
 v_cvt_pk_bf16_f32 v114, v64, v65
 v_lshlrev_b32 v64, 16, v114
 v_and_b32 v65, s61, v114
 v_mul_f32 v64, v64, v113
 v_mul_f32 v65, v65, v113
 v_cvt_pk_bf16_f32 v12, v64, v65
 v_sub_f32 v66, v66, v112
 v_sub_f32 v67, v67, v112
 v_cvt_pk_bf16_f32 v114, v66, v67
 v_lshlrev_b32 v66, 16, v114
 v_and_b32 v67, s61, v114
 v_mul_f32 v66, v66, v113
 v_mul_f32 v67, v67, v113
 v_cvt_pk_bf16_f32 v13, v66, v67
 v_sub_f32 v68, v68, v112
 v_sub_f32 v69, v69, v112
 v_cvt_pk_bf16_f32 v114, v68, v69
 v_lshlrev_b32 v68, 16, v114
 v_and_b32 v69, s61, v114
 v_mul_f32 v68, v68, v113
 v_mul_f32 v69, v69, v113
 v_cvt_pk_bf16_f32 v14, v68, v69
 v_sub_f32 v70, v70, v112
 v_sub_f32 v71, v71, v112
 v_cvt_pk_bf16_f32 v114, v70, v71
 v_lshlrev_b32 v70, 16, v114
 v_and_b32 v71, s61, v114
 v_mul_f32 v70, v70, v113
 v_mul_f32 v71, v71, v113
 v_cvt_pk_bf16_f32 v15, v70, v71
 v_sub_f32 v72, v72, v112
 v_sub_f32 v73, v73, v112
 v_cvt_pk_bf16_f32 v114, v72, v73
 v_lshlrev_b32 v72, 16, v114
 v_and_b32 v73, s61, v114
 v_mul_f32 v72, v72, v113
 v_mul_f32 v73, v73, v113
 v_cvt_pk_bf16_f32 v16, v72, v73
 v_sub_f32 v74, v74, v112
 v_sub_f32 v75, v75, v112
 v_cvt_pk_bf16_f32 v114, v74, v75
 v_lshlrev_b32 v74, 16, v114
 v_and_b32 v75, s61, v114
 v_mul_f32 v74, v74, v113
 v_mul_f32 v75, v75, v113
 v_cvt_pk_bf16_f32 v17, v74, v75
 v_sub_f32 v76, v76, v112
 v_sub_f32 v77, v77, v112
 v_cvt_pk_bf16_f32 v114, v76, v77
 v_lshlrev_b32 v76, 16, v114
 v_and_b32 v77, s61, v114
 v_mul_f32 v76, v76, v113
 v_mul_f32 v77, v77, v113
 v_cvt_pk_bf16_f32 v18, v76, v77
 v_sub_f32 v78, v78, v112
 v_sub_f32 v79, v79, v112
 v_cvt_pk_bf16_f32 v114, v78, v79
 v_lshlrev_b32 v78, 16, v114
 v_and_b32 v79, s61, v114
 v_mul_f32 v78, v78, v113
 v_mul_f32 v79, v79, v113
 v_cvt_pk_bf16_f32 v19, v78, v79
 v_sub_f32 v80, v80, v112
 v_sub_f32 v81, v81, v112
 v_cvt_pk_bf16_f32 v114, v80, v81
 v_lshlrev_b32 v80, 16, v114
 v_and_b32 v81, s61, v114
 v_mul_f32 v80, v80, v113
 v_mul_f32 v81, v81, v113
 v_cvt_pk_bf16_f32 v20, v80, v81
 v_sub_f32 v82, v82, v112
 v_sub_f32 v83, v83, v112
 v_cvt_pk_bf16_f32 v114, v82, v83
 v_lshlrev_b32 v82, 16, v114
 v_and_b32 v83, s61, v114
 v_mul_f32 v82, v82, v113
 v_mul_f32 v83, v83, v113
 v_cvt_pk_bf16_f32 v21, v82, v83
 v_sub_f32 v84, v84, v112
 v_sub_f32 v85, v85, v112
 v_cvt_pk_bf16_f32 v114, v84, v85
 v_lshlrev_b32 v84, 16, v114
 v_and_b32 v85, s61, v114
 v_mul_f32 v84, v84, v113
 v_mul_f32 v85, v85, v113
 v_cvt_pk_bf16_f32 v22, v84, v85
 v_sub_f32 v86, v86, v112
 v_sub_f32 v87, v87, v112
 v_cvt_pk_bf16_f32 v114, v86, v87
 v_lshlrev_b32 v86, 16, v114
 v_and_b32 v87, s61, v114
 v_mul_f32 v86, v86, v113
 v_mul_f32 v87, v87, v113
 v_cvt_pk_bf16_f32 v23, v86, v87
 v_sub_f32 v88, v88, v112
 v_sub_f32 v89, v89, v112
 v_cvt_pk_bf16_f32 v114, v88, v89
 v_lshlrev_b32 v88, 16, v114
 v_and_b32 v89, s61, v114
 v_mul_f32 v88, v88, v113
 v_mul_f32 v89, v89, v113
 v_cvt_pk_bf16_f32 v24, v88, v89
 v_sub_f32 v90, v90, v112
 v_sub_f32 v91, v91, v112
 v_cvt_pk_bf16_f32 v114, v90, v91
 v_lshlrev_b32 v90, 16, v114
 v_and_b32 v91, s61, v114
 v_mul_f32 v90, v90, v113
 v_mul_f32 v91, v91, v113
 v_cvt_pk_bf16_f32 v25, v90, v91
 v_sub_f32 v92, v92, v112
 v_sub_f32 v93, v93, v112
 v_cvt_pk_bf16_f32 v114, v92, v93
 v_lshlrev_b32 v92, 16, v114
 v_and_b32 v93, s61, v114
 v_mul_f32 v92, v92, v113
 v_mul_f32 v93, v93, v113
 v_cvt_pk_bf16_f32 v26, v92, v93
 v_sub_f32 v94, v94, v112
 v_sub_f32 v95, v95, v112
 v_cvt_pk_bf16_f32 v114, v94, v95
 v_lshlrev_b32 v94, 16, v114
 v_and_b32 v95, s61, v114
 v_mul_f32 v94, v94, v113
 v_mul_f32 v95, v95, v113
 v_cvt_pk_bf16_f32 v27, v94, v95
 v_sub_f32 v96, v96, v112
 v_sub_f32 v97, v97, v112
 v_cvt_pk_bf16_f32 v114, v96, v97
 v_lshlrev_b32 v96, 16, v114
 v_and_b32 v97, s61, v114
 v_mul_f32 v96, v96, v113
 v_mul_f32 v97, v97, v113
 v_cvt_pk_bf16_f32 v28, v96, v97
 v_sub_f32 v98, v98, v112
 v_sub_f32 v99, v99, v112
 v_cvt_pk_bf16_f32 v114, v98, v99
 v_lshlrev_b32 v98, 16, v114
 v_and_b32 v99, s61, v114
 v_mul_f32 v98, v98, v113
 v_mul_f32 v99, v99, v113
 v_cvt_pk_bf16_f32 v29, v98, v99
 v_sub_f32 v100, v100, v112
 v_sub_f32 v101, v101, v112
 v_cvt_pk_bf16_f32 v114, v100, v101
 v_lshlrev_b32 v100, 16, v114
 v_and_b32 v101, s61, v114
 v_mul_f32 v100, v100, v113
 v_mul_f32 v101, v101, v113
 v_cvt_pk_bf16_f32 v30, v100, v101
 v_sub_f32 v102, v102, v112
 v_sub_f32 v103, v103, v112
 v_cvt_pk_bf16_f32 v114, v102, v103
 v_lshlrev_b32 v102, 16, v114
 v_and_b32 v103, s61, v114
 v_mul_f32 v102, v102, v113
 v_mul_f32 v103, v103, v113
 v_cvt_pk_bf16_f32 v31, v102, v103
 v_sub_f32 v104, v104, v112
 v_sub_f32 v105, v105, v112
 v_cvt_pk_bf16_f32 v114, v104, v105
 v_lshlrev_b32 v104, 16, v114
 v_and_b32 v105, s61, v114
 v_mul_f32 v104, v104, v113
 v_mul_f32 v105, v105, v113
 v_cvt_pk_bf16_f32 v32, v104, v105
 v_sub_f32 v106, v106, v112
 v_sub_f32 v107, v107, v112
 v_cvt_pk_bf16_f32 v114, v106, v107
 v_lshlrev_b32 v106, 16, v114
 v_and_b32 v107, s61, v114
 v_mul_f32 v106, v106, v113
 v_mul_f32 v107, v107, v113
 v_cvt_pk_bf16_f32 v33, v106, v107
 v_sub_f32 v108, v108, v112
 v_sub_f32 v109, v109, v112
 v_cvt_pk_bf16_f32 v114, v108, v109
 v_lshlrev_b32 v108, 16, v114
 v_and_b32 v109, s61, v114
 v_mul_f32 v108, v108, v113
 v_mul_f32 v109, v109, v113
 v_cvt_pk_bf16_f32 v34, v108, v109
 v_sub_f32 v110, v110, v112
 v_sub_f32 v111, v111, v112
 v_cvt_pk_bf16_f32 v114, v110, v111
 v_lshlrev_b32 v110, 16, v114
 v_and_b32 v111, s61, v114
 v_mul_f32 v110, v110, v113
 v_mul_f32 v111, v111, v113
 v_cvt_pk_bf16_f32 v35, v110, v111
 s_add_u32 s61, s60, 0
 buffer_store_dwordx4 v[0:3], v117, s[4:7], s61 offen sc1
 s_add_u32 s61, s60, 4096
 buffer_store_dwordx4 v[4:7], v117, s[4:7], s61 offen sc1
 s_add_u32 s61, s60, 8192
 buffer_store_dwordx4 v[8:11], v117, s[4:7], s61 offen sc1
 s_add_u32 s61, s60, 12288
 buffer_store_dwordx4 v[12:15], v117, s[4:7], s61 offen sc1
 s_add_u32 s61, s60, 16384
 buffer_store_dwordx4 v[16:19], v117, s[4:7], s61 offen sc1
 s_add_u32 s61, s60, 20480
 buffer_store_dwordx4 v[20:23], v117, s[4:7], s61 offen sc1
 s_add_u32 s61, s60, 24576
 buffer_store_dwordx4 v[24:27], v117, s[4:7], s61 offen sc1
 s_add_u32 s61, s60, 28672
 buffer_store_dwordx4 v[28:31], v117, s[4:7], s61 offen sc1
 s_add_u32 s61, s60, 32768
 buffer_store_dwordx4 v[32:35], v117, s[4:7], s61 offen sc1
 s_waitcnt vmcnt(0)
 s_barrier
 s_cmp_eq_u32 s44, 0
 s_cbranch_scc0 L54
 s_lshl_b32 s60, s64, 2
 s_add_u32 s60, s60, 73408512
 s_mov_b32 s61, 1
 v_mov_b32 v6, 0
 v_mov_b32 v7, s61
 s_mov_b64 exec, 1
 buffer_store_dword v7, v6, s[4:7], s60 offen sc1
 s_mov_b64 exec, -1
L54:
L53:
 s_mov_b32 s48, s26
 s_mov_b32 s49, s27
 s_mov_b32 s50, 4718592
 s_mov_b32 s51, 0x20000
 s_mov_b32 s52, s16
 s_mov_b32 s53, s17
 s_mov_b32 s54, 2359296
 s_mov_b32 s55, 0x20000
 s_mul_i32 s67, s44, 5
 s_cmp_eq_u32 s44, 3
 s_cselect_b32 s67, 14, s67
 s_cmp_lt_u32 s44, 2
 s_cselect_b32 s68, 5, 4
 s_mul_i32 s66, s44, 40960
 v_mul_u32_u24 v6, 3277, v220
 v_lshrrev_b32 v6, 16, v6
 v_mul_u32_u24 v8, 20, v6
 v_sub_u32 v8, v220, v8
 v_mul_u32_u24 v6, 1152, v6
 v_lshlrev_b32 v8, 4, v8
 v_add_u32 v6, v6, v8
 s_mul_i32 s60, s46, 147456
 s_lshl_b32 s61, s67, 6
 s_add_u32 s60, s60, s61
 v_add_u32 v0, s60, v6
 v_lshrrev_b32 v6, 5, v220
 v_lshlrev_b32 v6, 3, v6
 v_bfe_u32 v8, v220, 2, 2
 v_add_u32 v6, v6, v8
 v_mul_u32_u24 v6, 320, v6
 v_bfe_u32 v8, v220, 4, 1
 v_lshlrev_b32 v8, 5, v8
 v_add_u32 v6, v6, v8
 v_and_b32 v8, 3, v220
 v_lshlrev_b32 v8, 3, v8
 v_add_u32 v6, v6, v8
 v_add_u32 v2, s66, v6
 s_barrier
 s_mov_b32 exec_lo, -1
 s_mov_b32 exec_hi, 0x0fffffff
 s_add_u32 m0, s66, 0
 s_mov_b32 s60, 0
 buffer_load_dwordx4 v0, s[48:51], s60 offen lds
 s_add_u32 m0, s66, 960
 s_mov_b32 s60, 3456
 buffer_load_dwordx4 v0, s[48:51], s60 offen lds
 s_add_u32 m0, s66, 1920
 s_mov_b32 s60, 6912
 buffer_load_dwordx4 v0, s[48:51], s60 offen lds
 s_add_u32 m0, s66, 2880
 s_mov_b32 s60, 10368
 buffer_load_dwordx4 v0, s[48:51], s60 offen lds
 s_add_u32 m0, s66, 3840
 s_mov_b32 s60, 13824
 buffer_load_dwordx4 v0, s[48:51], s60 offen lds
 s_add_u32 m0, s66, 4800
 s_mov_b32 s60, 17280
 buffer_load_dwordx4 v0, s[48:51], s60 offen lds
 s_add_u32 m0, s66, 5760
 s_mov_b32 s60, 20736
 buffer_load_dwordx4 v0, s[48:51], s60 offen lds
 s_add_u32 m0, s66, 6720
 s_mov_b32 s60, 24192
 buffer_load_dwordx4 v0, s[48:51], s60 offen lds
 s_add_u32 m0, s66, 7680
 s_mov_b32 s60, 27648
 buffer_load_dwordx4 v0, s[48:51], s60 offen lds
 s_add_u32 m0, s66, 8640
 s_mov_b32 s60, 31104
 buffer_load_dwordx4 v0, s[48:51], s60 offen lds
 s_add_u32 m0, s66, 9600
 s_mov_b32 s60, 34560
 buffer_load_dwordx4 v0, s[48:51], s60 offen lds
 s_add_u32 m0, s66, 10560
 s_mov_b32 s60, 38016
 buffer_load_dwordx4 v0, s[48:51], s60 offen lds
 s_add_u32 m0, s66, 11520
 s_mov_b32 s60, 41472
 buffer_load_dwordx4 v0, s[48:51], s60 offen lds
 s_add_u32 m0, s66, 12480
 s_mov_b32 s60, 44928
 buffer_load_dwordx4 v0, s[48:51], s60 offen lds
 s_add_u32 m0, s66, 13440
 s_mov_b32 s60, 48384
 buffer_load_dwordx4 v0, s[48:51], s60 offen lds
 s_add_u32 m0, s66, 14400
 s_mov_b32 s60, 51840
 buffer_load_dwordx4 v0, s[48:51], s60 offen lds
 s_add_u32 m0, s66, 15360
 s_mov_b32 s60, 55296
 buffer_load_dwordx4 v0, s[48:51], s60 offen lds
 s_add_u32 m0, s66, 16320
 s_mov_b32 s60, 58752
 buffer_load_dwordx4 v0, s[48:51], s60 offen lds
 s_add_u32 m0, s66, 17280
 s_mov_b32 s60, 62208
 buffer_load_dwordx4 v0, s[48:51], s60 offen lds
 s_add_u32 m0, s66, 18240
 s_mov_b32 s60, 65664
 buffer_load_dwordx4 v0, s[48:51], s60 offen lds
 s_add_u32 m0, s66, 19200
 s_mov_b32 s60, 69120
 buffer_load_dwordx4 v0, s[48:51], s60 offen lds
 s_add_u32 m0, s66, 20160
 s_mov_b32 s60, 72576
 buffer_load_dwordx4 v0, s[48:51], s60 offen lds
 s_add_u32 m0, s66, 21120
 s_mov_b32 s60, 76032
 buffer_load_dwordx4 v0, s[48:51], s60 offen lds
 s_add_u32 m0, s66, 22080
 s_mov_b32 s60, 79488
 buffer_load_dwordx4 v0, s[48:51], s60 offen lds
 s_add_u32 m0, s66, 23040
 s_mov_b32 s60, 82944
 buffer_load_dwordx4 v0, s[48:51], s60 offen lds
 s_add_u32 m0, s66, 24000
 s_mov_b32 s60, 86400
 buffer_load_dwordx4 v0, s[48:51], s60 offen lds
 s_add_u32 m0, s66, 24960
 s_mov_b32 s60, 89856
 buffer_load_dwordx4 v0, s[48:51], s60 offen lds
 s_add_u32 m0, s66, 25920
 s_mov_b32 s60, 93312
 buffer_load_dwordx4 v0, s[48:51], s60 offen lds
 s_add_u32 m0, s66, 26880
 s_mov_b32 s60, 96768
 buffer_load_dwordx4 v0, s[48:51], s60 offen lds
 s_add_u32 m0, s66, 27840
 s_mov_b32 s60, 100224
 buffer_load_dwordx4 v0, s[48:51], s60 offen lds
 s_add_u32 m0, s66, 28800
 s_mov_b32 s60, 103680
 buffer_load_dwordx4 v0, s[48:51], s60 offen lds
 s_add_u32 m0, s66, 29760
 s_mov_b32 s60, 107136
 buffer_load_dwordx4 v0, s[48:51], s60 offen lds
 s_add_u32 m0, s66, 30720
 s_mov_b32 s60, 110592
 buffer_load_dwordx4 v0, s[48:51], s60 offen lds
 s_add_u32 m0, s66, 31680
 s_mov_b32 s60, 114048
 buffer_load_dwordx4 v0, s[48:51], s60 offen lds
 s_add_u32 m0, s66, 32640
 s_mov_b32 s60, 117504
 buffer_load_dwordx4 v0, s[48:51], s60 offen lds
 s_add_u32 m0, s66, 33600
 s_mov_b32 s60, 120960
 buffer_load_dwordx4 v0, s[48:51], s60 offen lds
 s_add_u32 m0, s66, 34560
 s_mov_b32 s60, 124416
 buffer_load_dwordx4 v0, s[48:51], s60 offen lds
 s_add_u32 m0, s66, 35520
 s_mov_b32 s60, 127872
 buffer_load_dwordx4 v0, s[48:51], s60 offen lds
 s_add_u32 m0, s66, 36480
 s_mov_b32 s60, 131328
 buffer_load_dwordx4 v0, s[48:51], s60 offen lds
 s_add_u32 m0, s66, 37440
 s_mov_b32 s60, 134784
 buffer_load_dwordx4 v0, s[48:51], s60 offen lds
 s_add_u32 m0, s66, 38400
 s_mov_b32 s60, 138240
 buffer_load_dwordx4 v0, s[48:51], s60 offen lds
 s_add_u32 m0, s66, 39360
 s_mov_b32 s60, 141696
 buffer_load_dwordx4 v0, s[48:51], s60 offen lds
 s_mov_b32 exec_hi, 0xff
 s_add_u32 m0, s66, 40320
 s_mov_b32 s60, 145152
 buffer_load_dwordx4 v0, s[48:51], s60 offen lds
 s_mov_b64 exec, -1
 s_waitcnt vmcnt(0)
 ds_read_b64_tr_b16 a[0:1], v2 offset:0
 ds_read_b64_tr_b16 a[2:3], v2 offset:1280
 ds_read_b64_tr_b16 a[4:5], v2 offset:5120
 ds_read_b64_tr_b16 a[6:7], v2 offset:6400
 ds_read_b64_tr_b16 a[8:9], v2 offset:10240
 ds_read_b64_tr_b16 a[10:11], v2 offset:11520
 ds_read_b64_tr_b16 a[12:13], v2 offset:15360
 ds_read_b64_tr_b16 a[14:15], v2 offset:16640
 ds_read_b64_tr_b16 a[16:17], v2 offset:20480
 ds_read_b64_tr_b16 a[18:19], v2 offset:21760
 ds_read_b64_tr_b16 a[20:21], v2 offset:25600
 ds_read_b64_tr_b16 a[22:23], v2 offset:26880
 ds_read_b64_tr_b16 a[24:25], v2 offset:30720
 ds_read_b64_tr_b16 a[26:27], v2 offset:32000
 ds_read_b64_tr_b16 a[28:29], v2 offset:35840
 ds_read_b64_tr_b16 a[30:31], v2 offset:37120
 s_waitcnt lgkmcnt(0)
 ds_read_b64_tr_b16 a[32:33], v2 offset:64
 ds_read_b64_tr_b16 a[34:35], v2 offset:1344
 ds_read_b64_tr_b16 a[36:37], v2 offset:5184
 ds_read_b64_tr_b16 a[38:39], v2 offset:6464
 ds_read_b64_tr_b16 a[40:41], v2 offset:10304
 ds_read_b64_tr_b16 a[42:43], v2 offset:11584
 ds_read_b64_tr_b16 a[44:45], v2 offset:15424
 ds_read_b64_tr_b16 a[46:47], v2 offset:16704
 ds_read_b64_tr_b16 a[48:49], v2 offset:20544
 ds_read_b64_tr_b16 a[50:51], v2 offset:21824
 ds_read_b64_tr_b16 a[52:53], v2 offset:25664
 ds_read_b64_tr_b16 a[54:55], v2 offset:26944
 ds_read_b64_tr_b16 a[56:57], v2 offset:30784
 ds_read_b64_tr_b16 a[58:59], v2 offset:32064
 ds_read_b64_tr_b16 a[60:61], v2 offset:35904
 ds_read_b64_tr_b16 a[62:63], v2 offset:37184
 s_waitcnt lgkmcnt(0)
 ds_read_b64_tr_b16 a[64:65], v2 offset:128
 ds_read_b64_tr_b16 a[66:67], v2 offset:1408
 ds_read_b64_tr_b16 a[68:69], v2 offset:5248
 ds_read_b64_tr_b16 a[70:71], v2 offset:6528
 ds_read_b64_tr_b16 a[72:73], v2 offset:10368
 ds_read_b64_tr_b16 a[74:75], v2 offset:11648
 ds_read_b64_tr_b16 a[76:77], v2 offset:15488
 ds_read_b64_tr_b16 a[78:79], v2 offset:16768
 ds_read_b64_tr_b16 a[80:81], v2 offset:20608
 ds_read_b64_tr_b16 a[82:83], v2 offset:21888
 ds_read_b64_tr_b16 a[84:85], v2 offset:25728
 ds_read_b64_tr_b16 a[86:87], v2 offset:27008
 ds_read_b64_tr_b16 a[88:89], v2 offset:30848
 ds_read_b64_tr_b16 a[90:91], v2 offset:32128
 ds_read_b64_tr_b16 a[92:93], v2 offset:35968
 ds_read_b64_tr_b16 a[94:95], v2 offset:37248
 s_waitcnt lgkmcnt(0)
 ds_read_b64_tr_b16 a[96:97], v2 offset:192
 ds_read_b64_tr_b16 a[98:99], v2 offset:1472
 ds_read_b64_tr_b16 a[100:101], v2 offset:5312
 ds_read_b64_tr_b16 a[102:103], v2 offset:6592
 ds_read_b64_tr_b16 a[104:105], v2 offset:10432
 ds_read_b64_tr_b16 a[106:107], v2 offset:11712
 ds_read_b64_tr_b16 a[108:109], v2 offset:15552
 ds_read_b64_tr_b16 a[110:111], v2 offset:16832
 ds_read_b64_tr_b16 a[112:113], v2 offset:20672
 ds_read_b64_tr_b16 a[114:115], v2 offset:21952
 ds_read_b64_tr_b16 a[116:117], v2 offset:25792
 ds_read_b64_tr_b16 a[118:119], v2 offset:27072
 ds_read_b64_tr_b16 a[120:121], v2 offset:30912
 ds_read_b64_tr_b16 a[122:123], v2 offset:32192
 ds_read_b64_tr_b16 a[124:125], v2 offset:36032
 ds_read_b64_tr_b16 a[126:127], v2 offset:37312
 s_waitcnt lgkmcnt(0)
 ds_read_b64_tr_b16 a[128:129], v2 offset:256
 ds_read_b64_tr_b16 a[130:131], v2 offset:1536
 ds_read_b64_tr_b16 a[132:133], v2 offset:5376
 ds_read_b64_tr_b16 a[134:135], v2 offset:6656
 ds_read_b64_tr_b16 a[136:137], v2 offset:10496
 ds_read_b64_tr_b16 a[138:139], v2 offset:11776
 ds_read_b64_tr_b16 a[140:141], v2 offset:15616
 ds_read_b64_tr_b16 a[142:143], v2 offset:16896
 ds_read_b64_tr_b16 a[144:145], v2 offset:20736
 ds_read_b64_tr_b16 a[146:147], v2 offset:22016
 ds_read_b64_tr_b16 a[148:149], v2 offset:25856
 ds_read_b64_tr_b16 a[150:151], v2 offset:27136
 ds_read_b64_tr_b16 a[152:153], v2 offset:30976
 ds_read_b64_tr_b16 a[154:155], v2 offset:32256
 ds_read_b64_tr_b16 a[156:157], v2 offset:36096
 ds_read_b64_tr_b16 a[158:159], v2 offset:37376
 s_waitcnt lgkmcnt(0)
 s_mov_b32 s24, s20
 s_mov_b32 s25, s21
 s_mov_b32 s26, 4718592
 s_mov_b32 s27, 0x20000
 s_barrier
 v_lshrrev_b32 v6, 2, v220
 v_lshlrev_b32 v6, 13, v6
 v_and_b32 v7, 3, v220
 v_lshlrev_b32 v8, 4, v7
 v_add_u32 v6, v6, v8
 s_lshl_b32 s60, s46, 8
 s_lshl_b32 s61, s44, 6
 s_add_u32 s60, s60, s61
 v_add_u32 v0, s60, v6
 v_lshrrev_b32 v6, 5, v220
 v_lshlrev_b32 v6, 3, v6
 v_bfe_u32 v8, v220, 2, 2
 v_add_u32 v6, v6, v8
 v_lshlrev_b32 v6, 6, v6
 v_bfe_u32 v8, v220, 4, 1
 v_lshlrev_b32 v8, 5, v8
 v_add_u32 v6, v6, v8
 v_lshlrev_b32 v7, 3, v7
 v_add_u32 v6, v6, v7
 s_mul_i32 s60, s44, 12288
 v_add_u32 v2, s60, v6
 s_add_u32 s61, s60, 62464
 v_add_u32 v217, s61, v221
 s_mov_b32 s66, s60
 s_add_u32 m0, s66, 0
 s_mov_b32 s60, 0
 buffer_load_dwordx4 v0, s[24:27], s60 offen lds
 s_add_u32 m0, s66, 1024
 s_mov_b32 s60, 131072
 buffer_load_dwordx4 v0, s[24:27], s60 offen lds
 s_add_u32 m0, s66, 2048
 s_mov_b32 s60, 262144
 buffer_load_dwordx4 v0, s[24:27], s60 offen lds
 s_add_u32 m0, s66, 3072
 s_mov_b32 s60, 393216
 buffer_load_dwordx4 v0, s[24:27], s60 offen lds
 s_add_u32 m0, s66, 4096
 s_mov_b32 s60, 524288
 buffer_load_dwordx4 v0, s[24:27], s60 offen lds
 s_add_u32 m0, s66, 5120
 s_mov_b32 s60, 655360
 buffer_load_dwordx4 v0, s[24:27], s60 offen lds
 s_add_u32 m0, s66, 6144
 s_mov_b32 s60, 786432
 buffer_load_dwordx4 v0, s[24:27], s60 offen lds
 s_add_u32 m0, s66, 7168
 s_mov_b32 s60, 917504
 buffer_load_dwordx4 v0, s[24:27], s60 offen lds
 s_add_u32 m0, s66, 8192
 s_mov_b32 s60, 1048576
 buffer_load_dwordx4 v0, s[24:27], s60 offen lds
 s_add_u32 m0, s66, 9216
 s_mov_b32 s60, 1179648
 buffer_load_dwordx4 v0, s[24:27], s60 offen lds
 s_add_u32 m0, s66, 10240
 s_mov_b32 s60, 1310720
 buffer_load_dwordx4 v0, s[24:27], s60 offen lds
 s_add_u32 m0, s66, 11264
 s_mov_b32 s60, 1441792
 buffer_load_dwordx4 v0, s[24:27], s60 offen lds
 s_waitcnt vmcnt(8)
 ds_read_b64_tr_b16 a[160:161], v2 offset:0
 ds_read_b64_tr_b16 a[162:163], v2 offset:256
 ds_read_b64_tr_b16 a[164:165], v2 offset:1024
 ds_read_b64_tr_b16 a[166:167], v2 offset:1280
 ds_read_b64_tr_b16 a[168:169], v2 offset:2048
 ds_read_b64_tr_b16 a[170:171], v2 offset:2304
 ds_read_b64_tr_b16 a[172:173], v2 offset:3072
 ds_read_b64_tr_b16 a[174:175], v2 offset:3328
 s_waitcnt lgkmcnt(0)
 s_add_u32 m0, s66, 0
 s_mov_b32 s60, 1572864
 buffer_load_dwordx4 v0, s[24:27], s60 offen lds
 s_add_u32 m0, s66, 1024
 s_mov_b32 s60, 1703936
 buffer_load_dwordx4 v0, s[24:27], s60 offen lds
 s_add_u32 m0, s66, 2048
 s_mov_b32 s60, 1835008
 buffer_load_dwordx4 v0, s[24:27], s60 offen lds
 s_add_u32 m0, s66, 3072
 s_mov_b32 s60, 1966080
 buffer_load_dwordx4 v0, s[24:27], s60 offen lds
 s_waitcnt vmcnt(8)
 ds_read_b64_tr_b16 a[176:177], v2 offset:4096
 ds_read_b64_tr_b16 a[178:179], v2 offset:4352
 ds_read_b64_tr_b16 a[180:181], v2 offset:5120
 ds_read_b64_tr_b16 a[182:183], v2 offset:5376
 ds_read_b64_tr_b16 a[184:185], v2 offset:6144
 ds_read_b64_tr_b16 a[186:187], v2 offset:6400
 ds_read_b64_tr_b16 a[188:189], v2 offset:7168
 ds_read_b64_tr_b16 a[190:191], v2 offset:7424
 s_waitcnt lgkmcnt(0)
 s_add_u32 m0, s66, 4096
 s_mov_b32 s60, 2097152
 buffer_load_dwordx4 v0, s[24:27], s60 offen lds
 s_add_u32 m0, s66, 5120
 s_mov_b32 s60, 2228224
 buffer_load_dwordx4 v0, s[24:27], s60 offen lds
 s_add_u32 m0, s66, 6144
 s_mov_b32 s60, 2359296
 buffer_load_dwordx4 v0, s[24:27], s60 offen lds
 s_add_u32 m0, s66, 7168
 s_mov_b32 s60, 2490368
 buffer_load_dwordx4 v0, s[24:27], s60 offen lds
 s_waitcnt vmcnt(8)
 ds_read_b64_tr_b16 a[192:193], v2 offset:8192
 ds_read_b64_tr_b16 a[194:195], v2 offset:8448
 ds_read_b64_tr_b16 a[196:197], v2 offset:9216
 ds_read_b64_tr_b16 a[198:199], v2 offset:9472
 ds_read_b64_tr_b16 a[200:201], v2 offset:10240
 ds_read_b64_tr_b16 a[202:203], v2 offset:10496
 ds_read_b64_tr_b16 a[204:205], v2 offset:11264
 ds_read_b64_tr_b16 a[206:207], v2 offset:11520
 s_waitcnt lgkmcnt(0)
 s_add_u32 m0, s66, 8192
 s_mov_b32 s60, 2621440
 buffer_load_dwordx4 v0, s[24:27], s60 offen lds
 s_add_u32 m0, s66, 9216
 s_mov_b32 s60, 2752512
 buffer_load_dwordx4 v0, s[24:27], s60 offen lds
 s_add_u32 m0, s66, 10240
 s_mov_b32 s60, 2883584
 buffer_load_dwordx4 v0, s[24:27], s60 offen lds
 s_add_u32 m0, s66, 11264
 s_mov_b32 s60, 3014656
 buffer_load_dwordx4 v0, s[24:27], s60 offen lds
 s_waitcnt vmcnt(8)
 ds_read_b64_tr_b16 a[208:209], v2 offset:0
 ds_read_b64_tr_b16 a[210:211], v2 offset:256
 ds_read_b64_tr_b16 a[212:213], v2 offset:1024
 ds_read_b64_tr_b16 a[214:215], v2 offset:1280
 ds_read_b64_tr_b16 a[216:217], v2 offset:2048
 ds_read_b64_tr_b16 a[218:219], v2 offset:2304
 ds_read_b64_tr_b16 a[220:221], v2 offset:3072
 ds_read_b64_tr_b16 a[222:223], v2 offset:3328
 s_waitcnt lgkmcnt(0)
 s_add_u32 m0, s66, 0
 s_mov_b32 s60, 3145728
 buffer_load_dwordx4 v0, s[24:27], s60 offen lds
 s_add_u32 m0, s66, 1024
 s_mov_b32 s60, 3276800
 buffer_load_dwordx4 v0, s[24:27], s60 offen lds
 s_add_u32 m0, s66, 2048
 s_mov_b32 s60, 3407872
 buffer_load_dwordx4 v0, s[24:27], s60 offen lds
 s_add_u32 m0, s66, 3072
 s_mov_b32 s60, 3538944
 buffer_load_dwordx4 v0, s[24:27], s60 offen lds
 s_waitcnt vmcnt(8)
 ds_read_b64_tr_b16 a[224:225], v2 offset:4096
 ds_read_b64_tr_b16 a[226:227], v2 offset:4352
 ds_read_b64_tr_b16 a[228:229], v2 offset:5120
 ds_read_b64_tr_b16 a[230:231], v2 offset:5376
 ds_read_b64_tr_b16 a[232:233], v2 offset:6144
 ds_read_b64_tr_b16 a[234:235], v2 offset:6400
 ds_read_b64_tr_b16 a[236:237], v2 offset:7168
 ds_read_b64_tr_b16 a[238:239], v2 offset:7424
 s_waitcnt lgkmcnt(0)
 s_add_u32 m0, s66, 4096
 s_mov_b32 s60, 3670016
 buffer_load_dwordx4 v0, s[24:27], s60 offen lds
 s_add_u32 m0, s66, 5120
 s_mov_b32 s60, 3801088
 buffer_load_dwordx4 v0, s[24:27], s60 offen lds
 s_add_u32 m0, s66, 6144
 s_mov_b32 s60, 3932160
 buffer_load_dwordx4 v0, s[24:27], s60 offen lds
 s_add_u32 m0, s66, 7168
 s_mov_b32 s60, 4063232
 buffer_load_dwordx4 v0, s[24:27], s60 offen lds
 s_waitcnt vmcnt(8)
 ds_read_b64_tr_b16 a[240:241], v2 offset:8192
 ds_read_b64_tr_b16 a[242:243], v2 offset:8448
 ds_read_b64_tr_b16 a[244:245], v2 offset:9216
 ds_read_b64_tr_b16 a[246:247], v2 offset:9472
 ds_read_b64_tr_b16 a[248:249], v2 offset:10240
 ds_read_b64_tr_b16 a[250:251], v2 offset:10496
 ds_read_b64_tr_b16 a[252:253], v2 offset:11264
 ds_read_b64_tr_b16 a[254:255], v2 offset:11520
 s_waitcnt lgkmcnt(0)
 s_add_u32 m0, s66, 8192
 s_mov_b32 s60, 4194304
 buffer_load_dwordx4 v0, s[24:27], s60 offen lds
 s_add_u32 m0, s66, 9216
 s_mov_b32 s60, 4325376
 buffer_load_dwordx4 v0, s[24:27], s60 offen lds
 s_add_u32 m0, s66, 10240
 s_mov_b32 s60, 4456448
 buffer_load_dwordx4 v0, s[24:27], s60 offen lds
 s_add_u32 m0, s66, 11264
 s_mov_b32 s60, 4587520
 buffer_load_dwordx4 v0, s[24:27], s60 offen lds
 s_waitcnt vmcnt(8)
 ds_read_b64_tr_b16 v[16:17], v2 offset:0
 ds_read_b64_tr_b16 v[18:19], v2 offset:256
 ds_read_b64_tr_b16 v[20:21], v2 offset:1024
 ds_read_b64_tr_b16 v[22:23], v2 offset:1280
 ds_read_b64_tr_b16 v[24:25], v2 offset:2048
 ds_read_b64_tr_b16 v[26:27], v2 offset:2304
 ds_read_b64_tr_b16 v[28:29], v2 offset:3072
 ds_read_b64_tr_b16 v[30:31], v2 offset:3328
 s_waitcnt lgkmcnt(0)
 ds_write_b128 v217, v[16:19] offset:0
 ds_write_b128 v217, v[20:23] offset:1024
 ds_write_b128 v217, v[24:27] offset:2048
 ds_write_b128 v217, v[28:31] offset:3072
 s_waitcnt lgkmcnt(0)
 s_waitcnt vmcnt(4)
 ds_read_b64_tr_b16 v[16:17], v2 offset:4096
 ds_read_b64_tr_b16 v[18:19], v2 offset:4352
 ds_read_b64_tr_b16 v[20:21], v2 offset:5120
 ds_read_b64_tr_b16 v[22:23], v2 offset:5376
 ds_read_b64_tr_b16 v[24:25], v2 offset:6144
 ds_read_b64_tr_b16 v[26:27], v2 offset:6400
 ds_read_b64_tr_b16 v[28:29], v2 offset:7168
 ds_read_b64_tr_b16 v[30:31], v2 offset:7424
 s_waitcnt lgkmcnt(0)
 ds_write_b128 v217, v[16:19] offset:4096
 ds_write_b128 v217, v[20:23] offset:5120
 ds_write_b128 v217, v[24:27] offset:6144
 ds_write_b128 v217, v[28:31] offset:7168
 s_waitcnt lgkmcnt(0)
 s_waitcnt vmcnt(0)
 ds_read_b64_tr_b16 v[16:17], v2 offset:8192
 ds_read_b64_tr_b16 v[18:19], v2 offset:8448
 ds_read_b64_tr_b16 v[20:21], v2 offset:9216
 ds_read_b64_tr_b16 v[22:23], v2 offset:9472
 ds_read_b64_tr_b16 v[24:25], v2 offset:10240
 ds_read_b64_tr_b16 v[26:27], v2 offset:10496
 ds_read_b64_tr_b16 v[28:29], v2 offset:11264
 ds_read_b64_tr_b16 v[30:31], v2 offset:11520
 s_waitcnt lgkmcnt(0)
 ds_write_b128 v217, v[16:19] offset:8192
 ds_write_b128 v217, v[20:23] offset:9216
 ds_write_b128 v217, v[24:27] offset:10240
 ds_write_b128 v217, v[28:31] offset:11264
 s_waitcnt lgkmcnt(0)
 s_barrier
 v_min_u32 v6, 8, v220
 v_lshlrev_b32 v6, 2, v6
L55:
 buffer_load_dword v7, v6, s[8:11], 0 offen offset:64 sc1
 s_waitcnt vmcnt(0)
 v_cmp_eq_u32 vcc, 1, v7
 s_nop 3
 s_and_b32 s60, vcc_lo, 0x1ff
 s_cmp_ge_u32 s60, 0x100
 s_cbranch_scc1 L_FALLBACK
 s_cmp_eq_u32 s60, 0xff
 s_cbranch_scc0 L55
 v_and_b32 v6, 31, v220
 v_mul_u32_u24 v6, 1168, v6
 v_lshrrev_b32 v218, 5, v220
 v_lshlrev_b32 v218, 4, v218
 v_add_u32 v218, v218, v6
 v_add_u32 v218, 114688, v218
 v_lshrrev_b32 v6, 4, v220
 s_lshl_b32 s60, s44, 3
 v_add_u32 v6, s60, v6
 v_mul_u32_u24 v6, 1152, v6
 v_and_b32 v223, 15, v220
 v_lshlrev_b32 v223, 4, v223
 v_add_u32 v223, v223, v6
 s_mul_i32 s60, s46, 36864
 v_add_u32 v223, s60, v223
 v_lshrrev_b32 v6, 4, v220
 v_lshlrev_b32 v6, 7, v6
 v_bfe_u32 v224, v220, 2, 1
 v_lshlrev_b32 v224, 5, v224
 v_add_u32 v224, v224, v6
 v_and_b32 v6, 3, v220
 v_lshlrev_b32 v6, 2, v6
 v_add_u32 v224, v224, v6
 s_mul_i32 s60, s44, 2304
 v_add_u32 v224, s60, v224
 v_lshlrev_b32 v225, 5, v220
 v_and_b32 v6, 15, v220
 v_mov_b32 v9, 0x3f80
 v_subrev_u32 v7, 0, v6
 v_lshlrev_b32 v8, 4, v7
 v_cmp_gt_u32 vcc, 2, v7
 v_lshlrev_b32 v8, v8, v9
 s_nop 0
 v_cndmask_b32 v228, 0, v8, vcc
 v_subrev_u32 v7, 2, v6
 v_lshlrev_b32 v8, 4, v7
 v_cmp_gt_u32 vcc, 2, v7
 v_lshlrev_b32 v8, v8, v9
 s_nop 0
 v_cndmask_b32 v229, 0, v8, vcc
 v_subrev_u32 v7, 4, v6
 v_lshlrev_b32 v8, 4, v7
 v_cmp_gt_u32 vcc, 2, v7
 v_lshlrev_b32 v8, v8, v9
 s_nop 0
 v_cndmask_b32 v230, 0, v8, vcc
 v_subrev_u32 v7, 6, v6
 v_lshlrev_b32 v8, 4, v7
 v_cmp_gt_u32 vcc, 2, v7
 v_lshlrev_b32 v8, v8, v9
 s_nop 0
 v_cndmask_b32 v231, 0, v8, vcc
 s_and_b32 s60, s44, 1
 s_lshl_b32 s60, s60, 4
 v_and_b32 v6, 15, v220
 v_add_u32 v6, s60, v6
 v_lshrrev_b32 v7, 4, v220
 v_lshlrev_b32 v8, 2, v7
 v_sub_u32 v8, v6, v8
 v_cmp_le_i32 s[76:77], 0, v8
 v_cmp_le_i32 s[78:79], 1, v8
 v_cmp_le_i32 s[80:81], 2, v8
 v_cmp_le_i32 s[82:83], 3, v8
 v_cmp_le_i32 s[84:85], 16, v8
 v_cmp_le_i32 s[86:87], 17, v8
 v_cmp_le_i32 s[88:89], 18, v8
 v_cmp_le_i32 s[90:91], 19, v8
 v_lshlrev_b32 v6, 4, v6
 v_lshrrev_b32 v8, 1, v7
 v_lshlrev_b32 v8, 9, v8
 v_add_u32 v6, v6, v8
 v_and_b32 v8, 1, v7
 v_lshlrev_b32 v8, 3, v8
 v_add_u32 v6, v6, v8
 s_lshr_b32 s60, s44, 1
 s_lshl_b32 s60, s60, 12
 v_add_u32 v226, s60, v6
 v_cmp_gt_u32 vcc, 32, v220
 v_mov_b32 v6, 1.0
 v_mov_b32 v8, 0
 v_cndmask_b32 v227, v8, v6, vcc
 s_mov_b32 s92, -1
 s_mov_b32 s93, 0
 s_mov_b32 s94, 0x3db504f3
 s_mov_b32 s95, 0x3fb8aa3b
 s_mov_b32 s96, 0xffff0000
 s_mov_b32 s64, s47
 s_mov_b32 s65, 0
 s_mov_b32 s69, 0
 s_mov_b32 s97, 0
 s_mov_b32 s20, -1
 s_mov_b32 s21, 1
 v_lshlrev_b32 v6, 2, v220
 s_mov_b32 s60, 73408512
L56:
 buffer_load_dword v7, v6, s[4:7], s60 offen sc1
 s_waitcnt vmcnt(0)
 v_cmp_ne_u32 vcc, 1, v7
 s_cbranch_vccnz L56
 v_and_b32 v1, 15, v220
 v_lshlrev_b32 v1, 4, v1
 v_bfe_u32 v2, v220, 4, 1
 v_lshlrev_b32 v2, 12, v2
 v_add_u32 v1, v1, v2
 v_lshrrev_b32 v2, 5, v220
 v_lshlrev_b32 v3, 9, v2
 v_add_u32 v1, v1, v3
 s_lshl_b32 s60, s44, 10
 s_add_u32 s60, s60, 54272
 v_add_u32 v216, s60, v1
 s_cmp_lt_u32 s64, s69
 s_cbranch_scc1 L57
 s_lshl_b32 s60, s46, 6
 s_add_u32 s60, s60, 73400320
 v_mov_b32 v232, 0
L58:
 buffer_load_dword v233, v232, s[4:7], s60 offen sc1
 s_waitcnt vmcnt(0)
 v_readfirstlane_b32 s69, v233
 s_cmp_lt_u32 s64, s69
 s_cbranch_scc0 L58
L57:
 s_lshl_b32 s16, s64, 5
 s_add_u32 s16, s16, s46
 s_lshl_b32 s17, s16, 14
 s_add_u32 s17, s17, 20971520
 s_mul_i32 s22, s64, 36864
 s_mul_i32 s23, s44, 9216
 s_add_u32 s22, s22, s23
 s_add_u32 s22, s22, 0
 s_add_u32 s23, s23, 17408
 s_add_u32 s18, s17, 4096
 s_lshr_b32 s62, s44, 1
 s_lshl_b32 s62, s62, 12
 s_add_u32 s19, s17, s62
 s_add_u32 s19, s19, 8192
 s_add_u32 m0, s23, 0
 s_add_u32 s62, s22, 0
 buffer_load_dwordx4 v221, s[4:7], s62 offen sc1 lds
 s_add_u32 m0, s23, 1024
 s_add_u32 s62, s22, 1024
 buffer_load_dwordx4 v221, s[4:7], s62 offen sc1 lds
 s_add_u32 m0, s23, 2048
 s_add_u32 s62, s22, 2048
 buffer_load_dwordx4 v221, s[4:7], s62 offen sc1 lds
 s_add_u32 m0, s23, 3072
 s_add_u32 s62, s22, 3072
 buffer_load_dwordx4 v221, s[4:7], s62 offen sc1 lds
 s_add_u32 m0, s23, 4096
 s_add_u32 s62, s22, 4096
 buffer_load_dwordx4 v221, s[4:7], s62 offen sc1 lds
 s_add_u32 m0, s23, 5120
 s_add_u32 s62, s22, 5120
 buffer_load_dwordx4 v221, s[4:7], s62 offen sc1 lds
 s_add_u32 m0, s23, 6144
 s_add_u32 s62, s22, 6144
 buffer_load_dwordx4 v221, s[4:7], s62 offen sc1 lds
 s_add_u32 m0, s23, 7168
 s_add_u32 s62, s22, 7168
 buffer_load_dwordx4 v221, s[4:7], s62 offen sc1 lds
 s_add_u32 m0, s23, 8192
 s_add_u32 s62, s22, 8192
 buffer_load_dwordx4 v221, s[4:7], s62 offen sc1 lds
 buffer_load_dwordx4 v[16:19], v221, s[4:7], s17 offen offset:0 sc1
 buffer_load_dwordx4 v[20:23], v221, s[4:7], s17 offen offset:1024 sc1
 buffer_load_dwordx4 v[24:27], v221, s[4:7], s17 offen offset:2048 sc1
 buffer_load_dwordx4 v[28:31], v221, s[4:7], s17 offen offset:3072 sc1
 buffer_load_dwordx4 v[32:35], v221, s[4:7], s18 offen offset:0 sc1
 buffer_load_dwordx4 v[36:39], v221, s[4:7], s18 offen offset:1024 sc1
 buffer_load_dwordx4 v[40:43], v221, s[4:7], s18 offen offset:2048 sc1
 buffer_load_dwordx4 v[44:47], v221, s[4:7], s18 offen offset:3072 sc1
 buffer_load_dwordx4 v[64:67], v221, s[4:7], s19 offen offset:0 sc1
 buffer_load_dwordx4 v[68:71], v221, s[4:7], s19 offen offset:1024 sc1
 buffer_load_dwordx4 v[72:75], v221, s[4:7], s19 offen offset:2048 sc1
 buffer_load_dwordx4 v[76:79], v221, s[4:7], s19 offen offset:3072 sc1
 s_waitcnt vmcnt(0)
 s_barrier
 ds_read_b128 v[192:195], v221 offset:17408
 ds_read_b128 v[196:199], v221 offset:18432
 s_waitcnt lgkmcnt(1)
 v_mfma_f32_32x32x16_bf16 v[152:167], a[160:163], v[192:195], 0
 ds_read_b128 v[200:203], v221 offset:19456
 s_waitcnt lgkmcnt(1)
 v_mfma_f32_32x32x16_bf16 v[152:167], a[164:167], v[196:199], v[152:167]
 ds_read_b128 v[192:195], v221 offset:20480
 s_waitcnt lgkmcnt(1)
 v_mfma_f32_32x32x16_bf16 v[152:167], a[168:171], v[200:203], v[152:167]
 ds_read_b128 v[196:199], v221 offset:21504
 s_waitcnt lgkmcnt(1)
 v_mfma_f32_32x32x16_bf16 v[152:167], a[172:175], v[192:195], v[152:167]
 ds_read_b128 v[200:203], v221 offset:22528
 s_waitcnt lgkmcnt(1)
 v_mfma_f32_32x32x16_bf16 v[152:167], a[176:179], v[196:199], v[152:167]
 ds_read_b128 v[192:195], v221 offset:23552
 s_waitcnt lgkmcnt(1)
 v_mfma_f32_32x32x16_bf16 v[152:167], a[180:183], v[200:203], v[152:167]
 ds_read_b128 v[196:199], v221 offset:24576
 s_waitcnt lgkmcnt(1)
 v_mfma_f32_32x32x16_bf16 v[152:167], a[184:187], v[192:195], v[152:167]
 ds_read_b128 v[200:203], v221 offset:25600
 s_waitcnt lgkmcnt(1)
 v_mfma_f32_32x32x16_bf16 v[152:167], a[188:191], v[196:199], v[152:167]
 ds_read_b128 v[192:195], v221 offset:26624
 s_waitcnt lgkmcnt(1)
 v_mfma_f32_32x32x16_bf16 v[152:167], a[192:195], v[200:203], v[152:167]
 ds_read_b128 v[196:199], v221 offset:27648
 s_waitcnt lgkmcnt(1)
 v_mfma_f32_32x32x16_bf16 v[152:167], a[196:199], v[192:195], v[152:167]
 ds_read_b128 v[200:203], v221 offset:28672
 s_waitcnt lgkmcnt(1)
 v_mfma_f32_32x32x16_bf16 v[152:167], a[200:203], v[196:199], v[152:167]
 ds_read_b128 v[192:195], v221 offset:29696
 s_waitcnt lgkmcnt(1)
 v_mfma_f32_32x32x16_bf16 v[152:167], a[204:207], v[200:203], v[152:167]
 ds_read_b128 v[196:199], v221 offset:30720
 s_waitcnt lgkmcnt(1)
 v_mfma_f32_32x32x16_bf16 v[152:167], a[208:211], v[192:195], v[152:167]
 ds_read_b128 v[200:203], v221 offset:31744
 s_waitcnt lgkmcnt(1)
 v_mfma_f32_32x32x16_bf16 v[152:167], a[212:215], v[196:199], v[152:167]
 ds_read_b128 v[192:195], v221 offset:32768
 s_waitcnt lgkmcnt(1)
 v_mfma_f32_32x32x16_bf16 v[152:167], a[216:219], v[200:203], v[152:167]
 ds_read_b128 v[196:199], v221 offset:33792
 s_waitcnt lgkmcnt(1)
 v_mfma_f32_32x32x16_bf16 v[152:167], a[220:223], v[192:195], v[152:167]
 ds_read_b128 v[200:203], v221 offset:34816
 s_waitcnt lgkmcnt(1)
 v_mfma_f32_32x32x16_bf16 v[152:167], a[224:227], v[196:199], v[152:167]
 ds_read_b128 v[192:195], v221 offset:35840
 s_waitcnt lgkmcnt(1)
 v_mfma_f32_32x32x16_bf16 v[152:167], a[228:231], v[200:203], v[152:167]
 ds_read_b128 v[196:199], v221 offset:36864
 s_waitcnt lgkmcnt(1)
 v_mfma_f32_32x32x16_bf16 v[152:167], a[232:235], v[192:195], v[152:167]
 ds_read_b128 v[200:203], v221 offset:37888
 s_waitcnt lgkmcnt(1)
 v_mfma_f32_32x32x16_bf16 v[152:167], a[236:239], v[196:199], v[152:167]
 ds_read_b128 v[192:195], v221 offset:38912
 s_waitcnt lgkmcnt(1)
 v_mfma_f32_32x32x16_bf16 v[152:167], a[240:243], v[200:203], v[152:167]
 ds_read_b128 v[196:199], v221 offset:39936
 s_waitcnt lgkmcnt(1)
 v_mfma_f32_32x32x16_bf16 v[152:167], a[244:247], v[192:195], v[152:167]
 ds_read_b128 v[200:203], v221 offset:40960
 s_waitcnt lgkmcnt(1)
 v_mfma_f32_32x32x16_bf16 v[152:167], a[248:251], v[196:199], v[152:167]
 ds_read_b128 v[192:195], v221 offset:41984
 ds_read_b128 v[204:207], v217 offset:0
 s_waitcnt lgkmcnt(2)
 v_mfma_f32_32x32x16_bf16 v[152:167], a[252:255], v[200:203], v[152:167]
 ds_read_b128 v[196:199], v221 offset:43008
 ds_read_b128 v[232:235], v217 offset:1024
 s_waitcnt lgkmcnt(2)
 v_mfma_f32_32x32x16_bf16 v[152:167], v[204:207], v[192:195], v[152:167]
 ds_read_b128 v[200:203], v221 offset:44032
 ds_read_b128 v[204:207], v217 offset:2048
 s_waitcnt lgkmcnt(2)
 v_mfma_f32_32x32x16_bf16 v[152:167], v[232:235], v[196:199], v[152:167]
 ds_read_b128 v[192:195], v221 offset:45056
 ds_read_b128 v[232:235], v217 offset:3072
 s_waitcnt lgkmcnt(2)
 v_mfma_f32_32x32x16_bf16 v[152:167], v[204:207], v[200:203], v[152:167]
 ds_read_b128 v[196:199], v221 offset:46080
 ds_read_b128 v[204:207], v217 offset:4096
 s_waitcnt lgkmcnt(2)
 v_mfma_f32_32x32x16_bf16 v[152:167], v[232:235], v[192:195], v[152:167]
 ds_read_b128 v[200:203], v221 offset:47104
 ds_read_b128 v[232:235], v217 offset:5120
 s_waitcnt lgkmcnt(2)
 v_mfma_f32_32x32x16_bf16 v[152:167], v[204:207], v[196:199], v[152:167]
 ds_read_b128 v[192:195], v221 offset:48128
 ds_read_b128 v[204:207], v217 offset:6144
 s_waitcnt lgkmcnt(2)
 v_mfma_f32_32x32x16_bf16 v[152:167], v[232:235], v[200:203], v[152:167]
 ds_read_b128 v[196:199], v221 offset:49152
 ds_read_b128 v[232:235], v217 offset:7168
 s_waitcnt lgkmcnt(2)
 v_mfma_f32_32x32x16_bf16 v[152:167], v[204:207], v[192:195], v[152:167]
 ds_read_b128 v[200:203], v221 offset:50176
 ds_read_b128 v[204:207], v217 offset:8192
 s_waitcnt lgkmcnt(2)
 v_mfma_f32_32x32x16_bf16 v[152:167], v[232:235], v[196:199], v[152:167]
 ds_read_b128 v[192:195], v221 offset:51200
 ds_read_b128 v[232:235], v217 offset:9216
 s_waitcnt lgkmcnt(2)
 v_mfma_f32_32x32x16_bf16 v[152:167], v[204:207], v[200:203], v[152:167]
 ds_read_b128 v[196:199], v221 offset:52224
 ds_read_b128 v[204:207], v217 offset:10240
 s_waitcnt lgkmcnt(2)
 v_mfma_f32_32x32x16_bf16 v[152:167], v[232:235], v[192:195], v[152:167]
 ds_read_b128 v[200:203], v221 offset:53248
 ds_read_b128 v[232:235], v217 offset:11264
 s_waitcnt lgkmcnt(2)
 v_mfma_f32_32x32x16_bf16 v[152:167], v[204:207], v[196:199], v[152:167]
 s_waitcnt lgkmcnt(0)
 v_mfma_f32_32x32x16_bf16 v[152:167], v[232:235], v[200:203], v[152:167]
 s_nop 7
 s_nop 3
 v_cvt_pk_bf16_f32 v168, v152, v153
 v_cvt_pk_bf16_f32 v169, v154, v155
 v_cvt_pk_bf16_f32 v170, v156, v157
 v_cvt_pk_bf16_f32 v171, v158, v159
 ds_write_b128 v216, v[168:171] offset:0
 v_cvt_pk_bf16_f32 v172, v160, v161
 v_cvt_pk_bf16_f32 v173, v162, v163
 v_cvt_pk_bf16_f32 v174, v164, v165
 v_cvt_pk_bf16_f32 v175, v166, v167
 ds_write_b128 v216, v[172:175] offset:256
 s_waitcnt lgkmcnt(0)
 s_barrier
 s_and_b32 s60, s44, 1
 s_lshl_b32 s60, s60, 12
 v_add_u32 v232, s60, v221
 ds_read_b128 v[0:3], v232 offset:54272
 ds_read_b128 v[4:7], v232 offset:55296
 ds_read_b128 v[8:11], v232 offset:56320
 ds_read_b128 v[12:15], v232 offset:57344
T2_LOOP59:
 s_cmp_lt_u32 s64, s97
 s_cbranch_scc1 L60
 s_lshl_b32 s60, s46, 6
 s_add_u32 s60, s60, 73404416
 v_mov_b32 v232, 0
L61:
 buffer_load_dword v233, v232, s[4:7], s60 offen sc1
 s_waitcnt vmcnt(0)
 v_readfirstlane_b32 s97, v233
 s_cmp_eq_u32 s20, -1
 s_cbranch_scc1 L61n
 v_mov_b32 v234, 0
 v_mov_b32 v235, s21
 s_mov_b64 exec, 1
 buffer_store_dword v235, v234, s[4:7], s20 offen sc1
 s_mov_b64 exec, -1
 s_mov_b32 s20, -1
L61n:
 s_cmp_lt_u32 s64, s97
 s_cbranch_scc0 L61
L60:
 s_lshl_b32 s60, s64, 5
 s_add_u32 s60, s60, s46
 s_lshl_b32 s60, s60, 13
 s_add_u32 s60, s60, 54525952
 buffer_load_dwordx4 v[48:51], v221, s[4:7], s60 offen offset:0 sc1
 buffer_load_dwordx4 v[52:55], v221, s[4:7], s60 offen offset:1024 sc1
 buffer_load_dwordx4 v[56:59], v221, s[4:7], s60 offen offset:2048 sc1
 buffer_load_dwordx4 v[60:63], v221, s[4:7], s60 offen offset:3072 sc1
 s_lshr_b32 s61, s44, 1
 s_lshl_b32 s61, s61, 11
 s_add_u32 s60, s60, s61
 s_add_u32 s60, s60, 4096
 buffer_load_dwordx2 v[80:81], v221, s[4:7], s60 offen sc1
 buffer_load_dwordx2 v[82:83], v221, s[4:7], s60 offen offset:1024 sc1
 v_and_b32 v236, 31, v220
 v_lshlrev_b32 v236, 2, v236
 s_add_u32 s28, s72, 128
 buffer_load_dword v237, v236, s[4:7], s28 offen sc1
 s_cmp_eq_u32 s44, 0
 s_cbranch_scc0 L62
 s_lshl_b32 s60, s64, 5
 s_add_u32 s60, s60, s46
 s_mul_i32 s60, s60, 1152
 buffer_load_dwordx4 v[208:211], v221, s[52:55], s60 offen
 v_mov_b32 v212, 0
 v_mov_b32 v213, 0
 v_mov_b32 v214, 0
 v_mov_b32 v215, 0
 s_mov_b64 exec, 0xff
 buffer_load_dwordx4 v[212:215], v221, s[52:55], s60 offen offset:1024
 s_mov_b64 exec, -1
 s_waitcnt vmcnt(0)
 s_cmp_eq_u32 s20, -1
 s_cbranch_scc1 L62d
 v_mov_b32 v232, 0
 v_mov_b32 v233, s21
 s_mov_b64 exec, 1
 buffer_store_dword v233, v232, s[4:7], s20 offen sc1
 s_mov_b64 exec, -1
 s_mov_b32 s20, -1
 s_branch L62d
L62:
 s_waitcnt vmcnt(0)
L62d:
 v_cmp_gt_u32 vcc, s65, v237
 s_cbranch_vccz L64e
L64:
 buffer_load_dword v237, v236, s[4:7], s28 offen sc1
 s_waitcnt vmcnt(0)
 v_cmp_gt_u32 vcc, s65, v237
 s_cbranch_vccnz L64
L64e:
 s_waitcnt lgkmcnt(0)
 v_mfma_f32_16x16x32_bf16 v[88:91], v[16:19], v[0:3], 0
 v_mfma_f32_16x16x32_bf16 v[92:95], v[32:35], v[0:3], 0
 v_mfma_f32_16x16x32_bf16 v[84:87], v[48:51], v[0:3], 0
 v_mfma_f32_16x16x32_bf16 v[88:91], v[20:23], v[4:7], v[88:91]
 v_mfma_f32_16x16x32_bf16 v[92:95], v[36:39], v[4:7], v[92:95]
 v_mfma_f32_16x16x32_bf16 v[84:87], v[52:55], v[4:7], v[84:87]
 v_mfma_f32_16x16x32_bf16 v[88:91], v[24:27], v[8:11], v[88:91]
 v_mfma_f32_16x16x32_bf16 v[92:95], v[40:43], v[8:11], v[92:95]
 v_mfma_f32_16x16x32_bf16 v[84:87], v[56:59], v[8:11], v[84:87]
 v_mfma_f32_16x16x32_bf16 v[88:91], v[28:31], v[12:15], v[88:91]
 v_mfma_f32_16x16x32_bf16 v[92:95], v[44:47], v[12:15], v[92:95]
 v_mfma_f32_16x16x32_bf16 v[84:87], v[60:63], v[12:15], v[84:87]
 s_nop 7
 v_cvt_pk_bf16_f32 v232, v84, v85
 v_lshlrev_b32 v84, 16, v232
 v_and_b32 v85, s96, v232
 v_mul_f32 v84, s94, v84
 v_mul_f32 v85, s94, v85
 v_cvt_pk_bf16_f32 v232, v84, v85
 v_lshlrev_b32 v84, 16, v232
 v_and_b32 v85, s96, v232
 v_cvt_pk_bf16_f32 v232, v86, v87
 v_lshlrev_b32 v86, 16, v232
 v_and_b32 v87, s96, v232
 v_mul_f32 v86, s94, v86
 v_mul_f32 v87, s94, v87
 v_cvt_pk_bf16_f32 v232, v86, v87
 v_lshlrev_b32 v86, 16, v232
 v_and_b32 v87, s96, v232
 v_cvt_pk_bf16_f32 v232, v88, v89
 v_lshlrev_b32 v88, 16, v232
 v_and_b32 v89, s96, v232
 v_mul_f32 v88, s94, v88
 v_mul_f32 v89, s94, v89
 v_cvt_pk_bf16_f32 v232, v88, v89
 v_lshlrev_b32 v88, 16, v232
 v_and_b32 v89, s96, v232
 v_cvt_pk_bf16_f32 v232, v90, v91
 v_lshlrev_b32 v90, 16, v232
 v_and_b32 v91, s96, v232
 v_mul_f32 v90, s94, v90
 v_mul_f32 v91, s94, v91
 v_cvt_pk_bf16_f32 v232, v90, v91
 v_lshlrev_b32 v90, 16, v232
 v_and_b32 v91, s96, v232
 v_cvt_pk_bf16_f32 v232, v92, v93
 v_lshlrev_b32 v92, 16, v232
 v_and_b32 v93, s96, v232
 v_mul_f32 v92, s94, v92
 v_mul_f32 v93, s94, v93
 v_cvt_pk_bf16_f32 v232, v92, v93
 v_lshlrev_b32 v92, 16, v232
 v_and_b32 v93, s96, v232
 v_cvt_pk_bf16_f32 v232, v94, v95
 v_lshlrev_b32 v94, 16, v232
 v_and_b32 v95, s96, v232
 v_mul_f32 v94, s94, v94
 v_mul_f32 v95, s94, v95
 v_cvt_pk_bf16_f32 v232, v94, v95
 v_lshlrev_b32 v94, 16, v232
 v_and_b32 v95, s96, v232
 v_mov_b32 v233, 0xce6e6b28
 v_cndmask_b32 v88, v233, v88, s[76:77]
 v_cndmask_b32 v89, v233, v89, s[78:79]
 v_cndmask_b32 v90, v233, v90, s[80:81]
 v_cndmask_b32 v91, v233, v91, s[82:83]
 v_cndmask_b32 v92, v233, v92, s[84:85]
 v_cndmask_b32 v93, v233, v93, s[86:87]
 v_cndmask_b32 v94, v233, v94, s[88:89]
 v_cndmask_b32 v95, v233, v95, s[90:91]
 v_max3_f32 v232, v88, v89, v90
 v_max3_f32 v232, v232, v91, v92
 v_max3_f32 v233, v93, v94, v95
 v_max3_f32 v232, v232, v233, v84
 v_max3_f32 v232, v232, v85, v86
 v_max_f32 v232, v232, v87
 v_mov_b32 v233, v232
 s_nop 1
 v_permlane32_swap_b32 v232, v233
 v_max_f32 v232, v232, v233
 v_mov_b32 v233, v232
 s_nop 1
 v_permlane16_swap_b32 v232, v233
 v_max_f32 v232, v232, v233
 v_sub_f32 v84, v84, v232
 v_sub_f32 v85, v85, v232
 v_sub_f32 v86, v86, v232
 v_sub_f32 v87, v87, v232
 v_sub_f32 v88, v88, v232
 v_sub_f32 v89, v89, v232
 v_sub_f32 v90, v90, v232
 v_sub_f32 v91, v91, v232
 v_sub_f32 v92, v92, v232
 v_sub_f32 v93, v93, v232
 v_sub_f32 v94, v94, v232
 v_sub_f32 v95, v95, v232
 v_mul_f32 v84, s95, v84
 v_mul_f32 v85, s95, v85
 v_mul_f32 v86, s95, v86
 v_mul_f32 v87, s95, v87
 v_mul_f32 v88, s95, v88
 v_mul_f32 v89, s95, v89
 v_mul_f32 v90, s95, v90
 v_mul_f32 v91, s95, v91
 v_mul_f32 v92, s95, v92
 v_mul_f32 v93, s95, v93
 v_mul_f32 v94, s95, v94
 v_mul_f32 v95, s95, v95
 v_exp_f32 v84, v84
 v_exp_f32 v85, v85
 v_exp_f32 v86, v86
 v_exp_f32 v87, v87
 v_exp_f32 v88, v88
 v_exp_f32 v89, v89
 v_exp_f32 v90, v90
 v_exp_f32 v91, v91
 v_exp_f32 v92, v92
 v_exp_f32 v93, v93
 v_exp_f32 v94, v94
 v_exp_f32 v95, v95
 s_nop 0
 v_pk_add_f32 v[234:235], v[88:89], v[90:91]
 v_pk_add_f32 v[236:237], v[92:93], v[94:95]
 v_pk_add_f32 v[238:239], v[84:85], v[86:87]
 v_pk_add_f32 v[234:235], v[234:235], v[236:237]
 v_add_f32 v238, v238, v239
 v_add_f32 v234, v234, v235
 v_fma_f32 v234, v238, v227, v234
 v_mov_b32 v235, v234
 s_nop 1
 v_permlane32_swap_b32 v234, v235
 v_add_f32 v234, v234, v235
 v_mov_b32 v235, v234
 s_nop 1
 v_permlane16_swap_b32 v234, v235
 v_add_f32 v234, v234, v235
 v_rcp_f32 v235, v234
 s_nop 0
 v_mul_f32 v84, v84, v235
 v_mul_f32 v85, v85, v235
 v_mul_f32 v86, v86, v235
 v_mul_f32 v87, v87, v235
 v_mul_f32 v88, v88, v235
 v_mul_f32 v89, v89, v235
 v_mul_f32 v90, v90, v235
 v_mul_f32 v91, v91, v235
 v_mul_f32 v92, v92, v235
 v_mul_f32 v93, v93, v235
 v_mul_f32 v94, v94, v235
 v_mul_f32 v95, v95, v235
 v_cvt_pk_bf16_f32 v236, v84, v85
 v_cvt_pk_bf16_f32 v237, v86, v87
 v_cvt_pk_bf16_f32 v240, v88, v89
 v_cvt_pk_bf16_f32 v241, v90, v91
 v_cvt_pk_bf16_f32 v242, v92, v93
 v_cvt_pk_bf16_f32 v243, v94, v95
 v_cndmask_b32 v244, 0, v236, s[92:93]
 v_cndmask_b32 v245, 0, v237, s[92:93]
 v_cndmask_b32 v246, v236, 0, s[92:93]
 v_cndmask_b32 v247, v237, 0, s[92:93]
 s_nop 1
 v_mfma_f32_16x16x32_bf16 v[96:99], v[64:67], v[240:243], 0
 v_mfma_f32_16x16x32_bf16 v[100:103], v[68:71], v[240:243], 0
 v_mfma_f32_16x16x32_bf16 v[104:107], v[72:75], v[240:243], 0
 v_mfma_f32_16x16x32_bf16 v[108:111], v[76:79], v[240:243], 0
 v_mfma_f32_16x16x16_bf16 v[96:99], v[80:81], v[244:245], v[96:99]
 v_mfma_f32_16x16x16_bf16 v[100:103], v[80:81], v[246:247], v[100:103]
 v_mfma_f32_16x16x16_bf16 v[104:107], v[82:83], v[244:245], v[104:107]
 v_mfma_f32_16x16x16_bf16 v[108:111], v[82:83], v[246:247], v[108:111]
 s_nop 7
 v_cvt_pk_bf16_f32 v96, v96, v97
 v_cvt_pk_bf16_f32 v97, v98, v99
 ds_write_b64 v226, v[96:97] offset:0
 v_cvt_pk_bf16_f32 v100, v100, v101
 v_cvt_pk_bf16_f32 v101, v102, v103
 ds_write_b64 v226, v[100:101] offset:1024
 v_cvt_pk_bf16_f32 v104, v104, v105
 v_cvt_pk_bf16_f32 v105, v106, v107
 ds_write_b64 v226, v[104:105] offset:2048
 v_cvt_pk_bf16_f32 v108, v108, v109
 v_cvt_pk_bf16_f32 v109, v110, v111
 ds_write_b64 v226, v[108:109] offset:3072
 s_waitcnt lgkmcnt(0)
 s_barrier
 s_add_u32 s75, s64, 3
 s_cmp_ge_u32 s75, 64
 s_cbranch_scc1 L65
 s_cmp_lt_u32 s75, s69
 s_cbranch_scc1 L67
 s_lshl_b32 s60, s46, 6
 s_add_u32 s60, s60, 73400320
 v_mov_b32 v232, 0
L68:
 buffer_load_dword v233, v232, s[4:7], s60 offen sc1
 s_waitcnt vmcnt(0)
 v_readfirstlane_b32 s69, v233
 s_cmp_lt_u32 s75, s69
 s_cbranch_scc0 L68
L67:
 s_lshl_b32 s16, s75, 5
 s_add_u32 s16, s16, s46
 s_lshl_b32 s17, s16, 14
 s_add_u32 s17, s17, 20971520
 s_mul_i32 s22, s75, 36864
 s_mul_i32 s23, s44, 9216
 s_add_u32 s22, s22, s23
 s_add_u32 s22, s22, 0
 s_add_u32 s23, s23, 17408
 s_add_u32 s18, s17, 4096
 s_lshr_b32 s62, s44, 1
 s_lshl_b32 s62, s62, 12
 s_add_u32 s19, s17, s62
 s_add_u32 s19, s19, 8192
 ds_read_b128 v[192:195], v221 offset:0
 ds_read_b128 v[196:199], v221 offset:1024
 s_waitcnt lgkmcnt(1)
 v_mfma_f32_32x32x16_bf16 v[112:127], a[0:3], v[192:195], 0
 s_add_u32 m0, s23, 0
 s_add_u32 s62, s22, 0
 buffer_load_dwordx4 v221, s[4:7], s62 offen sc1 lds
 v_mfma_f32_32x32x16_bf16 v[128:143], a[32:35], v[192:195], 0
 s_add_u32 m0, s23, 1024
 s_add_u32 s62, s22, 1024
 buffer_load_dwordx4 v221, s[4:7], s62 offen sc1 lds
 v_mfma_f32_32x32x16_bf16 v[144:159], a[64:67], v[192:195], 0
 s_add_u32 m0, s23, 2048
 s_add_u32 s62, s22, 2048
 buffer_load_dwordx4 v221, s[4:7], s62 offen sc1 lds
 v_mfma_f32_32x32x16_bf16 v[160:175], a[96:99], v[192:195], 0
 s_cmp_eq_u32 s68, 4
 s_cbranch_scc1 L69
 v_mfma_f32_32x32x16_bf16 v[176:191], a[128:131], v[192:195], 0
L69:
 ds_read_b128 v[192:195], v221 offset:2048
 s_waitcnt lgkmcnt(1)
 v_mfma_f32_32x32x16_bf16 v[112:127], a[4:7], v[196:199], v[112:127]
 s_add_u32 m0, s23, 3072
 s_add_u32 s62, s22, 3072
 buffer_load_dwordx4 v221, s[4:7], s62 offen sc1 lds
 v_mfma_f32_32x32x16_bf16 v[128:143], a[36:39], v[196:199], v[128:143]
 s_add_u32 m0, s23, 4096
 s_add_u32 s62, s22, 4096
 buffer_load_dwordx4 v221, s[4:7], s62 offen sc1 lds
 v_mfma_f32_32x32x16_bf16 v[144:159], a[68:71], v[196:199], v[144:159]
 s_add_u32 m0, s23, 5120
 s_add_u32 s62, s22, 5120
 buffer_load_dwordx4 v221, s[4:7], s62 offen sc1 lds
 v_mfma_f32_32x32x16_bf16 v[160:175], a[100:103], v[196:199], v[160:175]
 s_cmp_eq_u32 s68, 4
 s_cbranch_scc1 L70
 v_mfma_f32_32x32x16_bf16 v[176:191], a[132:135], v[196:199], v[176:191]
L70:
 ds_read_b128 v[196:199], v221 offset:3072
 s_waitcnt lgkmcnt(1)
 v_mfma_f32_32x32x16_bf16 v[112:127], a[8:11], v[192:195], v[112:127]
 s_add_u32 m0, s23, 6144
 s_add_u32 s62, s22, 6144
 buffer_load_dwordx4 v221, s[4:7], s62 offen sc1 lds
 v_mfma_f32_32x32x16_bf16 v[128:143], a[40:43], v[192:195], v[128:143]
 s_add_u32 m0, s23, 7168
 s_add_u32 s62, s22, 7168
 buffer_load_dwordx4 v221, s[4:7], s62 offen sc1 lds
 v_mfma_f32_32x32x16_bf16 v[144:159], a[72:75], v[192:195], v[144:159]
 s_add_u32 m0, s23, 8192
 s_add_u32 s62, s22, 8192
 buffer_load_dwordx4 v221, s[4:7], s62 offen sc1 lds
 v_mfma_f32_32x32x16_bf16 v[160:175], a[104:107], v[192:195], v[160:175]
 s_cmp_eq_u32 s68, 4
 s_cbranch_scc1 L71
 v_mfma_f32_32x32x16_bf16 v[176:191], a[136:139], v[192:195], v[176:191]
L71:
 ds_read_b128 v[192:195], v221 offset:4096
 s_waitcnt lgkmcnt(1)
 v_mfma_f32_32x32x16_bf16 v[112:127], a[12:15], v[196:199], v[112:127]
 buffer_load_dwordx4 v[16:19], v221, s[4:7], s17 offen offset:0 sc1
 v_mfma_f32_32x32x16_bf16 v[128:143], a[44:47], v[196:199], v[128:143]
 buffer_load_dwordx4 v[20:23], v221, s[4:7], s17 offen offset:1024 sc1
 v_mfma_f32_32x32x16_bf16 v[144:159], a[76:79], v[196:199], v[144:159]
 buffer_load_dwordx4 v[24:27], v221, s[4:7], s17 offen offset:2048 sc1
 v_mfma_f32_32x32x16_bf16 v[160:175], a[108:111], v[196:199], v[160:175]
 s_cmp_eq_u32 s68, 4
 s_cbranch_scc1 L72
 v_mfma_f32_32x32x16_bf16 v[176:191], a[140:143], v[196:199], v[176:191]
L72:
 ds_read_b128 v[196:199], v221 offset:5120
 s_waitcnt lgkmcnt(1)
 v_mfma_f32_32x32x16_bf16 v[112:127], a[16:19], v[192:195], v[112:127]
 buffer_load_dwordx4 v[28:31], v221, s[4:7], s17 offen offset:3072 sc1
 v_mfma_f32_32x32x16_bf16 v[128:143], a[48:51], v[192:195], v[128:143]
 buffer_load_dwordx4 v[32:35], v221, s[4:7], s18 offen offset:0 sc1
 v_mfma_f32_32x32x16_bf16 v[144:159], a[80:83], v[192:195], v[144:159]
 buffer_load_dwordx4 v[36:39], v221, s[4:7], s18 offen offset:1024 sc1
 v_mfma_f32_32x32x16_bf16 v[160:175], a[112:115], v[192:195], v[160:175]
 s_cmp_eq_u32 s68, 4
 s_cbranch_scc1 L73
 v_mfma_f32_32x32x16_bf16 v[176:191], a[144:147], v[192:195], v[176:191]
L73:
 ds_read_b128 v[192:195], v221 offset:6144
 s_waitcnt lgkmcnt(1)
 v_mfma_f32_32x32x16_bf16 v[112:127], a[20:23], v[196:199], v[112:127]
 buffer_load_dwordx4 v[40:43], v221, s[4:7], s18 offen offset:2048 sc1
 v_mfma_f32_32x32x16_bf16 v[128:143], a[52:55], v[196:199], v[128:143]
 buffer_load_dwordx4 v[44:47], v221, s[4:7], s18 offen offset:3072 sc1
 v_mfma_f32_32x32x16_bf16 v[144:159], a[84:87], v[196:199], v[144:159]
 buffer_load_dwordx4 v[64:67], v221, s[4:7], s19 offen offset:0 sc1
 v_mfma_f32_32x32x16_bf16 v[160:175], a[116:119], v[196:199], v[160:175]
 s_cmp_eq_u32 s68, 4
 s_cbranch_scc1 L74
 v_mfma_f32_32x32x16_bf16 v[176:191], a[148:151], v[196:199], v[176:191]
L74:
 ds_read_b128 v[196:199], v221 offset:7168
 s_waitcnt lgkmcnt(1)
 v_mfma_f32_32x32x16_bf16 v[112:127], a[24:27], v[192:195], v[112:127]
 buffer_load_dwordx4 v[68:71], v221, s[4:7], s19 offen offset:1024 sc1
 v_mfma_f32_32x32x16_bf16 v[128:143], a[56:59], v[192:195], v[128:143]
 buffer_load_dwordx4 v[72:75], v221, s[4:7], s19 offen offset:2048 sc1
 v_mfma_f32_32x32x16_bf16 v[144:159], a[88:91], v[192:195], v[144:159]
 buffer_load_dwordx4 v[76:79], v221, s[4:7], s19 offen offset:3072 sc1
 v_mfma_f32_32x32x16_bf16 v[160:175], a[120:123], v[192:195], v[160:175]
 s_cmp_eq_u32 s68, 4
 s_cbranch_scc1 L75
 v_mfma_f32_32x32x16_bf16 v[176:191], a[152:155], v[192:195], v[176:191]
L75:
 s_waitcnt lgkmcnt(0)
 v_mfma_f32_32x32x16_bf16 v[112:127], a[28:31], v[196:199], v[112:127]
 v_mfma_f32_32x32x16_bf16 v[128:143], a[60:63], v[196:199], v[128:143]
 v_mfma_f32_32x32x16_bf16 v[144:159], a[92:95], v[196:199], v[144:159]
 v_mfma_f32_32x32x16_bf16 v[160:175], a[124:127], v[196:199], v[160:175]
 s_cmp_eq_u32 s68, 4
 s_cbranch_scc1 L76
 v_mfma_f32_32x32x16_bf16 v[176:191], a[156:159], v[196:199], v[176:191]
L76:
 s_branch L66
L65:
 ds_read_b128 v[192:195], v221 offset:0
 ds_read_b128 v[196:199], v221 offset:1024
 s_waitcnt lgkmcnt(1)
 v_mfma_f32_32x32x16_bf16 v[112:127], a[0:3], v[192:195], 0
 v_mfma_f32_32x32x16_bf16 v[128:143], a[32:35], v[192:195], 0
 v_mfma_f32_32x32x16_bf16 v[144:159], a[64:67], v[192:195], 0
 v_mfma_f32_32x32x16_bf16 v[160:175], a[96:99], v[192:195], 0
 s_cmp_eq_u32 s68, 4
 s_cbranch_scc1 L77
 v_mfma_f32_32x32x16_bf16 v[176:191], a[128:131], v[192:195], 0
L77:
 ds_read_b128 v[192:195], v221 offset:2048
 s_waitcnt lgkmcnt(1)
 v_mfma_f32_32x32x16_bf16 v[112:127], a[4:7], v[196:199], v[112:127]
 v_mfma_f32_32x32x16_bf16 v[128:143], a[36:39], v[196:199], v[128:143]
 v_mfma_f32_32x32x16_bf16 v[144:159], a[68:71], v[196:199], v[144:159]
 v_mfma_f32_32x32x16_bf16 v[160:175], a[100:103], v[196:199], v[160:175]
 s_cmp_eq_u32 s68, 4
 s_cbranch_scc1 L78
 v_mfma_f32_32x32x16_bf16 v[176:191], a[132:135], v[196:199], v[176:191]
L78:
 ds_read_b128 v[196:199], v221 offset:3072
 s_waitcnt lgkmcnt(1)
 v_mfma_f32_32x32x16_bf16 v[112:127], a[8:11], v[192:195], v[112:127]
 v_mfma_f32_32x32x16_bf16 v[128:143], a[40:43], v[192:195], v[128:143]
 v_mfma_f32_32x32x16_bf16 v[144:159], a[72:75], v[192:195], v[144:159]
 v_mfma_f32_32x32x16_bf16 v[160:175], a[104:107], v[192:195], v[160:175]
 s_cmp_eq_u32 s68, 4
 s_cbranch_scc1 L79
 v_mfma_f32_32x32x16_bf16 v[176:191], a[136:139], v[192:195], v[176:191]
L79:
 ds_read_b128 v[192:195], v221 offset:4096
 s_waitcnt lgkmcnt(1)
 v_mfma_f32_32x32x16_bf16 v[112:127], a[12:15], v[196:199], v[112:127]
 v_mfma_f32_32x32x16_bf16 v[128:143], a[44:47], v[196:199], v[128:143]
 v_mfma_f32_32x32x16_bf16 v[144:159], a[76:79], v[196:199], v[144:159]
 v_mfma_f32_32x32x16_bf16 v[160:175], a[108:111], v[196:199], v[160:175]
 s_cmp_eq_u32 s68, 4
 s_cbranch_scc1 L80
 v_mfma_f32_32x32x16_bf16 v[176:191], a[140:143], v[196:199], v[176:191]
L80:
 ds_read_b128 v[196:199], v221 offset:5120
 s_waitcnt lgkmcnt(1)
 v_mfma_f32_32x32x16_bf16 v[112:127], a[16:19], v[192:195], v[112:127]
 v_mfma_f32_32x32x16_bf16 v[128:143], a[48:51], v[192:195], v[128:143]
 v_mfma_f32_32x32x16_bf16 v[144:159], a[80:83], v[192:195], v[144:159]
 v_mfma_f32_32x32x16_bf16 v[160:175], a[112:115], v[192:195], v[160:175]
 s_cmp_eq_u32 s68, 4
 s_cbranch_scc1 L81
 v_mfma_f32_32x32x16_bf16 v[176:191], a[144:147], v[192:195], v[176:191]
L81:
 ds_read_b128 v[192:195], v221 offset:6144
 s_waitcnt lgkmcnt(1)
 v_mfma_f32_32x32x16_bf16 v[112:127], a[20:23], v[196:199], v[112:127]
 v_mfma_f32_32x32x16_bf16 v[128:143], a[52:55], v[196:199], v[128:143]
 v_mfma_f32_32x32x16_bf16 v[144:159], a[84:87], v[196:199], v[144:159]
 v_mfma_f32_32x32x16_bf16 v[160:175], a[116:119], v[196:199], v[160:175]
 s_cmp_eq_u32 s68, 4
 s_cbranch_scc1 L82
 v_mfma_f32_32x32x16_bf16 v[176:191], a[148:151], v[196:199], v[176:191]
L82:
 ds_read_b128 v[196:199], v221 offset:7168
 s_waitcnt lgkmcnt(1)
 v_mfma_f32_32x32x16_bf16 v[112:127], a[24:27], v[192:195], v[112:127]
 v_mfma_f32_32x32x16_bf16 v[128:143], a[56:59], v[192:195], v[128:143]
 v_mfma_f32_32x32x16_bf16 v[144:159], a[88:91], v[192:195], v[144:159]
 v_mfma_f32_32x32x16_bf16 v[160:175], a[120:123], v[192:195], v[160:175]
 s_cmp_eq_u32 s68, 4
 s_cbranch_scc1 L83
 v_mfma_f32_32x32x16_bf16 v[176:191], a[152:155], v[192:195], v[176:191]
L83:
 s_waitcnt lgkmcnt(0)
 v_mfma_f32_32x32x16_bf16 v[112:127], a[28:31], v[196:199], v[112:127]
 v_mfma_f32_32x32x16_bf16 v[128:143], a[60:63], v[196:199], v[128:143]
 v_mfma_f32_32x32x16_bf16 v[144:159], a[92:95], v[196:199], v[144:159]
 v_mfma_f32_32x32x16_bf16 v[160:175], a[124:127], v[196:199], v[160:175]
 s_cmp_eq_u32 s68, 4
 s_cbranch_scc1 L84
 v_mfma_f32_32x32x16_bf16 v[176:191], a[156:159], v[196:199], v[176:191]
L84:
L66:
 s_and_b32 s60, s65, 0
 s_lshl_b32 s61, s47, 1
 s_add_u32 s60, s60, s61
 s_mul_i32 s70, s60, 1179648
 s_add_u32 s70, s70, 83886080
 s_lshl_b32 s60, s67, 6
 v_add_u32 v232, s60, v218
 s_nop 7
 v_cvt_pk_bf16_f32 v200, v112, v113
 v_cvt_pk_bf16_f32 v201, v114, v115
 v_cvt_pk_bf16_f32 v202, v116, v117
 v_cvt_pk_bf16_f32 v203, v118, v119
 ds_write_b128 v232, v[200:203] offset:0
 v_cvt_pk_bf16_f32 v204, v120, v121
 v_cvt_pk_bf16_f32 v205, v122, v123
 v_cvt_pk_bf16_f32 v206, v124, v125
 v_cvt_pk_bf16_f32 v207, v126, v127
 ds_write_b128 v232, v[204:207] offset:32
 v_add_u32 v232, 64, v232
 v_cvt_pk_bf16_f32 v200, v128, v129
 v_cvt_pk_bf16_f32 v201, v130, v131
 v_cvt_pk_bf16_f32 v202, v132, v133
 v_cvt_pk_bf16_f32 v203, v134, v135
 ds_write_b128 v232, v[200:203] offset:0
 v_cvt_pk_bf16_f32 v204, v136, v137
 v_cvt_pk_bf16_f32 v205, v138, v139
 v_cvt_pk_bf16_f32 v206, v140, v141
 v_cvt_pk_bf16_f32 v207, v142, v143
 ds_write_b128 v232, v[204:207] offset:32
 v_add_u32 v232, 64, v232
 v_cvt_pk_bf16_f32 v200, v144, v145
 v_cvt_pk_bf16_f32 v201, v146, v147
 v_cvt_pk_bf16_f32 v202, v148, v149
 v_cvt_pk_bf16_f32 v203, v150, v151
 ds_write_b128 v232, v[200:203] offset:0
 v_cvt_pk_bf16_f32 v204, v152, v153
 v_cvt_pk_bf16_f32 v205, v154, v155
 v_cvt_pk_bf16_f32 v206, v156, v157
 v_cvt_pk_bf16_f32 v207, v158, v159
 ds_write_b128 v232, v[204:207] offset:32
 v_add_u32 v232, 64, v232
 v_cvt_pk_bf16_f32 v200, v160, v161
 v_cvt_pk_bf16_f32 v201, v162, v163
 v_cvt_pk_bf16_f32 v202, v164, v165
 v_cvt_pk_bf16_f32 v203, v166, v167
 ds_write_b128 v232, v[200:203] offset:0
 v_cvt_pk_bf16_f32 v204, v168, v169
 v_cvt_pk_bf16_f32 v205, v170, v171
 v_cvt_pk_bf16_f32 v206, v172, v173
 v_cvt_pk_bf16_f32 v207, v174, v175
 ds_write_b128 v232, v[204:207] offset:32
 v_add_u32 v232, 64, v232
 s_cmp_eq_u32 s68, 4
 s_cbranch_scc1 L85
 v_cvt_pk_bf16_f32 v200, v176, v177
 v_cvt_pk_bf16_f32 v201, v178, v179
 v_cvt_pk_bf16_f32 v202, v180, v181
 v_cvt_pk_bf16_f32 v203, v182, v183
 ds_write_b128 v232, v[200:203] offset:0
 v_cvt_pk_bf16_f32 v204, v184, v185
 v_cvt_pk_bf16_f32 v205, v186, v187
 v_cvt_pk_bf16_f32 v206, v188, v189
 v_cvt_pk_bf16_f32 v207, v190, v191
 ds_write_b128 v232, v[204:207] offset:32
 v_add_u32 v232, 64, v232
L85:
 s_waitcnt lgkmcnt(0)
 s_barrier
 s_mul_i32 s60, s44, 9344
 s_add_u32 s60, s60, 114688
 v_add_u32 v148, s60, v221
 ds_read_b128 v[112:115], v148 offset:0
 ds_read_b128 v[116:119], v148 offset:1168
 ds_read_b128 v[120:123], v148 offset:2336
 ds_read_b128 v[124:127], v148 offset:3504
 ds_read_b128 v[128:131], v148 offset:4672
 ds_read_b128 v[132:135], v148 offset:5840
 ds_read_b128 v[136:139], v148 offset:7008
 ds_read_b128 v[140:143], v148 offset:8176
 v_lshrrev_b32 v149, 3, v220
 s_lshl_b32 s61, s44, 3
 v_add_u32 v149, s61, v149
 v_and_b32 v150, 7, v220
 v_lshlrev_b32 v150, 4, v150
 v_add_u32 v150, 1024, v150
 v_mul_u32_u24 v151, 1168, v149
 v_add_u32 v151, v151, v150
 v_add_u32 v151, 114688, v151
 ds_read_b128 v[144:147], v151
 v_mul_u32_u24 v149, 36864, v149
 v_add_u32 v150, v150, v149
 s_mul_i32 s60, s44, 294912
 s_mul_i32 s61, s46, 1152
 s_add_u32 s60, s60, s61
 s_add_u32 s60, s60, s70
 s_add_u32 s61, s61, s70
 s_waitcnt lgkmcnt(8)
 buffer_store_dwordx4 v[112:115], v221, s[4:7], s60 offen
 s_add_u32 s60, s60, 36864
 s_waitcnt lgkmcnt(7)
 buffer_store_dwordx4 v[116:119], v221, s[4:7], s60 offen
 s_add_u32 s60, s60, 36864
 s_waitcnt lgkmcnt(6)
 buffer_store_dwordx4 v[120:123], v221, s[4:7], s60 offen
 s_add_u32 s60, s60, 36864
 s_waitcnt lgkmcnt(5)
 buffer_store_dwordx4 v[124:127], v221, s[4:7], s60 offen
 s_add_u32 s60, s60, 36864
 s_waitcnt lgkmcnt(4)
 buffer_store_dwordx4 v[128:131], v221, s[4:7], s60 offen
 s_add_u32 s60, s60, 36864
 s_waitcnt lgkmcnt(3)
 buffer_store_dwordx4 v[132:135], v221, s[4:7], s60 offen
 s_add_u32 s60, s60, 36864
 s_waitcnt lgkmcnt(2)
 buffer_store_dwordx4 v[136:139], v221, s[4:7], s60 offen
 s_add_u32 s60, s60, 36864
 s_waitcnt lgkmcnt(1)
 buffer_store_dwordx4 v[140:143], v221, s[4:7], s60 offen
 s_waitcnt lgkmcnt(0)
 buffer_store_dwordx4 v[144:147], v150, s[4:7], s61 offen
 s_add_u32 s65, s65, 1
 s_waitcnt vmcnt(0)
 s_barrier
 s_cmp_eq_u32 s44, 0
 s_cbranch_scc0 L86
 v_mov_b32 v232, 0
 v_mov_b32 v233, s65
 s_mov_b64 exec, 1
 buffer_store_dword v233, v232, s[4:7], s71 offen
 s_mov_b64 exec, -1
L86:
 v_and_b32 v232, 31, v220
 v_lshlrev_b32 v232, 2, v232
L87:
 buffer_load_dword v233, v232, s[4:7], s72 offen sc1
 s_waitcnt vmcnt(0)
 v_cmp_gt_u32 vcc, s65, v233
 s_cbranch_vccnz L87
 s_mov_b32 s73, s70
 s_add_u32 s74, s70, 4608
 buffer_load_dwordx4 v[112:115], v223, s[4:7], s73 offen offset:0 sc1
 buffer_load_dwordx4 v[116:119], v223, s[4:7], s74 offen offset:0 sc1
 buffer_load_dwordx4 v[120:123], v223, s[4:7], s73 offen offset:256 sc1
 buffer_load_dwordx4 v[124:127], v223, s[4:7], s74 offen offset:256 sc1
 buffer_load_dwordx4 v[128:131], v223, s[4:7], s73 offen offset:512 sc1
 buffer_load_dwordx4 v[132:135], v223, s[4:7], s74 offen offset:512 sc1
 buffer_load_dwordx4 v[136:139], v223, s[4:7], s73 offen offset:768 sc1
 buffer_load_dwordx4 v[140:143], v223, s[4:7], s74 offen offset:768 sc1
 buffer_load_dwordx4 v[144:147], v223, s[4:7], s73 offen offset:1024 sc1
 buffer_load_dwordx4 v[148:151], v223, s[4:7], s74 offen offset:1024 sc1
 s_waitcnt vmcnt(9)
 v_mfma_f32_16x16x32_bf16 v[152:155], v[112:115], v[228:231], 0
 s_waitcnt vmcnt(8)
 v_mfma_f32_16x16x32_bf16 v[152:155], v[116:119], v[228:231], v[152:155]
 s_waitcnt vmcnt(7)
 v_mfma_f32_16x16x32_bf16 v[156:159], v[120:123], v[228:231], 0
 s_waitcnt vmcnt(6)
 v_mfma_f32_16x16x32_bf16 v[156:159], v[124:127], v[228:231], v[156:159]
 s_waitcnt vmcnt(5)
 v_mfma_f32_16x16x32_bf16 v[160:163], v[128:131], v[228:231], 0
 s_waitcnt vmcnt(4)
 v_mfma_f32_16x16x32_bf16 v[160:163], v[132:135], v[228:231], v[160:163]
 s_waitcnt vmcnt(3)
 v_mfma_f32_16x16x32_bf16 v[164:167], v[136:139], v[228:231], 0
 s_waitcnt vmcnt(2)
 v_mfma_f32_16x16x32_bf16 v[164:167], v[140:143], v[228:231], v[164:167]
 s_waitcnt vmcnt(1)
 v_mfma_f32_16x16x32_bf16 v[168:171], v[144:147], v[228:231], 0
 s_waitcnt vmcnt(0)
 v_mfma_f32_16x16x32_bf16 v[168:171], v[148:151], v[228:231], v[168:171]
 s_nop 7
 s_mov_b32 exec_lo, 0x00ff00ff
 s_mov_b32 exec_hi, 0x00ff00ff
 ds_write_b32 v224, v152 offset:8192
 ds_write_b32 v224, v153 offset:8208
 ds_write_b32 v224, v154 offset:8256
 ds_write_b32 v224, v155 offset:8272
 ds_write_b32 v224, v156 offset:8704
 ds_write_b32 v224, v157 offset:8720
 ds_write_b32 v224, v158 offset:8768
 ds_write_b32 v224, v159 offset:8784
 ds_write_b32 v224, v160 offset:9216
 ds_write_b32 v224, v161 offset:9232
 ds_write_b32 v224, v162 offset:9280
 ds_write_b32 v224, v163 offset:9296
 ds_write_b32 v224, v164 offset:9728
 ds_write_b32 v224, v165 offset:9744
 ds_write_b32 v224, v166 offset:9792
 ds_write_b32 v224, v167 offset:9808
 s_mov_b32 exec_hi, 0
 ds_write_b32 v224, v168 offset:10240
 ds_write_b32 v224, v169 offset:10256
 ds_write_b32 v224, v170 offset:10304
 ds_write_b32 v224, v171 offset:10320
 s_mov_b64 exec, -1
 s_waitcnt lgkmcnt(0)
 s_barrier
 s_cmp_eq_u32 s44, 1
 s_cbranch_scc0 L88
 s_add_u32 s60, s71, 128
 v_mov_b32 v232, 0
 v_mov_b32 v233, s65
 s_mov_b64 exec, 1
 buffer_store_dword v233, v232, s[4:7], s60 offen
 s_mov_b64 exec, -1
L88:
 s_cmp_eq_u32 s44, 0
 s_cbranch_scc0 L89
 s_lshl_b32 s60, s64, 5
 s_add_u32 s60, s60, s46
 s_mul_i32 s60, s60, 1152
 ds_read_b128 v[172:175], v225 offset:8192
 ds_read_b128 v[176:179], v225 offset:8208
 ds_read_b128 v[188:191], v225 offset:10496
 ds_read_b128 v[192:195], v225 offset:10512
 s_waitcnt lgkmcnt(0)
 v_pk_add_f32 v[172:173], v[172:173], v[188:189]
 v_pk_add_f32 v[174:175], v[174:175], v[190:191]
 v_pk_add_f32 v[176:177], v[176:177], v[192:193]
 v_pk_add_f32 v[178:179], v[178:179], v[194:195]
 ds_read_b128 v[188:191], v225 offset:12800
 ds_read_b128 v[192:195], v225 offset:12816
 s_waitcnt lgkmcnt(0)
 v_pk_add_f32 v[172:173], v[172:173], v[188:189]
 v_pk_add_f32 v[174:175], v[174:175], v[190:191]
 v_pk_add_f32 v[176:177], v[176:177], v[192:193]
 v_pk_add_f32 v[178:179], v[178:179], v[194:195]
 ds_read_b128 v[188:191], v225 offset:15104
 ds_read_b128 v[192:195], v225 offset:15120
 s_waitcnt lgkmcnt(0)
 v_pk_add_f32 v[172:173], v[172:173], v[188:189]
 v_pk_add_f32 v[174:175], v[174:175], v[190:191]
 v_pk_add_f32 v[176:177], v[176:177], v[192:193]
 v_pk_add_f32 v[178:179], v[178:179], v[194:195]
 v_mov_b32 v180, 0
 v_mov_b32 v181, 0
 v_mov_b32 v182, 0
 v_mov_b32 v183, 0
 v_mov_b32 v184, 0
 v_mov_b32 v185, 0
 v_mov_b32 v186, 0
 v_mov_b32 v187, 0
 s_mov_b64 exec, 0xff
 ds_read_b128 v[180:183], v225 offset:10240
 ds_read_b128 v[184:187], v225 offset:10256
 ds_read_b128 v[188:191], v225 offset:12544
 ds_read_b128 v[192:195], v225 offset:12560
 s_waitcnt lgkmcnt(0)
 v_pk_add_f32 v[180:181], v[180:181], v[188:189]
 v_pk_add_f32 v[182:183], v[182:183], v[190:191]
 v_pk_add_f32 v[184:185], v[184:185], v[192:193]
 v_pk_add_f32 v[186:187], v[186:187], v[194:195]
 ds_read_b128 v[188:191], v225 offset:14848
 ds_read_b128 v[192:195], v225 offset:14864
 s_waitcnt lgkmcnt(0)
 v_pk_add_f32 v[180:181], v[180:181], v[188:189]
 v_pk_add_f32 v[182:183], v[182:183], v[190:191]
 v_pk_add_f32 v[184:185], v[184:185], v[192:193]
 v_pk_add_f32 v[186:187], v[186:187], v[194:195]
 ds_read_b128 v[188:191], v225 offset:17152
 ds_read_b128 v[192:195], v225 offset:17168
 s_waitcnt lgkmcnt(0)
 v_pk_add_f32 v[180:181], v[180:181], v[188:189]
 v_pk_add_f32 v[182:183], v[182:183], v[190:191]
 v_pk_add_f32 v[184:185], v[184:185], v[192:193]
 v_pk_add_f32 v[186:187], v[186:187], v[194:195]
 s_mov_b64 exec, -1
 v_cvt_pk_bf16_f32 v204, v172, v173
 v_lshlrev_b32 v172, 16, v204
 v_and_b32 v173, s96, v204
 v_lshlrev_b32 v205, 16, v208
 v_and_b32 v206, s96, v208
 v_add_f32 v172, v172, v205
 v_add_f32 v173, v173, v206
 v_cvt_pk_bf16_f32 v120, v172, v173
 v_lshlrev_b32 v172, 16, v120
 v_and_b32 v173, s96, v120
 v_cvt_pk_bf16_f32 v204, v174, v175
 v_lshlrev_b32 v174, 16, v204
 v_and_b32 v175, s96, v204
 v_lshlrev_b32 v205, 16, v209
 v_and_b32 v206, s96, v209
 v_add_f32 v174, v174, v205
 v_add_f32 v175, v175, v206
 v_cvt_pk_bf16_f32 v121, v174, v175
 v_lshlrev_b32 v174, 16, v121
 v_and_b32 v175, s96, v121
 v_cvt_pk_bf16_f32 v204, v176, v177
 v_lshlrev_b32 v176, 16, v204
 v_and_b32 v177, s96, v204
 v_lshlrev_b32 v205, 16, v210
 v_and_b32 v206, s96, v210
 v_add_f32 v176, v176, v205
 v_add_f32 v177, v177, v206
 v_cvt_pk_bf16_f32 v122, v176, v177
 v_lshlrev_b32 v176, 16, v122
 v_and_b32 v177, s96, v122
 v_cvt_pk_bf16_f32 v204, v178, v179
 v_lshlrev_b32 v178, 16, v204
 v_and_b32 v179, s96, v204
 v_lshlrev_b32 v205, 16, v211
 v_and_b32 v206, s96, v211
 v_add_f32 v178, v178, v205
 v_add_f32 v179, v179, v206
 v_cvt_pk_bf16_f32 v123, v178, v179
 v_lshlrev_b32 v178, 16, v123
 v_and_b32 v179, s96, v123
 v_cvt_pk_bf16_f32 v204, v180, v181
 v_lshlrev_b32 v180, 16, v204
 v_and_b32 v181, s96, v204
 v_lshlrev_b32 v205, 16, v212
 v_and_b32 v206, s96, v212
 v_add_f32 v180, v180, v205
 v_add_f32 v181, v181, v206
 v_cvt_pk_bf16_f32 v124, v180, v181
 v_lshlrev_b32 v180, 16, v124
 v_and_b32 v181, s96, v124
 v_cvt_pk_bf16_f32 v204, v182, v183
 v_lshlrev_b32 v182, 16, v204
 v_and_b32 v183, s96, v204
 v_lshlrev_b32 v205, 16, v213
 v_and_b32 v206, s96, v213
 v_add_f32 v182, v182, v205
 v_add_f32 v183, v183, v206
 v_cvt_pk_bf16_f32 v125, v182, v183
 v_lshlrev_b32 v182, 16, v125
 v_and_b32 v183, s96, v125
 v_cvt_pk_bf16_f32 v204, v184, v185
 v_lshlrev_b32 v184, 16, v204
 v_and_b32 v185, s96, v204
 v_lshlrev_b32 v205, 16, v214
 v_and_b32 v206, s96, v214
 v_add_f32 v184, v184, v205
 v_add_f32 v185, v185, v206
 v_cvt_pk_bf16_f32 v126, v184, v185
 v_lshlrev_b32 v184, 16, v126
 v_and_b32 v185, s96, v126
 v_cvt_pk_bf16_f32 v204, v186, v187
 v_lshlrev_b32 v186, 16, v204
 v_and_b32 v187, s96, v204
 v_lshlrev_b32 v205, 16, v215
 v_and_b32 v206, s96, v215
 v_add_f32 v186, v186, v205
 v_add_f32 v187, v187, v206
 v_cvt_pk_bf16_f32 v127, v186, v187
 v_lshlrev_b32 v186, 16, v127
 v_and_b32 v187, s96, v127
 s_add_u32 s61, s60, 75497472
 buffer_store_dwordx4 v[120:123], v221, s[4:7], s61 offen sc1
 s_mov_b64 exec, 0xff
 buffer_store_dwordx4 v[124:127], v221, s[4:7], s61 offen offset:1024 sc1
 s_mov_b64 exec, -1
 v_pk_add_f32 v[204:205], v[172:173], v[174:175]
 v_pk_add_f32 v[204:205], v[204:205], v[176:177]
 v_pk_add_f32 v[204:205], v[204:205], v[178:179]
 v_pk_add_f32 v[204:205], v[204:205], v[180:181]
 v_pk_add_f32 v[204:205], v[204:205], v[182:183]
 v_pk_add_f32 v[204:205], v[204:205], v[184:185]
 v_pk_add_f32 v[204:205], v[204:205], v[186:187]
 v_add_f32 v204, v204, v205
 s_nop 1
 v_add_f32_dpp v204, v204, v204 quad_perm:[1,0,3,2] row_mask:0xf bank_mask:0xf
 s_nop 1
 v_add_f32_dpp v204, v204, v204 quad_perm:[2,3,0,1] row_mask:0xf bank_mask:0xf
 s_nop 1
 v_add_f32_dpp v204, v204, v204 row_half_mirror row_mask:0xf bank_mask:0xf
 s_nop 1
 v_add_f32_dpp v204, v204, v204 row_ror:8 row_mask:0xf bank_mask:0xf
 v_mov_b32 v205, v204
 s_nop 1
 v_permlane32_swap_b32 v204, v205
 v_add_f32 v204, v204, v205
 v_mov_b32 v205, v204
 s_nop 1
 v_permlane16_swap_b32 v204, v205
 v_add_f32 v204, v204, v205
 v_mul_f32 v204, 0x3ae38e39, v204
 v_mov_b32 v205, 0
 v_mov_b32 v206, 0
 v_sub_f32 v207, v172, v204
 v_fmac_f32 v205, v207, v207
 v_sub_f32 v207, v173, v204
 v_fmac_f32 v205, v207, v207
 v_sub_f32 v207, v174, v204
 v_fmac_f32 v205, v207, v207
 v_sub_f32 v207, v175, v204
 v_fmac_f32 v205, v207, v207
 v_sub_f32 v207, v176, v204
 v_fmac_f32 v205, v207, v207
 v_sub_f32 v207, v177, v204
 v_fmac_f32 v205, v207, v207
 v_sub_f32 v207, v178, v204
 v_fmac_f32 v205, v207, v207
 v_sub_f32 v207, v179, v204
 v_fmac_f32 v205, v207, v207
 v_sub_f32 v207, v180, v204
 v_fmac_f32 v206, v207, v207
 v_sub_f32 v207, v181, v204
 v_fmac_f32 v206, v207, v207
 v_sub_f32 v207, v182, v204
 v_fmac_f32 v206, v207, v207
 v_sub_f32 v207, v183, v204
 v_fmac_f32 v206, v207, v207
 v_sub_f32 v207, v184, v204
 v_fmac_f32 v206, v207, v207
 v_sub_f32 v207, v185, v204
 v_fmac_f32 v206, v207, v207
 v_sub_f32 v207, v186, v204
 v_fmac_f32 v206, v207, v207
 v_sub_f32 v207, v187, v204
 v_fmac_f32 v206, v207, v207
 v_cmp_gt_u32 vcc, 8, v220
 s_nop 1
 v_cndmask_b32 v206, 0, v206, vcc
 v_add_f32 v205, v205, v206
 s_nop 1
 v_add_f32_dpp v205, v205, v205 quad_perm:[1,0,3,2] row_mask:0xf bank_mask:0xf
 s_nop 1
 v_add_f32_dpp v205, v205, v205 quad_perm:[2,3,0,1] row_mask:0xf bank_mask:0xf
 s_nop 1
 v_add_f32_dpp v205, v205, v205 row_half_mirror row_mask:0xf bank_mask:0xf
 s_nop 1
 v_add_f32_dpp v205, v205, v205 row_ror:8 row_mask:0xf bank_mask:0xf
 v_mov_b32 v206, v205
 s_nop 1
 v_permlane32_swap_b32 v205, v206
 v_add_f32 v205, v205, v206
 v_mov_b32 v206, v205
 s_nop 1
 v_permlane16_swap_b32 v205, v206
 v_add_f32 v205, v205, v206
 v_mul_f32 v205, 0x3ae38e39, v205
 v_cvt_pk_bf16_f32 v206, v204, v204
 v_lshlrev_b32 v204, 16, v206
 v_cvt_pk_bf16_f32 v206, v205, v205
 v_lshlrev_b32 v205, 16, v206
 v_add_f32 v205, 0x3727c5ac, v205
 v_cvt_pk_bf16_f32 v206, v205, v205
 v_lshlrev_b32 v205, 16, v206
 v_sqrt_f32 v205, v205
 s_nop 0
 v_cvt_pk_bf16_f32 v206, v205, v205
 v_lshlrev_b32 v205, 16, v206
 v_rcp_f32 v205, v205
 s_nop 0
 v_sub_f32 v172, v172, v204
 v_sub_f32 v173, v173, v204
 v_cvt_pk_bf16_f32 v206, v172, v173
 v_lshlrev_b32 v172, 16, v206
 v_and_b32 v173, s96, v206
 v_mul_f32 v172, v172, v205
 v_mul_f32 v173, v173, v205
 v_cvt_pk_bf16_f32 v128, v172, v173
 v_sub_f32 v174, v174, v204
 v_sub_f32 v175, v175, v204
 v_cvt_pk_bf16_f32 v206, v174, v175
 v_lshlrev_b32 v174, 16, v206
 v_and_b32 v175, s96, v206
 v_mul_f32 v174, v174, v205
 v_mul_f32 v175, v175, v205
 v_cvt_pk_bf16_f32 v129, v174, v175
 v_sub_f32 v176, v176, v204
 v_sub_f32 v177, v177, v204
 v_cvt_pk_bf16_f32 v206, v176, v177
 v_lshlrev_b32 v176, 16, v206
 v_and_b32 v177, s96, v206
 v_mul_f32 v176, v176, v205
 v_mul_f32 v177, v177, v205
 v_cvt_pk_bf16_f32 v130, v176, v177
 v_sub_f32 v178, v178, v204
 v_sub_f32 v179, v179, v204
 v_cvt_pk_bf16_f32 v206, v178, v179
 v_lshlrev_b32 v178, 16, v206
 v_and_b32 v179, s96, v206
 v_mul_f32 v178, v178, v205
 v_mul_f32 v179, v179, v205
 v_cvt_pk_bf16_f32 v131, v178, v179
 v_sub_f32 v180, v180, v204
 v_sub_f32 v181, v181, v204
 v_cvt_pk_bf16_f32 v206, v180, v181
 v_lshlrev_b32 v180, 16, v206
 v_and_b32 v181, s96, v206
 v_mul_f32 v180, v180, v205
 v_mul_f32 v181, v181, v205
 v_cvt_pk_bf16_f32 v132, v180, v181
 v_sub_f32 v182, v182, v204
 v_sub_f32 v183, v183, v204
 v_cvt_pk_bf16_f32 v206, v182, v183
 v_lshlrev_b32 v182, 16, v206
 v_and_b32 v183, s96, v206
 v_mul_f32 v182, v182, v205
 v_mul_f32 v183, v183, v205
 v_cvt_pk_bf16_f32 v133, v182, v183
 v_sub_f32 v184, v184, v204
 v_sub_f32 v185, v185, v204
 v_cvt_pk_bf16_f32 v206, v184, v185
 v_lshlrev_b32 v184, 16, v206
 v_and_b32 v185, s96, v206
 v_mul_f32 v184, v184, v205
 v_mul_f32 v185, v185, v205
 v_cvt_pk_bf16_f32 v134, v184, v185
 v_sub_f32 v186, v186, v204
 v_sub_f32 v187, v187, v204
 v_cvt_pk_bf16_f32 v206, v186, v187
 v_lshlrev_b32 v186, 16, v206
 v_and_b32 v187, s96, v206
 v_mul_f32 v186, v186, v205
 v_mul_f32 v187, v187, v205
 v_cvt_pk_bf16_f32 v135, v186, v187
 v_lshrrev_b32 v204, 2, v220
 v_lshlrev_b32 v204, 11, v204
 v_and_b32 v205, 3, v220
 v_lshlrev_b32 v205, 8, v205
 v_add_u32 v204, v204, v205
 s_mul_i32 s61, s64, 36864
 s_lshr_b32 s62, s46, 4
 s_lshl_b32 s62, s62, 10
 s_add_u32 s61, s61, s62
 s_and_b32 s62, s46, 15
 s_lshl_b32 s62, s62, 4
 s_add_u32 s61, s61, s62
 s_add_u32 s61, s61, 79691776
 buffer_store_dwordx4 v[128:131], v204, s[4:7], s61 offen sc1
 s_add_u32 s61, s61, 32768
 s_mov_b64 exec, 0xff
 buffer_store_dwordx4 v[132:135], v204, s[4:7], s61 offen sc1
 s_mov_b64 exec, -1
 s_lshl_b32 s60, s64, 7
 s_lshl_b32 s61, s46, 2
 s_add_u32 s60, s60, s61
 s_add_u32 s20, s60, 73416704
L89:
 s_add_u32 s64, s64, 3
 s_cmp_lt_u32 s64, 64
 s_cbranch_scc0 L90
 s_waitcnt vmcnt(0)
 s_cmp_eq_u32 s20, -1
 s_cbranch_scc1 L91
 v_mov_b32 v232, 0
 v_mov_b32 v233, s21
 s_mov_b64 exec, 1
 buffer_store_dword v233, v232, s[4:7], s20 offen sc1
 s_mov_b64 exec, -1
 s_mov_b32 s20, -1
L91:
 s_barrier
 ds_read_b128 v[192:195], v221 offset:17408
 ds_read_b128 v[196:199], v221 offset:18432
 s_waitcnt lgkmcnt(1)
 v_mfma_f32_32x32x16_bf16 v[152:167], a[160:163], v[192:195], 0
 ds_read_b128 v[200:203], v221 offset:19456
 s_waitcnt lgkmcnt(1)
 v_mfma_f32_32x32x16_bf16 v[152:167], a[164:167], v[196:199], v[152:167]
 ds_read_b128 v[192:195], v221 offset:20480
 s_waitcnt lgkmcnt(1)
 v_mfma_f32_32x32x16_bf16 v[152:167], a[168:171], v[200:203], v[152:167]
 ds_read_b128 v[196:199], v221 offset:21504
 s_waitcnt lgkmcnt(1)
 v_mfma_f32_32x32x16_bf16 v[152:167], a[172:175], v[192:195], v[152:167]
 ds_read_b128 v[200:203], v221 offset:22528
 s_waitcnt lgkmcnt(1)
 v_mfma_f32_32x32x16_bf16 v[152:167], a[176:179], v[196:199], v[152:167]
 ds_read_b128 v[192:195], v221 offset:23552
 s_waitcnt lgkmcnt(1)
 v_mfma_f32_32x32x16_bf16 v[152:167], a[180:183], v[200:203], v[152:167]
 ds_read_b128 v[196:199], v221 offset:24576
 s_waitcnt lgkmcnt(1)
 v_mfma_f32_32x32x16_bf16 v[152:167], a[184:187], v[192:195], v[152:167]
 ds_read_b128 v[200:203], v221 offset:25600
 s_waitcnt lgkmcnt(1)
 v_mfma_f32_32x32x16_bf16 v[152:167], a[188:191], v[196:199], v[152:167]
 ds_read_b128 v[192:195], v221 offset:26624
 s_waitcnt lgkmcnt(1)
 v_mfma_f32_32x32x16_bf16 v[152:167], a[192:195], v[200:203], v[152:167]
 ds_read_b128 v[196:199], v221 offset:27648
 s_waitcnt lgkmcnt(1)
 v_mfma_f32_32x32x16_bf16 v[152:167], a[196:199], v[192:195], v[152:167]
 ds_read_b128 v[200:203], v221 offset:28672
 s_waitcnt lgkmcnt(1)
 v_mfma_f32_32x32x16_bf16 v[152:167], a[200:203], v[196:199], v[152:167]
 ds_read_b128 v[192:195], v221 offset:29696
 s_waitcnt lgkmcnt(1)
 v_mfma_f32_32x32x16_bf16 v[152:167], a[204:207], v[200:203], v[152:167]
 ds_read_b128 v[196:199], v221 offset:30720
 s_waitcnt lgkmcnt(1)
 v_mfma_f32_32x32x16_bf16 v[152:167], a[208:211], v[192:195], v[152:167]
 ds_read_b128 v[200:203], v221 offset:31744
 s_waitcnt lgkmcnt(1)
 v_mfma_f32_32x32x16_bf16 v[152:167], a[212:215], v[196:199], v[152:167]
 ds_read_b128 v[192:195], v221 offset:32768
 s_waitcnt lgkmcnt(1)
 v_mfma_f32_32x32x16_bf16 v[152:167], a[216:219], v[200:203], v[152:167]
 ds_read_b128 v[196:199], v221 offset:33792
 s_waitcnt lgkmcnt(1)
 v_mfma_f32_32x32x16_bf16 v[152:167], a[220:223], v[192:195], v[152:167]
 ds_read_b128 v[200:203], v221 offset:34816
 s_waitcnt lgkmcnt(1)
 v_mfma_f32_32x32x16_bf16 v[152:167], a[224:227], v[196:199], v[152:167]
 ds_read_b128 v[192:195], v221 offset:35840
 s_waitcnt lgkmcnt(1)
 v_mfma_f32_32x32x16_bf16 v[152:167], a[228:231], v[200:203], v[152:167]
 ds_read_b128 v[196:199], v221 offset:36864
 s_waitcnt lgkmcnt(1)
 v_mfma_f32_32x32x16_bf16 v[152:167], a[232:235], v[192:195], v[152:167]
 ds_read_b128 v[200:203], v221 offset:37888
 s_waitcnt lgkmcnt(1)
 v_mfma_f32_32x32x16_bf16 v[152:167], a[236:239], v[196:199], v[152:167]
 ds_read_b128 v[192:195], v221 offset:38912
 s_waitcnt lgkmcnt(1)
 v_mfma_f32_32x32x16_bf16 v[152:167], a[240:243], v[200:203], v[152:167]
 ds_read_b128 v[196:199], v221 offset:39936
 s_waitcnt lgkmcnt(1)
 v_mfma_f32_32x32x16_bf16 v[152:167], a[244:247], v[192:195], v[152:167]
 ds_read_b128 v[200:203], v221 offset:40960
 s_waitcnt lgkmcnt(1)
 v_mfma_f32_32x32x16_bf16 v[152:167], a[248:251], v[196:199], v[152:167]
 ds_read_b128 v[192:195], v221 offset:41984
 ds_read_b128 v[204:207], v217 offset:0
 s_waitcnt lgkmcnt(2)
 v_mfma_f32_32x32x16_bf16 v[152:167], a[252:255], v[200:203], v[152:167]
 ds_read_b128 v[196:199], v221 offset:43008
 ds_read_b128 v[232:235], v217 offset:1024
 s_waitcnt lgkmcnt(2)
 v_mfma_f32_32x32x16_bf16 v[152:167], v[204:207], v[192:195], v[152:167]
 ds_read_b128 v[200:203], v221 offset:44032
 ds_read_b128 v[204:207], v217 offset:2048
 s_waitcnt lgkmcnt(2)
 v_mfma_f32_32x32x16_bf16 v[152:167], v[232:235], v[196:199], v[152:167]
 ds_read_b128 v[192:195], v221 offset:45056
 ds_read_b128 v[232:235], v217 offset:3072
 s_waitcnt lgkmcnt(2)
 v_mfma_f32_32x32x16_bf16 v[152:167], v[204:207], v[200:203], v[152:167]
 ds_read_b128 v[196:199], v221 offset:46080
 ds_read_b128 v[204:207], v217 offset:4096
 s_waitcnt lgkmcnt(2)
 v_mfma_f32_32x32x16_bf16 v[152:167], v[232:235], v[192:195], v[152:167]
 ds_read_b128 v[200:203], v221 offset:47104
 ds_read_b128 v[232:235], v217 offset:5120
 s_waitcnt lgkmcnt(2)
 v_mfma_f32_32x32x16_bf16 v[152:167], v[204:207], v[196:199], v[152:167]
 ds_read_b128 v[192:195], v221 offset:48128
 ds_read_b128 v[204:207], v217 offset:6144
 s_waitcnt lgkmcnt(2)
 v_mfma_f32_32x32x16_bf16 v[152:167], v[232:235], v[200:203], v[152:167]
 ds_read_b128 v[196:199], v221 offset:49152
 ds_read_b128 v[232:235], v217 offset:7168
 s_waitcnt lgkmcnt(2)
 v_mfma_f32_32x32x16_bf16 v[152:167], v[204:207], v[192:195], v[152:167]
 ds_read_b128 v[200:203], v221 offset:50176
 ds_read_b128 v[204:207], v217 offset:8192
 s_waitcnt lgkmcnt(2)
 v_mfma_f32_32x32x16_bf16 v[152:167], v[232:235], v[196:199], v[152:167]
 ds_read_b128 v[192:195], v221 offset:51200
 ds_read_b128 v[232:235], v217 offset:9216
 s_waitcnt lgkmcnt(2)
 v_mfma_f32_32x32x16_bf16 v[152:167], v[204:207], v[200:203], v[152:167]
 ds_read_b128 v[196:199], v221 offset:52224
 ds_read_b128 v[204:207], v217 offset:10240
 s_waitcnt lgkmcnt(2)
 v_mfma_f32_32x32x16_bf16 v[152:167], v[232:235], v[192:195], v[152:167]
 ds_read_b128 v[200:203], v221 offset:53248
 ds_read_b128 v[232:235], v217 offset:11264
 s_waitcnt lgkmcnt(2)
 v_mfma_f32_32x32x16_bf16 v[152:167], v[204:207], v[196:199], v[152:167]
 s_waitcnt lgkmcnt(0)
 v_mfma_f32_32x32x16_bf16 v[152:167], v[232:235], v[200:203], v[152:167]
 s_nop 7
 s_nop 3
 v_cvt_pk_bf16_f32 v168, v152, v153
 v_cvt_pk_bf16_f32 v169, v154, v155
 v_cvt_pk_bf16_f32 v170, v156, v157
 v_cvt_pk_bf16_f32 v171, v158, v159
 ds_write_b128 v216, v[168:171] offset:0
 v_cvt_pk_bf16_f32 v172, v160, v161
 v_cvt_pk_bf16_f32 v173, v162, v163
 v_cvt_pk_bf16_f32 v174, v164, v165
 v_cvt_pk_bf16_f32 v175, v166, v167
 ds_write_b128 v216, v[172:175] offset:256
 s_waitcnt lgkmcnt(0)
 s_barrier
 s_and_b32 s60, s44, 1
 s_lshl_b32 s60, s60, 12
 v_add_u32 v232, s60, v221
 ds_read_b128 v[0:3], v232 offset:54272
 ds_read_b128 v[4:7], v232 offset:55296
 ds_read_b128 v[8:11], v232 offset:56320
 ds_read_b128 v[12:15], v232 offset:57344
 s_branch T2_LOOP59
L90:
 s_waitcnt vmcnt(0)
 s_cmp_eq_u32 s44, 0
 s_cbranch_scc0 L92
 v_mov_b32 v232, 0
 v_mov_b32 v233, s21
 s_mov_b64 exec, 1
 buffer_store_dword v233, v232, s[4:7], s20 offen sc1
 s_mov_b64 exec, -1
L92:
 s_waitcnt vmcnt(0)
 s_endpgm
F_CHAIN:
 v_and_b32 v1, 63, v0
 v_mov_b32 v61, v1
 v_and_b32 v2, 8, v1
 v_cmp_eq_u32 vcc, 0, v2
 v_mov_b32 v3, 0xeeee
 v_mov_b32 v4, 0x4444
 v_lshlrev_b32 v5, 4, v1
 v_cndmask_b32 v48, v3, v4, vcc
 v_add_u32 v49, 131072, v5
 s_lshl_b32 s92, s44, 12
 v_add_u32 v50, s92, v5
 s_lshl_b32 s60, s44, 11
 v_add_u32 v58, s60, v49
 v_mov_b32 v57, v5
 v_and_b32 v7, 15, v1
 v_bfe_u32 v8, v1, 4, 1
 v_lshrrev_b32 v9, 5, v1
 v_lshlrev_b32 v6, 11, v9
 v_lshlrev_b32 v10, 4, v7
 v_add_u32 v6, v6, v10
 v_lshlrev_b32 v10, 3, v8
 v_add_u32 v6, v6, v10
 s_lshl_b32 s60, s44, 9
 s_add_u32 s60, s60, 156672
 v_add_u32 v51, s60, v6
 v_lshlrev_b32 v6, 8, v8
 v_lshlrev_b32 v10, 6, v9
 v_add_u32 v6, v6, v10
 v_bfe_u32 v10, v1, 2, 2
 v_lshlrev_b32 v10, 4, v10
 v_add_u32 v6, v6, v10
 v_and_b32 v10, 1, v1
 v_lshlrev_b32 v10, 3, v10
 v_add_u32 v6, v6, v10
 v_add_u32 v52, 156672, v6
 v_lshlrev_b32 v6, 7, v9
 v_lshlrev_b32 v10, 4, v7
 v_add_u32 v6, v6, v10
 v_lshlrev_b32 v10, 3, v8
 v_add_u32 v6, v6, v10
 s_lshr_b32 s60, s44, 1
 s_lshl_b32 s60, s60, 10
 s_and_b32 s61, s44, 1
 s_lshl_b32 s61, s61, 9
 s_add_u32 s60, s60, s61
 s_add_u32 s60, s60, 160768
 v_add_u32 v53, s60, v6
 v_lshlrev_b32 v6, 8, v9
 v_lshlrev_b32 v10, 7, v8
 v_add_u32 v6, v6, v10
 v_and_b32 v10, 7, v1
 v_lshlrev_b32 v10, 4, v10
 v_add_u32 v6, v6, v10
 v_add_u32 v59, 131072, v6
 s_lshl_b32 s60, s46, 13
 s_lshl_b32 s61, s44, 10
 s_add_u32 s60, s60, s61
 s_add_u32 s60, s60, 54525952
 v_add_u32 v62, s60, v5
 s_mul_i32 s60, s46, 10240
 s_lshl_b32 s61, s44, 11
 s_add_u32 s60, s60, s61
 s_add_u32 s60, s60, 72351744
 v_add_u32 v54, s60, v5
 v_cmp_gt_u32 vcc, 32, v1
 v_mov_b32 v6, 1.0
 v_mov_b32 v10, 0
 v_cndmask_b32 v60, v10, v6, vcc
 s_mov_b32 s72, 0
 s_mov_b32 s60, s46
 s_cmp_eq_u32 s44, 0
 s_cselect_b32 s72, 1, 0
 s_cmp_eq_u32 s44, 1
 s_cbranch_scc0 L93
 s_cmp_lt_u32 s46, 8
 s_cbranch_scc0 L93
 s_mov_b32 s72, 2
 s_add_u32 s60, s46, 32
L93:
 v_lshrrev_b32 v6, 4, v1
 v_mul_u32_u24 v6, 10240, v6
 v_lshlrev_b32 v10, 4, v7
 v_add_u32 v6, v6, v10
 s_lshl_b32 s61, s60, 8
 s_add_u32 s61, s61, 72351744
 v_add_u32 v55, s61, v6
 s_mov_b32 s64, 0
 s_mov_b32 s65, 40960
 s_mov_b32 s66, 81920
 s_mov_b32 s67, 122880
 s_mov_b32 s68, 163840
 s_mov_b32 s69, 204800
 s_mov_b32 s70, 245760
 s_mov_b32 s71, 286720
 s_cmp_eq_u32 s72, 2
 s_cbranch_scc0 L94
 s_sub_u32 s61, s60, 32
 s_lshr_b32 s61, s61, 1
 s_mul_i32 s61, s61, 9
 s_add_u32 s61, s61, 8
 v_mov_b32 v10, s61
 s_mov_b32 s82, 0x000f000f
 s_branch L95
L94:
 s_lshr_b32 s61, s60, 3
 s_mul_i32 s61, s61, 9
 s_bfe_u32 s62, s60, 0x10002
 s_lshl_b32 s62, s62, 2
 s_add_u32 s61, s61, s62
 s_bfe_u32 s62, s60, 0x10001
 s_add_u32 s61, s61, s62
 v_bfe_u32 v10, v1, 2, 1
 v_lshlrev_b32 v10, 1, v10
 v_add_u32 v10, s61, v10
 s_mov_b32 s82, 0x00ff00ff
L95:
 s_mov_b32 s83, s82
 s_and_b32 s62, s60, 1
 s_lshl_b32 s62, s62, 2
 v_and_b32 v11, 3, v1
 v_add_u32 v11, s62, v11
 v_lshrrev_b32 v12, 2, v10
 v_lshlrev_b32 v12, 10, v12
 v_and_b32 v13, 3, v10
 v_lshlrev_b32 v13, 8, v13
 v_add_u32 v12, v12, v13
 v_lshlrev_b32 v13, 7, v9
 v_add_u32 v12, v12, v13
 v_lshlrev_b32 v13, 4, v11
 v_add_u32 v12, v12, v13
 v_lshlrev_b32 v13, 3, v8
 v_add_u32 v12, v12, v13
 v_add_u32 v56, 71303168, v12
 s_mov_b32 s80, 0x3e0293ee
 s_mov_b32 s81, 0xbe0293ee
 s_mov_b32 s84, 0x00ff00ff
 s_mov_b32 s85, 0x00ff00ff
 s_mov_b32 s86, -1
 s_mov_b32 s87, 0x003fffff
 s_mov_b32 s88, -1
 s_mov_b32 s89, 0
 s_mov_b32 s91, 8192
 v_lshlrev_b32 v6, 4, v0
 s_mul_i32 s62, s46, 10240
 s_add_u32 s63, s62, 72351744
 v_add_u32 v7, s63, v6
 s_mul_i32 s62, s46, 18432
 s_add_u32 s63, s62, 71303168
 v_add_u32 v9, s63, v6
 v_mov_b32 v12, 0
 v_mov_b32 v13, 0
 v_mov_b32 v14, 0
 v_mov_b32 v15, 0
 v_mov_b32 v16, -1
 v_mov_b32 v17, -1
 v_mov_b32 v18, -1
 v_mov_b32 v19, -1
 s_mov_b32 s63, 0
 buffer_store_dwordx4 v[12:15], v7, s[4:7], s63 offen
 buffer_store_dwordx4 v[16:19], v9, s[4:7], s63 offen
 s_mov_b32 s63, 4096
 buffer_store_dwordx4 v[12:15], v7, s[4:7], s63 offen
 buffer_store_dwordx4 v[16:19], v9, s[4:7], s63 offen
 s_mov_b32 s63, 8192
 buffer_store_dwordx4 v[16:19], v9, s[4:7], s63 offen
 s_mov_b32 s63, 12288
 buffer_store_dwordx4 v[16:19], v9, s[4:7], s63 offen
 s_cmp_ge_u32 s44, 2
 s_cbranch_scc1 L96
 s_mov_b32 s63, 8192
 buffer_store_dwordx4 v[12:15], v7, s[4:7], s63 offen
 s_mov_b32 s63, 16384
 buffer_store_dwordx4 v[16:19], v9, s[4:7], s63 offen
L96:
 s_mov_b32 s61, 0
 s_lshl_b32 s60, s46, 6
 s_add_u32 s60, s60, 73404416
 v_mov_b32 v11, s61
 s_mov_b64 exec, 1
 buffer_store_dword v11, v57, s[4:7], s60 offen sc1
 s_mov_b64 exec, -1
 s_mov_b32 s12, s20
 s_mov_b32 s13, s21
 s_mov_b32 s14, 4718592
 s_mov_b32 s15, 0x20000
 s_mov_b32 s48, s22
 s_mov_b32 s49, s23
 s_mov_b32 s50, 4718592
 s_mov_b32 s51, 0x20000
 s_mov_b32 s52, s24
 s_mov_b32 s53, s25
 s_mov_b32 s54, 4718592
 s_mov_b32 s55, 0x20000
 s_mov_b32 s56, s26
 s_mov_b32 s57, s27
 s_mov_b32 s58, 4718592
 s_mov_b32 s59, 0x20000
 v_mov_b32 v1, v61
 v_lshrrev_b32 v6, 4, v1
 s_lshl_b32 s60, s44, 4
 v_add_u32 v6, s60, v6
 v_lshlrev_b32 v6, 13, v6
 v_and_b32 v7, 15, v1
 v_lshlrev_b32 v7, 4, v7
 v_add_u32 v6, v6, v7
 s_lshl_b32 s60, s46, 8
 v_add_u32 v0, s60, v6
 s_mul_i32 s60, s46, 147456
 v_lshlrev_b32 v6, 4, v1
 v_add_u32 v2, s60, v6
 v_lshrrev_b32 v6, 2, v1
 v_lshlrev_b32 v6, 13, v6
 v_and_b32 v7, 3, v1
 v_lshlrev_b32 v8, 4, v7
 v_add_u32 v6, v6, v8
 s_lshl_b32 s60, s46, 8
 s_lshl_b32 s61, s44, 6
 s_add_u32 s60, s60, s61
 v_add_u32 v3, s60, v6
 v_lshlrev_b32 v7, 3, v7
 v_lshrrev_b32 v6, 5, v1
 v_lshlrev_b32 v6, 3, v6
 v_bfe_u32 v8, v1, 4, 1
 v_lshlrev_b32 v8, 2, v8
 v_add_u32 v6, v6, v8
 v_bfe_u32 v8, v1, 2, 1
 v_add_u32 v6, v6, v8
 v_bfe_u32 v9, v1, 3, 1
 v_lshlrev_b32 v8, 8, v6
 v_add_u32 v8, v8, v7
 s_lshl_b32 s60, s44, 6
 v_add_u32 v8, s60, v8
 v_lshlrev_b32 v10, 14, v9
 v_add_u32 v4, v10, v8
 v_lshlrev_b32 v10, 5, v9
 v_add_u32 v5, v10, v8
 v_lshlrev_b32 v8, 6, v6
 v_add_u32 v8, v8, v7
 v_add_u32 v8, v8, v10
 v_add_u32 v14, s92, v8
 v_mul_u32_u24 v8, 1152, v6
 v_add_u32 v8, v8, v7
 v_add_u32 v8, v8, v10
 s_mul_i32 s60, s44, 288
 v_add_u32 v12, s60, v8
 v_lshrrev_b32 v6, 5, v1
 v_lshlrev_b32 v6, 4, v6
 v_bfe_u32 v8, v1, 4, 1
 v_lshlrev_b32 v8, 2, v8
 v_add_u32 v6, v6, v8
 v_bfe_u32 v8, v1, 2, 1
 v_add_u32 v6, v6, v8
 v_lshlrev_b32 v8, 3, v9
 v_add_u32 v6, v6, v8
 v_mul_u32_u24 v8, 1152, v6
 v_add_u32 v8, v8, v7
 v_add_u32 v13, s60, v8
 s_lshl_b32 s93, s44, 12
 s_mul_i32 s63, s46, 7
 s_mul_i32 s62, s44, 9
 s_add_u32 s63, s63, s62
 s_mul_hi_u32 s62, s63, 0x71c71c8
 s_mul_i32 s62, s62, 36
 s_sub_u32 s63, s63, s62
 s_lshl_b32 s63, s63, 10
 v_lshrrev_b32 v6, 4, v1
 v_and_b32 v7, 15, v1
 v_and_b32 v8, 1, v6
 s_lshl_b32 s60, s44, 4
 v_add_u32 v6, s60, v6
 v_lshlrev_b32 v6, 13, v6
 s_lshl_b32 s60, s46, 8
 v_add_u32 v6, s60, v6
 v_add_u32 v10, 0, v8
 v_lshlrev_b32 v10, 1, v10
 v_sub_u32 v10, v7, v10
 v_and_b32 v10, 15, v10
 v_lshlrev_b32 v10, 4, v10
 v_add_u32 v32, v6, v10
 v_add_u32 v10, 4, v8
 v_lshlrev_b32 v10, 1, v10
 v_sub_u32 v10, v7, v10
 v_and_b32 v10, 15, v10
 v_lshlrev_b32 v10, 4, v10
 v_add_u32 v33, v6, v10
 v_add_u32 v10, 2, v8
 v_lshlrev_b32 v10, 1, v10
 v_sub_u32 v10, v7, v10
 v_and_b32 v10, 15, v10
 v_lshlrev_b32 v10, 4, v10
 v_add_u32 v34, v6, v10
 v_add_u32 v10, 6, v8
 v_lshlrev_b32 v10, 1, v10
 v_sub_u32 v10, v7, v10
 v_and_b32 v10, 15, v10
 v_lshlrev_b32 v10, 4, v10
 v_add_u32 v35, v6, v10
 v_bfe_u32 v6, v1, 2, 1
 v_bfe_u32 v7, v1, 4, 1
 v_lshlrev_b32 v7, 1, v7
 v_add_u32 v6, v6, v7
 v_lshlrev_b32 v7, 2, v9
 v_add_u32 v6, v6, v7
 s_lshl_b32 s60, s44, 1
 v_add_u32 v6, s60, v6
 v_lshrrev_b32 v7, 5, v1
 v_lshlrev_b32 v7, 3, v7
 v_bfe_u32 v8, v1, 4, 1
 v_lshlrev_b32 v8, 2, v8
 v_add_u32 v7, v7, v8
 v_bfe_u32 v8, v1, 2, 1
 v_add_u32 v7, v7, v8
 v_lshlrev_b32 v7, 8, v7
 v_lshlrev_b32 v8, 14, v9
 v_add_u32 v7, v7, v8
 v_and_b32 v8, 3, v1
 v_lshlrev_b32 v8, 3, v8
 v_add_u32 v7, v7, v8
 v_add_u32 v8, 0, v6
 v_and_b32 v8, 7, v8
 v_lshlrev_b32 v8, 5, v8
 v_add_u32 v36, v7, v8
 v_add_u32 v8, 1, v6
 v_and_b32 v8, 7, v8
 v_lshlrev_b32 v8, 5, v8
 v_add_u32 v37, v7, v8
 s_add_u32 s62, s63, 0
 s_sub_u32 s61, s62, 36864
 s_cmp_ge_u32 s62, 36864
 s_cselect_b32 s62, s61, s62
 s_add_u32 m0, s62, 0
 s_add_u32 s60, s62, 0
 buffer_load_dwordx4 v2, s[56:59], s60 offen lds
 s_add_u32 s62, s63, 1024
 s_sub_u32 s61, s62, 36864
 s_cmp_ge_u32 s62, 36864
 s_cselect_b32 s62, s61, s62
 s_add_u32 m0, s62, 0
 s_add_u32 s60, s62, 0
 buffer_load_dwordx4 v2, s[56:59], s60 offen lds
 s_add_u32 s62, s63, 2048
 s_sub_u32 s61, s62, 36864
 s_cmp_ge_u32 s62, 36864
 s_cselect_b32 s62, s61, s62
 s_add_u32 m0, s62, 0
 s_add_u32 s60, s62, 0
 buffer_load_dwordx4 v2, s[56:59], s60 offen lds
 s_add_u32 s62, s63, 3072
 s_sub_u32 s61, s62, 36864
 s_cmp_ge_u32 s62, 36864
 s_cselect_b32 s62, s61, s62
 s_add_u32 m0, s62, 0
 s_add_u32 s60, s62, 0
 buffer_load_dwordx4 v2, s[56:59], s60 offen lds
 s_add_u32 s62, s63, 4096
 s_sub_u32 s61, s62, 36864
 s_cmp_ge_u32 s62, 36864
 s_cselect_b32 s62, s61, s62
 s_add_u32 m0, s62, 0
 s_add_u32 s60, s62, 0
 buffer_load_dwordx4 v2, s[56:59], s60 offen lds
 s_add_u32 s62, s63, 5120
 s_sub_u32 s61, s62, 36864
 s_cmp_ge_u32 s62, 36864
 s_cselect_b32 s62, s61, s62
 s_add_u32 m0, s62, 0
 s_add_u32 s60, s62, 0
 buffer_load_dwordx4 v2, s[56:59], s60 offen lds
 s_add_u32 s62, s63, 6144
 s_sub_u32 s61, s62, 36864
 s_cmp_ge_u32 s62, 36864
 s_cselect_b32 s62, s61, s62
 s_add_u32 m0, s62, 0
 s_add_u32 s60, s62, 0
 buffer_load_dwordx4 v2, s[56:59], s60 offen lds
 s_add_u32 s62, s63, 7168
 s_sub_u32 s61, s62, 36864
 s_cmp_ge_u32 s62, 36864
 s_cselect_b32 s62, s61, s62
 s_add_u32 m0, s62, 0
 s_add_u32 s60, s62, 0
 buffer_load_dwordx4 v2, s[56:59], s60 offen lds
 s_add_u32 s62, s63, 8192
 s_sub_u32 s61, s62, 36864
 s_cmp_ge_u32 s62, 36864
 s_cselect_b32 s62, s61, s62
 s_add_u32 m0, s62, 0
 s_add_u32 s60, s62, 0
 buffer_load_dwordx4 v2, s[56:59], s60 offen lds
 s_add_u32 s62, s63, 0
 s_sub_u32 s61, s62, 36864
 s_cmp_ge_u32 s62, 36864
 s_cselect_b32 s62, s61, s62
 s_add_u32 m0, s62, 36864
 s_add_u32 s60, s62, 36864
 buffer_load_dwordx4 v2, s[56:59], s60 offen lds
 s_add_u32 s62, s63, 1024
 s_sub_u32 s61, s62, 36864
 s_cmp_ge_u32 s62, 36864
 s_cselect_b32 s62, s61, s62
 s_add_u32 m0, s62, 36864
 s_add_u32 s60, s62, 36864
 buffer_load_dwordx4 v2, s[56:59], s60 offen lds
 s_add_u32 s62, s63, 2048
 s_sub_u32 s61, s62, 36864
 s_cmp_ge_u32 s62, 36864
 s_cselect_b32 s62, s61, s62
 s_add_u32 m0, s62, 36864
 s_add_u32 s60, s62, 36864
 buffer_load_dwordx4 v2, s[56:59], s60 offen lds
 s_add_u32 s62, s63, 3072
 s_sub_u32 s61, s62, 36864
 s_cmp_ge_u32 s62, 36864
 s_cselect_b32 s62, s61, s62
 s_add_u32 m0, s62, 36864
 s_add_u32 s60, s62, 36864
 buffer_load_dwordx4 v2, s[56:59], s60 offen lds
 s_add_u32 s62, s63, 4096
 s_sub_u32 s61, s62, 36864
 s_cmp_ge_u32 s62, 36864
 s_cselect_b32 s62, s61, s62
 s_add_u32 m0, s62, 36864
 s_add_u32 s60, s62, 36864
 buffer_load_dwordx4 v2, s[56:59], s60 offen lds
 s_add_u32 s62, s63, 5120
 s_sub_u32 s61, s62, 36864
 s_cmp_ge_u32 s62, 36864
 s_cselect_b32 s62, s61, s62
 s_add_u32 m0, s62, 36864
 s_add_u32 s60, s62, 36864
 buffer_load_dwordx4 v2, s[56:59], s60 offen lds
 s_add_u32 s62, s63, 6144
 s_sub_u32 s61, s62, 36864
 s_cmp_ge_u32 s62, 36864
 s_cselect_b32 s62, s61, s62
 s_add_u32 m0, s62, 36864
 s_add_u32 s60, s62, 36864
 buffer_load_dwordx4 v2, s[56:59], s60 offen lds
 s_add_u32 s62, s63, 7168
 s_sub_u32 s61, s62, 36864
 s_cmp_ge_u32 s62, 36864
 s_cselect_b32 s62, s61, s62
 s_add_u32 m0, s62, 36864
 s_add_u32 s60, s62, 36864
 buffer_load_dwordx4 v2, s[56:59], s60 offen lds
 s_add_u32 s62, s63, 8192
 s_sub_u32 s61, s62, 36864
 s_cmp_ge_u32 s62, 36864
 s_cselect_b32 s62, s61, s62
 s_add_u32 m0, s62, 36864
 s_add_u32 s60, s62, 36864
 buffer_load_dwordx4 v2, s[56:59], s60 offen lds
 s_add_u32 s62, s63, 0
 s_sub_u32 s61, s62, 36864
 s_cmp_ge_u32 s62, 36864
 s_cselect_b32 s62, s61, s62
 s_add_u32 m0, s62, 73728
 s_add_u32 s60, s62, 73728
 buffer_load_dwordx4 v2, s[56:59], s60 offen lds
 s_add_u32 s62, s63, 1024
 s_sub_u32 s61, s62, 36864
 s_cmp_ge_u32 s62, 36864
 s_cselect_b32 s62, s61, s62
 s_add_u32 m0, s62, 73728
 s_add_u32 s60, s62, 73728
 buffer_load_dwordx4 v2, s[56:59], s60 offen lds
 s_add_u32 s62, s63, 2048
 s_sub_u32 s61, s62, 36864
 s_cmp_ge_u32 s62, 36864
 s_cselect_b32 s62, s61, s62
 s_add_u32 m0, s62, 73728
 s_add_u32 s60, s62, 73728
 buffer_load_dwordx4 v2, s[56:59], s60 offen lds
 s_add_u32 s62, s63, 3072
 s_sub_u32 s61, s62, 36864
 s_cmp_ge_u32 s62, 36864
 s_cselect_b32 s62, s61, s62
 s_add_u32 m0, s62, 73728
 s_add_u32 s60, s62, 73728
 buffer_load_dwordx4 v2, s[56:59], s60 offen lds
 s_add_u32 s62, s63, 4096
 s_sub_u32 s61, s62, 36864
 s_cmp_ge_u32 s62, 36864
 s_cselect_b32 s62, s61, s62
 s_add_u32 m0, s62, 73728
 s_add_u32 s60, s62, 73728
 buffer_load_dwordx4 v2, s[56:59], s60 offen lds
 s_add_u32 s62, s63, 5120
 s_sub_u32 s61, s62, 36864
 s_cmp_ge_u32 s62, 36864
 s_cselect_b32 s62, s61, s62
 s_add_u32 m0, s62, 73728
 s_add_u32 s60, s62, 73728
 buffer_load_dwordx4 v2, s[56:59], s60 offen lds
 s_add_u32 s62, s63, 6144
 s_sub_u32 s61, s62, 36864
 s_cmp_ge_u32 s62, 36864
 s_cselect_b32 s62, s61, s62
 s_add_u32 m0, s62, 73728
 s_add_u32 s60, s62, 73728
 buffer_load_dwordx4 v2, s[56:59], s60 offen lds
 s_add_u32 s62, s63, 7168
 s_sub_u32 s61, s62, 36864
 s_cmp_ge_u32 s62, 36864
 s_cselect_b32 s62, s61, s62
 s_add_u32 m0, s62, 73728
 s_add_u32 s60, s62, 73728
 buffer_load_dwordx4 v2, s[56:59], s60 offen lds
 s_add_u32 s62, s63, 8192
 s_sub_u32 s61, s62, 36864
 s_cmp_ge_u32 s62, 36864
 s_cselect_b32 s62, s61, s62
 s_add_u32 m0, s62, 73728
 s_add_u32 s60, s62, 73728
 buffer_load_dwordx4 v2, s[56:59], s60 offen lds
 s_add_u32 s62, s63, 0
 s_sub_u32 s61, s62, 36864
 s_cmp_ge_u32 s62, 36864
 s_cselect_b32 s62, s61, s62
 s_add_u32 m0, s62, 110592
 s_add_u32 s60, s62, 110592
 buffer_load_dwordx4 v2, s[56:59], s60 offen lds
 s_add_u32 s62, s63, 1024
 s_sub_u32 s61, s62, 36864
 s_cmp_ge_u32 s62, 36864
 s_cselect_b32 s62, s61, s62
 s_add_u32 m0, s62, 110592
 s_add_u32 s60, s62, 110592
 buffer_load_dwordx4 v2, s[56:59], s60 offen lds
 s_add_u32 s62, s63, 2048
 s_sub_u32 s61, s62, 36864
 s_cmp_ge_u32 s62, 36864
 s_cselect_b32 s62, s61, s62
 s_add_u32 m0, s62, 110592
 s_add_u32 s60, s62, 110592
 buffer_load_dwordx4 v2, s[56:59], s60 offen lds
 s_add_u32 s62, s63, 3072
 s_sub_u32 s61, s62, 36864
 s_cmp_ge_u32 s62, 36864
 s_cselect_b32 s62, s61, s62
 s_add_u32 m0, s62, 110592
 s_add_u32 s60, s62, 110592
 buffer_load_dwordx4 v2, s[56:59], s60 offen lds
 s_add_u32 s62, s63, 4096
 s_sub_u32 s61, s62, 36864
 s_cmp_ge_u32 s62, 36864
 s_cselect_b32 s62, s61, s62
 s_add_u32 m0, s62, 110592
 s_add_u32 s60, s62, 110592
 buffer_load_dwordx4 v2, s[56:59], s60 offen lds
 s_add_u32 s62, s63, 5120
 s_sub_u32 s61, s62, 36864
 s_cmp_ge_u32 s62, 36864
 s_cselect_b32 s62, s61, s62
 s_add_u32 m0, s62, 110592
 s_add_u32 s60, s62, 110592
 buffer_load_dwordx4 v2, s[56:59], s60 offen lds
 s_add_u32 s62, s63, 6144
 s_sub_u32 s61, s62, 36864
 s_cmp_ge_u32 s62, 36864
 s_cselect_b32 s62, s61, s62
 s_add_u32 m0, s62, 110592
 s_add_u32 s60, s62, 110592
 buffer_load_dwordx4 v2, s[56:59], s60 offen lds
 s_add_u32 s62, s63, 7168
 s_sub_u32 s61, s62, 36864
 s_cmp_ge_u32 s62, 36864
 s_cselect_b32 s62, s61, s62
 s_add_u32 m0, s62, 110592
 s_add_u32 s60, s62, 110592
 buffer_load_dwordx4 v2, s[56:59], s60 offen lds
 s_add_u32 s62, s63, 8192
 s_sub_u32 s61, s62, 36864
 s_cmp_ge_u32 s62, 36864
 s_cselect_b32 s62, s61, s62
 s_add_u32 m0, s62, 110592
 s_add_u32 s60, s62, 110592
 buffer_load_dwordx4 v2, s[56:59], s60 offen lds
 s_waitcnt vmcnt(27)
 s_barrier
 v_mov_b32 v40, 0
 v_mov_b32 v41, 0
 s_cmp_eq_u32 s44, 0
 s_cbranch_scc0 L97
 s_lshl_b32 s60, s45, 2
 v_mov_b32 v40, s60
 v_mov_b32 v41, 1
 s_mov_b64 exec, 1
 buffer_atomic_add v41, v40, s[8:11], 0 offen offset:32 sc0
 s_mov_b64 exec, -1
L97:
 v_add_u32 v15, 0, v12
 ds_read_b64_tr_b16 v[64:65], v15 offset:0
 ds_read_b64_tr_b16 v[66:67], v15 offset:2304
 ds_read_b64_tr_b16 v[68:69], v15 offset:18432
 ds_read_b64_tr_b16 v[70:71], v15 offset:20736
 ds_read_b64_tr_b16 v[96:97], v15 offset:64
 ds_read_b64_tr_b16 v[98:99], v15 offset:2368
 ds_read_b64_tr_b16 v[100:101], v15 offset:18496
 ds_read_b64_tr_b16 v[102:103], v15 offset:20800
 ds_read_b64_tr_b16 v[128:129], v15 offset:128
 ds_read_b64_tr_b16 v[130:131], v15 offset:2432
 ds_read_b64_tr_b16 v[132:133], v15 offset:18560
 ds_read_b64_tr_b16 v[134:135], v15 offset:20864
 ds_read_b64_tr_b16 v[160:161], v15 offset:192
 ds_read_b64_tr_b16 v[162:163], v15 offset:2496
 ds_read_b64_tr_b16 v[164:165], v15 offset:18624
 ds_read_b64_tr_b16 v[166:167], v15 offset:20928
 v_add_u32 v15, 0, v13
 ds_read_b64_tr_b16 v[192:193], v15 offset:256
 ds_read_b64_tr_b16 v[194:195], v15 offset:2560
 s_waitcnt lgkmcnt(0)
 s_barrier
 s_add_u32 m0, s93, 0
 s_mov_b32 s60, 0
 buffer_load_dwordx4 v32, s[12:15], s60 offen lds
 s_add_u32 m0, s93, 1024
 s_mov_b32 s60, 32768
 buffer_load_dwordx4 v34, s[12:15], s60 offen lds
 s_add_u32 m0, s93, 2048
 s_mov_b32 s60, 65536
 buffer_load_dwordx4 v32, s[12:15], s60 offen lds
 s_add_u32 m0, s93, 3072
 s_mov_b32 s60, 98304
 buffer_load_dwordx4 v34, s[12:15], s60 offen lds
 s_add_u32 m0, s93, 16384
 s_mov_b32 s60, 0
 buffer_load_dwordx4 v33, s[48:51], s60 offen lds
 s_add_u32 m0, s93, 17408
 s_mov_b32 s60, 32768
 buffer_load_dwordx4 v35, s[48:51], s60 offen lds
 s_add_u32 m0, s93, 18432
 s_mov_b32 s60, 65536
 buffer_load_dwordx4 v33, s[48:51], s60 offen lds
 s_add_u32 m0, s93, 19456
 s_mov_b32 s60, 98304
 buffer_load_dwordx4 v35, s[48:51], s60 offen lds
 s_waitcnt vmcnt(26)
 s_barrier
 v_add_u32 v15, 36864, v12
 ds_read_b64_tr_b16 v[72:73], v15 offset:0
 ds_read_b64_tr_b16 v[74:75], v15 offset:2304
 ds_read_b64_tr_b16 v[76:77], v15 offset:18432
 ds_read_b64_tr_b16 v[78:79], v15 offset:20736
 ds_read_b64_tr_b16 v[104:105], v15 offset:64
 ds_read_b64_tr_b16 v[106:107], v15 offset:2368
 ds_read_b64_tr_b16 v[108:109], v15 offset:18496
 ds_read_b64_tr_b16 v[110:111], v15 offset:20800
 ds_read_b64_tr_b16 v[136:137], v15 offset:128
 ds_read_b64_tr_b16 v[138:139], v15 offset:2432
 ds_read_b64_tr_b16 v[140:141], v15 offset:18560
 ds_read_b64_tr_b16 v[142:143], v15 offset:20864
 ds_read_b64_tr_b16 v[168:169], v15 offset:192
 ds_read_b64_tr_b16 v[170:171], v15 offset:2496
 ds_read_b64_tr_b16 v[172:173], v15 offset:18624
 ds_read_b64_tr_b16 v[174:175], v15 offset:20928
 v_add_u32 v15, 36864, v13
 ds_read_b64_tr_b16 v[196:197], v15 offset:256
 ds_read_b64_tr_b16 v[198:199], v15 offset:2560
 s_waitcnt lgkmcnt(0)
 s_barrier
 s_add_u32 m0, s93, 36864
 s_mov_b32 s60, 524288
 buffer_load_dwordx4 v32, s[12:15], s60 offen lds
 s_add_u32 m0, s93, 37888
 s_mov_b32 s60, 557056
 buffer_load_dwordx4 v34, s[12:15], s60 offen lds
 s_add_u32 m0, s93, 38912
 s_mov_b32 s60, 589824
 buffer_load_dwordx4 v32, s[12:15], s60 offen lds
 s_add_u32 m0, s93, 39936
 s_mov_b32 s60, 622592
 buffer_load_dwordx4 v34, s[12:15], s60 offen lds
 s_add_u32 m0, s93, 53248
 s_mov_b32 s60, 524288
 buffer_load_dwordx4 v33, s[48:51], s60 offen lds
 s_add_u32 m0, s93, 54272
 s_mov_b32 s60, 557056
 buffer_load_dwordx4 v35, s[48:51], s60 offen lds
 s_add_u32 m0, s93, 55296
 s_mov_b32 s60, 589824
 buffer_load_dwordx4 v33, s[48:51], s60 offen lds
 s_add_u32 m0, s93, 56320
 s_mov_b32 s60, 622592
 buffer_load_dwordx4 v35, s[48:51], s60 offen lds
 s_waitcnt vmcnt(25)
 s_barrier
 v_add_u32 v15, 73728, v12
 ds_read_b64_tr_b16 v[80:81], v15 offset:0
 ds_read_b64_tr_b16 v[82:83], v15 offset:2304
 ds_read_b64_tr_b16 v[84:85], v15 offset:18432
 ds_read_b64_tr_b16 v[86:87], v15 offset:20736
 ds_read_b64_tr_b16 v[112:113], v15 offset:64
 ds_read_b64_tr_b16 v[114:115], v15 offset:2368
 ds_read_b64_tr_b16 v[116:117], v15 offset:18496
 ds_read_b64_tr_b16 v[118:119], v15 offset:20800
 ds_read_b64_tr_b16 v[144:145], v15 offset:128
 ds_read_b64_tr_b16 v[146:147], v15 offset:2432
 ds_read_b64_tr_b16 v[148:149], v15 offset:18560
 ds_read_b64_tr_b16 v[150:151], v15 offset:20864
 ds_read_b64_tr_b16 v[176:177], v15 offset:192
 ds_read_b64_tr_b16 v[178:179], v15 offset:2496
 ds_read_b64_tr_b16 v[180:181], v15 offset:18624
 ds_read_b64_tr_b16 v[182:183], v15 offset:20928
 v_add_u32 v15, 73728, v13
 ds_read_b64_tr_b16 v[200:201], v15 offset:256
 ds_read_b64_tr_b16 v[202:203], v15 offset:2560
 s_waitcnt lgkmcnt(0)
 s_barrier
 s_add_u32 m0, s93, 73728
 s_mov_b32 s60, 1048576
 buffer_load_dwordx4 v32, s[12:15], s60 offen lds
 s_add_u32 m0, s93, 74752
 s_mov_b32 s60, 1081344
 buffer_load_dwordx4 v34, s[12:15], s60 offen lds
 s_add_u32 m0, s93, 75776
 s_mov_b32 s60, 1114112
 buffer_load_dwordx4 v32, s[12:15], s60 offen lds
 s_add_u32 m0, s93, 76800
 s_mov_b32 s60, 1146880
 buffer_load_dwordx4 v34, s[12:15], s60 offen lds
 s_add_u32 m0, s93, 90112
 s_mov_b32 s60, 1048576
 buffer_load_dwordx4 v33, s[48:51], s60 offen lds
 s_add_u32 m0, s93, 91136
 s_mov_b32 s60, 1081344
 buffer_load_dwordx4 v35, s[48:51], s60 offen lds
 s_add_u32 m0, s93, 92160
 s_mov_b32 s60, 1114112
 buffer_load_dwordx4 v33, s[48:51], s60 offen lds
 s_add_u32 m0, s93, 93184
 s_mov_b32 s60, 1146880
 buffer_load_dwordx4 v35, s[48:51], s60 offen lds
 s_waitcnt vmcnt(24)
 s_barrier
 v_add_u32 v15, 110592, v12
 ds_read_b64_tr_b16 v[88:89], v15 offset:0
 ds_read_b64_tr_b16 v[90:91], v15 offset:2304
 ds_read_b64_tr_b16 v[92:93], v15 offset:18432
 ds_read_b64_tr_b16 v[94:95], v15 offset:20736
 ds_read_b64_tr_b16 v[120:121], v15 offset:64
 ds_read_b64_tr_b16 v[122:123], v15 offset:2368
 ds_read_b64_tr_b16 v[124:125], v15 offset:18496
 ds_read_b64_tr_b16 v[126:127], v15 offset:20800
 ds_read_b64_tr_b16 v[152:153], v15 offset:128
 ds_read_b64_tr_b16 v[154:155], v15 offset:2432
 ds_read_b64_tr_b16 v[156:157], v15 offset:18560
 ds_read_b64_tr_b16 v[158:159], v15 offset:20864
 ds_read_b64_tr_b16 v[184:185], v15 offset:192
 ds_read_b64_tr_b16 v[186:187], v15 offset:2496
 ds_read_b64_tr_b16 v[188:189], v15 offset:18624
 ds_read_b64_tr_b16 v[190:191], v15 offset:20928
 v_add_u32 v15, 110592, v13
 ds_read_b64_tr_b16 v[204:205], v15 offset:256
 ds_read_b64_tr_b16 v[206:207], v15 offset:2560
 s_waitcnt lgkmcnt(0)
 s_barrier
 s_add_u32 m0, s93, 110592
 s_mov_b32 s60, 1572864
 buffer_load_dwordx4 v32, s[12:15], s60 offen lds
 s_add_u32 m0, s93, 111616
 s_mov_b32 s60, 1605632
 buffer_load_dwordx4 v34, s[12:15], s60 offen lds
 s_add_u32 m0, s93, 112640
 s_mov_b32 s60, 1638400
 buffer_load_dwordx4 v32, s[12:15], s60 offen lds
 s_add_u32 m0, s93, 113664
 s_mov_b32 s60, 1671168
 buffer_load_dwordx4 v34, s[12:15], s60 offen lds
 s_add_u32 m0, s93, 126976
 s_mov_b32 s60, 1572864
 buffer_load_dwordx4 v33, s[48:51], s60 offen lds
 s_add_u32 m0, s93, 128000
 s_mov_b32 s60, 1605632
 buffer_load_dwordx4 v35, s[48:51], s60 offen lds
 s_add_u32 m0, s93, 129024
 s_mov_b32 s60, 1638400
 buffer_load_dwordx4 v33, s[48:51], s60 offen lds
 s_add_u32 m0, s93, 130048
 s_mov_b32 s60, 1671168
 buffer_load_dwordx4 v35, s[48:51], s60 offen lds
 s_waitcnt vmcnt(24)
 s_barrier
 s_cmp_eq_u32 s44, 0
 s_cbranch_scc0 L98
 s_mov_b64 exec, 1
 v_cmp_eq_u32 vcc, 31, v41
 s_and_b64 exec, exec, vcc
 v_mov_b32 v41, 1
 s_cbranch_execz L99
 buffer_store_dword v41, v40, s[8:11], 0 offen offset:64 sc1
L99:
 s_mov_b64 exec, -1
L98:
 v_add_u32 v38, 0, v36
 v_add_u32 v39, 0, v37
 ds_read_b64_tr_b16 v[224:225], v38 offset:0
 ds_read_b64_tr_b16 v[226:227], v38 offset:512
 ds_read_b64_tr_b16 v[228:229], v38 offset:4096
 ds_read_b64_tr_b16 v[230:231], v38 offset:4608
 ds_read_b64_tr_b16 v[232:233], v39 offset:0
 ds_read_b64_tr_b16 v[234:235], v39 offset:512
 ds_read_b64_tr_b16 v[236:237], v39 offset:4096
 ds_read_b64_tr_b16 v[238:239], v39 offset:4608
 ds_read_b64_tr_b16 v[240:241], v38 offset:8192
 ds_read_b64_tr_b16 v[242:243], v38 offset:8704
 ds_read_b64_tr_b16 v[244:245], v38 offset:12288
 ds_read_b64_tr_b16 v[246:247], v38 offset:12800
 ds_read_b64_tr_b16 v[248:249], v39 offset:8192
 ds_read_b64_tr_b16 v[250:251], v39 offset:8704
 ds_read_b64_tr_b16 v[252:253], v39 offset:12288
 ds_read_b64_tr_b16 v[254:255], v39 offset:12800
 s_waitcnt lgkmcnt(0)
 s_barrier
 s_add_u32 m0, s93, 0
 s_mov_b32 s60, 2097152
 buffer_load_dwordx4 v32, s[12:15], s60 offen lds
 s_add_u32 m0, s93, 1024
 s_mov_b32 s60, 2129920
 buffer_load_dwordx4 v34, s[12:15], s60 offen lds
 s_add_u32 m0, s93, 2048
 s_mov_b32 s60, 2162688
 buffer_load_dwordx4 v32, s[12:15], s60 offen lds
 s_add_u32 m0, s93, 3072
 s_mov_b32 s60, 2195456
 buffer_load_dwordx4 v34, s[12:15], s60 offen lds
 s_add_u32 m0, s93, 16384
 s_mov_b32 s60, 2097152
 buffer_load_dwordx4 v33, s[48:51], s60 offen lds
 s_add_u32 m0, s93, 17408
 s_mov_b32 s60, 2129920
 buffer_load_dwordx4 v35, s[48:51], s60 offen lds
 s_add_u32 m0, s93, 18432
 s_mov_b32 s60, 2162688
 buffer_load_dwordx4 v33, s[48:51], s60 offen lds
 s_add_u32 m0, s93, 19456
 s_mov_b32 s60, 2195456
 buffer_load_dwordx4 v35, s[48:51], s60 offen lds
 s_waitcnt vmcnt(24)
 s_barrier
 v_add_u32 v38, 36864, v36
 v_add_u32 v39, 36864, v37
 ds_read_b64_tr_b16 a[0:1], v38 offset:0
 ds_read_b64_tr_b16 a[2:3], v38 offset:512
 ds_read_b64_tr_b16 a[4:5], v38 offset:4096
 ds_read_b64_tr_b16 a[6:7], v38 offset:4608
 ds_read_b64_tr_b16 a[8:9], v39 offset:0
 ds_read_b64_tr_b16 a[10:11], v39 offset:512
 ds_read_b64_tr_b16 a[12:13], v39 offset:4096
 ds_read_b64_tr_b16 a[14:15], v39 offset:4608
 ds_read_b64_tr_b16 a[16:17], v38 offset:8192
 ds_read_b64_tr_b16 a[18:19], v38 offset:8704
 ds_read_b64_tr_b16 a[20:21], v38 offset:12288
 ds_read_b64_tr_b16 a[22:23], v38 offset:12800
 ds_read_b64_tr_b16 a[24:25], v39 offset:8192
 ds_read_b64_tr_b16 a[26:27], v39 offset:8704
 ds_read_b64_tr_b16 a[28:29], v39 offset:12288
 ds_read_b64_tr_b16 a[30:31], v39 offset:12800
 s_waitcnt lgkmcnt(0)
 s_barrier
 s_add_u32 m0, s93, 36864
 s_mov_b32 s60, 2621440
 buffer_load_dwordx4 v32, s[12:15], s60 offen lds
 s_add_u32 m0, s93, 37888
 s_mov_b32 s60, 2654208
 buffer_load_dwordx4 v34, s[12:15], s60 offen lds
 s_add_u32 m0, s93, 38912
 s_mov_b32 s60, 2686976
 buffer_load_dwordx4 v32, s[12:15], s60 offen lds
 s_add_u32 m0, s93, 39936
 s_mov_b32 s60, 2719744
 buffer_load_dwordx4 v34, s[12:15], s60 offen lds
 s_add_u32 m0, s93, 53248
 s_mov_b32 s60, 2621440
 buffer_load_dwordx4 v33, s[48:51], s60 offen lds
 s_add_u32 m0, s93, 54272
 s_mov_b32 s60, 2654208
 buffer_load_dwordx4 v35, s[48:51], s60 offen lds
 s_add_u32 m0, s93, 55296
 s_mov_b32 s60, 2686976
 buffer_load_dwordx4 v33, s[48:51], s60 offen lds
 s_add_u32 m0, s93, 56320
 s_mov_b32 s60, 2719744
 buffer_load_dwordx4 v35, s[48:51], s60 offen lds
 s_waitcnt vmcnt(24)
 s_barrier
 v_add_u32 v38, 73728, v36
 v_add_u32 v39, 73728, v37
 ds_read_b64_tr_b16 a[32:33], v38 offset:0
 ds_read_b64_tr_b16 a[34:35], v38 offset:512
 ds_read_b64_tr_b16 a[36:37], v38 offset:4096
 ds_read_b64_tr_b16 a[38:39], v38 offset:4608
 ds_read_b64_tr_b16 a[40:41], v39 offset:0
 ds_read_b64_tr_b16 a[42:43], v39 offset:512
 ds_read_b64_tr_b16 a[44:45], v39 offset:4096
 ds_read_b64_tr_b16 a[46:47], v39 offset:4608
 ds_read_b64_tr_b16 a[48:49], v38 offset:8192
 ds_read_b64_tr_b16 a[50:51], v38 offset:8704
 ds_read_b64_tr_b16 a[52:53], v38 offset:12288
 ds_read_b64_tr_b16 a[54:55], v38 offset:12800
 ds_read_b64_tr_b16 a[56:57], v39 offset:8192
 ds_read_b64_tr_b16 a[58:59], v39 offset:8704
 ds_read_b64_tr_b16 a[60:61], v39 offset:12288
 ds_read_b64_tr_b16 a[62:63], v39 offset:12800
 s_waitcnt lgkmcnt(0)
 s_barrier
 s_add_u32 m0, s93, 73728
 s_mov_b32 s60, 3145728
 buffer_load_dwordx4 v32, s[12:15], s60 offen lds
 s_add_u32 m0, s93, 74752
 s_mov_b32 s60, 3178496
 buffer_load_dwordx4 v34, s[12:15], s60 offen lds
 s_add_u32 m0, s93, 75776
 s_mov_b32 s60, 3211264
 buffer_load_dwordx4 v32, s[12:15], s60 offen lds
 s_add_u32 m0, s93, 76800
 s_mov_b32 s60, 3244032
 buffer_load_dwordx4 v34, s[12:15], s60 offen lds
 s_add_u32 m0, s93, 90112
 s_mov_b32 s60, 3145728
 buffer_load_dwordx4 v33, s[48:51], s60 offen lds
 s_add_u32 m0, s93, 91136
 s_mov_b32 s60, 3178496
 buffer_load_dwordx4 v35, s[48:51], s60 offen lds
 s_add_u32 m0, s93, 92160
 s_mov_b32 s60, 3211264
 buffer_load_dwordx4 v33, s[48:51], s60 offen lds
 s_add_u32 m0, s93, 93184
 s_mov_b32 s60, 3244032
 buffer_load_dwordx4 v35, s[48:51], s60 offen lds
 s_waitcnt vmcnt(24)
 s_barrier
 v_add_u32 v38, 110592, v36
 v_add_u32 v39, 110592, v37
 ds_read_b64_tr_b16 a[64:65], v38 offset:0
 ds_read_b64_tr_b16 a[66:67], v38 offset:512
 ds_read_b64_tr_b16 a[68:69], v38 offset:4096
 ds_read_b64_tr_b16 a[70:71], v38 offset:4608
 ds_read_b64_tr_b16 a[72:73], v39 offset:0
 ds_read_b64_tr_b16 a[74:75], v39 offset:512
 ds_read_b64_tr_b16 a[76:77], v39 offset:4096
 ds_read_b64_tr_b16 a[78:79], v39 offset:4608
 ds_read_b64_tr_b16 a[80:81], v38 offset:8192
 ds_read_b64_tr_b16 a[82:83], v38 offset:8704
 ds_read_b64_tr_b16 a[84:85], v38 offset:12288
 ds_read_b64_tr_b16 a[86:87], v38 offset:12800
 ds_read_b64_tr_b16 a[88:89], v39 offset:8192
 ds_read_b64_tr_b16 a[90:91], v39 offset:8704
 ds_read_b64_tr_b16 a[92:93], v39 offset:12288
 ds_read_b64_tr_b16 a[94:95], v39 offset:12800
 s_waitcnt lgkmcnt(0)
 s_barrier
 s_add_u32 m0, s93, 110592
 s_mov_b32 s60, 3670016
 buffer_load_dwordx4 v32, s[12:15], s60 offen lds
 s_add_u32 m0, s93, 111616
 s_mov_b32 s60, 3702784
 buffer_load_dwordx4 v34, s[12:15], s60 offen lds
 s_add_u32 m0, s93, 112640
 s_mov_b32 s60, 3735552
 buffer_load_dwordx4 v32, s[12:15], s60 offen lds
 s_add_u32 m0, s93, 113664
 s_mov_b32 s60, 3768320
 buffer_load_dwordx4 v34, s[12:15], s60 offen lds
 s_add_u32 m0, s93, 126976
 s_mov_b32 s60, 3670016
 buffer_load_dwordx4 v33, s[48:51], s60 offen lds
 s_add_u32 m0, s93, 128000
 s_mov_b32 s60, 3702784
 buffer_load_dwordx4 v35, s[48:51], s60 offen lds
 s_add_u32 m0, s93, 129024
 s_mov_b32 s60, 3735552
 buffer_load_dwordx4 v33, s[48:51], s60 offen lds
 s_add_u32 m0, s93, 130048
 s_mov_b32 s60, 3768320
 buffer_load_dwordx4 v35, s[48:51], s60 offen lds
 s_waitcnt vmcnt(24)
 s_barrier
 v_add_u32 v38, 0, v36
 v_add_u32 v39, 0, v37
 ds_read_b64_tr_b16 a[96:97], v38 offset:0
 ds_read_b64_tr_b16 a[98:99], v38 offset:512
 ds_read_b64_tr_b16 a[100:101], v38 offset:4096
 ds_read_b64_tr_b16 a[102:103], v38 offset:4608
 ds_read_b64_tr_b16 a[104:105], v39 offset:0
 ds_read_b64_tr_b16 a[106:107], v39 offset:512
 ds_read_b64_tr_b16 a[108:109], v39 offset:4096
 ds_read_b64_tr_b16 a[110:111], v39 offset:4608
 ds_read_b64_tr_b16 a[112:113], v38 offset:8192
 ds_read_b64_tr_b16 a[114:115], v38 offset:8704
 ds_read_b64_tr_b16 a[116:117], v38 offset:12288
 ds_read_b64_tr_b16 a[118:119], v38 offset:12800
 ds_read_b64_tr_b16 a[120:121], v39 offset:8192
 ds_read_b64_tr_b16 a[122:123], v39 offset:8704
 ds_read_b64_tr_b16 a[124:125], v39 offset:12288
 ds_read_b64_tr_b16 a[126:127], v39 offset:12800
 s_waitcnt lgkmcnt(0)
 s_barrier
 s_add_u32 m0, s93, 0
 s_mov_b32 s60, 4194304
 buffer_load_dwordx4 v32, s[12:15], s60 offen lds
 s_add_u32 m0, s93, 1024
 s_mov_b32 s60, 4227072
 buffer_load_dwordx4 v34, s[12:15], s60 offen lds
 s_add_u32 m0, s93, 2048
 s_mov_b32 s60, 4259840
 buffer_load_dwordx4 v32, s[12:15], s60 offen lds
 s_add_u32 m0, s93, 3072
 s_mov_b32 s60, 4292608
 buffer_load_dwordx4 v34, s[12:15], s60 offen lds
 s_add_u32 m0, s93, 16384
 s_mov_b32 s60, 4194304
 buffer_load_dwordx4 v33, s[48:51], s60 offen lds
 s_add_u32 m0, s93, 17408
 s_mov_b32 s60, 4227072
 buffer_load_dwordx4 v35, s[48:51], s60 offen lds
 s_add_u32 m0, s93, 18432
 s_mov_b32 s60, 4259840
 buffer_load_dwordx4 v33, s[48:51], s60 offen lds
 s_add_u32 m0, s93, 19456
 s_mov_b32 s60, 4292608
 buffer_load_dwordx4 v35, s[48:51], s60 offen lds
 s_waitcnt vmcnt(24)
 s_barrier
 v_add_u32 v38, 36864, v36
 v_add_u32 v39, 36864, v37
 ds_read_b64_tr_b16 a[128:129], v38 offset:0
 ds_read_b64_tr_b16 a[130:131], v38 offset:512
 ds_read_b64_tr_b16 a[132:133], v38 offset:4096
 ds_read_b64_tr_b16 a[134:135], v38 offset:4608
 ds_read_b64_tr_b16 a[136:137], v39 offset:0
 ds_read_b64_tr_b16 a[138:139], v39 offset:512
 ds_read_b64_tr_b16 a[140:141], v39 offset:4096
 ds_read_b64_tr_b16 a[142:143], v39 offset:4608
 ds_read_b64_tr_b16 a[144:145], v38 offset:8192
 ds_read_b64_tr_b16 a[146:147], v38 offset:8704
 ds_read_b64_tr_b16 a[148:149], v38 offset:12288
 ds_read_b64_tr_b16 a[150:151], v38 offset:12800
 ds_read_b64_tr_b16 a[152:153], v39 offset:8192
 ds_read_b64_tr_b16 a[154:155], v39 offset:8704
 ds_read_b64_tr_b16 a[156:157], v39 offset:12288
 ds_read_b64_tr_b16 a[158:159], v39 offset:12800
 s_waitcnt lgkmcnt(0)
 s_barrier
 s_add_u32 m0, s93, 36864
 s_mov_b32 s60, 4194304
 buffer_load_dwordx4 v0, s[52:55], s60 offen lds
 s_add_u32 m0, s93, 37888
 s_mov_b32 s60, 4227072
 buffer_load_dwordx4 v0, s[52:55], s60 offen lds
 s_add_u32 m0, s93, 38912
 s_mov_b32 s60, 4259840
 buffer_load_dwordx4 v0, s[52:55], s60 offen lds
 s_add_u32 m0, s93, 39936
 s_mov_b32 s60, 4292608
 buffer_load_dwordx4 v0, s[52:55], s60 offen lds
 s_waitcnt vmcnt(20)
 s_barrier
 v_add_u32 v38, 73728, v36
 v_add_u32 v39, 73728, v37
 ds_read_b64_tr_b16 a[160:161], v38 offset:0
 ds_read_b64_tr_b16 a[162:163], v38 offset:512
 ds_read_b64_tr_b16 a[164:165], v38 offset:4096
 ds_read_b64_tr_b16 a[166:167], v38 offset:4608
 ds_read_b64_tr_b16 a[168:169], v39 offset:0
 ds_read_b64_tr_b16 a[170:171], v39 offset:512
 ds_read_b64_tr_b16 a[172:173], v39 offset:4096
 ds_read_b64_tr_b16 a[174:175], v39 offset:4608
 ds_read_b64_tr_b16 a[176:177], v38 offset:8192
 ds_read_b64_tr_b16 a[178:179], v38 offset:8704
 ds_read_b64_tr_b16 a[180:181], v38 offset:12288
 ds_read_b64_tr_b16 a[182:183], v38 offset:12800
 ds_read_b64_tr_b16 a[184:185], v39 offset:8192
 ds_read_b64_tr_b16 a[186:187], v39 offset:8704
 ds_read_b64_tr_b16 a[188:189], v39 offset:12288
 ds_read_b64_tr_b16 a[190:191], v39 offset:12800
 s_waitcnt lgkmcnt(0)
 s_barrier
 s_add_u32 m0, s93, 81920
 s_mov_b32 s60, 2621440
 buffer_load_dwordx4 v0, s[52:55], s60 offen lds
 s_add_u32 m0, s93, 82944
 s_mov_b32 s60, 2654208
 buffer_load_dwordx4 v0, s[52:55], s60 offen lds
 s_add_u32 m0, s93, 83968
 s_mov_b32 s60, 2686976
 buffer_load_dwordx4 v0, s[52:55], s60 offen lds
 s_add_u32 m0, s93, 84992
 s_mov_b32 s60, 2719744
 buffer_load_dwordx4 v0, s[52:55], s60 offen lds
 s_waitcnt vmcnt(16)
 s_barrier
 v_add_u32 v38, 110592, v36
 v_add_u32 v39, 110592, v37
 ds_read_b64_tr_b16 a[192:193], v38 offset:0
 ds_read_b64_tr_b16 a[194:195], v38 offset:512
 ds_read_b64_tr_b16 a[196:197], v38 offset:4096
 ds_read_b64_tr_b16 a[198:199], v38 offset:4608
 ds_read_b64_tr_b16 a[200:201], v39 offset:0
 ds_read_b64_tr_b16 a[202:203], v39 offset:512
 ds_read_b64_tr_b16 a[204:205], v39 offset:4096
 ds_read_b64_tr_b16 a[206:207], v39 offset:4608
 ds_read_b64_tr_b16 a[208:209], v38 offset:8192
 ds_read_b64_tr_b16 a[210:211], v38 offset:8704
 ds_read_b64_tr_b16 a[212:213], v38 offset:12288
 ds_read_b64_tr_b16 a[214:215], v38 offset:12800
 ds_read_b64_tr_b16 a[216:217], v39 offset:8192
 ds_read_b64_tr_b16 a[218:219], v39 offset:8704
 ds_read_b64_tr_b16 a[220:221], v39 offset:12288
 ds_read_b64_tr_b16 a[222:223], v39 offset:12800
 s_waitcnt lgkmcnt(0)
 s_barrier
 s_add_u32 m0, s93, 98304
 s_mov_b32 s60, 3145728
 buffer_load_dwordx4 v0, s[52:55], s60 offen lds
 s_add_u32 m0, s93, 99328
 s_mov_b32 s60, 3178496
 buffer_load_dwordx4 v0, s[52:55], s60 offen lds
 s_add_u32 m0, s93, 100352
 s_mov_b32 s60, 3211264
 buffer_load_dwordx4 v0, s[52:55], s60 offen lds
 s_add_u32 m0, s93, 101376
 s_mov_b32 s60, 3244032
 buffer_load_dwordx4 v0, s[52:55], s60 offen lds
 s_add_u32 m0, s93, 114688
 s_mov_b32 s60, 3670016
 buffer_load_dwordx4 v0, s[52:55], s60 offen lds
 s_add_u32 m0, s93, 115712
 s_mov_b32 s60, 3702784
 buffer_load_dwordx4 v0, s[52:55], s60 offen lds
 s_add_u32 m0, s93, 116736
 s_mov_b32 s60, 3735552
 buffer_load_dwordx4 v0, s[52:55], s60 offen lds
 s_add_u32 m0, s93, 117760
 s_mov_b32 s60, 3768320
 buffer_load_dwordx4 v0, s[52:55], s60 offen lds
 s_waitcnt vmcnt(16)
 s_barrier
 v_add_u32 v38, 0, v36
 v_add_u32 v39, 0, v37
 ds_read_b64_tr_b16 a[224:225], v38 offset:0
 ds_read_b64_tr_b16 a[226:227], v38 offset:512
 ds_read_b64_tr_b16 a[228:229], v38 offset:4096
 ds_read_b64_tr_b16 a[230:231], v38 offset:4608
 ds_read_b64_tr_b16 a[232:233], v39 offset:0
 ds_read_b64_tr_b16 a[234:235], v39 offset:512
 ds_read_b64_tr_b16 a[236:237], v39 offset:4096
 ds_read_b64_tr_b16 a[238:239], v39 offset:4608
 ds_read_b64_tr_b16 a[240:241], v38 offset:8192
 ds_read_b64_tr_b16 a[242:243], v38 offset:8704
 ds_read_b64_tr_b16 a[244:245], v38 offset:12288
 ds_read_b64_tr_b16 a[246:247], v38 offset:12800
 ds_read_b64_tr_b16 a[248:249], v39 offset:8192
 ds_read_b64_tr_b16 a[250:251], v39 offset:8704
 ds_read_b64_tr_b16 a[252:253], v39 offset:12288
 ds_read_b64_tr_b16 a[254:255], v39 offset:12800
 s_waitcnt lgkmcnt(0)
 s_barrier
 s_add_u32 m0, s93, 0
 s_mov_b32 s60, 0
 buffer_load_dwordx4 v0, s[52:55], s60 offen lds
 s_add_u32 m0, s93, 1024
 s_mov_b32 s60, 32768
 buffer_load_dwordx4 v0, s[52:55], s60 offen lds
 s_add_u32 m0, s93, 2048
 s_mov_b32 s60, 65536
 buffer_load_dwordx4 v0, s[52:55], s60 offen lds
 s_add_u32 m0, s93, 3072
 s_mov_b32 s60, 98304
 buffer_load_dwordx4 v0, s[52:55], s60 offen lds
 s_add_u32 m0, s93, 16384
 s_mov_b32 s60, 524288
 buffer_load_dwordx4 v0, s[52:55], s60 offen lds
 s_add_u32 m0, s93, 17408
 s_mov_b32 s60, 557056
 buffer_load_dwordx4 v0, s[52:55], s60 offen lds
 s_add_u32 m0, s93, 18432
 s_mov_b32 s60, 589824
 buffer_load_dwordx4 v0, s[52:55], s60 offen lds
 s_add_u32 m0, s93, 19456
 s_mov_b32 s60, 622592
 buffer_load_dwordx4 v0, s[52:55], s60 offen lds
 s_waitcnt vmcnt(20)
 s_barrier
 v_add_u32 v15, 36864, v5
 ds_read_b64_tr_b16 v[208:209], v15 offset:0
 ds_read_b64_tr_b16 v[210:211], v15 offset:512
 ds_read_b64_tr_b16 v[212:213], v15 offset:4096
 ds_read_b64_tr_b16 v[214:215], v15 offset:4608
 ds_read_b64_tr_b16 v[216:217], v15 offset:8192
 ds_read_b64_tr_b16 v[218:219], v15 offset:8704
 ds_read_b64_tr_b16 v[220:221], v15 offset:12288
 ds_read_b64_tr_b16 v[222:223], v15 offset:12800
 s_waitcnt lgkmcnt(0)
 s_barrier
 s_add_u32 m0, s93, 32768
 s_mov_b32 s60, 1048576
 buffer_load_dwordx4 v0, s[52:55], s60 offen lds
 s_add_u32 m0, s93, 33792
 s_mov_b32 s60, 1081344
 buffer_load_dwordx4 v0, s[52:55], s60 offen lds
 s_add_u32 m0, s93, 34816
 s_mov_b32 s60, 1114112
 buffer_load_dwordx4 v0, s[52:55], s60 offen lds
 s_add_u32 m0, s93, 35840
 s_mov_b32 s60, 1146880
 buffer_load_dwordx4 v0, s[52:55], s60 offen lds
 s_add_u32 m0, s93, 49152
 s_mov_b32 s60, 1572864
 buffer_load_dwordx4 v0, s[52:55], s60 offen lds
 s_add_u32 m0, s93, 50176
 s_mov_b32 s60, 1605632
 buffer_load_dwordx4 v0, s[52:55], s60 offen lds
 s_add_u32 m0, s93, 51200
 s_mov_b32 s60, 1638400
 buffer_load_dwordx4 v0, s[52:55], s60 offen lds
 s_add_u32 m0, s93, 52224
 s_mov_b32 s60, 1671168
 buffer_load_dwordx4 v0, s[52:55], s60 offen lds
 s_add_u32 m0, s93, 65536
 s_mov_b32 s60, 2097152
 buffer_load_dwordx4 v0, s[52:55], s60 offen lds
 s_add_u32 m0, s93, 66560
 s_mov_b32 s60, 2129920
 buffer_load_dwordx4 v0, s[52:55], s60 offen lds
 s_add_u32 m0, s93, 67584
 s_mov_b32 s60, 2162688
 buffer_load_dwordx4 v0, s[52:55], s60 offen lds
 s_add_u32 m0, s93, 68608
 s_mov_b32 s60, 2195456
 buffer_load_dwordx4 v0, s[52:55], s60 offen lds
 s_mov_b32 s12, s18
 s_mov_b32 s13, s19
 s_mov_b32 s14, 9216
 s_mov_b32 s15, 0x20000
 v_and_b32 v6, 7, v61
 v_mul_u32_u24 v6, 1152, v6
 v_lshrrev_b32 v7, 4, v61
 v_lshlrev_b32 v7, 5, v7
 v_add_u32 v6, v6, v7
 v_bfe_u32 v7, v61, 3, 1
 v_lshlrev_b32 v7, 4, v7
 v_add_u32 v6, v6, v7
 s_min_u32 s60, s44, 2
 s_mul_i32 s60, s60, 384
 buffer_load_dwordx4 v[40:43], v6, s[12:15], s60 offen
 buffer_load_dwordx4 v[44:47], v6, s[12:15], s60 offen offset:128
 buffer_load_dwordx4 v[8:11], v6, s[12:15], s60 offen offset:256
 s_waitcnt vmcnt(28)
 s_barrier
 v_add_u32 v15, 81920, v5
 ds_read_b64_tr_b16 v[16:17], v15 offset:0
 ds_read_b64_tr_b16 v[18:19], v15 offset:512
 ds_read_b64_tr_b16 v[20:21], v15 offset:4096
 ds_read_b64_tr_b16 v[22:23], v15 offset:4608
 ds_read_b64_tr_b16 v[24:25], v15 offset:8192
 ds_read_b64_tr_b16 v[26:27], v15 offset:8704
 ds_read_b64_tr_b16 v[28:29], v15 offset:12288
 ds_read_b64_tr_b16 v[30:31], v15 offset:12800
 s_waitcnt lgkmcnt(0)
 s_barrier
 v_add_u32 v15, 81920, v50
 ds_write_b128 v15, v[16:19] offset:0
 ds_write_b128 v15, v[20:23] offset:1024
 ds_write_b128 v15, v[24:27] offset:2048
 ds_write_b128 v15, v[28:31] offset:3072
 s_waitcnt vmcnt(24)
 s_barrier
 v_add_u32 v15, 98304, v5
 ds_read_b64_tr_b16 v[16:17], v15 offset:0
 ds_read_b64_tr_b16 v[18:19], v15 offset:512
 ds_read_b64_tr_b16 v[20:21], v15 offset:4096
 ds_read_b64_tr_b16 v[22:23], v15 offset:4608
 ds_read_b64_tr_b16 v[24:25], v15 offset:8192
 ds_read_b64_tr_b16 v[26:27], v15 offset:8704
 ds_read_b64_tr_b16 v[28:29], v15 offset:12288
 ds_read_b64_tr_b16 v[30:31], v15 offset:12800
 s_waitcnt lgkmcnt(0)
 s_barrier
 v_add_u32 v15, 98304, v50
 ds_write_b128 v15, v[16:19] offset:0
 ds_write_b128 v15, v[20:23] offset:1024
 ds_write_b128 v15, v[24:27] offset:2048
 ds_write_b128 v15, v[28:31] offset:3072
 s_waitcnt vmcnt(20)
 s_barrier
 v_add_u32 v15, 114688, v5
 ds_read_b64_tr_b16 v[16:17], v15 offset:0
 ds_read_b64_tr_b16 v[18:19], v15 offset:512
 ds_read_b64_tr_b16 v[20:21], v15 offset:4096
 ds_read_b64_tr_b16 v[22:23], v15 offset:4608
 ds_read_b64_tr_b16 v[24:25], v15 offset:8192
 ds_read_b64_tr_b16 v[26:27], v15 offset:8704
 ds_read_b64_tr_b16 v[28:29], v15 offset:12288
 ds_read_b64_tr_b16 v[30:31], v15 offset:12800
 s_waitcnt lgkmcnt(0)
 s_barrier
 v_add_u32 v15, 114688, v50
 ds_write_b128 v15, v[16:19] offset:0
 ds_write_b128 v15, v[20:23] offset:1024
 ds_write_b128 v15, v[24:27] offset:2048
 ds_write_b128 v15, v[28:31] offset:3072
 s_waitcnt vmcnt(16)
 s_barrier
 v_add_u32 v15, 0, v5
 ds_read_b64_tr_b16 v[16:17], v15 offset:0
 ds_read_b64_tr_b16 v[18:19], v15 offset:512
 ds_read_b64_tr_b16 v[20:21], v15 offset:4096
 ds_read_b64_tr_b16 v[22:23], v15 offset:4608
 ds_read_b64_tr_b16 v[24:25], v15 offset:8192
 ds_read_b64_tr_b16 v[26:27], v15 offset:8704
 ds_read_b64_tr_b16 v[28:29], v15 offset:12288
 ds_read_b64_tr_b16 v[30:31], v15 offset:12800
 s_waitcnt lgkmcnt(0)
 s_barrier
 v_add_u32 v15, 0, v50
 ds_write_b128 v15, v[16:19] offset:0
 ds_write_b128 v15, v[20:23] offset:1024
 ds_write_b128 v15, v[24:27] offset:2048
 ds_write_b128 v15, v[28:31] offset:3072
 s_waitcnt vmcnt(12)
 s_barrier
 v_add_u32 v15, 16384, v5
 ds_read_b64_tr_b16 v[16:17], v15 offset:0
 ds_read_b64_tr_b16 v[18:19], v15 offset:512
 ds_read_b64_tr_b16 v[20:21], v15 offset:4096
 ds_read_b64_tr_b16 v[22:23], v15 offset:4608
 ds_read_b64_tr_b16 v[24:25], v15 offset:8192
 ds_read_b64_tr_b16 v[26:27], v15 offset:8704
 ds_read_b64_tr_b16 v[28:29], v15 offset:12288
 ds_read_b64_tr_b16 v[30:31], v15 offset:12800
 s_waitcnt lgkmcnt(0)
 s_barrier
 v_add_u32 v15, 16384, v50
 ds_write_b128 v15, v[16:19] offset:0
 ds_write_b128 v15, v[20:23] offset:1024
 ds_write_b128 v15, v[24:27] offset:2048
 ds_write_b128 v15, v[28:31] offset:3072
 s_waitcnt vmcnt(8)
 s_barrier
 v_add_u32 v15, 32768, v5
 ds_read_b64_tr_b16 v[16:17], v15 offset:0
 ds_read_b64_tr_b16 v[18:19], v15 offset:512
 ds_read_b64_tr_b16 v[20:21], v15 offset:4096
 ds_read_b64_tr_b16 v[22:23], v15 offset:4608
 ds_read_b64_tr_b16 v[24:25], v15 offset:8192
 ds_read_b64_tr_b16 v[26:27], v15 offset:8704
 ds_read_b64_tr_b16 v[28:29], v15 offset:12288
 ds_read_b64_tr_b16 v[30:31], v15 offset:12800
 s_waitcnt lgkmcnt(0)
 s_barrier
 v_add_u32 v15, 32768, v50
 ds_write_b128 v15, v[16:19] offset:0
 ds_write_b128 v15, v[20:23] offset:1024
 ds_write_b128 v15, v[24:27] offset:2048
 ds_write_b128 v15, v[28:31] offset:3072
 s_waitcnt vmcnt(4)
 s_barrier
 v_add_u32 v15, 49152, v5
 ds_read_b64_tr_b16 v[16:17], v15 offset:0
 ds_read_b64_tr_b16 v[18:19], v15 offset:512
 ds_read_b64_tr_b16 v[20:21], v15 offset:4096
 ds_read_b64_tr_b16 v[22:23], v15 offset:4608
 ds_read_b64_tr_b16 v[24:25], v15 offset:8192
 ds_read_b64_tr_b16 v[26:27], v15 offset:8704
 ds_read_b64_tr_b16 v[28:29], v15 offset:12288
 ds_read_b64_tr_b16 v[30:31], v15 offset:12800
 s_waitcnt lgkmcnt(0)
 s_barrier
 v_add_u32 v15, 49152, v50
 ds_write_b128 v15, v[16:19] offset:0
 ds_write_b128 v15, v[20:23] offset:1024
 ds_write_b128 v15, v[24:27] offset:2048
 ds_write_b128 v15, v[28:31] offset:3072
 s_waitcnt vmcnt(0)
 s_barrier
 v_add_u32 v15, 65536, v5
 ds_read_b64_tr_b16 v[16:17], v15 offset:0
 ds_read_b64_tr_b16 v[18:19], v15 offset:512
 ds_read_b64_tr_b16 v[20:21], v15 offset:4096
 ds_read_b64_tr_b16 v[22:23], v15 offset:4608
 ds_read_b64_tr_b16 v[24:25], v15 offset:8192
 ds_read_b64_tr_b16 v[26:27], v15 offset:8704
 ds_read_b64_tr_b16 v[28:29], v15 offset:12288
 ds_read_b64_tr_b16 v[30:31], v15 offset:12800
 s_waitcnt lgkmcnt(0)
 s_barrier
 v_add_u32 v15, 65536, v50
 ds_write_b128 v15, v[16:19] offset:0
 ds_write_b128 v15, v[20:23] offset:1024
 ds_write_b128 v15, v[24:27] offset:2048
 ds_write_b128 v15, v[28:31] offset:3072
 s_waitcnt vmcnt(0) lgkmcnt(0)
 s_barrier
 s_cmp_eq_u32 s44, 3
 s_cbranch_scc1 L100
 v_min_u32 v40, -2, v40
 v_min_u32 v41, -2, v41
 v_min_u32 v42, -2, v42
 v_min_u32 v43, -2, v43
 v_min_u32 v44, -2, v44
 v_min_u32 v45, -2, v45
 v_min_u32 v46, -2, v46
 v_min_u32 v47, -2, v47
 v_min_u32 v8, -2, v8
 v_min_u32 v9, -2, v9
 v_min_u32 v10, -2, v10
 v_min_u32 v11, -2, v11
 s_mul_i32 s60, s44, 3072
 v_add_u32 v16, s60, v49
 ds_write_b128 v16, v[40:43] offset:0
 ds_write_b128 v16, v[44:47] offset:1024
 ds_write_b128 v16, v[8:11] offset:2048
L100:
 v_min_u32 v6, 8, v61
 v_lshlrev_b32 v6, 2, v6
L101:
 buffer_load_dword v7, v6, s[8:11], 0 offen offset:64 sc1
 s_waitcnt vmcnt(0)
 v_cmp_eq_u32 vcc, 1, v7
 s_nop 3
 s_and_b32 s60, vcc_lo, 0x1ff
 s_cmp_ge_u32 s60, 0x100
 s_cbranch_scc1 L_FALLBACK
 s_cmp_eq_u32 s60, 0xff
 s_cbranch_scc0 L101
 s_mov_b32 s47, 0
 s_mov_b32 s78, 0
 s_cmp_eq_u32 s44, 3
 s_cbranch_scc0 L103
 s_mov_b32 s63, 0
 s_mov_b32 s74, 0
 s_cmp_lt_u32 s63, s78
 s_cbranch_scc1 L104
 s_lshl_b32 s60, s46, 6
 s_add_u32 s60, s60, 73400320
 v_mov_b32 v46, 0
L105:
 buffer_load_dword v47, v46, s[4:7], s60 offen sc1
 s_waitcnt vmcnt(0)
 v_readfirstlane_b32 s78, v47
 s_cmp_lt_u32 s63, s78
 s_cbranch_scc0 L105
L104:
 s_lshl_b32 s77, s63, 5
 s_add_u32 s77, s77, s46
 s_lshl_b32 s77, s77, 14
 s_add_u32 s77, s77, 20971520
 s_mov_b32 m0, 140288
 s_add_u32 s60, s77, 0
 buffer_load_dwordx4 v57, s[4:7], s60 offen offset:0 sc1 lds
 buffer_load_dwordx4 v57, s[4:7], s60 offen offset:1024 sc1 lds
 buffer_load_dwordx4 v57, s[4:7], s60 offen offset:2048 sc1 lds
 buffer_load_dwordx4 v57, s[4:7], s60 offen offset:3072 sc1 lds
 s_mov_b32 m0, 144384
 s_add_u32 s60, s77, 4096
 buffer_load_dwordx4 v57, s[4:7], s60 offen offset:0 sc1 lds
 buffer_load_dwordx4 v57, s[4:7], s60 offen offset:1024 sc1 lds
 buffer_load_dwordx4 v57, s[4:7], s60 offen offset:2048 sc1 lds
 buffer_load_dwordx4 v57, s[4:7], s60 offen offset:3072 sc1 lds
 s_mov_b32 m0, 148480
 s_add_u32 s60, s77, 8192
 buffer_load_dwordx4 v57, s[4:7], s60 offen offset:0 sc1 lds
 buffer_load_dwordx4 v57, s[4:7], s60 offen offset:1024 sc1 lds
 buffer_load_dwordx4 v57, s[4:7], s60 offen offset:2048 sc1 lds
 buffer_load_dwordx4 v57, s[4:7], s60 offen offset:3072 sc1 lds
 s_mov_b32 m0, 152576
 s_add_u32 s60, s77, 12288
 buffer_load_dwordx4 v57, s[4:7], s60 offen offset:0 sc1 lds
 buffer_load_dwordx4 v57, s[4:7], s60 offen offset:1024 sc1 lds
 buffer_load_dwordx4 v57, s[4:7], s60 offen offset:2048 sc1 lds
 buffer_load_dwordx4 v57, s[4:7], s60 offen offset:3072 sc1 lds
L103:
 v_pk_mov_b32 v[0:1], 0, 0
 v_pk_mov_b32 v[2:3], 0, 0
 v_pk_mov_b32 v[4:5], 0, 0
 v_pk_mov_b32 v[6:7], 0, 0
 v_pk_mov_b32 v[8:9], 0, 0
 v_pk_mov_b32 v[10:11], 0, 0
 s_waitcnt vmcnt(0) lgkmcnt(0)
 s_barrier
 s_mul_i32 s15, s46, 10240
 s_lshl_b32 s61, s44, 9
 s_add_u32 s15, s15, s61
 s_add_u32 s15, s15, 72359936
 s_lshl_b32 s14, s46, 6
 s_add_u32 s14, s14, 73404416
 s_lshl_b32 s61, s44, 2
 s_add_u32 s61, s61, 4
 s_add_u32 s61, s61, s14
 s_cmp_eq_u32 s44, 3
 s_cselect_b32 s14, s14, s61
 s_mov_b32 s86, -1
 s_mov_b32 s87, -1
 s_cmp_eq_u32 s44, 2
 s_cselect_b32 s86, 0x1ff, s86
 s_cselect_b32 s87, 0, s87
 s_cmp_eq_u32 s44, 3
 s_cselect_b32 s16, 1, 0
 s_mov_b32 s17, 0
 s_cselect_b32 s86, 0, s86
 s_cselect_b32 s87, 0, s87
 s_lshl_b32 s79, s47, 18
 s_add_u32 s60, s47, 1
 s_and_b32 s75, s60, 1
 s_mul_i32 s74, s60, 9216
 s_add_u32 s60, s47, 63
 s_and_b32 s60, s60, 63
 s_lshl_b32 s73, s60, 18
 s_add_u32 s76, s73, 4096
 s_sub_u32 s90, s47, 1
 s_max_i32 s90, s90, 0
 s_add_u32 s63, s47, 1
 s_min_u32 s63, s63, 62
 s_cmp_lt_u32 s63, s78
 s_cbranch_scc1 L108
 s_lshl_b32 s60, s46, 6
 s_add_u32 s60, s60, 73400320
 v_mov_b32 v46, 0
L109:
 buffer_load_dword v47, v46, s[4:7], s60 offen sc1
 s_waitcnt vmcnt(0)
 v_readfirstlane_b32 s78, v47
 s_cmp_lt_u32 s63, s78
 s_cbranch_scc0 L109
L108:
 s_lshl_b32 s13, s63, 5
 s_add_u32 s13, s13, s46
 s_lshl_b32 s13, s13, 14
 s_add_u32 s13, s13, 20971520
 s_mov_b32 s77, s13
 s_add_u32 s60, s13, 8192
 s_cmp_eq_u32 s44, 1
 s_cselect_b32 s13, s60, s13
 s_and_b32 s60, s46, 7
 s_mul_i32 s60, s60, 1152
 s_add_u32 s60, s60, s74
 s_add_u32 s60, s60, 71303168
 s_cmp_eq_u32 s44, 2
 s_cselect_b32 s13, s60, s13
 s_branch CH_TOP106x
CH_TOP106:
 s_barrier
CH_TOP106x:
 ds_read_b128 v[12:15], v59 offset:0
 ds_read_b128 v[24:27], v50 offset:0
 ds_read_b128 v[28:31], v50 offset:1024
 ds_read_b128 v[16:19], v59 offset:512
 ds_read_b128 v[32:35], v50 offset:2048
 ds_read_b128 v[36:39], v50 offset:3072
 s_waitcnt lgkmcnt(5)
 v_smfmac_f32_16x16x64_bf16 v[0:3], v[12:15], v[224:231], v48
 ds_read_b128 v[20:23], v59 offset:1024
 v_smfmac_f32_16x16x64_bf16 v[4:7], v[12:15], v[232:239], v48
 s_waitcnt lgkmcnt(4)
 v_smfmac_f32_16x16x64_bf16 v[8:11], v[12:15], v[24:31], v48
 ds_read_b128 v[24:27], v50 offset:16384
 ds_read_b128 v[28:31], v50 offset:17408
 v_mov_b32 v47, s90
 s_mov_b64 exec, s[16:17]
 buffer_store_dword v47, v57, s[4:7], s14 offen sc1
 s_mov_b64 exec, -1
 s_waitcnt lgkmcnt(5)
 v_smfmac_f32_16x16x64_bf16 v[0:3], v[16:19], v[240:247], v48
 ds_read_b128 v[12:15], v59 offset:1536
 v_smfmac_f32_16x16x64_bf16 v[4:7], v[16:19], v[248:255], v48
 s_waitcnt lgkmcnt(4)
 v_smfmac_f32_16x16x64_bf16 v[8:11], v[16:19], v[32:39], v48
 ds_read_b128 v[32:35], v50 offset:18432
 ds_read_b128 v[36:39], v50 offset:19456
 buffer_store_dwordx4 v[40:43], v62, s[4:7], s73 offen sc1
 s_waitcnt lgkmcnt(5)
 v_smfmac_f32_16x16x64_bf16 v[0:3], v[20:23], a[0:7], v48
 ds_read_b128 v[16:19], v59 offset:2048
 v_smfmac_f32_16x16x64_bf16 v[4:7], v[20:23], a[8:15], v48
 s_waitcnt lgkmcnt(4)
 v_smfmac_f32_16x16x64_bf16 v[8:11], v[20:23], v[24:31], v48
 ds_read_b128 v[24:27], v50 offset:32768
 ds_read_b128 v[28:31], v50 offset:33792
 buffer_store_dwordx2 v[44:45], v62, s[4:7], s76 offen sc1
 s_waitcnt lgkmcnt(5)
 v_smfmac_f32_16x16x64_bf16 v[0:3], v[12:15], a[16:23], v48
 ds_read_b128 v[20:23], v59 offset:2560
 v_smfmac_f32_16x16x64_bf16 v[4:7], v[12:15], a[24:31], v48
 s_waitcnt lgkmcnt(4)
 v_smfmac_f32_16x16x64_bf16 v[8:11], v[12:15], v[32:39], v48
 ds_read_b128 v[32:35], v50 offset:34816
 ds_read_b128 v[36:39], v50 offset:35840
 v_lshlrev_b32 v46, 3, v57
 s_mov_b64 exec, s[86:87]
 buffer_load_dword v63, v46, s[4:7], s13 offen sc1
 s_mov_b64 exec, -1
 s_waitcnt lgkmcnt(5)
 v_smfmac_f32_16x16x64_bf16 v[0:3], v[16:19], a[32:39], v48
 ds_read_b128 v[12:15], v59 offset:3072
 v_smfmac_f32_16x16x64_bf16 v[4:7], v[16:19], a[40:47], v48
 s_waitcnt lgkmcnt(4)
 v_smfmac_f32_16x16x64_bf16 v[8:11], v[16:19], v[24:31], v48
 ds_read_b128 v[24:27], v50 offset:49152
 ds_read_b128 v[28:31], v50 offset:50176
 s_waitcnt lgkmcnt(5)
 v_smfmac_f32_16x16x64_bf16 v[0:3], v[20:23], a[48:55], v48
 ds_read_b128 v[16:19], v59 offset:3584
 v_smfmac_f32_16x16x64_bf16 v[4:7], v[20:23], a[56:63], v48
 s_waitcnt lgkmcnt(4)
 v_smfmac_f32_16x16x64_bf16 v[8:11], v[20:23], v[32:39], v48
 ds_read_b128 v[32:35], v50 offset:51200
 ds_read_b128 v[36:39], v50 offset:52224
 s_waitcnt lgkmcnt(5)
 v_smfmac_f32_16x16x64_bf16 v[0:3], v[12:15], a[64:71], v48
 ds_read_b128 v[20:23], v59 offset:4096
 v_smfmac_f32_16x16x64_bf16 v[4:7], v[12:15], a[72:79], v48
 s_waitcnt lgkmcnt(4)
 v_smfmac_f32_16x16x64_bf16 v[8:11], v[12:15], v[24:31], v48
 v_add_u32 v50, 0x10000, v50
 ds_read_b128 v[24:27], v50 offset:0
 ds_read_b128 v[28:31], v50 offset:1024
 s_waitcnt lgkmcnt(5)
 v_smfmac_f32_16x16x64_bf16 v[0:3], v[16:19], a[80:87], v48
 ds_read_b128 v[12:15], v59 offset:4608
 v_smfmac_f32_16x16x64_bf16 v[4:7], v[16:19], a[88:95], v48
 s_waitcnt lgkmcnt(4)
 v_smfmac_f32_16x16x64_bf16 v[8:11], v[16:19], v[32:39], v48
 ds_read_b128 v[32:35], v50 offset:2048
 ds_read_b128 v[36:39], v50 offset:3072
 s_waitcnt lgkmcnt(5)
 v_smfmac_f32_16x16x64_bf16 v[0:3], v[20:23], a[96:103], v48
 ds_read_b128 v[16:19], v59 offset:5120
 v_smfmac_f32_16x16x64_bf16 v[4:7], v[20:23], a[104:111], v48
 s_waitcnt lgkmcnt(4)
 v_smfmac_f32_16x16x64_bf16 v[8:11], v[20:23], v[24:31], v48
 ds_read_b128 v[24:27], v50 offset:16384
 ds_read_b128 v[28:31], v50 offset:17408
 s_waitcnt lgkmcnt(5)
 v_smfmac_f32_16x16x64_bf16 v[0:3], v[12:15], a[112:119], v48
 ds_read_b128 v[20:23], v59 offset:5632
 v_smfmac_f32_16x16x64_bf16 v[4:7], v[12:15], a[120:127], v48
 s_waitcnt lgkmcnt(4)
 v_smfmac_f32_16x16x64_bf16 v[8:11], v[12:15], v[32:39], v48
 ds_read_b128 v[32:35], v50 offset:18432
 ds_read_b128 v[36:39], v50 offset:19456
 s_waitcnt lgkmcnt(5)
 v_smfmac_f32_16x16x64_bf16 v[0:3], v[16:19], a[128:135], v48
 ds_read_b128 v[12:15], v59 offset:6144
 v_smfmac_f32_16x16x64_bf16 v[4:7], v[16:19], a[136:143], v48
 s_waitcnt lgkmcnt(4)
 v_smfmac_f32_16x16x64_bf16 v[8:11], v[16:19], v[24:31], v48
 ds_read_b128 v[24:27], v50 offset:32768
 ds_read_b128 v[28:31], v50 offset:33792
 s_waitcnt lgkmcnt(5)
 v_smfmac_f32_16x16x64_bf16 v[0:3], v[20:23], a[144:151], v48
 ds_read_b128 v[16:19], v59 offset:6656
 v_smfmac_f32_16x16x64_bf16 v[4:7], v[20:23], a[152:159], v48
 s_waitcnt lgkmcnt(4)
 v_smfmac_f32_16x16x64_bf16 v[8:11], v[20:23], v[32:39], v48
 ds_read_b128 v[32:35], v50 offset:34816
 ds_read_b128 v[36:39], v50 offset:35840
 s_waitcnt lgkmcnt(5)
 v_smfmac_f32_16x16x64_bf16 v[0:3], v[12:15], a[160:167], v48
 ds_read_b128 v[20:23], v59 offset:7168
 v_smfmac_f32_16x16x64_bf16 v[4:7], v[12:15], a[168:175], v48
 s_waitcnt lgkmcnt(4)
 v_smfmac_f32_16x16x64_bf16 v[8:11], v[12:15], v[24:31], v48
 ds_read_b128 v[24:27], v50 offset:49152
 ds_read_b128 v[28:31], v50 offset:50176
 s_waitcnt lgkmcnt(5)
 v_smfmac_f32_16x16x64_bf16 v[0:3], v[16:19], a[176:183], v48
 ds_read_b128 v[12:15], v59 offset:7680
 v_smfmac_f32_16x16x64_bf16 v[4:7], v[16:19], a[184:191], v48
 s_waitcnt lgkmcnt(4)
 v_smfmac_f32_16x16x64_bf16 v[8:11], v[16:19], v[32:39], v48
 ds_read_b128 v[32:35], v50 offset:51200
 ds_read_b128 v[36:39], v50 offset:52224
 v_subrev_u32 v50, 0x10000, v50
 s_waitcnt lgkmcnt(5)
 v_smfmac_f32_16x16x64_bf16 v[0:3], v[20:23], a[192:199], v48
 ds_read_b128 v[16:19], v59 offset:8192
 v_smfmac_f32_16x16x64_bf16 v[4:7], v[20:23], a[200:207], v48
 s_waitcnt lgkmcnt(4)
 v_smfmac_f32_16x16x64_bf16 v[8:11], v[20:23], v[24:31], v48
 s_waitcnt lgkmcnt(3)
 v_smfmac_f32_16x16x64_bf16 v[0:3], v[12:15], a[208:215], v48
 ds_read_b128 v[20:23], v59 offset:8704
 v_smfmac_f32_16x16x64_bf16 v[4:7], v[12:15], a[216:223], v48
 s_waitcnt lgkmcnt(1)
 v_smfmac_f32_16x16x64_bf16 v[0:3], v[16:19], a[224:231], v48
 v_smfmac_f32_16x16x64_bf16 v[4:7], v[16:19], a[232:239], v48
 s_waitcnt lgkmcnt(0)
 v_smfmac_f32_16x16x64_bf16 v[0:3], v[20:23], a[240:247], v48
 v_smfmac_f32_16x16x64_bf16 v[4:7], v[20:23], a[248:255], v48
 s_waitcnt lgkmcnt(2)
 v_smfmac_f32_16x16x64_bf16 v[8:11], v[12:15], v[32:39], v48
 v_cvt_pk_bf16_f32 v0, v0, v1
 v_cvt_pk_bf16_f32 v1, v2, v3
 ds_write_b64 v51, v[0:1]
 ds_read_b128 v[32:35], v49 offset:9216
 ds_read_b128 v[36:39], v49 offset:13312
 v_smfmac_f32_16x16x64_bf16 v[8:11], v[16:19], v[208:215], v48
 v_cvt_pk_bf16_f32 v4, v4, v5
 v_cvt_pk_bf16_f32 v5, v6, v7
 ds_write_b64 v51, v[4:5] offset:256
 v_smfmac_f32_16x16x64_bf16 v[8:11], v[20:23], v[216:223], v48
 ds_read_b128 v[16:19], v49 offset:10240
 ds_read_b128 v[20:23], v49 offset:14336
 s_waitcnt lgkmcnt(2)
 s_barrier
 ds_read_b64_tr_b16 v[24:25], v52 offset:0
 ds_read_b64_tr_b16 v[26:27], v52 offset:128
 ds_read_b64_tr_b16 v[28:29], v52 offset:2048
 ds_read_b64_tr_b16 v[30:31], v52 offset:2176
 ds_read_b64_tr_b16 v[40:41], v52 offset:512
 ds_read_b64_tr_b16 v[42:43], v52 offset:640
 ds_read_b64_tr_b16 v[44:45], v52 offset:2560
 ds_read_b64_tr_b16 v[46:47], v52 offset:2688
 v_cvt_pk_bf16_f32 v8, v8, v9
 v_cvt_pk_bf16_f32 v9, v10, v11
 s_waitcnt lgkmcnt(4)
 v_mfma_f32_16x16x32_bf16 v[4:7], v[32:35], v[24:27], 0
 v_mfma_f32_16x16x32_bf16 v[12:15], v[36:39], v[24:27], 0
 v_mfma_f32_16x16x32_bf16 v[0:3], v[28:31], v[24:27], 0
 ds_read_b128 v[32:35], v49 offset:11264
 ds_read_b128 v[36:39], v49 offset:15360
 ds_read_b64_tr_b16 v[24:25], v52 offset:1024
 ds_read_b64_tr_b16 v[26:27], v52 offset:1152
 ds_read_b64_tr_b16 v[28:29], v52 offset:3072
 ds_read_b64_tr_b16 v[30:31], v52 offset:3200
 s_waitcnt lgkmcnt(6)
 v_mfma_f32_16x16x32_bf16 v[4:7], v[16:19], v[40:43], v[4:7]
 v_mfma_f32_16x16x32_bf16 v[12:15], v[20:23], v[40:43], v[12:15]
 v_mfma_f32_16x16x32_bf16 v[0:3], v[44:47], v[40:43], v[0:3]
 ds_read_b128 v[16:19], v49 offset:12288
 ds_read_b128 v[20:23], v49 offset:16384
 ds_read_b64_tr_b16 v[40:41], v52 offset:1536
 ds_read_b64_tr_b16 v[42:43], v52 offset:1664
 ds_read_b64_tr_b16 v[44:45], v52 offset:3584
 ds_read_b64_tr_b16 v[46:47], v52 offset:3712
 s_waitcnt lgkmcnt(6)
 v_mfma_f32_16x16x32_bf16 v[4:7], v[32:35], v[24:27], v[4:7]
 v_mfma_f32_16x16x32_bf16 v[12:15], v[36:39], v[24:27], v[12:15]
 v_mfma_f32_16x16x32_bf16 v[0:3], v[28:31], v[24:27], v[0:3]
 ds_read_b128 v[24:27], v58 offset:17408
 ds_read_b128 v[28:31], v58 offset:18432
 s_waitcnt lgkmcnt(2)
 v_mfma_f32_16x16x32_bf16 v[4:7], v[16:19], v[40:43], v[4:7]
 v_mfma_f32_16x16x32_bf16 v[12:15], v[20:23], v[40:43], v[12:15]
 v_mfma_f32_16x16x32_bf16 v[0:3], v[44:47], v[40:43], v[0:3]
 v_cndmask_b32 v16, 0, v8, s[88:89]
 v_cndmask_b32 v17, 0, v9, s[88:89]
 v_cndmask_b32 v18, v8, 0, s[88:89]
 v_cndmask_b32 v19, v9, 0, s[88:89]
 v_mov_b32 v10, v8
 v_mov_b32 v11, v9
 v_max3_f32 v32, v4, v5, v6
 v_max3_f32 v33, v12, v13, v14
 v_max3_f32 v32, v32, v7, v15
 v_max3_f32 v33, v33, v0, v1
 v_max3_f32 v32, v32, v2, v3
 v_max_f32 v32, v32, v33
 v_mov_b32 v33, v32
 s_nop 1
 v_permlane32_swap_b32 v32, v33
 v_max_f32 v32, v32, v33
 v_mov_b32 v33, v32
 s_nop 1
 v_permlane16_swap_b32 v32, v33
 v_max_f32 v32, v32, v33
 v_mul_f32 v33, s81, v32
 v_fma_f32 v0, v0, s80, v33
 v_fma_f32 v1, v1, s80, v33
 v_fma_f32 v2, v2, s80, v33
 v_fma_f32 v3, v3, s80, v33
 v_fma_f32 v4, v4, s80, v33
 v_fma_f32 v5, v5, s80, v33
 v_fma_f32 v6, v6, s80, v33
 v_fma_f32 v7, v7, s80, v33
 v_fma_f32 v12, v12, s80, v33
 v_fma_f32 v13, v13, s80, v33
 v_fma_f32 v14, v14, s80, v33
 v_fma_f32 v15, v15, s80, v33
 v_exp_f32 v0, v0
 v_exp_f32 v1, v1
 v_exp_f32 v2, v2
 v_exp_f32 v3, v3
 v_exp_f32 v4, v4
 v_exp_f32 v5, v5
 v_exp_f32 v6, v6
 v_exp_f32 v7, v7
 v_exp_f32 v12, v12
 v_exp_f32 v13, v13
 v_exp_f32 v14, v14
 v_exp_f32 v15, v15
 v_cvt_pk_bf16_f32 v36, v4, v5
 v_cvt_pk_bf16_f32 v37, v6, v7
 v_cvt_pk_bf16_f32 v38, v12, v13
 v_cvt_pk_bf16_f32 v39, v14, v15
 v_cvt_pk_bf16_f32 v34, v0, v1
 v_cvt_pk_bf16_f32 v35, v2, v3
 s_waitcnt lgkmcnt(0)
 v_mfma_f32_16x16x32_bf16 v[40:43], v[24:27], v[36:39], 0
 v_pk_add_f32 v[4:5], v[4:5], v[6:7]
 v_pk_add_f32 v[12:13], v[12:13], v[14:15]
 v_mfma_f32_16x16x32_bf16 v[44:47], v[28:31], v[36:39], 0
 v_pk_add_f32 v[0:1], v[0:1], v[2:3]
 v_pk_add_f32 v[4:5], v[4:5], v[12:13]
 v_mfma_f32_16x16x16_bf16 v[40:43], v[16:17], v[34:35], v[40:43]
 v_add_f32 v0, v0, v1
 v_add_f32 v4, v4, v5
 v_mfma_f32_16x16x16_bf16 v[44:47], v[18:19], v[34:35], v[44:47]
 v_fma_f32 v20, v0, v60, v4
 v_mov_b32 v21, v20
 v_pk_mov_b32 v[0:1], 0, 0
 v_pk_mov_b32 v[2:3], 0, 0
 v_permlane32_swap_b32 v20, v21
 v_add_f32 v20, v20, v21
 v_mov_b32 v21, v20
 v_pk_mov_b32 v[4:5], 0, 0
 v_pk_mov_b32 v[6:7], 0, 0
 v_permlane16_swap_b32 v20, v21
 v_add_f32 v20, v20, v21
 v_rcp_f32 v22, v20
 v_pk_mov_b32 v[8:9], 0, 0
 v_mov_b32 v23, v22
 v_pk_mul_f32 v[40:41], v[40:41], v[22:23]
 v_pk_mul_f32 v[42:43], v[42:43], v[22:23]
 v_pk_mul_f32 v[44:45], v[44:45], v[22:23]
 v_pk_mul_f32 v[46:47], v[46:47], v[22:23]
 v_cvt_pk_bf16_f32 v40, v40, v41
 v_cvt_pk_bf16_f32 v41, v42, v43
 v_cvt_pk_bf16_f32 v42, v44, v45
 v_cvt_pk_bf16_f32 v43, v46, v47
 s_mov_b64 exec, s[84:85]
 ds_write_b64 v53, v[40:41]
 ds_write_b64 v53, v[42:43] offset:256
 s_mov_b64 exec, -1
 v_mov_b32 v44, v10
 v_mov_b32 v45, v11
 v_pk_mov_b32 v[10:11], 0, 0
 v_pk_mov_b32 v[12:13], 0, 0
 v_pk_mov_b32 v[14:15], 0, 0
 v_pk_mov_b32 v[16:17], 0, 0
 v_pk_mov_b32 v[18:19], 0, 0
 v_and_b32 v46, 31, v61
 v_lshlrev_b32 v46, 4, v46
 v_lshrrev_b32 v47, 5, v61
 v_lshlrev_b32 v47, 3, v47
 v_add_u32 v46, v46, v47
 s_waitcnt lgkmcnt(0)
 s_barrier
 ds_read_b128 v[36:39], v49 offset:29696
 ds_read_b128 v[40:43], v49 offset:30720
 ds_read_b128 v[20:23], v59 offset:29696
 ds_read_b128 v[24:27], v59 offset:30208
 ds_read_b128 v[28:31], v59 offset:30720
 ds_read_b128 v[32:35], v59 offset:31232
 s_waitcnt lgkmcnt(5)
 v_smfmac_f32_16x16x64_bf16 v[16:19], v[36:39], v[192:199], v48
 s_waitcnt lgkmcnt(4)
 v_smfmac_f32_16x16x64_bf16 v[16:19], v[40:43], v[200:207], v48
 s_waitcnt lgkmcnt(3)
 v_smfmac_f32_16x16x64_bf16 v[0:3], v[20:23], v[64:71], v48
 v_smfmac_f32_16x16x64_bf16 v[4:7], v[20:23], v[96:103], v48
 s_waitcnt lgkmcnt(2)
 v_smfmac_f32_16x16x64_bf16 v[0:3], v[24:27], v[72:79], v48
 v_smfmac_f32_16x16x64_bf16 v[4:7], v[24:27], v[104:111], v48
 v_cvt_pk_bf16_f32 v16, v16, v17
 v_cvt_pk_bf16_f32 v17, v18, v19
 v_and_or_b32 v16, v16, -2, s75
 buffer_store_dwordx2 v[16:17], v46, s[4:7], s15 offen
 s_waitcnt lgkmcnt(1)
 v_smfmac_f32_16x16x64_bf16 v[0:3], v[28:31], v[80:87], v48
 v_smfmac_f32_16x16x64_bf16 v[4:7], v[28:31], v[112:119], v48
 s_waitcnt lgkmcnt(0)
 v_smfmac_f32_16x16x64_bf16 v[0:3], v[32:35], v[88:95], v48
 v_smfmac_f32_16x16x64_bf16 v[4:7], v[32:35], v[120:127], v48
 v_smfmac_f32_16x16x64_bf16 v[8:11], v[20:23], v[128:135], v48
 v_smfmac_f32_16x16x64_bf16 v[12:15], v[20:23], v[160:167], v48
 v_smfmac_f32_16x16x64_bf16 v[8:11], v[24:27], v[136:143], v48
 v_smfmac_f32_16x16x64_bf16 v[12:15], v[24:27], v[168:175], v48
 v_cvt_pk_bf16_f32 v0, v0, v1
 v_cvt_pk_bf16_f32 v1, v2, v3
 v_cvt_pk_bf16_f32 v2, v4, v5
 v_cvt_pk_bf16_f32 v3, v6, v7
 v_and_or_b32 v0, v0, -2, s75
 buffer_store_dwordx4 v[0:3], v54, s[4:7], 0 offen offset:0
 v_smfmac_f32_16x16x64_bf16 v[8:11], v[28:31], v[144:151], v48
 v_smfmac_f32_16x16x64_bf16 v[12:15], v[28:31], v[176:183], v48
 v_smfmac_f32_16x16x64_bf16 v[8:11], v[32:35], v[152:159], v48
 v_smfmac_f32_16x16x64_bf16 v[12:15], v[32:35], v[184:191], v48
 s_nop 7
 v_cvt_pk_bf16_f32 v8, v8, v9
 v_cvt_pk_bf16_f32 v9, v10, v11
 v_cvt_pk_bf16_f32 v10, v12, v13
 v_cvt_pk_bf16_f32 v11, v14, v15
 v_and_or_b32 v8, v8, -2, s75
 buffer_store_dwordx4 v[8:11], v54, s[4:7], 0 offen offset:1024
 s_cmp_eq_u32 s44, 3
 s_cbranch_scc1 L110
 s_cmp_eq_u32 s72, 0
 s_cbranch_scc1 L113
 s_cmp_eq_u32 s72, 2
 s_cbranch_scc1 L112
 v_and_b32 v40, 15, v61
 v_mov_b32 v43, 0x3f80
 v_subrev_u32 v41, 0, v40
 v_lshlrev_b32 v42, 4, v41
 v_cmp_gt_u32 vcc, 2, v41
 v_lshlrev_b32 v42, v42, v43
 s_nop 0
 v_cndmask_b32 v32, 0, v42, vcc
 v_subrev_u32 v41, 2, v40
 v_lshlrev_b32 v42, 4, v41
 v_cmp_gt_u32 vcc, 2, v41
 v_lshlrev_b32 v42, v42, v43
 s_nop 0
 v_cndmask_b32 v33, 0, v42, vcc
 v_subrev_u32 v41, 4, v40
 v_lshlrev_b32 v42, 4, v41
 v_cmp_gt_u32 vcc, 2, v41
 v_lshlrev_b32 v42, v42, v43
 s_nop 0
 v_cndmask_b32 v34, 0, v42, vcc
 v_subrev_u32 v41, 6, v40
 v_lshlrev_b32 v42, 4, v41
 v_cmp_gt_u32 vcc, 2, v41
 v_lshlrev_b32 v42, v42, v43
 s_nop 0
 v_cndmask_b32 v35, 0, v42, vcc
 s_waitcnt vmcnt(0)
 buffer_load_dwordx4 v[0:3], v55, s[4:7], s64 offen sc1
 buffer_load_dwordx4 v[4:7], v55, s[4:7], s65 offen sc1
 buffer_load_dwordx4 v[8:11], v55, s[4:7], s66 offen sc1
 buffer_load_dwordx4 v[12:15], v55, s[4:7], s67 offen sc1
 buffer_load_dwordx4 v[16:19], v55, s[4:7], s68 offen sc1
 buffer_load_dwordx4 v[20:23], v55, s[4:7], s69 offen sc1
 buffer_load_dwordx4 v[24:27], v55, s[4:7], s70 offen sc1
 buffer_load_dwordx4 v[28:31], v55, s[4:7], s71 offen sc1
 s_barrier
 s_branch L115
L114:
 buffer_load_dwordx4 v[0:3], v55, s[4:7], s64 offen sc1
 buffer_load_dwordx4 v[4:7], v55, s[4:7], s65 offen sc1
 buffer_load_dwordx4 v[8:11], v55, s[4:7], s66 offen sc1
 buffer_load_dwordx4 v[12:15], v55, s[4:7], s67 offen sc1
 buffer_load_dwordx4 v[16:19], v55, s[4:7], s68 offen sc1
 buffer_load_dwordx4 v[20:23], v55, s[4:7], s69 offen sc1
 buffer_load_dwordx4 v[24:27], v55, s[4:7], s70 offen sc1
 buffer_load_dwordx4 v[28:31], v55, s[4:7], s71 offen sc1
L115:
 s_waitcnt vmcnt(7)
 v_mfma_f32_16x16x32_bf16 v[36:39], v[0:3], v[32:35], 0
 s_waitcnt vmcnt(6)
 v_mfma_f32_16x16x32_bf16 v[36:39], v[4:7], v[32:35], v[36:39]
 v_bitop3_b32 v47, v0, v4, s75 bitop3:0x7e
 v_mov_b32 v46, v47
 s_waitcnt vmcnt(5)
 v_mfma_f32_16x16x32_bf16 v[36:39], v[8:11], v[32:35], v[36:39]
 s_waitcnt vmcnt(4)
 v_mfma_f32_16x16x32_bf16 v[36:39], v[12:15], v[32:35], v[36:39]
 v_bitop3_b32 v47, v8, v12, s75 bitop3:0x7e
 v_or_b32 v46, v46, v47
 s_waitcnt vmcnt(3)
 v_mfma_f32_16x16x32_bf16 v[36:39], v[16:19], v[32:35], v[36:39]
 s_waitcnt vmcnt(2)
 v_mfma_f32_16x16x32_bf16 v[36:39], v[20:23], v[32:35], v[36:39]
 v_bitop3_b32 v47, v16, v20, s75 bitop3:0x7e
 v_or_b32 v46, v46, v47
 s_waitcnt vmcnt(1)
 v_mfma_f32_16x16x32_bf16 v[36:39], v[24:27], v[32:35], v[36:39]
 s_waitcnt vmcnt(0)
 v_mfma_f32_16x16x32_bf16 v[36:39], v[28:31], v[32:35], v[36:39]
 v_bitop3_b32 v47, v24, v28, s75 bitop3:0x7e
 v_or_b32 v46, v46, v47
 v_and_b32 v46, 1, v46
 v_cmp_ne_u32 vcc, 0, v46
 s_cbranch_vccnz L114
 s_nop 2
 v_cvt_pk_bf16_f32 v46, v36, v37
 v_cvt_pk_bf16_f32 v47, v38, v39
 v_min_u32 v46, -2, v46
 v_min_u32 v47, -2, v47
 s_mov_b64 exec, s[82:83]
 buffer_store_dwordx2 v[46:47], v56, s[4:7], s74 offen
 s_mov_b64 exec, -1
 s_branch L111
L112:
 v_and_b32 v40, 15, v61
 v_mov_b32 v43, 0x3f80
 v_subrev_u32 v41, 0, v40
 v_lshlrev_b32 v42, 4, v41
 v_cmp_gt_u32 vcc, 2, v41
 v_lshlrev_b32 v42, v42, v43
 s_nop 0
 v_cndmask_b32 v32, 0, v42, vcc
 v_subrev_u32 v41, 2, v40
 v_lshlrev_b32 v42, 4, v41
 v_cmp_gt_u32 vcc, 2, v41
 v_lshlrev_b32 v42, v42, v43
 s_nop 0
 v_cndmask_b32 v33, 0, v42, vcc
 v_subrev_u32 v41, 0, v40
 v_lshlrev_b32 v42, 4, v41
 v_cmp_gt_u32 vcc, 2, v41
 v_lshlrev_b32 v42, v42, v43
 s_nop 0
 v_cndmask_b32 v34, 0, v42, vcc
 v_subrev_u32 v41, 2, v40
 v_lshlrev_b32 v42, 4, v41
 v_cmp_gt_u32 vcc, 2, v41
 v_lshlrev_b32 v42, v42, v43
 s_nop 0
 v_cndmask_b32 v35, 0, v42, vcc
 s_waitcnt vmcnt(0)
 buffer_load_dwordx4 v[0:3], v55, s[4:7], s64 offen sc1
 buffer_load_dwordx4 v[4:7], v55, s[4:7], s65 offen sc1
 buffer_load_dwordx4 v[8:11], v55, s[4:7], s66 offen sc1
 buffer_load_dwordx4 v[12:15], v55, s[4:7], s67 offen sc1
 buffer_load_dwordx4 v[16:19], v55, s[4:7], s68 offen sc1
 buffer_load_dwordx4 v[20:23], v55, s[4:7], s69 offen sc1
 buffer_load_dwordx4 v[24:27], v55, s[4:7], s70 offen sc1
 buffer_load_dwordx4 v[28:31], v55, s[4:7], s71 offen sc1
 s_barrier
 s_branch L117
L116:
 buffer_load_dwordx4 v[0:3], v55, s[4:7], s64 offen sc1
 buffer_load_dwordx4 v[4:7], v55, s[4:7], s65 offen sc1
 buffer_load_dwordx4 v[8:11], v55, s[4:7], s66 offen sc1
 buffer_load_dwordx4 v[12:15], v55, s[4:7], s67 offen sc1
 buffer_load_dwordx4 v[16:19], v55, s[4:7], s68 offen sc1
 buffer_load_dwordx4 v[20:23], v55, s[4:7], s69 offen sc1
 buffer_load_dwordx4 v[24:27], v55, s[4:7], s70 offen sc1
 buffer_load_dwordx4 v[28:31], v55, s[4:7], s71 offen sc1
L117:
 s_waitcnt vmcnt(7)
 v_mfma_f32_16x16x32_bf16 v[36:39], v[0:3], v[32:35], 0
 v_bitop3_b32 v47, v0, v2, s75 bitop3:0x7e
 v_mov_b32 v46, v47
 s_waitcnt vmcnt(6)
 v_mfma_f32_16x16x32_bf16 v[36:39], v[4:7], v[32:35], v[36:39]
 v_bitop3_b32 v47, v4, v6, s75 bitop3:0x7e
 v_or_b32 v46, v46, v47
 s_waitcnt vmcnt(5)
 v_mfma_f32_16x16x32_bf16 v[36:39], v[8:11], v[32:35], v[36:39]
 v_bitop3_b32 v47, v8, v10, s75 bitop3:0x7e
 v_or_b32 v46, v46, v47
 s_waitcnt vmcnt(4)
 v_mfma_f32_16x16x32_bf16 v[36:39], v[12:15], v[32:35], v[36:39]
 v_bitop3_b32 v47, v12, v14, s75 bitop3:0x7e
 v_or_b32 v46, v46, v47
 s_waitcnt vmcnt(3)
 v_mfma_f32_16x16x32_bf16 v[36:39], v[16:19], v[32:35], v[36:39]
 v_bitop3_b32 v47, v16, v18, s75 bitop3:0x7e
 v_or_b32 v46, v46, v47
 s_waitcnt vmcnt(2)
 v_mfma_f32_16x16x32_bf16 v[36:39], v[20:23], v[32:35], v[36:39]
 v_bitop3_b32 v47, v20, v22, s75 bitop3:0x7e
 v_or_b32 v46, v46, v47
 s_waitcnt vmcnt(1)
 v_mfma_f32_16x16x32_bf16 v[36:39], v[24:27], v[32:35], v[36:39]
 v_bitop3_b32 v47, v24, v26, s75 bitop3:0x7e
 v_or_b32 v46, v46, v47
 s_waitcnt vmcnt(0)
 v_mfma_f32_16x16x32_bf16 v[36:39], v[28:31], v[32:35], v[36:39]
 v_bitop3_b32 v47, v28, v30, s75 bitop3:0x7e
 v_or_b32 v46, v46, v47
 v_and_b32 v46, 1, v46
 v_cmp_ne_u32 vcc, 0, v46
 s_cbranch_vccnz L116
 s_nop 2
 v_cvt_pk_bf16_f32 v46, v36, v37
 v_cvt_pk_bf16_f32 v47, v38, v39
 v_min_u32 v46, -2, v46
 v_min_u32 v47, -2, v47
 s_mov_b64 exec, s[82:83]
 buffer_store_dwordx2 v[46:47], v56, s[4:7], s74 offen
 s_mov_b64 exec, -1
 s_branch L111
L113:
 s_barrier
L111:
 s_lshl_b32 s60, s44, 9
 v_add_u32 v46, s60, v52
 ds_read_b64_tr_b16 v[40:41], v46 offset:2048
 ds_read_b64_tr_b16 v[42:43], v46 offset:2176
 s_barrier
 s_mul_i32 s61, s44, 3072
 s_add_u32 s12, s61, s74
 s_add_u32 s12, s12, 71303168
 v_add_u32 v36, s61, v49
 v_pk_mov_b32 v[0:1], 0, 0
 v_pk_mov_b32 v[2:3], 0, 0
 v_pk_mov_b32 v[4:5], 0, 0
 v_pk_mov_b32 v[6:7], 0, 0
 v_pk_mov_b32 v[8:9], 0, 0
 v_pk_mov_b32 v[10:11], 0, 0
 s_add_u32 s47, s47, 1
 s_lshl_b32 s79, s47, 18
 s_add_u32 s60, s47, 1
 s_and_b32 s75, s60, 1
 s_mul_i32 s74, s60, 9216
 s_add_u32 s60, s47, 63
 s_and_b32 s60, s60, 63
 s_lshl_b32 s73, s60, 18
 s_add_u32 s76, s73, 4096
 s_sub_u32 s90, s47, 1
 s_max_i32 s90, s90, 0
 s_add_u32 s63, s47, 1
 s_min_u32 s63, s63, 62
 s_cmp_lt_u32 s63, s78
 s_cbranch_scc1 L119
 s_lshl_b32 s60, s46, 6
 s_add_u32 s60, s60, 73400320
 v_mov_b32 v46, 0
L120:
 buffer_load_dword v47, v46, s[4:7], s60 offen sc1
 s_waitcnt vmcnt(0)
 v_readfirstlane_b32 s78, v47
 s_cmp_lt_u32 s63, s78
 s_cbranch_scc0 L120
L119:
 s_lshl_b32 s13, s63, 5
 s_add_u32 s13, s13, s46
 s_lshl_b32 s13, s13, 14
 s_add_u32 s13, s13, 20971520
 s_mov_b32 s77, s13
 s_add_u32 s60, s13, 8192
 s_cmp_eq_u32 s44, 1
 s_cselect_b32 s13, s60, s13
 s_and_b32 s60, s46, 7
 s_mul_i32 s60, s60, 1152
 s_add_u32 s60, s60, s74
 s_add_u32 s60, s60, 71303168
 s_cmp_eq_u32 s44, 2
 s_cselect_b32 s13, s60, s13
L118:
 buffer_load_dwordx4 v[12:15], v57, s[4:7], s12 offen offset:0 sc1
 buffer_load_dwordx4 v[16:19], v57, s[4:7], s12 offen offset:1024 sc1
 buffer_load_dwordx4 v[20:23], v57, s[4:7], s12 offen offset:2048 sc1
 s_waitcnt vmcnt(2)
 ds_write_b128 v36, v[12:15] offset:0
 s_waitcnt vmcnt(1)
 ds_write_b128 v36, v[16:19] offset:1024
 s_waitcnt vmcnt(0)
 ds_write_b128 v36, v[20:23] offset:2048
 v_max3_u32 v37, v12, v14, v16
 v_max3_u32 v38, v18, v20, v22
 v_max_u32 v37, v37, v38
 v_cmp_eq_u32 vcc, -1, v37
 s_cbranch_vccnz L118
 s_waitcnt lgkmcnt(0)
L121:
 s_cmp_eq_u32 s47, 63
 s_cbranch_scc0 CH_TOP106
 s_branch CH_LAST107
L110:
 s_barrier
 s_add_u32 s63, s47, 1
 s_cmp_ge_u32 s63, 63
 s_cbranch_scc1 L122
 s_mov_b32 m0, 140288
 s_add_u32 s60, s77, 0
 buffer_load_dwordx4 v57, s[4:7], s60 offen offset:0 sc1 lds
 buffer_load_dwordx4 v57, s[4:7], s60 offen offset:1024 sc1 lds
 buffer_load_dwordx4 v57, s[4:7], s60 offen offset:2048 sc1 lds
 buffer_load_dwordx4 v57, s[4:7], s60 offen offset:3072 sc1 lds
 s_mov_b32 m0, 144384
 s_add_u32 s60, s77, 4096
 buffer_load_dwordx4 v57, s[4:7], s60 offen offset:0 sc1 lds
 buffer_load_dwordx4 v57, s[4:7], s60 offen offset:1024 sc1 lds
 buffer_load_dwordx4 v57, s[4:7], s60 offen offset:2048 sc1 lds
 buffer_load_dwordx4 v57, s[4:7], s60 offen offset:3072 sc1 lds
 s_mov_b32 m0, 148480
 s_add_u32 s60, s77, 8192
 buffer_load_dwordx4 v57, s[4:7], s60 offen offset:0 sc1 lds
 buffer_load_dwordx4 v57, s[4:7], s60 offen offset:1024 sc1 lds
 buffer_load_dwordx4 v57, s[4:7], s60 offen offset:2048 sc1 lds
 buffer_load_dwordx4 v57, s[4:7], s60 offen offset:3072 sc1 lds
 s_mov_b32 m0, 152576
 s_add_u32 s60, s77, 12288
 buffer_load_dwordx4 v57, s[4:7], s60 offen offset:0 sc1 lds
 buffer_load_dwordx4 v57, s[4:7], s60 offen offset:1024 sc1 lds
 buffer_load_dwordx4 v57, s[4:7], s60 offen offset:2048 sc1 lds
 buffer_load_dwordx4 v57, s[4:7], s60 offen offset:3072 sc1 lds
L122:
 s_lshl_b32 s60, s44, 9
 v_add_u32 v46, s60, v52
 ds_read_b64_tr_b16 v[40:41], v46 offset:2048
 ds_read_b64_tr_b16 v[42:43], v46 offset:2176
 s_barrier
 v_pk_mov_b32 v[0:1], 0, 0
 v_pk_mov_b32 v[2:3], 0, 0
 v_pk_mov_b32 v[4:5], 0, 0
 v_pk_mov_b32 v[6:7], 0, 0
 v_pk_mov_b32 v[8:9], 0, 0
 v_pk_mov_b32 v[10:11], 0, 0
 s_add_u32 s47, s47, 1
 s_lshl_b32 s79, s47, 18
 s_add_u32 s60, s47, 1
 s_and_b32 s75, s60, 1
 s_mul_i32 s74, s60, 9216
 s_add_u32 s60, s47, 63
 s_and_b32 s60, s60, 63
 s_lshl_b32 s73, s60, 18
 s_add_u32 s76, s73, 4096
 s_sub_u32 s90, s47, 1
 s_max_i32 s90, s90, 0
 s_add_u32 s63, s47, 1
 s_min_u32 s63, s63, 62
 s_cmp_lt_u32 s63, s78
 s_cbranch_scc1 L123
 s_lshl_b32 s60, s46, 6
 s_add_u32 s60, s60, 73400320
 v_mov_b32 v46, 0
L124:
 buffer_load_dword v47, v46, s[4:7], s60 offen sc1
 s_waitcnt vmcnt(0)
 v_readfirstlane_b32 s78, v47
 s_cmp_lt_u32 s63, s78
 s_cbranch_scc0 L124
L123:
 s_lshl_b32 s13, s63, 5
 s_add_u32 s13, s13, s46
 s_lshl_b32 s13, s13, 14
 s_add_u32 s13, s13, 20971520
 s_mov_b32 s77, s13
 s_add_u32 s60, s13, 8192
 s_cmp_eq_u32 s44, 1
 s_cselect_b32 s13, s60, s13
 s_and_b32 s60, s46, 7
 s_mul_i32 s60, s60, 1152
 s_add_u32 s60, s60, s74
 s_add_u32 s60, s60, 71303168
 s_cmp_eq_u32 s44, 2
 s_cselect_b32 s13, s60, s13
 s_waitcnt vmcnt(0) lgkmcnt(0)
 s_branch L121
CH_LAST107:
 s_barrier
 ds_read_b128 v[12:15], v59 offset:0
 ds_read_b128 v[24:27], v50 offset:0
 ds_read_b128 v[28:31], v50 offset:1024
 ds_read_b128 v[16:19], v59 offset:512
 ds_read_b128 v[32:35], v50 offset:2048
 ds_read_b128 v[36:39], v50 offset:3072
 s_waitcnt lgkmcnt(5)
 v_smfmac_f32_16x16x64_bf16 v[0:3], v[12:15], v[224:231], v48
 ds_read_b128 v[20:23], v59 offset:1024
 v_smfmac_f32_16x16x64_bf16 v[4:7], v[12:15], v[232:239], v48
 s_waitcnt lgkmcnt(4)
 v_smfmac_f32_16x16x64_bf16 v[8:11], v[12:15], v[24:31], v48
 ds_read_b128 v[24:27], v50 offset:16384
 ds_read_b128 v[28:31], v50 offset:17408
 v_mov_b32 v47, s90
 s_mov_b64 exec, s[16:17]
 buffer_store_dword v47, v57, s[4:7], s14 offen sc1
 s_mov_b64 exec, -1
 s_waitcnt lgkmcnt(5)
 v_smfmac_f32_16x16x64_bf16 v[0:3], v[16:19], v[240:247], v48
 ds_read_b128 v[12:15], v59 offset:1536
 v_smfmac_f32_16x16x64_bf16 v[4:7], v[16:19], v[248:255], v48
 s_waitcnt lgkmcnt(4)
 v_smfmac_f32_16x16x64_bf16 v[8:11], v[16:19], v[32:39], v48
 ds_read_b128 v[32:35], v50 offset:18432
 ds_read_b128 v[36:39], v50 offset:19456
 buffer_store_dwordx4 v[40:43], v62, s[4:7], s73 offen sc1
 s_waitcnt lgkmcnt(5)
 v_smfmac_f32_16x16x64_bf16 v[0:3], v[20:23], a[0:7], v48
 ds_read_b128 v[16:19], v59 offset:2048
 v_smfmac_f32_16x16x64_bf16 v[4:7], v[20:23], a[8:15], v48
 s_waitcnt lgkmcnt(4)
 v_smfmac_f32_16x16x64_bf16 v[8:11], v[20:23], v[24:31], v48
 ds_read_b128 v[24:27], v50 offset:32768
 ds_read_b128 v[28:31], v50 offset:33792
 buffer_store_dwordx2 v[44:45], v62, s[4:7], s76 offen sc1
 s_waitcnt lgkmcnt(5)
 v_smfmac_f32_16x16x64_bf16 v[0:3], v[12:15], a[16:23], v48
 ds_read_b128 v[20:23], v59 offset:2560
 v_smfmac_f32_16x16x64_bf16 v[4:7], v[12:15], a[24:31], v48
 s_waitcnt lgkmcnt(4)
 v_smfmac_f32_16x16x64_bf16 v[8:11], v[12:15], v[32:39], v48
 ds_read_b128 v[32:35], v50 offset:34816
 ds_read_b128 v[36:39], v50 offset:35840
 v_lshlrev_b32 v46, 3, v57
 s_mov_b64 exec, s[86:87]
 buffer_load_dword v63, v46, s[4:7], s13 offen sc1
 s_mov_b64 exec, -1
 s_waitcnt lgkmcnt(5)
 v_smfmac_f32_16x16x64_bf16 v[0:3], v[16:19], a[32:39], v48
 ds_read_b128 v[12:15], v59 offset:3072
 v_smfmac_f32_16x16x64_bf16 v[4:7], v[16:19], a[40:47], v48
 s_waitcnt lgkmcnt(4)
 v_smfmac_f32_16x16x64_bf16 v[8:11], v[16:19], v[24:31], v48
 ds_read_b128 v[24:27], v50 offset:49152
 ds_read_b128 v[28:31], v50 offset:50176
 s_waitcnt lgkmcnt(5)
 v_smfmac_f32_16x16x64_bf16 v[0:3], v[20:23], a[48:55], v48
 ds_read_b128 v[16:19], v59 offset:3584
 v_smfmac_f32_16x16x64_bf16 v[4:7], v[20:23], a[56:63], v48
 s_waitcnt lgkmcnt(4)
 v_smfmac_f32_16x16x64_bf16 v[8:11], v[20:23], v[32:39], v48
 ds_read_b128 v[32:35], v50 offset:51200
 ds_read_b128 v[36:39], v50 offset:52224
 s_waitcnt lgkmcnt(5)
 v_smfmac_f32_16x16x64_bf16 v[0:3], v[12:15], a[64:71], v48
 ds_read_b128 v[20:23], v59 offset:4096
 v_smfmac_f32_16x16x64_bf16 v[4:7], v[12:15], a[72:79], v48
 s_waitcnt lgkmcnt(4)
 v_smfmac_f32_16x16x64_bf16 v[8:11], v[12:15], v[24:31], v48
 v_add_u32 v50, 0x10000, v50
 ds_read_b128 v[24:27], v50 offset:0
 ds_read_b128 v[28:31], v50 offset:1024
 s_waitcnt lgkmcnt(5)
 v_smfmac_f32_16x16x64_bf16 v[0:3], v[16:19], a[80:87], v48
 ds_read_b128 v[12:15], v59 offset:4608
 v_smfmac_f32_16x16x64_bf16 v[4:7], v[16:19], a[88:95], v48
 s_waitcnt lgkmcnt(4)
 v_smfmac_f32_16x16x64_bf16 v[8:11], v[16:19], v[32:39], v48
 ds_read_b128 v[32:35], v50 offset:2048
 ds_read_b128 v[36:39], v50 offset:3072
 s_waitcnt lgkmcnt(5)
 v_smfmac_f32_16x16x64_bf16 v[0:3], v[20:23], a[96:103], v48
 ds_read_b128 v[16:19], v59 offset:5120
 v_smfmac_f32_16x16x64_bf16 v[4:7], v[20:23], a[104:111], v48
 s_waitcnt lgkmcnt(4)
 v_smfmac_f32_16x16x64_bf16 v[8:11], v[20:23], v[24:31], v48
 ds_read_b128 v[24:27], v50 offset:16384
 ds_read_b128 v[28:31], v50 offset:17408
 s_waitcnt lgkmcnt(5)
 v_smfmac_f32_16x16x64_bf16 v[0:3], v[12:15], a[112:119], v48
 ds_read_b128 v[20:23], v59 offset:5632
 v_smfmac_f32_16x16x64_bf16 v[4:7], v[12:15], a[120:127], v48
 s_waitcnt lgkmcnt(4)
 v_smfmac_f32_16x16x64_bf16 v[8:11], v[12:15], v[32:39], v48
 ds_read_b128 v[32:35], v50 offset:18432
 ds_read_b128 v[36:39], v50 offset:19456
 s_waitcnt lgkmcnt(5)
 v_smfmac_f32_16x16x64_bf16 v[0:3], v[16:19], a[128:135], v48
 ds_read_b128 v[12:15], v59 offset:6144
 v_smfmac_f32_16x16x64_bf16 v[4:7], v[16:19], a[136:143], v48
 s_waitcnt lgkmcnt(4)
 v_smfmac_f32_16x16x64_bf16 v[8:11], v[16:19], v[24:31], v48
 ds_read_b128 v[24:27], v50 offset:32768
 ds_read_b128 v[28:31], v50 offset:33792
 s_waitcnt lgkmcnt(5)
 v_smfmac_f32_16x16x64_bf16 v[0:3], v[20:23], a[144:151], v48
 ds_read_b128 v[16:19], v59 offset:6656
 v_smfmac_f32_16x16x64_bf16 v[4:7], v[20:23], a[152:159], v48
 s_waitcnt lgkmcnt(4)
 v_smfmac_f32_16x16x64_bf16 v[8:11], v[20:23], v[32:39], v48
 ds_read_b128 v[32:35], v50 offset:34816
 ds_read_b128 v[36:39], v50 offset:35840
 s_waitcnt lgkmcnt(5)
 v_smfmac_f32_16x16x64_bf16 v[0:3], v[12:15], a[160:167], v48
 ds_read_b128 v[20:23], v59 offset:7168
 v_smfmac_f32_16x16x64_bf16 v[4:7], v[12:15], a[168:175], v48
 s_waitcnt lgkmcnt(4)
 v_smfmac_f32_16x16x64_bf16 v[8:11], v[12:15], v[24:31], v48
 ds_read_b128 v[24:27], v50 offset:49152
 ds_read_b128 v[28:31], v50 offset:50176
 s_waitcnt lgkmcnt(5)
 v_smfmac_f32_16x16x64_bf16 v[0:3], v[16:19], a[176:183], v48
 ds_read_b128 v[12:15], v59 offset:7680
 v_smfmac_f32_16x16x64_bf16 v[4:7], v[16:19], a[184:191], v48
 s_waitcnt lgkmcnt(4)
 v_smfmac_f32_16x16x64_bf16 v[8:11], v[16:19], v[32:39], v48
 ds_read_b128 v[32:35], v50 offset:51200
 ds_read_b128 v[36:39], v50 offset:52224
 v_subrev_u32 v50, 0x10000, v50
 s_waitcnt lgkmcnt(5)
 v_smfmac_f32_16x16x64_bf16 v[0:3], v[20:23], a[192:199], v48
 ds_read_b128 v[16:19], v59 offset:8192
 v_smfmac_f32_16x16x64_bf16 v[4:7], v[20:23], a[200:207], v48
 s_waitcnt lgkmcnt(4)
 v_smfmac_f32_16x16x64_bf16 v[8:11], v[20:23], v[24:31], v48
 s_waitcnt lgkmcnt(3)
 v_smfmac_f32_16x16x64_bf16 v[0:3], v[12:15], a[208:215], v48
 ds_read_b128 v[20:23], v59 offset:8704
 v_smfmac_f32_16x16x64_bf16 v[4:7], v[12:15], a[216:223], v48
 s_waitcnt lgkmcnt(1)
 v_smfmac_f32_16x16x64_bf16 v[0:3], v[16:19], a[224:231], v48
 v_smfmac_f32_16x16x64_bf16 v[4:7], v[16:19], a[232:239], v48
 s_waitcnt lgkmcnt(0)
 v_smfmac_f32_16x16x64_bf16 v[0:3], v[20:23], a[240:247], v48
 v_smfmac_f32_16x16x64_bf16 v[4:7], v[20:23], a[248:255], v48
 s_waitcnt lgkmcnt(2)
 v_smfmac_f32_16x16x64_bf16 v[8:11], v[12:15], v[32:39], v48
 v_cvt_pk_bf16_f32 v0, v0, v1
 v_cvt_pk_bf16_f32 v1, v2, v3
 ds_write_b64 v51, v[0:1]
 ds_read_b128 v[32:35], v49 offset:9216
 ds_read_b128 v[36:39], v49 offset:13312
 v_smfmac_f32_16x16x64_bf16 v[8:11], v[16:19], v[208:215], v48
 v_cvt_pk_bf16_f32 v4, v4, v5
 v_cvt_pk_bf16_f32 v5, v6, v7
 ds_write_b64 v51, v[4:5] offset:256
 v_smfmac_f32_16x16x64_bf16 v[8:11], v[20:23], v[216:223], v48
 ds_read_b128 v[16:19], v49 offset:10240
 ds_read_b128 v[20:23], v49 offset:14336
 s_waitcnt lgkmcnt(2)
 s_barrier
 s_nop 7
 v_cvt_pk_bf16_f32 v8, v8, v9
 v_cvt_pk_bf16_f32 v9, v10, v11
 s_lshl_b32 s60, s44, 9
 v_add_u32 v46, s60, v52
 ds_read_b64_tr_b16 v[40:41], v46 offset:2048
 ds_read_b64_tr_b16 v[42:43], v46 offset:2176
 s_waitcnt lgkmcnt(0)
 buffer_store_dwordx4 v[40:43], v62, s[4:7], s79 offen sc1
 s_add_u32 s60, s79, 4096
 buffer_store_dwordx2 v[8:9], v62, s[4:7], s60 offen sc1
 s_waitcnt vmcnt(0)
 s_barrier
 s_cmp_eq_u32 s44, 3
 s_cbranch_scc0 L125
 s_add_u32 s61, s47, 1
 s_lshl_b32 s60, s46, 6
 s_add_u32 s60, s60, 73404416
 v_mov_b32 v11, s61
 s_mov_b64 exec, 1
 buffer_store_dword v11, v57, s[4:7], s60 offen sc1
 s_mov_b64 exec, -1
L125:
 s_waitcnt vmcnt(0)
 s_endpgm
L_OVF:
 v_mov_b32 v2, 0
 v_mov_b32 v3, 1
 s_mov_b64 exec, 1
 buffer_store_dword v3, v2, s[8:11], 0 offen offset:96 sc1
 s_mov_b64 exec, -1
L_FALLBACK:
 s_waitcnt vmcnt(0) lgkmcnt(0)
 s_mov_b64 exec, -1
 s_barrier
 s_load_dwordx16 s[16:31], s[0:1], 0
 s_load_dwordx8 s[32:39], s[0:1], 64
 s_load_dwordx4 s[40:43], s[0:1], 96
 v_mbcnt_lo_u32_b32 v0, -1, 0
 v_mbcnt_hi_u32_b32 v0, -1, v0
 s_lshl_b32 s60, s44, 6
 v_add_u32 v0, s60, v0
 s_waitcnt lgkmcnt(0)
 s_add_u32 s4, s42, 0x8000000
 s_addc_u32 s5, s43, 0
 s_mov_b32 s6, 0x8000000
 s_mov_b32 s7, 0x20000
 s_mov_b32 s8, s40
 s_mov_b32 s9, s41
 s_mov_b32 s10, 256
 s_mov_b32 s11, 0x20000
 s_cmp_eq_u32 s44, 0
 s_cbranch_scc0 L_FB_TK
 v_mov_b32 v2, 0
 v_mov_b32 v3, 1
 s_mov_b64 exec, 1
 buffer_atomic_add v3, v2, s[8:11], 0 offen offset:108 sc0 sc1
 s_waitcnt vmcnt(0)
 ds_write_b32 v2, v3
 s_waitcnt lgkmcnt(0)
 s_mov_b64 exec, -1
L_FB_TK:
 s_barrier
 v_mov_b32 v2, 0
 ds_read_b32 v3, v2
 s_waitcnt lgkmcnt(0)
 v_readfirstlane_b32 s60, v3
 s_barrier
 s_cmp_ge_u32 s60, 256
 s_cbranch_scc1 L_EXIT
 s_lshr_b32 s45, s60, 5
 s_and_b32 s46, s60, 31
 s_cmp_eq_u32 s45, 0
 s_cbranch_scc1 S_CHAIN
 s_cmp_lt_u32 s45, 2
 s_cbranch_scc1 S_T1
 s_cmp_lt_u32 s45, 5
 s_cbranch_scc1 S_T2
 s_sub_u32 s47, s45, 5
 v_and_b32 v68, 63, v0
 v_lshlrev_b32 v69, 4, v68
 s_lshl_b32 s72, s47, 8
 s_add_u32 s72, s72, 73437184
 s_lshl_b32 s71, s46, 2
 s_add_u32 s71, s71, s72
 s_mov_b32 s61, 0
 v_mov_b32 v6, 0
 v_mov_b32 v7, s61
 s_mov_b64 exec, 1
 buffer_store_dword v7, v6, s[4:7], s71 offen sc1
 s_mov_b64 exec, -1
 s_add_u32 s60, s71, 128
 s_mov_b32 s61, 0
 v_mov_b32 v6, 0
 v_mov_b32 v7, s61
 s_mov_b64 exec, 1
 buffer_store_dword v7, v6, s[4:7], s60 offen sc1
 s_mov_b64 exec, -1
 s_waitcnt vmcnt(0)
 s_barrier
 v_mov_b32 v6, 0
 s_cmp_eq_u32 s44, 0
 s_cbranch_scc0 L126
 v_mov_b32 v6, 0
 v_mov_b32 v7, 1
 s_mov_b64 exec, 1
 buffer_atomic_add v7, v6, s[8:11], 0 offen offset:112 sc1
 s_mov_b64 exec, -1
 s_waitcnt vmcnt(0)
L126:
 s_mov_b32 s12, s32
 s_mov_b32 s13, s33
 s_mov_b32 s14, 5308416
 s_mov_b32 s15, 0x20000
 s_mov_b32 s48, s34
 s_mov_b32 s49, s35
 s_mov_b32 s50, 5308416
 s_mov_b32 s51, 0x20000
 s_mov_b32 s52, s36
 s_mov_b32 s53, s37
 s_mov_b32 s54, 5308416
 s_mov_b32 s55, 0x20000
 s_mov_b32 s56, s38
 s_mov_b32 s57, s39
 s_mov_b32 s58, 2359296
 s_mov_b32 s59, 0x20000
 s_mul_i32 s67, s44, 5
 s_cmp_eq_u32 s44, 3
 s_cselect_b32 s67, 14, s67
 s_lshl_b32 s68, s44, 2
 s_cmp_eq_u32 s44, 3
 s_cselect_b32 s68, 13, s68
 s_cmp_lt_u32 s44, 2
 s_cselect_b32 s69, 1, 0
 s_mul_i32 s66, s44, 13824
 v_mul_u32_u24 v6, 13108, v68
 v_lshrrev_b32 v6, 16, v6
 v_mul_u32_u24 v8, 5, v6
 v_sub_u32 v8, v68, v8
 v_mul_u32_u24 v6, 9216, v6
 v_lshlrev_b32 v8, 4, v8
 v_add_u32 v6, v6, v8
 s_mul_i32 s60, s46, 288
 s_lshl_b32 s61, s67, 4
 s_add_u32 s60, s60, s61
 v_add_u32 v0, s60, v6
 v_mul_u32_u24 v6, 3277, v68
 v_lshrrev_b32 v6, 16, v6
 v_mul_u32_u24 v8, 20, v6
 v_sub_u32 v8, v68, v8
 v_mul_u32_u24 v6, 1152, v6
 v_lshlrev_b32 v8, 4, v8
 v_add_u32 v6, v6, v8
 s_mul_i32 s60, s46, 165888
 s_lshl_b32 s61, s68, 6
 s_add_u32 s60, s60, s61
 v_add_u32 v2, s60, v6
 v_lshrrev_b32 v6, 4, v68
 v_lshlrev_b32 v6, 3, v6
 v_bfe_u32 v8, v68, 2, 2
 v_add_u32 v6, v6, v8
 v_mul_u32_u24 v6, 80, v6
 v_and_b32 v8, 1, v68
 v_mul_u32_u24 v8, 3840, v8
 v_add_u32 v6, v6, v8
 v_bfe_u32 v8, v68, 1, 1
 v_lshlrev_b32 v8, 3, v8
 v_add_u32 v6, v6, v8
 v_add_u32 v3, s66, v6
 v_lshrrev_b32 v6, 5, v68
 v_lshlrev_b32 v6, 3, v6
 v_bfe_u32 v8, v68, 2, 2
 v_add_u32 v6, v6, v8
 v_mul_u32_u24 v6, 320, v6
 v_bfe_u32 v8, v68, 4, 1
 v_lshlrev_b32 v8, 5, v8
 v_add_u32 v6, v6, v8
 v_and_b32 v8, 3, v68
 v_lshlrev_b32 v8, 3, v8
 v_add_u32 v6, v6, v8
 v_add_u32 v4, s66, v6
 s_and_b32 s60, s44, 1
 s_mul_i32 s61, s60, 18432
 s_add_u32 s61, s61, 55296
 s_mul_i32 s62, s60, 9216
 s_add_u32 s62, s62, 92160
 s_cmp_eq_u32 s69, 1
 s_cselect_b32 s61, s61, s62
 v_add_u32 v75, s61, v69
 s_mov_b32 exec_lo, -1
 s_mov_b32 exec_hi, 0x0fffffff
 s_add_u32 m0, s66, 0
 s_mov_b32 s60, 0
 buffer_load_dwordx4 v0, s[12:15], s60 offen lds
 s_add_u32 m0, s66, 960
 s_mov_b32 s60, 110592
 buffer_load_dwordx4 v0, s[12:15], s60 offen lds
 s_add_u32 m0, s66, 1920
 s_mov_b32 s60, 221184
 buffer_load_dwordx4 v0, s[12:15], s60 offen lds
 s_add_u32 m0, s66, 3840
 s_mov_b32 s60, 0
 buffer_load_dwordx4 v0, s[48:51], s60 offen lds
 s_add_u32 m0, s66, 4800
 s_mov_b32 s60, 110592
 buffer_load_dwordx4 v0, s[48:51], s60 offen lds
 s_add_u32 m0, s66, 5760
 s_mov_b32 s60, 221184
 buffer_load_dwordx4 v0, s[48:51], s60 offen lds
 s_mov_b64 exec, -1
 s_mov_b32 exec_lo, -1
 s_mov_b32 exec_hi, 0x0fffffff
 s_add_u32 m0, s66, 6720
 s_mov_b32 s60, 294912
 buffer_load_dwordx4 v0, s[12:15], s60 offen lds
 s_add_u32 m0, s66, 7680
 s_mov_b32 s60, 405504
 buffer_load_dwordx4 v0, s[12:15], s60 offen lds
 s_add_u32 m0, s66, 8640
 s_mov_b32 s60, 516096
 buffer_load_dwordx4 v0, s[12:15], s60 offen lds
 s_add_u32 m0, s66, 10560
 s_mov_b32 s60, 294912
 buffer_load_dwordx4 v0, s[48:51], s60 offen lds
 s_add_u32 m0, s66, 11520
 s_mov_b32 s60, 405504
 buffer_load_dwordx4 v0, s[48:51], s60 offen lds
 s_add_u32 m0, s66, 12480
 s_mov_b32 s60, 516096
 buffer_load_dwordx4 v0, s[48:51], s60 offen lds
 s_mov_b64 exec, -1
 s_waitcnt vmcnt(6)
 ds_read_b64_tr_b16 v[80:81], v3 offset:0
 ds_read_b64_tr_b16 v[82:83], v3 offset:320
 ds_read_b64_tr_b16 v[152:153], v3 offset:16
 ds_read_b64_tr_b16 v[154:155], v3 offset:336
 ds_read_b64_tr_b16 v[224:225], v3 offset:32
 ds_read_b64_tr_b16 v[226:227], v3 offset:352
 ds_read_b64_tr_b16 a[40:41], v3 offset:48
 ds_read_b64_tr_b16 a[42:43], v3 offset:368
 ds_read_b64_tr_b16 v[16:17], v3 offset:64
 ds_read_b64_tr_b16 v[18:19], v3 offset:384
 s_cmp_eq_u32 s69, 1
 s_cbranch_scc0 L127
 s_waitcnt lgkmcnt(0)
 ds_write_b128 v75, v[16:19] offset:0
L127:
 s_waitcnt lgkmcnt(0)
 s_mov_b32 exec_lo, -1
 s_mov_b32 exec_hi, 0x0fffffff
 s_add_u32 m0, s66, 0
 s_mov_b32 s60, 589824
 buffer_load_dwordx4 v0, s[12:15], s60 offen lds
 s_add_u32 m0, s66, 960
 s_mov_b32 s60, 700416
 buffer_load_dwordx4 v0, s[12:15], s60 offen lds
 s_add_u32 m0, s66, 1920
 s_mov_b32 s60, 811008
 buffer_load_dwordx4 v0, s[12:15], s60 offen lds
 s_add_u32 m0, s66, 3840
 s_mov_b32 s60, 589824
 buffer_load_dwordx4 v0, s[48:51], s60 offen lds
 s_add_u32 m0, s66, 4800
 s_mov_b32 s60, 700416
 buffer_load_dwordx4 v0, s[48:51], s60 offen lds
 s_add_u32 m0, s66, 5760
 s_mov_b32 s60, 811008
 buffer_load_dwordx4 v0, s[48:51], s60 offen lds
 s_mov_b64 exec, -1
 s_waitcnt vmcnt(6)
 ds_read_b64_tr_b16 v[84:85], v3 offset:6720
 ds_read_b64_tr_b16 v[86:87], v3 offset:7040
 ds_read_b64_tr_b16 v[156:157], v3 offset:6736
 ds_read_b64_tr_b16 v[158:159], v3 offset:7056
 ds_read_b64_tr_b16 v[228:229], v3 offset:6752
 ds_read_b64_tr_b16 v[230:231], v3 offset:7072
 ds_read_b64_tr_b16 a[44:45], v3 offset:6768
 ds_read_b64_tr_b16 a[46:47], v3 offset:7088
 ds_read_b64_tr_b16 v[16:17], v3 offset:6784
 ds_read_b64_tr_b16 v[18:19], v3 offset:7104
 s_cmp_eq_u32 s69, 1
 s_cbranch_scc0 L128
 s_waitcnt lgkmcnt(0)
 ds_write_b128 v75, v[16:19] offset:1024
L128:
 s_waitcnt lgkmcnt(0)
 s_mov_b32 exec_lo, -1
 s_mov_b32 exec_hi, 0x0fffffff
 s_add_u32 m0, s66, 6720
 s_mov_b32 s60, 884736
 buffer_load_dwordx4 v0, s[12:15], s60 offen lds
 s_add_u32 m0, s66, 7680
 s_mov_b32 s60, 995328
 buffer_load_dwordx4 v0, s[12:15], s60 offen lds
 s_add_u32 m0, s66, 8640
 s_mov_b32 s60, 1105920
 buffer_load_dwordx4 v0, s[12:15], s60 offen lds
 s_add_u32 m0, s66, 10560
 s_mov_b32 s60, 884736
 buffer_load_dwordx4 v0, s[48:51], s60 offen lds
 s_add_u32 m0, s66, 11520
 s_mov_b32 s60, 995328
 buffer_load_dwordx4 v0, s[48:51], s60 offen lds
 s_add_u32 m0, s66, 12480
 s_mov_b32 s60, 1105920
 buffer_load_dwordx4 v0, s[48:51], s60 offen lds
 s_mov_b64 exec, -1
 s_waitcnt vmcnt(6)
 ds_read_b64_tr_b16 v[88:89], v3 offset:0
 ds_read_b64_tr_b16 v[90:91], v3 offset:320
 ds_read_b64_tr_b16 v[160:161], v3 offset:16
 ds_read_b64_tr_b16 v[162:163], v3 offset:336
 ds_read_b64_tr_b16 v[232:233], v3 offset:32
 ds_read_b64_tr_b16 v[234:235], v3 offset:352
 ds_read_b64_tr_b16 a[48:49], v3 offset:48
 ds_read_b64_tr_b16 a[50:51], v3 offset:368
 ds_read_b64_tr_b16 v[16:17], v3 offset:64
 ds_read_b64_tr_b16 v[18:19], v3 offset:384
 s_cmp_eq_u32 s69, 1
 s_cbranch_scc0 L129
 s_waitcnt lgkmcnt(0)
 ds_write_b128 v75, v[16:19] offset:2048
L129:
 s_waitcnt lgkmcnt(0)
 s_mov_b32 exec_lo, -1
 s_mov_b32 exec_hi, 0x0fffffff
 s_add_u32 m0, s66, 0
 s_mov_b32 s60, 1179648
 buffer_load_dwordx4 v0, s[12:15], s60 offen lds
 s_add_u32 m0, s66, 960
 s_mov_b32 s60, 1290240
 buffer_load_dwordx4 v0, s[12:15], s60 offen lds
 s_add_u32 m0, s66, 1920
 s_mov_b32 s60, 1400832
 buffer_load_dwordx4 v0, s[12:15], s60 offen lds
 s_add_u32 m0, s66, 3840
 s_mov_b32 s60, 1179648
 buffer_load_dwordx4 v0, s[48:51], s60 offen lds
 s_add_u32 m0, s66, 4800
 s_mov_b32 s60, 1290240
 buffer_load_dwordx4 v0, s[48:51], s60 offen lds
 s_add_u32 m0, s66, 5760
 s_mov_b32 s60, 1400832
 buffer_load_dwordx4 v0, s[48:51], s60 offen lds
 s_mov_b64 exec, -1
 s_waitcnt vmcnt(6)
 ds_read_b64_tr_b16 v[92:93], v3 offset:6720
 ds_read_b64_tr_b16 v[94:95], v3 offset:7040
 ds_read_b64_tr_b16 v[164:165], v3 offset:6736
 ds_read_b64_tr_b16 v[166:167], v3 offset:7056
 ds_read_b64_tr_b16 v[236:237], v3 offset:6752
 ds_read_b64_tr_b16 v[238:239], v3 offset:7072
 ds_read_b64_tr_b16 a[52:53], v3 offset:6768
 ds_read_b64_tr_b16 a[54:55], v3 offset:7088
 ds_read_b64_tr_b16 v[16:17], v3 offset:6784
 ds_read_b64_tr_b16 v[18:19], v3 offset:7104
 s_cmp_eq_u32 s69, 1
 s_cbranch_scc0 L130
 s_waitcnt lgkmcnt(0)
 ds_write_b128 v75, v[16:19] offset:3072
L130:
 s_waitcnt lgkmcnt(0)
 s_mov_b32 exec_lo, -1
 s_mov_b32 exec_hi, 0x0fffffff
 s_add_u32 m0, s66, 6720
 s_mov_b32 s60, 1474560
 buffer_load_dwordx4 v0, s[12:15], s60 offen lds
 s_add_u32 m0, s66, 7680
 s_mov_b32 s60, 1585152
 buffer_load_dwordx4 v0, s[12:15], s60 offen lds
 s_add_u32 m0, s66, 8640
 s_mov_b32 s60, 1695744
 buffer_load_dwordx4 v0, s[12:15], s60 offen lds
 s_add_u32 m0, s66, 10560
 s_mov_b32 s60, 1474560
 buffer_load_dwordx4 v0, s[48:51], s60 offen lds
 s_add_u32 m0, s66, 11520
 s_mov_b32 s60, 1585152
 buffer_load_dwordx4 v0, s[48:51], s60 offen lds
 s_add_u32 m0, s66, 12480
 s_mov_b32 s60, 1695744
 buffer_load_dwordx4 v0, s[48:51], s60 offen lds
 s_mov_b64 exec, -1
 s_waitcnt vmcnt(6)
 ds_read_b64_tr_b16 v[96:97], v3 offset:0
 ds_read_b64_tr_b16 v[98:99], v3 offset:320
 ds_read_b64_tr_b16 v[168:169], v3 offset:16
 ds_read_b64_tr_b16 v[170:171], v3 offset:336
 ds_read_b64_tr_b16 v[240:241], v3 offset:32
 ds_read_b64_tr_b16 v[242:243], v3 offset:352
 ds_read_b64_tr_b16 a[56:57], v3 offset:48
 ds_read_b64_tr_b16 a[58:59], v3 offset:368
 ds_read_b64_tr_b16 v[16:17], v3 offset:64
 ds_read_b64_tr_b16 v[18:19], v3 offset:384
 s_cmp_eq_u32 s69, 1
 s_cbranch_scc0 L131
 s_waitcnt lgkmcnt(0)
 ds_write_b128 v75, v[16:19] offset:4096
L131:
 s_waitcnt lgkmcnt(0)
 s_mov_b32 exec_lo, -1
 s_mov_b32 exec_hi, 0x0fffffff
 s_add_u32 m0, s66, 0
 s_mov_b32 s60, 1769472
 buffer_load_dwordx4 v0, s[12:15], s60 offen lds
 s_add_u32 m0, s66, 960
 s_mov_b32 s60, 1880064
 buffer_load_dwordx4 v0, s[12:15], s60 offen lds
 s_add_u32 m0, s66, 1920
 s_mov_b32 s60, 1990656
 buffer_load_dwordx4 v0, s[12:15], s60 offen lds
 s_add_u32 m0, s66, 3840
 s_mov_b32 s60, 1769472
 buffer_load_dwordx4 v0, s[48:51], s60 offen lds
 s_add_u32 m0, s66, 4800
 s_mov_b32 s60, 1880064
 buffer_load_dwordx4 v0, s[48:51], s60 offen lds
 s_add_u32 m0, s66, 5760
 s_mov_b32 s60, 1990656
 buffer_load_dwordx4 v0, s[48:51], s60 offen lds
 s_mov_b64 exec, -1
 s_waitcnt vmcnt(6)
 ds_read_b64_tr_b16 v[100:101], v3 offset:6720
 ds_read_b64_tr_b16 v[102:103], v3 offset:7040
 ds_read_b64_tr_b16 v[172:173], v3 offset:6736
 ds_read_b64_tr_b16 v[174:175], v3 offset:7056
 ds_read_b64_tr_b16 v[244:245], v3 offset:6752
 ds_read_b64_tr_b16 v[246:247], v3 offset:7072
 ds_read_b64_tr_b16 a[60:61], v3 offset:6768
 ds_read_b64_tr_b16 a[62:63], v3 offset:7088
 ds_read_b64_tr_b16 v[16:17], v3 offset:6784
 ds_read_b64_tr_b16 v[18:19], v3 offset:7104
 s_cmp_eq_u32 s69, 1
 s_cbranch_scc0 L132
 s_waitcnt lgkmcnt(0)
 ds_write_b128 v75, v[16:19] offset:5120
L132:
 s_waitcnt lgkmcnt(0)
 s_mov_b32 exec_lo, -1
 s_mov_b32 exec_hi, 0x0fffffff
 s_add_u32 m0, s66, 6720
 s_mov_b32 s60, 2064384
 buffer_load_dwordx4 v0, s[12:15], s60 offen lds
 s_add_u32 m0, s66, 7680
 s_mov_b32 s60, 2174976
 buffer_load_dwordx4 v0, s[12:15], s60 offen lds
 s_add_u32 m0, s66, 8640
 s_mov_b32 s60, 2285568
 buffer_load_dwordx4 v0, s[12:15], s60 offen lds
 s_add_u32 m0, s66, 10560
 s_mov_b32 s60, 2064384
 buffer_load_dwordx4 v0, s[48:51], s60 offen lds
 s_add_u32 m0, s66, 11520
 s_mov_b32 s60, 2174976
 buffer_load_dwordx4 v0, s[48:51], s60 offen lds
 s_add_u32 m0, s66, 12480
 s_mov_b32 s60, 2285568
 buffer_load_dwordx4 v0, s[48:51], s60 offen lds
 s_mov_b64 exec, -1
 s_waitcnt vmcnt(6)
 ds_read_b64_tr_b16 v[104:105], v3 offset:0
 ds_read_b64_tr_b16 v[106:107], v3 offset:320
 ds_read_b64_tr_b16 v[176:177], v3 offset:16
 ds_read_b64_tr_b16 v[178:179], v3 offset:336
 ds_read_b64_tr_b16 v[248:249], v3 offset:32
 ds_read_b64_tr_b16 v[250:251], v3 offset:352
 ds_read_b64_tr_b16 a[64:65], v3 offset:48
 ds_read_b64_tr_b16 a[66:67], v3 offset:368
 ds_read_b64_tr_b16 v[16:17], v3 offset:64
 ds_read_b64_tr_b16 v[18:19], v3 offset:384
 s_cmp_eq_u32 s69, 1
 s_cbranch_scc0 L133
 s_waitcnt lgkmcnt(0)
 ds_write_b128 v75, v[16:19] offset:6144
L133:
 s_waitcnt lgkmcnt(0)
 s_mov_b32 exec_lo, -1
 s_mov_b32 exec_hi, 0x0fffffff
 s_add_u32 m0, s66, 0
 s_mov_b32 s60, 2359296
 buffer_load_dwordx4 v0, s[12:15], s60 offen lds
 s_add_u32 m0, s66, 960
 s_mov_b32 s60, 2469888
 buffer_load_dwordx4 v0, s[12:15], s60 offen lds
 s_add_u32 m0, s66, 1920
 s_mov_b32 s60, 2580480
 buffer_load_dwordx4 v0, s[12:15], s60 offen lds
 s_add_u32 m0, s66, 3840
 s_mov_b32 s60, 2359296
 buffer_load_dwordx4 v0, s[48:51], s60 offen lds
 s_add_u32 m0, s66, 4800
 s_mov_b32 s60, 2469888
 buffer_load_dwordx4 v0, s[48:51], s60 offen lds
 s_add_u32 m0, s66, 5760
 s_mov_b32 s60, 2580480
 buffer_load_dwordx4 v0, s[48:51], s60 offen lds
 s_mov_b64 exec, -1
 s_waitcnt vmcnt(6)
 ds_read_b64_tr_b16 v[108:109], v3 offset:6720
 ds_read_b64_tr_b16 v[110:111], v3 offset:7040
 ds_read_b64_tr_b16 v[180:181], v3 offset:6736
 ds_read_b64_tr_b16 v[182:183], v3 offset:7056
 ds_read_b64_tr_b16 v[252:253], v3 offset:6752
 ds_read_b64_tr_b16 v[254:255], v3 offset:7072
 ds_read_b64_tr_b16 a[68:69], v3 offset:6768
 ds_read_b64_tr_b16 a[70:71], v3 offset:7088
 ds_read_b64_tr_b16 v[16:17], v3 offset:6784
 ds_read_b64_tr_b16 v[18:19], v3 offset:7104
 s_cmp_eq_u32 s69, 1
 s_cbranch_scc0 L134
 s_waitcnt lgkmcnt(0)
 ds_write_b128 v75, v[16:19] offset:7168
L134:
 s_waitcnt lgkmcnt(0)
 s_mov_b32 exec_lo, -1
 s_mov_b32 exec_hi, 0x0fffffff
 s_add_u32 m0, s66, 6720
 s_mov_b32 s60, 2654208
 buffer_load_dwordx4 v0, s[12:15], s60 offen lds
 s_add_u32 m0, s66, 7680
 s_mov_b32 s60, 2764800
 buffer_load_dwordx4 v0, s[12:15], s60 offen lds
 s_add_u32 m0, s66, 8640
 s_mov_b32 s60, 2875392
 buffer_load_dwordx4 v0, s[12:15], s60 offen lds
 s_add_u32 m0, s66, 10560
 s_mov_b32 s60, 2654208
 buffer_load_dwordx4 v0, s[48:51], s60 offen lds
 s_add_u32 m0, s66, 11520
 s_mov_b32 s60, 2764800
 buffer_load_dwordx4 v0, s[48:51], s60 offen lds
 s_add_u32 m0, s66, 12480
 s_mov_b32 s60, 2875392
 buffer_load_dwordx4 v0, s[48:51], s60 offen lds
 s_mov_b64 exec, -1
 s_waitcnt vmcnt(6)
 ds_read_b64_tr_b16 v[112:113], v3 offset:0
 ds_read_b64_tr_b16 v[114:115], v3 offset:320
 ds_read_b64_tr_b16 v[184:185], v3 offset:16
 ds_read_b64_tr_b16 v[186:187], v3 offset:336
 ds_read_b64_tr_b16 a[0:1], v3 offset:32
 ds_read_b64_tr_b16 a[2:3], v3 offset:352
 ds_read_b64_tr_b16 a[72:73], v3 offset:48
 ds_read_b64_tr_b16 a[74:75], v3 offset:368
 ds_read_b64_tr_b16 v[16:17], v3 offset:64
 ds_read_b64_tr_b16 v[18:19], v3 offset:384
 s_cmp_eq_u32 s69, 1
 s_cbranch_scc0 L135
 s_waitcnt lgkmcnt(0)
 ds_write_b128 v75, v[16:19] offset:8192
L135:
 s_waitcnt lgkmcnt(0)
 s_mov_b32 exec_lo, -1
 s_mov_b32 exec_hi, 0x0fffffff
 s_add_u32 m0, s66, 0
 s_mov_b32 s60, 2949120
 buffer_load_dwordx4 v0, s[12:15], s60 offen lds
 s_add_u32 m0, s66, 960
 s_mov_b32 s60, 3059712
 buffer_load_dwordx4 v0, s[12:15], s60 offen lds
 s_add_u32 m0, s66, 1920
 s_mov_b32 s60, 3170304
 buffer_load_dwordx4 v0, s[12:15], s60 offen lds
 s_add_u32 m0, s66, 3840
 s_mov_b32 s60, 2949120
 buffer_load_dwordx4 v0, s[48:51], s60 offen lds
 s_add_u32 m0, s66, 4800
 s_mov_b32 s60, 3059712
 buffer_load_dwordx4 v0, s[48:51], s60 offen lds
 s_add_u32 m0, s66, 5760
 s_mov_b32 s60, 3170304
 buffer_load_dwordx4 v0, s[48:51], s60 offen lds
 s_mov_b64 exec, -1
 s_waitcnt vmcnt(6)
 ds_read_b64_tr_b16 v[116:117], v3 offset:6720
 ds_read_b64_tr_b16 v[118:119], v3 offset:7040
 ds_read_b64_tr_b16 v[188:189], v3 offset:6736
 ds_read_b64_tr_b16 v[190:191], v3 offset:7056
 ds_read_b64_tr_b16 a[4:5], v3 offset:6752
 ds_read_b64_tr_b16 a[6:7], v3 offset:7072
 ds_read_b64_tr_b16 a[76:77], v3 offset:6768
 ds_read_b64_tr_b16 a[78:79], v3 offset:7088
 ds_read_b64_tr_b16 v[16:17], v3 offset:6784
 ds_read_b64_tr_b16 v[18:19], v3 offset:7104
 s_cmp_eq_u32 s69, 1
 s_cbranch_scc0 L136
 s_waitcnt lgkmcnt(0)
 ds_write_b128 v75, v[16:19] offset:9216
L136:
 s_waitcnt lgkmcnt(0)
 s_mov_b32 exec_lo, -1
 s_mov_b32 exec_hi, 0x0fffffff
 s_add_u32 m0, s66, 6720
 s_mov_b32 s60, 3244032
 buffer_load_dwordx4 v0, s[12:15], s60 offen lds
 s_add_u32 m0, s66, 7680
 s_mov_b32 s60, 3354624
 buffer_load_dwordx4 v0, s[12:15], s60 offen lds
 s_add_u32 m0, s66, 8640
 s_mov_b32 s60, 3465216
 buffer_load_dwordx4 v0, s[12:15], s60 offen lds
 s_add_u32 m0, s66, 10560
 s_mov_b32 s60, 3244032
 buffer_load_dwordx4 v0, s[48:51], s60 offen lds
 s_add_u32 m0, s66, 11520
 s_mov_b32 s60, 3354624
 buffer_load_dwordx4 v0, s[48:51], s60 offen lds
 s_add_u32 m0, s66, 12480
 s_mov_b32 s60, 3465216
 buffer_load_dwordx4 v0, s[48:51], s60 offen lds
 s_mov_b64 exec, -1
 s_waitcnt vmcnt(6)
 ds_read_b64_tr_b16 v[120:121], v3 offset:0
 ds_read_b64_tr_b16 v[122:123], v3 offset:320
 ds_read_b64_tr_b16 v[192:193], v3 offset:16
 ds_read_b64_tr_b16 v[194:195], v3 offset:336
 ds_read_b64_tr_b16 a[8:9], v3 offset:32
 ds_read_b64_tr_b16 a[10:11], v3 offset:352
 ds_read_b64_tr_b16 a[80:81], v3 offset:48
 ds_read_b64_tr_b16 a[82:83], v3 offset:368
 ds_read_b64_tr_b16 v[16:17], v3 offset:64
 ds_read_b64_tr_b16 v[18:19], v3 offset:384
 s_cmp_eq_u32 s69, 1
 s_cbranch_scc0 L137
 s_waitcnt lgkmcnt(0)
 ds_write_b128 v75, v[16:19] offset:10240
L137:
 s_waitcnt lgkmcnt(0)
 s_mov_b32 exec_lo, -1
 s_mov_b32 exec_hi, 0x0fffffff
 s_add_u32 m0, s66, 0
 s_mov_b32 s60, 3538944
 buffer_load_dwordx4 v0, s[12:15], s60 offen lds
 s_add_u32 m0, s66, 960
 s_mov_b32 s60, 3649536
 buffer_load_dwordx4 v0, s[12:15], s60 offen lds
 s_add_u32 m0, s66, 1920
 s_mov_b32 s60, 3760128
 buffer_load_dwordx4 v0, s[12:15], s60 offen lds
 s_add_u32 m0, s66, 3840
 s_mov_b32 s60, 3538944
 buffer_load_dwordx4 v0, s[48:51], s60 offen lds
 s_add_u32 m0, s66, 4800
 s_mov_b32 s60, 3649536
 buffer_load_dwordx4 v0, s[48:51], s60 offen lds
 s_add_u32 m0, s66, 5760
 s_mov_b32 s60, 3760128
 buffer_load_dwordx4 v0, s[48:51], s60 offen lds
 s_mov_b64 exec, -1
 s_waitcnt vmcnt(6)
 ds_read_b64_tr_b16 v[124:125], v3 offset:6720
 ds_read_b64_tr_b16 v[126:127], v3 offset:7040
 ds_read_b64_tr_b16 v[196:197], v3 offset:6736
 ds_read_b64_tr_b16 v[198:199], v3 offset:7056
 ds_read_b64_tr_b16 a[12:13], v3 offset:6752
 ds_read_b64_tr_b16 a[14:15], v3 offset:7072
 ds_read_b64_tr_b16 a[84:85], v3 offset:6768
 ds_read_b64_tr_b16 a[86:87], v3 offset:7088
 ds_read_b64_tr_b16 v[16:17], v3 offset:6784
 ds_read_b64_tr_b16 v[18:19], v3 offset:7104
 s_cmp_eq_u32 s69, 1
 s_cbranch_scc0 L138
 s_waitcnt lgkmcnt(0)
 ds_write_b128 v75, v[16:19] offset:11264
L138:
 s_waitcnt lgkmcnt(0)
 s_mov_b32 exec_lo, -1
 s_mov_b32 exec_hi, 0x0fffffff
 s_add_u32 m0, s66, 6720
 s_mov_b32 s60, 3833856
 buffer_load_dwordx4 v0, s[12:15], s60 offen lds
 s_add_u32 m0, s66, 7680
 s_mov_b32 s60, 3944448
 buffer_load_dwordx4 v0, s[12:15], s60 offen lds
 s_add_u32 m0, s66, 8640
 s_mov_b32 s60, 4055040
 buffer_load_dwordx4 v0, s[12:15], s60 offen lds
 s_add_u32 m0, s66, 10560
 s_mov_b32 s60, 3833856
 buffer_load_dwordx4 v0, s[48:51], s60 offen lds
 s_add_u32 m0, s66, 11520
 s_mov_b32 s60, 3944448
 buffer_load_dwordx4 v0, s[48:51], s60 offen lds
 s_add_u32 m0, s66, 12480
 s_mov_b32 s60, 4055040
 buffer_load_dwordx4 v0, s[48:51], s60 offen lds
 s_mov_b64 exec, -1
 s_waitcnt vmcnt(6)
 ds_read_b64_tr_b16 v[128:129], v3 offset:0
 ds_read_b64_tr_b16 v[130:131], v3 offset:320
 ds_read_b64_tr_b16 v[200:201], v3 offset:16
 ds_read_b64_tr_b16 v[202:203], v3 offset:336
 ds_read_b64_tr_b16 a[16:17], v3 offset:32
 ds_read_b64_tr_b16 a[18:19], v3 offset:352
 ds_read_b64_tr_b16 a[88:89], v3 offset:48
 ds_read_b64_tr_b16 a[90:91], v3 offset:368
 ds_read_b64_tr_b16 v[16:17], v3 offset:64
 ds_read_b64_tr_b16 v[18:19], v3 offset:384
 s_cmp_eq_u32 s69, 1
 s_cbranch_scc0 L139
 s_waitcnt lgkmcnt(0)
 ds_write_b128 v75, v[16:19] offset:12288
L139:
 s_waitcnt lgkmcnt(0)
 s_mov_b32 exec_lo, -1
 s_mov_b32 exec_hi, 0x0fffffff
 s_add_u32 m0, s66, 0
 s_mov_b32 s60, 4128768
 buffer_load_dwordx4 v0, s[12:15], s60 offen lds
 s_add_u32 m0, s66, 960
 s_mov_b32 s60, 4239360
 buffer_load_dwordx4 v0, s[12:15], s60 offen lds
 s_add_u32 m0, s66, 1920
 s_mov_b32 s60, 4349952
 buffer_load_dwordx4 v0, s[12:15], s60 offen lds
 s_add_u32 m0, s66, 3840
 s_mov_b32 s60, 4128768
 buffer_load_dwordx4 v0, s[48:51], s60 offen lds
 s_add_u32 m0, s66, 4800
 s_mov_b32 s60, 4239360
 buffer_load_dwordx4 v0, s[48:51], s60 offen lds
 s_add_u32 m0, s66, 5760
 s_mov_b32 s60, 4349952
 buffer_load_dwordx4 v0, s[48:51], s60 offen lds
 s_mov_b64 exec, -1
 s_waitcnt vmcnt(6)
 ds_read_b64_tr_b16 v[132:133], v3 offset:6720
 ds_read_b64_tr_b16 v[134:135], v3 offset:7040
 ds_read_b64_tr_b16 v[204:205], v3 offset:6736
 ds_read_b64_tr_b16 v[206:207], v3 offset:7056
 ds_read_b64_tr_b16 a[20:21], v3 offset:6752
 ds_read_b64_tr_b16 a[22:23], v3 offset:7072
 ds_read_b64_tr_b16 a[92:93], v3 offset:6768
 ds_read_b64_tr_b16 a[94:95], v3 offset:7088
 ds_read_b64_tr_b16 v[16:17], v3 offset:6784
 ds_read_b64_tr_b16 v[18:19], v3 offset:7104
 s_cmp_eq_u32 s69, 1
 s_cbranch_scc0 L140
 s_waitcnt lgkmcnt(0)
 ds_write_b128 v75, v[16:19] offset:13312
L140:
 s_waitcnt lgkmcnt(0)
 s_mov_b32 exec_lo, -1
 s_mov_b32 exec_hi, 0x0fffffff
 s_add_u32 m0, s66, 6720
 s_mov_b32 s60, 4423680
 buffer_load_dwordx4 v0, s[12:15], s60 offen lds
 s_add_u32 m0, s66, 7680
 s_mov_b32 s60, 4534272
 buffer_load_dwordx4 v0, s[12:15], s60 offen lds
 s_add_u32 m0, s66, 8640
 s_mov_b32 s60, 4644864
 buffer_load_dwordx4 v0, s[12:15], s60 offen lds
 s_add_u32 m0, s66, 10560
 s_mov_b32 s60, 4423680
 buffer_load_dwordx4 v0, s[48:51], s60 offen lds
 s_add_u32 m0, s66, 11520
 s_mov_b32 s60, 4534272
 buffer_load_dwordx4 v0, s[48:51], s60 offen lds
 s_add_u32 m0, s66, 12480
 s_mov_b32 s60, 4644864
 buffer_load_dwordx4 v0, s[48:51], s60 offen lds
 s_mov_b64 exec, -1
 s_waitcnt vmcnt(6)
 ds_read_b64_tr_b16 v[136:137], v3 offset:0
 ds_read_b64_tr_b16 v[138:139], v3 offset:320
 ds_read_b64_tr_b16 v[208:209], v3 offset:16
 ds_read_b64_tr_b16 v[210:211], v3 offset:336
 ds_read_b64_tr_b16 a[24:25], v3 offset:32
 ds_read_b64_tr_b16 a[26:27], v3 offset:352
 ds_read_b64_tr_b16 a[96:97], v3 offset:48
 ds_read_b64_tr_b16 a[98:99], v3 offset:368
 ds_read_b64_tr_b16 v[16:17], v3 offset:64
 ds_read_b64_tr_b16 v[18:19], v3 offset:384
 s_cmp_eq_u32 s69, 1
 s_cbranch_scc0 L141
 s_waitcnt lgkmcnt(0)
 ds_write_b128 v75, v[16:19] offset:14336
L141:
 s_waitcnt lgkmcnt(0)
 s_mov_b32 exec_lo, -1
 s_mov_b32 exec_hi, 0x0fffffff
 s_add_u32 m0, s66, 0
 s_mov_b32 s60, 4718592
 buffer_load_dwordx4 v0, s[12:15], s60 offen lds
 s_add_u32 m0, s66, 960
 s_mov_b32 s60, 4829184
 buffer_load_dwordx4 v0, s[12:15], s60 offen lds
 s_add_u32 m0, s66, 1920
 s_mov_b32 s60, 4939776
 buffer_load_dwordx4 v0, s[12:15], s60 offen lds
 s_add_u32 m0, s66, 3840
 s_mov_b32 s60, 4718592
 buffer_load_dwordx4 v0, s[48:51], s60 offen lds
 s_add_u32 m0, s66, 4800
 s_mov_b32 s60, 4829184
 buffer_load_dwordx4 v0, s[48:51], s60 offen lds
 s_add_u32 m0, s66, 5760
 s_mov_b32 s60, 4939776
 buffer_load_dwordx4 v0, s[48:51], s60 offen lds
 s_mov_b64 exec, -1
 s_waitcnt vmcnt(6)
 ds_read_b64_tr_b16 v[140:141], v3 offset:6720
 ds_read_b64_tr_b16 v[142:143], v3 offset:7040
 ds_read_b64_tr_b16 v[212:213], v3 offset:6736
 ds_read_b64_tr_b16 v[214:215], v3 offset:7056
 ds_read_b64_tr_b16 a[28:29], v3 offset:6752
 ds_read_b64_tr_b16 a[30:31], v3 offset:7072
 ds_read_b64_tr_b16 a[100:101], v3 offset:6768
 ds_read_b64_tr_b16 a[102:103], v3 offset:7088
 ds_read_b64_tr_b16 v[16:17], v3 offset:6784
 ds_read_b64_tr_b16 v[18:19], v3 offset:7104
 s_cmp_eq_u32 s69, 1
 s_cbranch_scc0 L142
 s_waitcnt lgkmcnt(0)
 ds_write_b128 v75, v[16:19] offset:15360
L142:
 s_waitcnt lgkmcnt(0)
 s_mov_b32 exec_lo, -1
 s_mov_b32 exec_hi, 0x0fffffff
 s_add_u32 m0, s66, 6720
 s_mov_b32 s60, 5013504
 buffer_load_dwordx4 v0, s[12:15], s60 offen lds
 s_add_u32 m0, s66, 7680
 s_mov_b32 s60, 5124096
 buffer_load_dwordx4 v0, s[12:15], s60 offen lds
 s_add_u32 m0, s66, 8640
 s_mov_b32 s60, 5234688
 buffer_load_dwordx4 v0, s[12:15], s60 offen lds
 s_add_u32 m0, s66, 10560
 s_mov_b32 s60, 5013504
 buffer_load_dwordx4 v0, s[48:51], s60 offen lds
 s_add_u32 m0, s66, 11520
 s_mov_b32 s60, 5124096
 buffer_load_dwordx4 v0, s[48:51], s60 offen lds
 s_add_u32 m0, s66, 12480
 s_mov_b32 s60, 5234688
 buffer_load_dwordx4 v0, s[48:51], s60 offen lds
 s_mov_b64 exec, -1
 s_waitcnt vmcnt(6)
 ds_read_b64_tr_b16 v[144:145], v3 offset:0
 ds_read_b64_tr_b16 v[146:147], v3 offset:320
 ds_read_b64_tr_b16 v[216:217], v3 offset:16
 ds_read_b64_tr_b16 v[218:219], v3 offset:336
 ds_read_b64_tr_b16 a[32:33], v3 offset:32
 ds_read_b64_tr_b16 a[34:35], v3 offset:352
 ds_read_b64_tr_b16 a[104:105], v3 offset:48
 ds_read_b64_tr_b16 a[106:107], v3 offset:368
 ds_read_b64_tr_b16 v[16:17], v3 offset:64
 ds_read_b64_tr_b16 v[18:19], v3 offset:384
 s_cmp_eq_u32 s69, 1
 s_cbranch_scc0 L143
 s_waitcnt lgkmcnt(0)
 ds_write_b128 v75, v[16:19] offset:16384
L143:
 s_waitcnt lgkmcnt(0)
 s_mov_b32 exec_lo, -1
 s_mov_b32 exec_hi, 0x0fffffff
 s_add_u32 m0, s66, 0
 s_mov_b32 s60, 0
 buffer_load_dwordx4 v2, s[52:55], s60 offen lds
 s_add_u32 m0, s66, 960
 s_mov_b32 s60, 3456
 buffer_load_dwordx4 v2, s[52:55], s60 offen lds
 s_add_u32 m0, s66, 1920
 s_mov_b32 s60, 6912
 buffer_load_dwordx4 v2, s[52:55], s60 offen lds
 s_add_u32 m0, s66, 2880
 s_mov_b32 s60, 10368
 buffer_load_dwordx4 v2, s[52:55], s60 offen lds
 s_add_u32 m0, s66, 3840
 s_mov_b32 s60, 13824
 buffer_load_dwordx4 v2, s[52:55], s60 offen lds
 s_add_u32 m0, s66, 4800
 s_mov_b32 s60, 17280
 buffer_load_dwordx4 v2, s[52:55], s60 offen lds
 s_mov_b64 exec, -1
 s_waitcnt vmcnt(6)
 ds_read_b64_tr_b16 v[148:149], v3 offset:6720
 ds_read_b64_tr_b16 v[150:151], v3 offset:7040
 ds_read_b64_tr_b16 v[220:221], v3 offset:6736
 ds_read_b64_tr_b16 v[222:223], v3 offset:7056
 ds_read_b64_tr_b16 a[36:37], v3 offset:6752
 ds_read_b64_tr_b16 a[38:39], v3 offset:7072
 ds_read_b64_tr_b16 a[108:109], v3 offset:6768
 ds_read_b64_tr_b16 a[110:111], v3 offset:7088
 ds_read_b64_tr_b16 v[16:17], v3 offset:6784
 ds_read_b64_tr_b16 v[18:19], v3 offset:7104
 s_cmp_eq_u32 s69, 1
 s_cbranch_scc0 L144
 s_waitcnt lgkmcnt(0)
 ds_write_b128 v75, v[16:19] offset:17408
L144:
 s_waitcnt lgkmcnt(0)
 s_mov_b32 exec_lo, -1
 s_mov_b32 exec_hi, 0x0fffffff
 s_add_u32 m0, s66, 5760
 s_mov_b32 s60, 18432
 buffer_load_dwordx4 v2, s[52:55], s60 offen lds
 s_add_u32 m0, s66, 6720
 s_mov_b32 s60, 21888
 buffer_load_dwordx4 v2, s[52:55], s60 offen lds
 s_add_u32 m0, s66, 7680
 s_mov_b32 s60, 25344
 buffer_load_dwordx4 v2, s[52:55], s60 offen lds
 s_add_u32 m0, s66, 8640
 s_mov_b32 s60, 28800
 buffer_load_dwordx4 v2, s[52:55], s60 offen lds
 s_add_u32 m0, s66, 9600
 s_mov_b32 s60, 32256
 buffer_load_dwordx4 v2, s[52:55], s60 offen lds
 s_add_u32 m0, s66, 10560
 s_mov_b32 s60, 35712
 buffer_load_dwordx4 v2, s[52:55], s60 offen lds
 s_mov_b64 exec, -1
 s_waitcnt vmcnt(6)
 ds_read_b64_tr_b16 a[112:113], v4 offset:0
 ds_read_b64_tr_b16 a[114:115], v4 offset:1280
 ds_read_b64_tr_b16 a[148:149], v4 offset:64
 ds_read_b64_tr_b16 a[150:151], v4 offset:1344
 ds_read_b64_tr_b16 a[184:185], v4 offset:128
 ds_read_b64_tr_b16 a[186:187], v4 offset:1408
 ds_read_b64_tr_b16 a[220:221], v4 offset:192
 ds_read_b64_tr_b16 a[222:223], v4 offset:1472
 ds_read_b64_tr_b16 v[16:17], v4 offset:256
 ds_read_b64_tr_b16 v[18:19], v4 offset:1536
 s_cmp_eq_u32 s69, 0
 s_cbranch_scc0 L145
 s_waitcnt lgkmcnt(0)
 ds_write_b128 v75, v[16:19] offset:0
L145:
 s_waitcnt lgkmcnt(0)
 s_mov_b32 exec_lo, -1
 s_mov_b32 exec_hi, 0x0fffffff
 s_add_u32 m0, s66, 0
 s_mov_b32 s60, 36864
 buffer_load_dwordx4 v2, s[52:55], s60 offen lds
 s_add_u32 m0, s66, 960
 s_mov_b32 s60, 40320
 buffer_load_dwordx4 v2, s[52:55], s60 offen lds
 s_add_u32 m0, s66, 1920
 s_mov_b32 s60, 43776
 buffer_load_dwordx4 v2, s[52:55], s60 offen lds
 s_add_u32 m0, s66, 2880
 s_mov_b32 s60, 47232
 buffer_load_dwordx4 v2, s[52:55], s60 offen lds
 s_add_u32 m0, s66, 3840
 s_mov_b32 s60, 50688
 buffer_load_dwordx4 v2, s[52:55], s60 offen lds
 s_add_u32 m0, s66, 4800
 s_mov_b32 s60, 54144
 buffer_load_dwordx4 v2, s[52:55], s60 offen lds
 s_mov_b64 exec, -1
 s_waitcnt vmcnt(6)
 ds_read_b64_tr_b16 a[116:117], v4 offset:5760
 ds_read_b64_tr_b16 a[118:119], v4 offset:7040
 ds_read_b64_tr_b16 a[152:153], v4 offset:5824
 ds_read_b64_tr_b16 a[154:155], v4 offset:7104
 ds_read_b64_tr_b16 a[188:189], v4 offset:5888
 ds_read_b64_tr_b16 a[190:191], v4 offset:7168
 ds_read_b64_tr_b16 a[224:225], v4 offset:5952
 ds_read_b64_tr_b16 a[226:227], v4 offset:7232
 ds_read_b64_tr_b16 v[16:17], v4 offset:6016
 ds_read_b64_tr_b16 v[18:19], v4 offset:7296
 s_cmp_eq_u32 s69, 0
 s_cbranch_scc0 L146
 s_waitcnt lgkmcnt(0)
 ds_write_b128 v75, v[16:19] offset:1024
L146:
 s_waitcnt lgkmcnt(0)
 s_mov_b32 exec_lo, -1
 s_mov_b32 exec_hi, 0x0fffffff
 s_add_u32 m0, s66, 5760
 s_mov_b32 s60, 55296
 buffer_load_dwordx4 v2, s[52:55], s60 offen lds
 s_add_u32 m0, s66, 6720
 s_mov_b32 s60, 58752
 buffer_load_dwordx4 v2, s[52:55], s60 offen lds
 s_add_u32 m0, s66, 7680
 s_mov_b32 s60, 62208
 buffer_load_dwordx4 v2, s[52:55], s60 offen lds
 s_add_u32 m0, s66, 8640
 s_mov_b32 s60, 65664
 buffer_load_dwordx4 v2, s[52:55], s60 offen lds
 s_add_u32 m0, s66, 9600
 s_mov_b32 s60, 69120
 buffer_load_dwordx4 v2, s[52:55], s60 offen lds
 s_add_u32 m0, s66, 10560
 s_mov_b32 s60, 72576
 buffer_load_dwordx4 v2, s[52:55], s60 offen lds
 s_mov_b64 exec, -1
 s_waitcnt vmcnt(6)
 ds_read_b64_tr_b16 a[120:121], v4 offset:0
 ds_read_b64_tr_b16 a[122:123], v4 offset:1280
 ds_read_b64_tr_b16 a[156:157], v4 offset:64
 ds_read_b64_tr_b16 a[158:159], v4 offset:1344
 ds_read_b64_tr_b16 a[192:193], v4 offset:128
 ds_read_b64_tr_b16 a[194:195], v4 offset:1408
 ds_read_b64_tr_b16 a[228:229], v4 offset:192
 ds_read_b64_tr_b16 a[230:231], v4 offset:1472
 ds_read_b64_tr_b16 v[16:17], v4 offset:256
 ds_read_b64_tr_b16 v[18:19], v4 offset:1536
 s_cmp_eq_u32 s69, 0
 s_cbranch_scc0 L147
 s_waitcnt lgkmcnt(0)
 ds_write_b128 v75, v[16:19] offset:2048
L147:
 s_waitcnt lgkmcnt(0)
 s_mov_b32 exec_lo, -1
 s_mov_b32 exec_hi, 0x0fffffff
 s_add_u32 m0, s66, 0
 s_mov_b32 s60, 73728
 buffer_load_dwordx4 v2, s[52:55], s60 offen lds
 s_add_u32 m0, s66, 960
 s_mov_b32 s60, 77184
 buffer_load_dwordx4 v2, s[52:55], s60 offen lds
 s_add_u32 m0, s66, 1920
 s_mov_b32 s60, 80640
 buffer_load_dwordx4 v2, s[52:55], s60 offen lds
 s_add_u32 m0, s66, 2880
 s_mov_b32 s60, 84096
 buffer_load_dwordx4 v2, s[52:55], s60 offen lds
 s_add_u32 m0, s66, 3840
 s_mov_b32 s60, 87552
 buffer_load_dwordx4 v2, s[52:55], s60 offen lds
 s_add_u32 m0, s66, 4800
 s_mov_b32 s60, 91008
 buffer_load_dwordx4 v2, s[52:55], s60 offen lds
 s_mov_b64 exec, -1
 s_waitcnt vmcnt(6)
 ds_read_b64_tr_b16 a[124:125], v4 offset:5760
 ds_read_b64_tr_b16 a[126:127], v4 offset:7040
 ds_read_b64_tr_b16 a[160:161], v4 offset:5824
 ds_read_b64_tr_b16 a[162:163], v4 offset:7104
 ds_read_b64_tr_b16 a[196:197], v4 offset:5888
 ds_read_b64_tr_b16 a[198:199], v4 offset:7168
 ds_read_b64_tr_b16 a[232:233], v4 offset:5952
 ds_read_b64_tr_b16 a[234:235], v4 offset:7232
 ds_read_b64_tr_b16 v[16:17], v4 offset:6016
 ds_read_b64_tr_b16 v[18:19], v4 offset:7296
 s_cmp_eq_u32 s69, 0
 s_cbranch_scc0 L148
 s_waitcnt lgkmcnt(0)
 ds_write_b128 v75, v[16:19] offset:3072
L148:
 s_waitcnt lgkmcnt(0)
 s_mov_b32 exec_lo, -1
 s_mov_b32 exec_hi, 0x0fffffff
 s_add_u32 m0, s66, 5760
 s_mov_b32 s60, 92160
 buffer_load_dwordx4 v2, s[52:55], s60 offen lds
 s_add_u32 m0, s66, 6720
 s_mov_b32 s60, 95616
 buffer_load_dwordx4 v2, s[52:55], s60 offen lds
 s_add_u32 m0, s66, 7680
 s_mov_b32 s60, 99072
 buffer_load_dwordx4 v2, s[52:55], s60 offen lds
 s_add_u32 m0, s66, 8640
 s_mov_b32 s60, 102528
 buffer_load_dwordx4 v2, s[52:55], s60 offen lds
 s_add_u32 m0, s66, 9600
 s_mov_b32 s60, 105984
 buffer_load_dwordx4 v2, s[52:55], s60 offen lds
 s_add_u32 m0, s66, 10560
 s_mov_b32 s60, 109440
 buffer_load_dwordx4 v2, s[52:55], s60 offen lds
 s_mov_b64 exec, -1
 s_waitcnt vmcnt(6)
 ds_read_b64_tr_b16 a[128:129], v4 offset:0
 ds_read_b64_tr_b16 a[130:131], v4 offset:1280
 ds_read_b64_tr_b16 a[164:165], v4 offset:64
 ds_read_b64_tr_b16 a[166:167], v4 offset:1344
 ds_read_b64_tr_b16 a[200:201], v4 offset:128
 ds_read_b64_tr_b16 a[202:203], v4 offset:1408
 ds_read_b64_tr_b16 a[236:237], v4 offset:192
 ds_read_b64_tr_b16 a[238:239], v4 offset:1472
 ds_read_b64_tr_b16 v[16:17], v4 offset:256
 ds_read_b64_tr_b16 v[18:19], v4 offset:1536
 s_cmp_eq_u32 s69, 0
 s_cbranch_scc0 L149
 s_waitcnt lgkmcnt(0)
 ds_write_b128 v75, v[16:19] offset:4096
L149:
 s_waitcnt lgkmcnt(0)
 s_mov_b32 exec_lo, -1
 s_mov_b32 exec_hi, 0x0fffffff
 s_add_u32 m0, s66, 0
 s_mov_b32 s60, 110592
 buffer_load_dwordx4 v2, s[52:55], s60 offen lds
 s_add_u32 m0, s66, 960
 s_mov_b32 s60, 114048
 buffer_load_dwordx4 v2, s[52:55], s60 offen lds
 s_add_u32 m0, s66, 1920
 s_mov_b32 s60, 117504
 buffer_load_dwordx4 v2, s[52:55], s60 offen lds
 s_add_u32 m0, s66, 2880
 s_mov_b32 s60, 120960
 buffer_load_dwordx4 v2, s[52:55], s60 offen lds
 s_add_u32 m0, s66, 3840
 s_mov_b32 s60, 124416
 buffer_load_dwordx4 v2, s[52:55], s60 offen lds
 s_add_u32 m0, s66, 4800
 s_mov_b32 s60, 127872
 buffer_load_dwordx4 v2, s[52:55], s60 offen lds
 s_mov_b64 exec, -1
 s_waitcnt vmcnt(6)
 ds_read_b64_tr_b16 a[132:133], v4 offset:5760
 ds_read_b64_tr_b16 a[134:135], v4 offset:7040
 ds_read_b64_tr_b16 a[168:169], v4 offset:5824
 ds_read_b64_tr_b16 a[170:171], v4 offset:7104
 ds_read_b64_tr_b16 a[204:205], v4 offset:5888
 ds_read_b64_tr_b16 a[206:207], v4 offset:7168
 ds_read_b64_tr_b16 a[240:241], v4 offset:5952
 ds_read_b64_tr_b16 a[242:243], v4 offset:7232
 ds_read_b64_tr_b16 v[16:17], v4 offset:6016
 ds_read_b64_tr_b16 v[18:19], v4 offset:7296
 s_cmp_eq_u32 s69, 0
 s_cbranch_scc0 L150
 s_waitcnt lgkmcnt(0)
 ds_write_b128 v75, v[16:19] offset:5120
L150:
 s_waitcnt lgkmcnt(0)
 s_mov_b32 exec_lo, -1
 s_mov_b32 exec_hi, 0x0fffffff
 s_add_u32 m0, s66, 5760
 s_mov_b32 s60, 129024
 buffer_load_dwordx4 v2, s[52:55], s60 offen lds
 s_add_u32 m0, s66, 6720
 s_mov_b32 s60, 132480
 buffer_load_dwordx4 v2, s[52:55], s60 offen lds
 s_add_u32 m0, s66, 7680
 s_mov_b32 s60, 135936
 buffer_load_dwordx4 v2, s[52:55], s60 offen lds
 s_add_u32 m0, s66, 8640
 s_mov_b32 s60, 139392
 buffer_load_dwordx4 v2, s[52:55], s60 offen lds
 s_add_u32 m0, s66, 9600
 s_mov_b32 s60, 142848
 buffer_load_dwordx4 v2, s[52:55], s60 offen lds
 s_add_u32 m0, s66, 10560
 s_mov_b32 s60, 146304
 buffer_load_dwordx4 v2, s[52:55], s60 offen lds
 s_mov_b64 exec, -1
 s_waitcnt vmcnt(6)
 ds_read_b64_tr_b16 a[136:137], v4 offset:0
 ds_read_b64_tr_b16 a[138:139], v4 offset:1280
 ds_read_b64_tr_b16 a[172:173], v4 offset:64
 ds_read_b64_tr_b16 a[174:175], v4 offset:1344
 ds_read_b64_tr_b16 a[208:209], v4 offset:128
 ds_read_b64_tr_b16 a[210:211], v4 offset:1408
 ds_read_b64_tr_b16 a[244:245], v4 offset:192
 ds_read_b64_tr_b16 a[246:247], v4 offset:1472
 ds_read_b64_tr_b16 v[16:17], v4 offset:256
 ds_read_b64_tr_b16 v[18:19], v4 offset:1536
 s_cmp_eq_u32 s69, 0
 s_cbranch_scc0 L151
 s_waitcnt lgkmcnt(0)
 ds_write_b128 v75, v[16:19] offset:6144
L151:
 s_waitcnt lgkmcnt(0)
 s_mov_b32 exec_lo, -1
 s_mov_b32 exec_hi, 0x0fffffff
 s_add_u32 m0, s66, 0
 s_mov_b32 s60, 147456
 buffer_load_dwordx4 v2, s[52:55], s60 offen lds
 s_add_u32 m0, s66, 960
 s_mov_b32 s60, 150912
 buffer_load_dwordx4 v2, s[52:55], s60 offen lds
 s_add_u32 m0, s66, 1920
 s_mov_b32 s60, 154368
 buffer_load_dwordx4 v2, s[52:55], s60 offen lds
 s_add_u32 m0, s66, 2880
 s_mov_b32 s60, 157824
 buffer_load_dwordx4 v2, s[52:55], s60 offen lds
 s_add_u32 m0, s66, 3840
 s_mov_b32 s60, 161280
 buffer_load_dwordx4 v2, s[52:55], s60 offen lds
 s_add_u32 m0, s66, 4800
 s_mov_b32 s60, 164736
 buffer_load_dwordx4 v2, s[52:55], s60 offen lds
 s_mov_b64 exec, -1
 s_waitcnt vmcnt(6)
 ds_read_b64_tr_b16 a[140:141], v4 offset:5760
 ds_read_b64_tr_b16 a[142:143], v4 offset:7040
 ds_read_b64_tr_b16 a[176:177], v4 offset:5824
 ds_read_b64_tr_b16 a[178:179], v4 offset:7104
 ds_read_b64_tr_b16 a[212:213], v4 offset:5888
 ds_read_b64_tr_b16 a[214:215], v4 offset:7168
 ds_read_b64_tr_b16 a[248:249], v4 offset:5952
 ds_read_b64_tr_b16 a[250:251], v4 offset:7232
 ds_read_b64_tr_b16 v[16:17], v4 offset:6016
 ds_read_b64_tr_b16 v[18:19], v4 offset:7296
 s_cmp_eq_u32 s69, 0
 s_cbranch_scc0 L152
 s_waitcnt lgkmcnt(0)
 ds_write_b128 v75, v[16:19] offset:7168
L152:
 s_waitcnt lgkmcnt(0)
 s_waitcnt vmcnt(0)
 ds_read_b64_tr_b16 a[144:145], v4 offset:0
 ds_read_b64_tr_b16 a[146:147], v4 offset:1280
 ds_read_b64_tr_b16 a[180:181], v4 offset:64
 ds_read_b64_tr_b16 a[182:183], v4 offset:1344
 ds_read_b64_tr_b16 a[216:217], v4 offset:128
 ds_read_b64_tr_b16 a[218:219], v4 offset:1408
 ds_read_b64_tr_b16 a[252:253], v4 offset:192
 ds_read_b64_tr_b16 a[254:255], v4 offset:1472
 ds_read_b64_tr_b16 v[16:17], v4 offset:256
 ds_read_b64_tr_b16 v[18:19], v4 offset:1536
 s_cmp_eq_u32 s69, 0
 s_cbranch_scc0 L153
 s_waitcnt lgkmcnt(0)
 ds_write_b128 v75, v[16:19] offset:8192
L153:
 s_waitcnt lgkmcnt(0)
 s_barrier
 v_mov_b32 v6, 0
L154:
 buffer_load_dword v7, v6, s[8:11], 0 offen offset:112 sc1
 s_waitcnt vmcnt(0)
 v_mov_b32 v6, 0x100
 v_cmp_ne_u32 vcc, v6, v7
 v_mov_b32 v6, 0
 s_cbranch_vccnz L154
 v_and_b32 v6, 31, v68
 v_mul_u32_u24 v6, 1168, v6
 v_lshrrev_b32 v70, 5, v68
 v_lshlrev_b32 v70, 4, v70
 v_add_u32 v70, v70, v6
 v_add_u32 v70, 112640, v70
 v_lshrrev_b32 v6, 4, v68
 s_lshl_b32 s60, s44, 3
 v_add_u32 v6, s60, v6
 v_mul_u32_u24 v6, 1152, v6
 v_and_b32 v71, 15, v68
 v_lshlrev_b32 v71, 4, v71
 v_add_u32 v71, v71, v6
 s_mul_i32 s60, s46, 36864
 v_add_u32 v71, s60, v71
 v_lshrrev_b32 v6, 4, v68
 v_lshlrev_b32 v6, 7, v6
 v_bfe_u32 v72, v68, 2, 1
 v_lshlrev_b32 v72, 5, v72
 v_add_u32 v72, v72, v6
 v_and_b32 v6, 3, v68
 v_lshlrev_b32 v6, 2, v6
 v_add_u32 v72, v72, v6
 s_mul_i32 s60, s44, 2304
 v_add_u32 v72, s60, v72
 v_lshlrev_b32 v73, 5, v68
 v_and_b32 v6, 15, v68
 v_mov_b32 v9, 0x3f80
 v_subrev_u32 v7, 0, v6
 v_lshlrev_b32 v8, 4, v7
 v_cmp_gt_u32 vcc, 2, v7
 v_lshlrev_b32 v8, v8, v9
 s_nop 0
 v_cndmask_b32 v76, 0, v8, vcc
 v_subrev_u32 v7, 2, v6
 v_lshlrev_b32 v8, 4, v7
 v_cmp_gt_u32 vcc, 2, v7
 v_lshlrev_b32 v8, v8, v9
 s_nop 0
 v_cndmask_b32 v77, 0, v8, vcc
 v_subrev_u32 v7, 4, v6
 v_lshlrev_b32 v8, 4, v7
 v_cmp_gt_u32 vcc, 2, v7
 v_lshlrev_b32 v8, v8, v9
 s_nop 0
 v_cndmask_b32 v78, 0, v8, vcc
 v_subrev_u32 v7, 6, v6
 v_lshlrev_b32 v8, 4, v7
 v_cmp_gt_u32 vcc, 2, v7
 v_lshlrev_b32 v8, v8, v9
 s_nop 0
 v_cndmask_b32 v79, 0, v8, vcc
 v_and_b32 v6, 31, v68
 v_lshlrev_b32 v6, 4, v6
 v_lshrrev_b32 v7, 5, v68
 v_lshlrev_b32 v7, 3, v7
 v_add_u32 v6, v6, v7
 s_lshl_b32 s60, s67, 9
 s_add_u32 s60, s60, 36864
 v_add_u32 v74, s60, v6
 s_mov_b32 s75, 0xffff0000
 s_mov_b32 s76, 0xbfb8aa3b
 s_mov_b32 s64, s47
 s_mov_b32 s65, 0
FF_LOOP155:
 s_lshl_b32 s60, s64, 7
 s_add_u32 s60, s60, 73416704
 s_mov_b32 s61, 1
 v_and_b32 v0, 31, v68
 v_lshlrev_b32 v0, 2, v0
L156:
 buffer_load_dword v1, v0, s[4:7], s60 offen sc1
 s_waitcnt vmcnt(0)
 v_cmp_gt_u32 vcc, s61, v1
 s_cbranch_vccnz L156
 s_mul_i32 s60, s64, 36864
 s_mul_i32 s61, s44, 9216
 s_add_u32 s60, s60, s61
 s_add_u32 s60, s60, 79691776
 s_add_u32 m0, s61, 0
 s_add_u32 s62, s60, 0
 buffer_load_dwordx4 v69, s[4:7], s62 offen offset:0 sc1 lds
 buffer_load_dwordx4 v69, s[4:7], s62 offen offset:1024 sc1 lds
 buffer_load_dwordx4 v69, s[4:7], s62 offen offset:2048 sc1 lds
 s_add_u32 m0, s61, 3072
 s_add_u32 s62, s60, 3072
 buffer_load_dwordx4 v69, s[4:7], s62 offen offset:0 sc1 lds
 buffer_load_dwordx4 v69, s[4:7], s62 offen offset:1024 sc1 lds
 buffer_load_dwordx4 v69, s[4:7], s62 offen offset:2048 sc1 lds
 s_add_u32 m0, s61, 6144
 s_add_u32 s62, s60, 6144
 buffer_load_dwordx4 v69, s[4:7], s62 offen offset:0 sc1 lds
 buffer_load_dwordx4 v69, s[4:7], s62 offen offset:1024 sc1 lds
 buffer_load_dwordx4 v69, s[4:7], s62 offen offset:2048 sc1 lds
 s_cmp_eq_u32 s44, 0
 s_cbranch_scc0 L157
 s_lshl_b32 s60, s64, 5
 s_add_u32 s60, s60, s46
 s_mul_i32 s60, s60, 1152
 s_add_u32 s60, s60, 75497472
 s_mov_b32 m0, 151552
 s_nop 0
 buffer_load_dwordx4 v69, s[4:7], s60 offen sc1 lds
 s_mov_b64 exec, 0xff
 buffer_load_dwordx4 v69, s[4:7], s60 offen offset:1024 sc1 lds
 s_mov_b64 exec, -1
L157:
 v_and_b32 v0, 31, v68
 v_lshlrev_b32 v0, 2, v0
 s_add_u32 s63, s72, 128
 buffer_load_dword v1, v0, s[4:7], s63 offen sc1
 s_waitcnt vmcnt(0)
 v_cmp_gt_u32 vcc, s65, v1
 s_cbranch_vccz L158e
L158:
 buffer_load_dword v1, v0, s[4:7], s63 offen sc1
 s_waitcnt vmcnt(0)
 v_cmp_gt_u32 vcc, s65, v1
 s_cbranch_vccnz L158
L158e:
 s_barrier
 ds_read_b128 v[40:43], v69 offset:0
 ds_read_b128 v[44:47], v69 offset:1024
 ds_read_b128 v[48:51], v69 offset:2048
 ds_read_b128 v[52:55], v69 offset:3072
 s_waitcnt lgkmcnt(2)
 v_mfma_f32_16x16x32_bf16 v[0:3], v[80:83], v[40:43], 0
 v_mfma_f32_16x16x32_bf16 v[4:7], v[80:83], v[44:47], 0
 v_mfma_f32_16x16x32_bf16 v[8:11], v[152:155], v[40:43], 0
 v_mfma_f32_16x16x32_bf16 v[12:15], v[152:155], v[44:47], 0
 v_mfma_f32_16x16x32_bf16 v[16:19], v[224:227], v[40:43], 0
 v_mfma_f32_16x16x32_bf16 v[20:23], v[224:227], v[44:47], 0
 ds_read_b128 v[40:43], v69 offset:4096
 ds_read_b128 v[44:47], v69 offset:5120
 s_waitcnt lgkmcnt(2)
 v_mfma_f32_16x16x32_bf16 v[0:3], v[84:87], v[48:51], v[0:3]
 v_mfma_f32_16x16x32_bf16 v[4:7], v[84:87], v[52:55], v[4:7]
 v_mfma_f32_16x16x32_bf16 v[8:11], v[156:159], v[48:51], v[8:11]
 v_mfma_f32_16x16x32_bf16 v[12:15], v[156:159], v[52:55], v[12:15]
 v_mfma_f32_16x16x32_bf16 v[16:19], v[228:231], v[48:51], v[16:19]
 v_mfma_f32_16x16x32_bf16 v[20:23], v[228:231], v[52:55], v[20:23]
 ds_read_b128 v[48:51], v69 offset:6144
 ds_read_b128 v[52:55], v69 offset:7168
 s_waitcnt lgkmcnt(2)
 v_mfma_f32_16x16x32_bf16 v[0:3], v[88:91], v[40:43], v[0:3]
 v_mfma_f32_16x16x32_bf16 v[4:7], v[88:91], v[44:47], v[4:7]
 v_mfma_f32_16x16x32_bf16 v[8:11], v[160:163], v[40:43], v[8:11]
 v_mfma_f32_16x16x32_bf16 v[12:15], v[160:163], v[44:47], v[12:15]
 v_mfma_f32_16x16x32_bf16 v[16:19], v[232:235], v[40:43], v[16:19]
 v_mfma_f32_16x16x32_bf16 v[20:23], v[232:235], v[44:47], v[20:23]
 ds_read_b128 v[40:43], v69 offset:8192
 ds_read_b128 v[44:47], v69 offset:9216
 s_waitcnt lgkmcnt(2)
 v_mfma_f32_16x16x32_bf16 v[0:3], v[92:95], v[48:51], v[0:3]
 v_mfma_f32_16x16x32_bf16 v[4:7], v[92:95], v[52:55], v[4:7]
 v_mfma_f32_16x16x32_bf16 v[8:11], v[164:167], v[48:51], v[8:11]
 v_mfma_f32_16x16x32_bf16 v[12:15], v[164:167], v[52:55], v[12:15]
 v_mfma_f32_16x16x32_bf16 v[16:19], v[236:239], v[48:51], v[16:19]
 v_mfma_f32_16x16x32_bf16 v[20:23], v[236:239], v[52:55], v[20:23]
 ds_read_b128 v[48:51], v69 offset:10240
 ds_read_b128 v[52:55], v69 offset:11264
 s_waitcnt lgkmcnt(2)
 v_mfma_f32_16x16x32_bf16 v[0:3], v[96:99], v[40:43], v[0:3]
 v_mfma_f32_16x16x32_bf16 v[4:7], v[96:99], v[44:47], v[4:7]
 v_mfma_f32_16x16x32_bf16 v[8:11], v[168:171], v[40:43], v[8:11]
 v_mfma_f32_16x16x32_bf16 v[12:15], v[168:171], v[44:47], v[12:15]
 v_mfma_f32_16x16x32_bf16 v[16:19], v[240:243], v[40:43], v[16:19]
 v_mfma_f32_16x16x32_bf16 v[20:23], v[240:243], v[44:47], v[20:23]
 ds_read_b128 v[40:43], v69 offset:12288
 ds_read_b128 v[44:47], v69 offset:13312
 s_waitcnt lgkmcnt(2)
 v_mfma_f32_16x16x32_bf16 v[0:3], v[100:103], v[48:51], v[0:3]
 v_mfma_f32_16x16x32_bf16 v[4:7], v[100:103], v[52:55], v[4:7]
 v_mfma_f32_16x16x32_bf16 v[8:11], v[172:175], v[48:51], v[8:11]
 v_mfma_f32_16x16x32_bf16 v[12:15], v[172:175], v[52:55], v[12:15]
 v_mfma_f32_16x16x32_bf16 v[16:19], v[244:247], v[48:51], v[16:19]
 v_mfma_f32_16x16x32_bf16 v[20:23], v[244:247], v[52:55], v[20:23]
 ds_read_b128 v[48:51], v69 offset:14336
 ds_read_b128 v[52:55], v69 offset:15360
 s_waitcnt lgkmcnt(2)
 v_mfma_f32_16x16x32_bf16 v[0:3], v[104:107], v[40:43], v[0:3]
 v_mfma_f32_16x16x32_bf16 v[4:7], v[104:107], v[44:47], v[4:7]
 v_mfma_f32_16x16x32_bf16 v[8:11], v[176:179], v[40:43], v[8:11]
 v_mfma_f32_16x16x32_bf16 v[12:15], v[176:179], v[44:47], v[12:15]
 v_mfma_f32_16x16x32_bf16 v[16:19], v[248:251], v[40:43], v[16:19]
 v_mfma_f32_16x16x32_bf16 v[20:23], v[248:251], v[44:47], v[20:23]
 ds_read_b128 v[40:43], v69 offset:16384
 ds_read_b128 v[44:47], v69 offset:17408
 s_waitcnt lgkmcnt(2)
 v_mfma_f32_16x16x32_bf16 v[0:3], v[108:111], v[48:51], v[0:3]
 v_mfma_f32_16x16x32_bf16 v[4:7], v[108:111], v[52:55], v[4:7]
 v_mfma_f32_16x16x32_bf16 v[8:11], v[180:183], v[48:51], v[8:11]
 v_mfma_f32_16x16x32_bf16 v[12:15], v[180:183], v[52:55], v[12:15]
 v_mfma_f32_16x16x32_bf16 v[16:19], v[252:255], v[48:51], v[16:19]
 v_mfma_f32_16x16x32_bf16 v[20:23], v[252:255], v[52:55], v[20:23]
 ds_read_b128 v[48:51], v69 offset:18432
 ds_read_b128 v[52:55], v69 offset:19456
 s_waitcnt lgkmcnt(2)
 v_mfma_f32_16x16x32_bf16 v[0:3], v[112:115], v[40:43], v[0:3]
 v_mfma_f32_16x16x32_bf16 v[4:7], v[112:115], v[44:47], v[4:7]
 v_mfma_f32_16x16x32_bf16 v[8:11], v[184:187], v[40:43], v[8:11]
 v_mfma_f32_16x16x32_bf16 v[12:15], v[184:187], v[44:47], v[12:15]
 v_mfma_f32_16x16x32_bf16 v[16:19], a[0:3], v[40:43], v[16:19]
 v_mfma_f32_16x16x32_bf16 v[20:23], a[0:3], v[44:47], v[20:23]
 ds_read_b128 v[40:43], v69 offset:20480
 ds_read_b128 v[44:47], v69 offset:21504
 s_waitcnt lgkmcnt(2)
 v_mfma_f32_16x16x32_bf16 v[0:3], v[116:119], v[48:51], v[0:3]
 v_mfma_f32_16x16x32_bf16 v[4:7], v[116:119], v[52:55], v[4:7]
 v_mfma_f32_16x16x32_bf16 v[8:11], v[188:191], v[48:51], v[8:11]
 v_mfma_f32_16x16x32_bf16 v[12:15], v[188:191], v[52:55], v[12:15]
 v_mfma_f32_16x16x32_bf16 v[16:19], a[4:7], v[48:51], v[16:19]
 v_mfma_f32_16x16x32_bf16 v[20:23], a[4:7], v[52:55], v[20:23]
 ds_read_b128 v[48:51], v69 offset:22528
 ds_read_b128 v[52:55], v69 offset:23552
 s_waitcnt lgkmcnt(2)
 v_mfma_f32_16x16x32_bf16 v[0:3], v[120:123], v[40:43], v[0:3]
 v_mfma_f32_16x16x32_bf16 v[4:7], v[120:123], v[44:47], v[4:7]
 v_mfma_f32_16x16x32_bf16 v[8:11], v[192:195], v[40:43], v[8:11]
 v_mfma_f32_16x16x32_bf16 v[12:15], v[192:195], v[44:47], v[12:15]
 v_mfma_f32_16x16x32_bf16 v[16:19], a[8:11], v[40:43], v[16:19]
 v_mfma_f32_16x16x32_bf16 v[20:23], a[8:11], v[44:47], v[20:23]
 ds_read_b128 v[40:43], v69 offset:24576
 ds_read_b128 v[44:47], v69 offset:25600
 s_waitcnt lgkmcnt(2)
 v_mfma_f32_16x16x32_bf16 v[0:3], v[124:127], v[48:51], v[0:3]
 v_mfma_f32_16x16x32_bf16 v[4:7], v[124:127], v[52:55], v[4:7]
 v_mfma_f32_16x16x32_bf16 v[8:11], v[196:199], v[48:51], v[8:11]
 v_mfma_f32_16x16x32_bf16 v[12:15], v[196:199], v[52:55], v[12:15]
 v_mfma_f32_16x16x32_bf16 v[16:19], a[12:15], v[48:51], v[16:19]
 v_mfma_f32_16x16x32_bf16 v[20:23], a[12:15], v[52:55], v[20:23]
 ds_read_b128 v[48:51], v69 offset:26624
 ds_read_b128 v[52:55], v69 offset:27648
 s_waitcnt lgkmcnt(2)
 v_mfma_f32_16x16x32_bf16 v[0:3], v[128:131], v[40:43], v[0:3]
 v_mfma_f32_16x16x32_bf16 v[4:7], v[128:131], v[44:47], v[4:7]
 v_mfma_f32_16x16x32_bf16 v[8:11], v[200:203], v[40:43], v[8:11]
 v_mfma_f32_16x16x32_bf16 v[12:15], v[200:203], v[44:47], v[12:15]
 v_mfma_f32_16x16x32_bf16 v[16:19], a[16:19], v[40:43], v[16:19]
 v_mfma_f32_16x16x32_bf16 v[20:23], a[16:19], v[44:47], v[20:23]
 ds_read_b128 v[40:43], v69 offset:28672
 ds_read_b128 v[44:47], v69 offset:29696
 s_waitcnt lgkmcnt(2)
 v_mfma_f32_16x16x32_bf16 v[0:3], v[132:135], v[48:51], v[0:3]
 v_mfma_f32_16x16x32_bf16 v[4:7], v[132:135], v[52:55], v[4:7]
 v_mfma_f32_16x16x32_bf16 v[8:11], v[204:207], v[48:51], v[8:11]
 v_mfma_f32_16x16x32_bf16 v[12:15], v[204:207], v[52:55], v[12:15]
 v_mfma_f32_16x16x32_bf16 v[16:19], a[20:23], v[48:51], v[16:19]
 v_mfma_f32_16x16x32_bf16 v[20:23], a[20:23], v[52:55], v[20:23]
 ds_read_b128 v[48:51], v69 offset:30720
 ds_read_b128 v[52:55], v69 offset:31744
 s_waitcnt lgkmcnt(2)
 v_mfma_f32_16x16x32_bf16 v[0:3], v[136:139], v[40:43], v[0:3]
 v_mfma_f32_16x16x32_bf16 v[4:7], v[136:139], v[44:47], v[4:7]
 v_mfma_f32_16x16x32_bf16 v[8:11], v[208:211], v[40:43], v[8:11]
 v_mfma_f32_16x16x32_bf16 v[12:15], v[208:211], v[44:47], v[12:15]
 v_mfma_f32_16x16x32_bf16 v[16:19], a[24:27], v[40:43], v[16:19]
 v_mfma_f32_16x16x32_bf16 v[20:23], a[24:27], v[44:47], v[20:23]
 ds_read_b128 v[40:43], v69 offset:32768
 ds_read_b128 v[44:47], v69 offset:33792
 s_waitcnt lgkmcnt(2)
 v_mfma_f32_16x16x32_bf16 v[0:3], v[140:143], v[48:51], v[0:3]
 v_mfma_f32_16x16x32_bf16 v[4:7], v[140:143], v[52:55], v[4:7]
 v_mfma_f32_16x16x32_bf16 v[8:11], v[212:215], v[48:51], v[8:11]
 v_mfma_f32_16x16x32_bf16 v[12:15], v[212:215], v[52:55], v[12:15]
 v_mfma_f32_16x16x32_bf16 v[16:19], a[28:31], v[48:51], v[16:19]
 v_mfma_f32_16x16x32_bf16 v[20:23], a[28:31], v[52:55], v[20:23]
 ds_read_b128 v[48:51], v69 offset:34816
 ds_read_b128 v[52:55], v69 offset:35840
 s_waitcnt lgkmcnt(2)
 v_mfma_f32_16x16x32_bf16 v[0:3], v[144:147], v[40:43], v[0:3]
 v_mfma_f32_16x16x32_bf16 v[4:7], v[144:147], v[44:47], v[4:7]
 v_mfma_f32_16x16x32_bf16 v[8:11], v[216:219], v[40:43], v[8:11]
 v_mfma_f32_16x16x32_bf16 v[12:15], v[216:219], v[44:47], v[12:15]
 v_mfma_f32_16x16x32_bf16 v[16:19], a[32:35], v[40:43], v[16:19]
 v_mfma_f32_16x16x32_bf16 v[20:23], a[32:35], v[44:47], v[20:23]
 s_waitcnt lgkmcnt(0)
 v_mfma_f32_16x16x32_bf16 v[0:3], v[148:151], v[48:51], v[0:3]
 v_mfma_f32_16x16x32_bf16 v[4:7], v[148:151], v[52:55], v[4:7]
 v_mfma_f32_16x16x32_bf16 v[8:11], v[220:223], v[48:51], v[8:11]
 v_mfma_f32_16x16x32_bf16 v[12:15], v[220:223], v[52:55], v[12:15]
 v_mfma_f32_16x16x32_bf16 v[16:19], a[36:39], v[48:51], v[16:19]
 v_mfma_f32_16x16x32_bf16 v[20:23], a[36:39], v[52:55], v[20:23]
 ds_read_b128 v[40:43], v69 offset:0
 ds_read_b128 v[44:47], v69 offset:1024
 ds_read_b128 v[56:59], v75 offset:0
 ds_read_b128 v[48:51], v69 offset:2048
 ds_read_b128 v[52:55], v69 offset:3072
 ds_read_b128 v[60:63], v75 offset:1024
 s_waitcnt lgkmcnt(3)
 v_mfma_f32_16x16x32_bf16 v[24:27], a[40:43], v[40:43], 0
 s_nop 0
 s_nop 0
 v_mfma_f32_16x16x32_bf16 v[28:31], a[40:43], v[44:47], 0
 s_nop 0
 s_nop 0
 v_mfma_f32_16x16x32_bf16 v[32:35], v[56:59], v[40:43], 0
 s_nop 0
 s_nop 0
 v_mfma_f32_16x16x32_bf16 v[36:39], v[56:59], v[44:47], 0
 v_permlane16_swap_b32 v0, v4
 v_permlane16_swap_b32 v1, v5
 ds_read_b128 v[40:43], v69 offset:4096
 ds_read_b128 v[44:47], v69 offset:5120
 ds_read_b128 v[56:59], v75 offset:2048
 s_waitcnt lgkmcnt(3)
 v_mfma_f32_16x16x32_bf16 v[24:27], a[44:47], v[48:51], v[24:27]
 v_permlane16_swap_b32 v2, v6
 v_permlane16_swap_b32 v3, v7
 v_mfma_f32_16x16x32_bf16 v[28:31], a[44:47], v[52:55], v[28:31]
 v_cvt_pk_bf16_f32 v64, v0, v1
 v_lshlrev_b32 v0, 16, v64
 v_mfma_f32_16x16x32_bf16 v[32:35], v[60:63], v[48:51], v[32:35]
 v_and_b32 v1, s75, v64
 v_mul_f32 v65, s76, v0
 v_mfma_f32_16x16x32_bf16 v[36:39], v[60:63], v[52:55], v[36:39]
 v_mul_f32 v66, s76, v1
 v_exp_f32 v65, v65
 ds_read_b128 v[48:51], v69 offset:6144
 ds_read_b128 v[52:55], v69 offset:7168
 ds_read_b128 v[60:63], v75 offset:3072
 s_waitcnt lgkmcnt(3)
 v_mfma_f32_16x16x32_bf16 v[24:27], a[48:51], v[40:43], v[24:27]
 v_exp_f32 v66, v66
 v_cvt_pk_bf16_f32 v64, v4, v5
 v_mfma_f32_16x16x32_bf16 v[28:31], a[48:51], v[44:47], v[28:31]
 v_add_f32 v65, 1.0, v65
 v_add_f32 v66, 1.0, v66
 v_mfma_f32_16x16x32_bf16 v[32:35], v[56:59], v[40:43], v[32:35]
 v_rcp_f32 v65, v65
 v_rcp_f32 v66, v66
 v_mfma_f32_16x16x32_bf16 v[36:39], v[56:59], v[44:47], v[36:39]
 v_lshlrev_b32 v4, 16, v64
 v_and_b32 v5, s75, v64
 ds_read_b128 v[40:43], v69 offset:8192
 ds_read_b128 v[44:47], v69 offset:9216
 ds_read_b128 v[56:59], v75 offset:4096
 s_waitcnt lgkmcnt(3)
 v_mfma_f32_16x16x32_bf16 v[24:27], a[52:55], v[48:51], v[24:27]
 v_mul_f32 v0, v0, v65
 v_mul_f32 v1, v1, v66
 v_mfma_f32_16x16x32_bf16 v[28:31], a[52:55], v[52:55], v[28:31]
 v_cvt_pk_bf16_f32 v64, v0, v1
 v_lshlrev_b32 v0, 16, v64
 v_mfma_f32_16x16x32_bf16 v[32:35], v[60:63], v[48:51], v[32:35]
 v_and_b32 v1, s75, v64
 v_mul_f32 v0, v0, v4
 v_mfma_f32_16x16x32_bf16 v[36:39], v[60:63], v[52:55], v[36:39]
 v_mul_f32 v1, v1, v5
 v_cvt_pk_bf16_f32 v4, v0, v1
 ds_read_b128 v[48:51], v69 offset:10240
 ds_read_b128 v[52:55], v69 offset:11264
 ds_read_b128 v[60:63], v75 offset:5120
 s_waitcnt lgkmcnt(3)
 v_mfma_f32_16x16x32_bf16 v[24:27], a[56:59], v[40:43], v[24:27]
 v_cvt_pk_bf16_f32 v64, v2, v3
 v_lshlrev_b32 v2, 16, v64
 v_mfma_f32_16x16x32_bf16 v[28:31], a[56:59], v[44:47], v[28:31]
 v_and_b32 v3, s75, v64
 v_mul_f32 v65, s76, v2
 v_mfma_f32_16x16x32_bf16 v[32:35], v[56:59], v[40:43], v[32:35]
 v_mul_f32 v66, s76, v3
 v_exp_f32 v65, v65
 v_mfma_f32_16x16x32_bf16 v[36:39], v[56:59], v[44:47], v[36:39]
 v_exp_f32 v66, v66
 v_cvt_pk_bf16_f32 v64, v6, v7
 ds_read_b128 v[40:43], v69 offset:12288
 ds_read_b128 v[44:47], v69 offset:13312
 ds_read_b128 v[56:59], v75 offset:6144
 s_waitcnt lgkmcnt(3)
 v_mfma_f32_16x16x32_bf16 v[24:27], a[60:63], v[48:51], v[24:27]
 v_add_f32 v65, 1.0, v65
 v_add_f32 v66, 1.0, v66
 v_mfma_f32_16x16x32_bf16 v[28:31], a[60:63], v[52:55], v[28:31]
 v_rcp_f32 v65, v65
 v_rcp_f32 v66, v66
 v_mfma_f32_16x16x32_bf16 v[32:35], v[60:63], v[48:51], v[32:35]
 v_lshlrev_b32 v6, 16, v64
 v_and_b32 v7, s75, v64
 v_mfma_f32_16x16x32_bf16 v[36:39], v[60:63], v[52:55], v[36:39]
 v_mul_f32 v2, v2, v65
 v_mul_f32 v3, v3, v66
 ds_read_b128 v[48:51], v69 offset:14336
 ds_read_b128 v[52:55], v69 offset:15360
 ds_read_b128 v[60:63], v75 offset:7168
 s_waitcnt lgkmcnt(3)
 v_mfma_f32_16x16x32_bf16 v[24:27], a[64:67], v[40:43], v[24:27]
 v_cvt_pk_bf16_f32 v64, v2, v3
 v_lshlrev_b32 v2, 16, v64
 v_mfma_f32_16x16x32_bf16 v[28:31], a[64:67], v[44:47], v[28:31]
 v_and_b32 v3, s75, v64
 v_mul_f32 v2, v2, v6
 v_mfma_f32_16x16x32_bf16 v[32:35], v[56:59], v[40:43], v[32:35]
 v_mul_f32 v3, v3, v7
 v_cvt_pk_bf16_f32 v5, v2, v3
 v_mfma_f32_16x16x32_bf16 v[36:39], v[56:59], v[44:47], v[36:39]
 ds_write_b64 v74, v[4:5] offset:0
 ds_read_b128 v[40:43], v69 offset:16384
 ds_read_b128 v[44:47], v69 offset:17408
 ds_read_b128 v[56:59], v75 offset:8192
 s_waitcnt lgkmcnt(3)
 v_mfma_f32_16x16x32_bf16 v[24:27], a[68:71], v[48:51], v[24:27]
 v_permlane16_swap_b32 v8, v12
 v_permlane16_swap_b32 v9, v13
 v_mfma_f32_16x16x32_bf16 v[28:31], a[68:71], v[52:55], v[28:31]
 v_permlane16_swap_b32 v10, v14
 v_permlane16_swap_b32 v11, v15
 v_mfma_f32_16x16x32_bf16 v[32:35], v[60:63], v[48:51], v[32:35]
 v_cvt_pk_bf16_f32 v64, v8, v9
 v_lshlrev_b32 v8, 16, v64
 v_mfma_f32_16x16x32_bf16 v[36:39], v[60:63], v[52:55], v[36:39]
 v_and_b32 v9, s75, v64
 v_mul_f32 v65, s76, v8
 ds_read_b128 v[48:51], v69 offset:18432
 ds_read_b128 v[52:55], v69 offset:19456
 ds_read_b128 v[60:63], v75 offset:9216
 s_waitcnt lgkmcnt(3)
 v_mfma_f32_16x16x32_bf16 v[24:27], a[72:75], v[40:43], v[24:27]
 v_mul_f32 v66, s76, v9
 v_exp_f32 v65, v65
 v_mfma_f32_16x16x32_bf16 v[28:31], a[72:75], v[44:47], v[28:31]
 v_exp_f32 v66, v66
 v_cvt_pk_bf16_f32 v64, v12, v13
 v_mfma_f32_16x16x32_bf16 v[32:35], v[56:59], v[40:43], v[32:35]
 v_add_f32 v65, 1.0, v65
 v_add_f32 v66, 1.0, v66
 v_mfma_f32_16x16x32_bf16 v[36:39], v[56:59], v[44:47], v[36:39]
 v_rcp_f32 v65, v65
 v_rcp_f32 v66, v66
 ds_read_b128 v[40:43], v69 offset:20480
 ds_read_b128 v[44:47], v69 offset:21504
 ds_read_b128 v[56:59], v75 offset:10240
 s_waitcnt lgkmcnt(3)
 v_mfma_f32_16x16x32_bf16 v[24:27], a[76:79], v[48:51], v[24:27]
 v_lshlrev_b32 v12, 16, v64
 v_and_b32 v13, s75, v64
 v_mfma_f32_16x16x32_bf16 v[28:31], a[76:79], v[52:55], v[28:31]
 v_mul_f32 v8, v8, v65
 v_mul_f32 v9, v9, v66
 v_mfma_f32_16x16x32_bf16 v[32:35], v[60:63], v[48:51], v[32:35]
 v_cvt_pk_bf16_f32 v64, v8, v9
 v_lshlrev_b32 v8, 16, v64
 v_mfma_f32_16x16x32_bf16 v[36:39], v[60:63], v[52:55], v[36:39]
 v_and_b32 v9, s75, v64
 v_mul_f32 v8, v8, v12
 ds_read_b128 v[48:51], v69 offset:22528
 ds_read_b128 v[52:55], v69 offset:23552
 ds_read_b128 v[60:63], v75 offset:11264
 s_waitcnt lgkmcnt(3)
 v_mfma_f32_16x16x32_bf16 v[24:27], a[80:83], v[40:43], v[24:27]
 v_mul_f32 v9, v9, v13
 v_cvt_pk_bf16_f32 v12, v8, v9
 v_mfma_f32_16x16x32_bf16 v[28:31], a[80:83], v[44:47], v[28:31]
 v_cvt_pk_bf16_f32 v64, v10, v11
 v_lshlrev_b32 v10, 16, v64
 v_mfma_f32_16x16x32_bf16 v[32:35], v[56:59], v[40:43], v[32:35]
 v_and_b32 v11, s75, v64
 v_mul_f32 v65, s76, v10
 v_mfma_f32_16x16x32_bf16 v[36:39], v[56:59], v[44:47], v[36:39]
 v_mul_f32 v66, s76, v11
 v_exp_f32 v65, v65
 ds_read_b128 v[40:43], v69 offset:24576
 ds_read_b128 v[44:47], v69 offset:25600
 ds_read_b128 v[56:59], v75 offset:12288
 s_waitcnt lgkmcnt(3)
 v_mfma_f32_16x16x32_bf16 v[24:27], a[84:87], v[48:51], v[24:27]
 v_exp_f32 v66, v66
 v_cvt_pk_bf16_f32 v64, v14, v15
 v_mfma_f32_16x16x32_bf16 v[28:31], a[84:87], v[52:55], v[28:31]
 v_add_f32 v65, 1.0, v65
 v_add_f32 v66, 1.0, v66
 v_mfma_f32_16x16x32_bf16 v[32:35], v[60:63], v[48:51], v[32:35]
 v_rcp_f32 v65, v65
 v_rcp_f32 v66, v66
 v_mfma_f32_16x16x32_bf16 v[36:39], v[60:63], v[52:55], v[36:39]
 v_lshlrev_b32 v14, 16, v64
 v_and_b32 v15, s75, v64
 ds_read_b128 v[48:51], v69 offset:26624
 ds_read_b128 v[52:55], v69 offset:27648
 ds_read_b128 v[60:63], v75 offset:13312
 s_waitcnt lgkmcnt(3)
 v_mfma_f32_16x16x32_bf16 v[24:27], a[88:91], v[40:43], v[24:27]
 v_mul_f32 v10, v10, v65
 v_mul_f32 v11, v11, v66
 v_mfma_f32_16x16x32_bf16 v[28:31], a[88:91], v[44:47], v[28:31]
 v_cvt_pk_bf16_f32 v64, v10, v11
 v_lshlrev_b32 v10, 16, v64
 v_mfma_f32_16x16x32_bf16 v[32:35], v[56:59], v[40:43], v[32:35]
 v_and_b32 v11, s75, v64
 v_mul_f32 v10, v10, v14
 v_mfma_f32_16x16x32_bf16 v[36:39], v[56:59], v[44:47], v[36:39]
 v_mul_f32 v11, v11, v15
 v_cvt_pk_bf16_f32 v13, v10, v11
 ds_write_b64 v74, v[12:13] offset:512
 ds_read_b128 v[40:43], v69 offset:28672
 ds_read_b128 v[44:47], v69 offset:29696
 ds_read_b128 v[56:59], v75 offset:14336
 s_waitcnt lgkmcnt(3)
 v_mfma_f32_16x16x32_bf16 v[24:27], a[92:95], v[48:51], v[24:27]
 v_permlane16_swap_b32 v16, v20
 v_permlane16_swap_b32 v17, v21
 v_mfma_f32_16x16x32_bf16 v[28:31], a[92:95], v[52:55], v[28:31]
 v_permlane16_swap_b32 v18, v22
 v_permlane16_swap_b32 v19, v23
 v_mfma_f32_16x16x32_bf16 v[32:35], v[60:63], v[48:51], v[32:35]
 v_cvt_pk_bf16_f32 v64, v16, v17
 v_lshlrev_b32 v16, 16, v64
 v_mfma_f32_16x16x32_bf16 v[36:39], v[60:63], v[52:55], v[36:39]
 v_and_b32 v17, s75, v64
 v_mul_f32 v65, s76, v16
 ds_read_b128 v[48:51], v69 offset:30720
 ds_read_b128 v[52:55], v69 offset:31744
 ds_read_b128 v[60:63], v75 offset:15360
 s_waitcnt lgkmcnt(3)
 v_mfma_f32_16x16x32_bf16 v[24:27], a[96:99], v[40:43], v[24:27]
 v_mul_f32 v66, s76, v17
 v_exp_f32 v65, v65
 v_mfma_f32_16x16x32_bf16 v[28:31], a[96:99], v[44:47], v[28:31]
 v_exp_f32 v66, v66
 v_cvt_pk_bf16_f32 v64, v20, v21
 v_mfma_f32_16x16x32_bf16 v[32:35], v[56:59], v[40:43], v[32:35]
 v_add_f32 v65, 1.0, v65
 v_add_f32 v66, 1.0, v66
 v_mfma_f32_16x16x32_bf16 v[36:39], v[56:59], v[44:47], v[36:39]
 v_rcp_f32 v65, v65
 v_rcp_f32 v66, v66
 ds_read_b128 v[40:43], v69 offset:32768
 ds_read_b128 v[44:47], v69 offset:33792
 ds_read_b128 v[56:59], v75 offset:16384
 s_waitcnt lgkmcnt(3)
 v_mfma_f32_16x16x32_bf16 v[24:27], a[100:103], v[48:51], v[24:27]
 v_lshlrev_b32 v20, 16, v64
 v_and_b32 v21, s75, v64
 v_mfma_f32_16x16x32_bf16 v[28:31], a[100:103], v[52:55], v[28:31]
 v_mul_f32 v16, v16, v65
 v_mul_f32 v17, v17, v66
 v_mfma_f32_16x16x32_bf16 v[32:35], v[60:63], v[48:51], v[32:35]
 v_cvt_pk_bf16_f32 v64, v16, v17
 v_lshlrev_b32 v16, 16, v64
 v_mfma_f32_16x16x32_bf16 v[36:39], v[60:63], v[52:55], v[36:39]
 v_and_b32 v17, s75, v64
 v_mul_f32 v16, v16, v20
 ds_read_b128 v[48:51], v69 offset:34816
 ds_read_b128 v[52:55], v69 offset:35840
 ds_read_b128 v[60:63], v75 offset:17408
 s_waitcnt lgkmcnt(3)
 v_mfma_f32_16x16x32_bf16 v[24:27], a[104:107], v[40:43], v[24:27]
 v_mul_f32 v17, v17, v21
 v_cvt_pk_bf16_f32 v20, v16, v17
 v_mfma_f32_16x16x32_bf16 v[28:31], a[104:107], v[44:47], v[28:31]
 v_cvt_pk_bf16_f32 v64, v18, v19
 v_lshlrev_b32 v18, 16, v64
 v_mfma_f32_16x16x32_bf16 v[32:35], v[56:59], v[40:43], v[32:35]
 v_and_b32 v19, s75, v64
 v_mul_f32 v65, s76, v18
 v_mfma_f32_16x16x32_bf16 v[36:39], v[56:59], v[44:47], v[36:39]
 v_mul_f32 v66, s76, v19
 v_exp_f32 v65, v65
 s_waitcnt lgkmcnt(0)
 v_mfma_f32_16x16x32_bf16 v[24:27], a[108:111], v[48:51], v[24:27]
 v_exp_f32 v66, v66
 v_cvt_pk_bf16_f32 v64, v22, v23
 v_mfma_f32_16x16x32_bf16 v[28:31], a[108:111], v[52:55], v[28:31]
 v_add_f32 v65, 1.0, v65
 v_add_f32 v66, 1.0, v66
 v_mfma_f32_16x16x32_bf16 v[32:35], v[60:63], v[48:51], v[32:35]
 v_rcp_f32 v65, v65
 v_rcp_f32 v66, v66
 v_mfma_f32_16x16x32_bf16 v[36:39], v[60:63], v[52:55], v[36:39]
 v_lshlrev_b32 v22, 16, v64
 v_and_b32 v23, s75, v64
 v_mul_f32 v18, v18, v65
 v_mul_f32 v19, v19, v66
 v_cvt_pk_bf16_f32 v64, v18, v19
 v_lshlrev_b32 v18, 16, v64
 v_and_b32 v19, s75, v64
 v_mul_f32 v18, v18, v22
 v_mul_f32 v19, v19, v23
 v_cvt_pk_bf16_f32 v21, v18, v19
 ds_write_b64 v74, v[20:21] offset:1024
 s_nop 7
 v_permlane16_swap_b32 v24, v28
 v_permlane16_swap_b32 v25, v29
 v_permlane16_swap_b32 v26, v30
 v_permlane16_swap_b32 v27, v31
 v_cvt_pk_bf16_f32 v64, v24, v25
 v_lshlrev_b32 v24, 16, v64
 v_and_b32 v25, s75, v64
 v_mul_f32 v65, s76, v24
 v_mul_f32 v66, s76, v25
 v_exp_f32 v65, v65
 v_exp_f32 v66, v66
 v_cvt_pk_bf16_f32 v64, v28, v29
 v_add_f32 v65, 1.0, v65
 v_add_f32 v66, 1.0, v66
 v_rcp_f32 v65, v65
 v_rcp_f32 v66, v66
 v_lshlrev_b32 v28, 16, v64
 v_and_b32 v29, s75, v64
 v_mul_f32 v24, v24, v65
 v_mul_f32 v25, v25, v66
 v_cvt_pk_bf16_f32 v64, v24, v25
 v_lshlrev_b32 v24, 16, v64
 v_and_b32 v25, s75, v64
 v_mul_f32 v24, v24, v28
 v_mul_f32 v25, v25, v29
 v_cvt_pk_bf16_f32 v28, v24, v25
 v_cvt_pk_bf16_f32 v64, v26, v27
 v_lshlrev_b32 v26, 16, v64
 v_and_b32 v27, s75, v64
 v_mul_f32 v65, s76, v26
 v_mul_f32 v66, s76, v27
 v_exp_f32 v65, v65
 v_exp_f32 v66, v66
 v_cvt_pk_bf16_f32 v64, v30, v31
 v_add_f32 v65, 1.0, v65
 v_add_f32 v66, 1.0, v66
 v_rcp_f32 v65, v65
 v_rcp_f32 v66, v66
 v_lshlrev_b32 v30, 16, v64
 v_and_b32 v31, s75, v64
 v_mul_f32 v26, v26, v65
 v_mul_f32 v27, v27, v66
 v_cvt_pk_bf16_f32 v64, v26, v27
 v_lshlrev_b32 v26, 16, v64
 v_and_b32 v27, s75, v64
 v_mul_f32 v26, v26, v30
 v_mul_f32 v27, v27, v31
 v_cvt_pk_bf16_f32 v29, v26, v27
 ds_write_b64 v74, v[28:29] offset:1536
 s_cmp_eq_u32 s69, 0
 s_cbranch_scc1 L159
 v_permlane16_swap_b32 v32, v36
 v_permlane16_swap_b32 v33, v37
 v_permlane16_swap_b32 v34, v38
 v_permlane16_swap_b32 v35, v39
 v_cvt_pk_bf16_f32 v64, v32, v33
 v_lshlrev_b32 v32, 16, v64
 v_and_b32 v33, s75, v64
 v_mul_f32 v65, s76, v32
 v_mul_f32 v66, s76, v33
 v_exp_f32 v65, v65
 v_exp_f32 v66, v66
 v_cvt_pk_bf16_f32 v64, v36, v37
 v_add_f32 v65, 1.0, v65
 v_add_f32 v66, 1.0, v66
 v_rcp_f32 v65, v65
 v_rcp_f32 v66, v66
 v_lshlrev_b32 v36, 16, v64
 v_and_b32 v37, s75, v64
 v_mul_f32 v32, v32, v65
 v_mul_f32 v33, v33, v66
 v_cvt_pk_bf16_f32 v64, v32, v33
 v_lshlrev_b32 v32, 16, v64
 v_and_b32 v33, s75, v64
 v_mul_f32 v32, v32, v36
 v_mul_f32 v33, v33, v37
 v_cvt_pk_bf16_f32 v36, v32, v33
 v_cvt_pk_bf16_f32 v64, v34, v35
 v_lshlrev_b32 v34, 16, v64
 v_and_b32 v35, s75, v64
 v_mul_f32 v65, s76, v34
 v_mul_f32 v66, s76, v35
 v_exp_f32 v65, v65
 v_exp_f32 v66, v66
 v_cvt_pk_bf16_f32 v64, v38, v39
 v_add_f32 v65, 1.0, v65
 v_add_f32 v66, 1.0, v66
 v_rcp_f32 v65, v65
 v_rcp_f32 v66, v66
 v_lshlrev_b32 v38, 16, v64
 v_and_b32 v39, s75, v64
 v_mul_f32 v34, v34, v65
 v_mul_f32 v35, v35, v66
 v_cvt_pk_bf16_f32 v64, v34, v35
 v_lshlrev_b32 v34, 16, v64
 v_and_b32 v35, s75, v64
 v_mul_f32 v34, v34, v38
 v_mul_f32 v35, v35, v39
 v_cvt_pk_bf16_f32 v37, v34, v35
 ds_write_b64 v74, v[36:37] offset:2048
L159:
 s_waitcnt lgkmcnt(0)
 s_barrier
 s_mul_i32 s60, s65, 1
 s_and_b32 s60, s60, 0
 s_lshl_b32 s61, s47, 1
 s_add_u32 s60, s60, s61
 s_mul_i32 s70, s60, 1179648
 s_add_u32 s70, s70, 94371840
 s_lshl_b32 s63, s68, 6
 ds_read_b128 v[0:3], v69 offset:36864
 ds_read_b128 v[4:7], v69 offset:37888
 ds_read_b128 v[8:11], v69 offset:38912
 ds_read_b128 v[12:15], v69 offset:39936
 ds_read_b128 v[16:19], v69 offset:40960
 ds_read_b128 v[20:23], v69 offset:41984
 ds_read_b128 v[24:27], v69 offset:43008
 ds_read_b128 v[28:31], v69 offset:44032
 ds_read_b128 v[32:35], v69 offset:45056
 s_waitcnt lgkmcnt(8)
 v_mfma_f32_32x32x16_bf16 v[36:51], a[112:115], v[0:3], 0
 s_waitcnt lgkmcnt(7)
 v_mfma_f32_32x32x16_bf16 v[36:51], a[116:119], v[4:7], v[36:51]
 s_waitcnt lgkmcnt(6)
 v_mfma_f32_32x32x16_bf16 v[36:51], a[120:123], v[8:11], v[36:51]
 s_waitcnt lgkmcnt(5)
 v_mfma_f32_32x32x16_bf16 v[36:51], a[124:127], v[12:15], v[36:51]
 s_waitcnt lgkmcnt(4)
 v_mfma_f32_32x32x16_bf16 v[36:51], a[128:131], v[16:19], v[36:51]
 s_waitcnt lgkmcnt(3)
 v_mfma_f32_32x32x16_bf16 v[36:51], a[132:135], v[20:23], v[36:51]
 s_waitcnt lgkmcnt(2)
 v_mfma_f32_32x32x16_bf16 v[36:51], a[136:139], v[24:27], v[36:51]
 s_waitcnt lgkmcnt(1)
 v_mfma_f32_32x32x16_bf16 v[36:51], a[140:143], v[28:31], v[36:51]
 s_waitcnt lgkmcnt(0)
 v_mfma_f32_32x32x16_bf16 v[36:51], a[144:147], v[32:35], v[36:51]
 v_mfma_f32_32x32x16_bf16 v[52:67], a[148:151], v[0:3], 0
 v_mfma_f32_32x32x16_bf16 v[52:67], a[152:155], v[4:7], v[52:67]
 v_cvt_pk_bf16_f32 v36, v36, v37
 v_cvt_pk_bf16_f32 v37, v38, v39
 v_cvt_pk_bf16_f32 v38, v40, v41
 v_cvt_pk_bf16_f32 v39, v42, v43
 v_cvt_pk_bf16_f32 v40, v44, v45
 v_cvt_pk_bf16_f32 v41, v46, v47
 v_cvt_pk_bf16_f32 v42, v48, v49
 v_cvt_pk_bf16_f32 v43, v50, v51
 s_add_u32 s60, s63, 0
 v_add_u32 v44, s60, v70
 ds_write_b128 v44, v[36:39] offset:0
 ds_write_b128 v44, v[40:43] offset:32
 v_mfma_f32_32x32x16_bf16 v[52:67], a[156:159], v[8:11], v[52:67]
 v_mfma_f32_32x32x16_bf16 v[52:67], a[160:163], v[12:15], v[52:67]
 v_mfma_f32_32x32x16_bf16 v[52:67], a[164:167], v[16:19], v[52:67]
 v_mfma_f32_32x32x16_bf16 v[52:67], a[168:171], v[20:23], v[52:67]
 v_mfma_f32_32x32x16_bf16 v[52:67], a[172:175], v[24:27], v[52:67]
 v_mfma_f32_32x32x16_bf16 v[52:67], a[176:179], v[28:31], v[52:67]
 v_mfma_f32_32x32x16_bf16 v[52:67], a[180:183], v[32:35], v[52:67]
 v_mfma_f32_32x32x16_bf16 v[36:51], a[184:187], v[0:3], 0
 v_mfma_f32_32x32x16_bf16 v[36:51], a[188:191], v[4:7], v[36:51]
 v_cvt_pk_bf16_f32 v52, v52, v53
 v_cvt_pk_bf16_f32 v53, v54, v55
 v_cvt_pk_bf16_f32 v54, v56, v57
 v_cvt_pk_bf16_f32 v55, v58, v59
 v_cvt_pk_bf16_f32 v56, v60, v61
 v_cvt_pk_bf16_f32 v57, v62, v63
 v_cvt_pk_bf16_f32 v58, v64, v65
 v_cvt_pk_bf16_f32 v59, v66, v67
 s_add_u32 s60, s63, 64
 v_add_u32 v60, s60, v70
 ds_write_b128 v60, v[52:55] offset:0
 ds_write_b128 v60, v[56:59] offset:32
 v_mfma_f32_32x32x16_bf16 v[36:51], a[192:195], v[8:11], v[36:51]
 v_mfma_f32_32x32x16_bf16 v[36:51], a[196:199], v[12:15], v[36:51]
 v_mfma_f32_32x32x16_bf16 v[36:51], a[200:203], v[16:19], v[36:51]
 v_mfma_f32_32x32x16_bf16 v[36:51], a[204:207], v[20:23], v[36:51]
 v_mfma_f32_32x32x16_bf16 v[36:51], a[208:211], v[24:27], v[36:51]
 v_mfma_f32_32x32x16_bf16 v[36:51], a[212:215], v[28:31], v[36:51]
 v_mfma_f32_32x32x16_bf16 v[36:51], a[216:219], v[32:35], v[36:51]
 v_mfma_f32_32x32x16_bf16 v[52:67], a[220:223], v[0:3], 0
 v_mfma_f32_32x32x16_bf16 v[52:67], a[224:227], v[4:7], v[52:67]
 v_cvt_pk_bf16_f32 v36, v36, v37
 v_cvt_pk_bf16_f32 v37, v38, v39
 v_cvt_pk_bf16_f32 v38, v40, v41
 v_cvt_pk_bf16_f32 v39, v42, v43
 v_cvt_pk_bf16_f32 v40, v44, v45
 v_cvt_pk_bf16_f32 v41, v46, v47
 v_cvt_pk_bf16_f32 v42, v48, v49
 v_cvt_pk_bf16_f32 v43, v50, v51
 s_add_u32 s60, s63, 128
 v_add_u32 v44, s60, v70
 ds_write_b128 v44, v[36:39] offset:0
 ds_write_b128 v44, v[40:43] offset:32
 v_mfma_f32_32x32x16_bf16 v[52:67], a[228:231], v[8:11], v[52:67]
 v_mfma_f32_32x32x16_bf16 v[52:67], a[232:235], v[12:15], v[52:67]
 v_mfma_f32_32x32x16_bf16 v[52:67], a[236:239], v[16:19], v[52:67]
 v_mfma_f32_32x32x16_bf16 v[52:67], a[240:243], v[20:23], v[52:67]
 v_mfma_f32_32x32x16_bf16 v[52:67], a[244:247], v[24:27], v[52:67]
 v_mfma_f32_32x32x16_bf16 v[52:67], a[248:251], v[28:31], v[52:67]
 v_mfma_f32_32x32x16_bf16 v[52:67], a[252:255], v[32:35], v[52:67]
 s_cmp_eq_u32 s69, 1
 s_cbranch_scc1 L161
 s_nop 7
 s_nop 3
 v_cvt_pk_bf16_f32 v52, v52, v53
 v_cvt_pk_bf16_f32 v53, v54, v55
 v_cvt_pk_bf16_f32 v54, v56, v57
 v_cvt_pk_bf16_f32 v55, v58, v59
 v_cvt_pk_bf16_f32 v56, v60, v61
 v_cvt_pk_bf16_f32 v57, v62, v63
 v_cvt_pk_bf16_f32 v58, v64, v65
 v_cvt_pk_bf16_f32 v59, v66, v67
 s_add_u32 s60, s63, 192
 v_add_u32 v60, s60, v70
 ds_write_b128 v60, v[52:55] offset:0
 ds_write_b128 v60, v[56:59] offset:32
 ds_read_b128 v[60:63], v75
 ds_read_b128 v[64:67], v75 offset:1024
 s_waitcnt lgkmcnt(1)
 v_mfma_f32_32x32x16_bf16 v[36:51], v[60:63], v[0:3], 0
 ds_read_b128 v[60:63], v75 offset:2048
 s_waitcnt lgkmcnt(1)
 v_mfma_f32_32x32x16_bf16 v[36:51], v[64:67], v[4:7], v[36:51]
 ds_read_b128 v[64:67], v75 offset:3072
 s_waitcnt lgkmcnt(1)
 v_mfma_f32_32x32x16_bf16 v[36:51], v[60:63], v[8:11], v[36:51]
 ds_read_b128 v[60:63], v75 offset:4096
 s_waitcnt lgkmcnt(1)
 v_mfma_f32_32x32x16_bf16 v[36:51], v[64:67], v[12:15], v[36:51]
 ds_read_b128 v[64:67], v75 offset:5120
 s_waitcnt lgkmcnt(1)
 v_mfma_f32_32x32x16_bf16 v[36:51], v[60:63], v[16:19], v[36:51]
 ds_read_b128 v[60:63], v75 offset:6144
 s_waitcnt lgkmcnt(1)
 v_mfma_f32_32x32x16_bf16 v[36:51], v[64:67], v[20:23], v[36:51]
 ds_read_b128 v[64:67], v75 offset:7168
 s_waitcnt lgkmcnt(1)
 v_mfma_f32_32x32x16_bf16 v[36:51], v[60:63], v[24:27], v[36:51]
 ds_read_b128 v[60:63], v75 offset:8192
 s_waitcnt lgkmcnt(1)
 v_mfma_f32_32x32x16_bf16 v[36:51], v[64:67], v[28:31], v[36:51]
 s_waitcnt lgkmcnt(0)
 v_mfma_f32_32x32x16_bf16 v[36:51], v[60:63], v[32:35], v[36:51]
 s_nop 7
 s_nop 3
 v_cvt_pk_bf16_f32 v36, v36, v37
 v_cvt_pk_bf16_f32 v37, v38, v39
 v_cvt_pk_bf16_f32 v38, v40, v41
 v_cvt_pk_bf16_f32 v39, v42, v43
 v_cvt_pk_bf16_f32 v40, v44, v45
 v_cvt_pk_bf16_f32 v41, v46, v47
 v_cvt_pk_bf16_f32 v42, v48, v49
 v_cvt_pk_bf16_f32 v43, v50, v51
 s_add_u32 s60, s63, 256
 v_add_u32 v44, s60, v70
 ds_write_b128 v44, v[36:39] offset:0
 ds_write_b128 v44, v[40:43] offset:32
 s_branch L160
L161:
 s_nop 7
 s_nop 3
 v_cvt_pk_bf16_f32 v52, v52, v53
 v_cvt_pk_bf16_f32 v53, v54, v55
 v_cvt_pk_bf16_f32 v54, v56, v57
 v_cvt_pk_bf16_f32 v55, v58, v59
 v_cvt_pk_bf16_f32 v56, v60, v61
 v_cvt_pk_bf16_f32 v57, v62, v63
 v_cvt_pk_bf16_f32 v58, v64, v65
 v_cvt_pk_bf16_f32 v59, v66, v67
 s_add_u32 s60, s63, 192
 v_add_u32 v60, s60, v70
 ds_write_b128 v60, v[52:55] offset:0
 ds_write_b128 v60, v[56:59] offset:32
L160:
 s_waitcnt lgkmcnt(0)
 s_barrier
 s_mul_i32 s60, s44, 9344
 s_add_u32 s60, s60, 112640
 v_add_u32 v36, s60, v69
 ds_read_b128 v[0:3], v36 offset:0
 ds_read_b128 v[4:7], v36 offset:1168
 ds_read_b128 v[8:11], v36 offset:2336
 ds_read_b128 v[12:15], v36 offset:3504
 ds_read_b128 v[16:19], v36 offset:4672
 ds_read_b128 v[20:23], v36 offset:5840
 ds_read_b128 v[24:27], v36 offset:7008
 ds_read_b128 v[28:31], v36 offset:8176
 v_lshrrev_b32 v37, 3, v68
 s_lshl_b32 s61, s44, 3
 v_add_u32 v37, s61, v37
 v_and_b32 v38, 7, v68
 v_lshlrev_b32 v38, 4, v38
 v_add_u32 v38, 1024, v38
 v_mul_u32_u24 v39, 1168, v37
 v_add_u32 v39, v39, v38
 v_add_u32 v39, 112640, v39
 ds_read_b128 v[32:35], v39
 v_mul_u32_u24 v37, 36864, v37
 v_add_u32 v38, v38, v37
 s_mul_i32 s60, s44, 294912
 s_mul_i32 s61, s46, 1152
 s_add_u32 s60, s60, s61
 s_add_u32 s60, s60, s70
 s_add_u32 s61, s61, s70
 s_waitcnt lgkmcnt(8)
 buffer_store_dwordx4 v[0:3], v69, s[4:7], s60 offen sc1
 s_add_u32 s60, s60, 36864
 s_waitcnt lgkmcnt(7)
 buffer_store_dwordx4 v[4:7], v69, s[4:7], s60 offen sc1
 s_add_u32 s60, s60, 36864
 s_waitcnt lgkmcnt(6)
 buffer_store_dwordx4 v[8:11], v69, s[4:7], s60 offen sc1
 s_add_u32 s60, s60, 36864
 s_waitcnt lgkmcnt(5)
 buffer_store_dwordx4 v[12:15], v69, s[4:7], s60 offen sc1
 s_add_u32 s60, s60, 36864
 s_waitcnt lgkmcnt(4)
 buffer_store_dwordx4 v[16:19], v69, s[4:7], s60 offen sc1
 s_add_u32 s60, s60, 36864
 s_waitcnt lgkmcnt(3)
 buffer_store_dwordx4 v[20:23], v69, s[4:7], s60 offen sc1
 s_add_u32 s60, s60, 36864
 s_waitcnt lgkmcnt(2)
 buffer_store_dwordx4 v[24:27], v69, s[4:7], s60 offen sc1
 s_add_u32 s60, s60, 36864
 s_waitcnt lgkmcnt(1)
 buffer_store_dwordx4 v[28:31], v69, s[4:7], s60 offen sc1
 s_waitcnt lgkmcnt(0)
 buffer_store_dwordx4 v[32:35], v38, s[4:7], s61 offen sc1
 s_add_u32 s65, s65, 1
 s_waitcnt vmcnt(0)
 s_barrier
 s_cmp_eq_u32 s44, 0
 s_cbranch_scc0 L162
 v_mov_b32 v6, 0
 v_mov_b32 v7, s65
 s_mov_b64 exec, 1
 buffer_store_dword v7, v6, s[4:7], s71 offen sc1
 s_mov_b64 exec, -1
L162:
 v_and_b32 v0, 31, v68
 v_lshlrev_b32 v0, 2, v0
L163:
 buffer_load_dword v1, v0, s[4:7], s72 offen sc1
 s_waitcnt vmcnt(0)
 v_cmp_gt_u32 vcc, s65, v1
 s_cbranch_vccnz L163
 s_mov_b32 s73, s70
 s_add_u32 s74, s70, 4608
 buffer_load_dwordx4 v[0:3], v71, s[4:7], s73 offen offset:0 sc1
 buffer_load_dwordx4 v[4:7], v71, s[4:7], s74 offen offset:0 sc1
 buffer_load_dwordx4 v[8:11], v71, s[4:7], s73 offen offset:256 sc1
 buffer_load_dwordx4 v[12:15], v71, s[4:7], s74 offen offset:256 sc1
 buffer_load_dwordx4 v[16:19], v71, s[4:7], s73 offen offset:512 sc1
 buffer_load_dwordx4 v[20:23], v71, s[4:7], s74 offen offset:512 sc1
 buffer_load_dwordx4 v[24:27], v71, s[4:7], s73 offen offset:768 sc1
 buffer_load_dwordx4 v[28:31], v71, s[4:7], s74 offen offset:768 sc1
 buffer_load_dwordx4 v[32:35], v71, s[4:7], s73 offen offset:1024 sc1
 buffer_load_dwordx4 v[36:39], v71, s[4:7], s74 offen offset:1024 sc1
 s_waitcnt vmcnt(9)
 v_mfma_f32_16x16x32_bf16 v[40:43], v[0:3], v[76:79], 0
 s_waitcnt vmcnt(8)
 v_mfma_f32_16x16x32_bf16 v[40:43], v[4:7], v[76:79], v[40:43]
 s_waitcnt vmcnt(7)
 v_mfma_f32_16x16x32_bf16 v[44:47], v[8:11], v[76:79], 0
 s_waitcnt vmcnt(6)
 v_mfma_f32_16x16x32_bf16 v[44:47], v[12:15], v[76:79], v[44:47]
 s_waitcnt vmcnt(5)
 v_mfma_f32_16x16x32_bf16 v[48:51], v[16:19], v[76:79], 0
 s_waitcnt vmcnt(4)
 v_mfma_f32_16x16x32_bf16 v[48:51], v[20:23], v[76:79], v[48:51]
 s_waitcnt vmcnt(3)
 v_mfma_f32_16x16x32_bf16 v[52:55], v[24:27], v[76:79], 0
 s_waitcnt vmcnt(2)
 v_mfma_f32_16x16x32_bf16 v[52:55], v[28:31], v[76:79], v[52:55]
 s_waitcnt vmcnt(1)
 v_mfma_f32_16x16x32_bf16 v[56:59], v[32:35], v[76:79], 0
 s_waitcnt vmcnt(0)
 v_mfma_f32_16x16x32_bf16 v[56:59], v[36:39], v[76:79], v[56:59]
 s_nop 7
 s_mov_b32 exec_lo, 0x00ff00ff
 s_mov_b32 exec_hi, 0x00ff00ff
 ds_write_b32 v72, v40 offset:46080
 ds_write_b32 v72, v41 offset:46096
 ds_write_b32 v72, v42 offset:46144
 ds_write_b32 v72, v43 offset:46160
 ds_write_b32 v72, v44 offset:46592
 ds_write_b32 v72, v45 offset:46608
 ds_write_b32 v72, v46 offset:46656
 ds_write_b32 v72, v47 offset:46672
 ds_write_b32 v72, v48 offset:47104
 ds_write_b32 v72, v49 offset:47120
 ds_write_b32 v72, v50 offset:47168
 ds_write_b32 v72, v51 offset:47184
 ds_write_b32 v72, v52 offset:47616
 ds_write_b32 v72, v53 offset:47632
 ds_write_b32 v72, v54 offset:47680
 ds_write_b32 v72, v55 offset:47696
 s_mov_b32 exec_hi, 0
 ds_write_b32 v72, v56 offset:48128
 ds_write_b32 v72, v57 offset:48144
 ds_write_b32 v72, v58 offset:48192
 ds_write_b32 v72, v59 offset:48208
 s_mov_b64 exec, -1
 s_waitcnt lgkmcnt(0)
 s_barrier
 s_cmp_eq_u32 s44, 1
 s_cbranch_scc0 L164
 s_add_u32 s60, s71, 128
 v_mov_b32 v60, 0
 v_mov_b32 v61, s65
 s_mov_b64 exec, 1
 buffer_store_dword v61, v60, s[4:7], s60 offen sc1
 s_mov_b64 exec, -1
L164:
 s_cmp_eq_u32 s44, 0
 s_cbranch_scc0 L165
 s_lshl_b32 s60, s64, 5
 s_add_u32 s60, s60, s46
 s_mul_i32 s60, s60, 1152
 v_add_u32 v40, 151552, v69
 ds_read_b128 v[32:35], v40
 ds_read_b128 v[36:39], v40 offset:1024
 ds_read_b128 v[0:3], v73 offset:46080
 ds_read_b128 v[4:7], v73 offset:46096
 ds_read_b128 v[16:19], v73 offset:48384
 ds_read_b128 v[20:23], v73 offset:48400
 s_waitcnt lgkmcnt(0)
 v_pk_add_f32 v[0:1], v[0:1], v[16:17]
 v_pk_add_f32 v[2:3], v[2:3], v[18:19]
 v_pk_add_f32 v[4:5], v[4:5], v[20:21]
 v_pk_add_f32 v[6:7], v[6:7], v[22:23]
 ds_read_b128 v[16:19], v73 offset:50688
 ds_read_b128 v[20:23], v73 offset:50704
 s_waitcnt lgkmcnt(0)
 v_pk_add_f32 v[0:1], v[0:1], v[16:17]
 v_pk_add_f32 v[2:3], v[2:3], v[18:19]
 v_pk_add_f32 v[4:5], v[4:5], v[20:21]
 v_pk_add_f32 v[6:7], v[6:7], v[22:23]
 ds_read_b128 v[16:19], v73 offset:52992
 ds_read_b128 v[20:23], v73 offset:53008
 s_waitcnt lgkmcnt(0)
 v_pk_add_f32 v[0:1], v[0:1], v[16:17]
 v_pk_add_f32 v[2:3], v[2:3], v[18:19]
 v_pk_add_f32 v[4:5], v[4:5], v[20:21]
 v_pk_add_f32 v[6:7], v[6:7], v[22:23]
 v_mov_b32 v8, 0
 v_mov_b32 v9, 0
 v_mov_b32 v10, 0
 v_mov_b32 v11, 0
 v_mov_b32 v12, 0
 v_mov_b32 v13, 0
 v_mov_b32 v14, 0
 v_mov_b32 v15, 0
 s_mov_b64 exec, 0xff
 ds_read_b128 v[8:11], v73 offset:48128
 ds_read_b128 v[12:15], v73 offset:48144
 ds_read_b128 v[16:19], v73 offset:50432
 ds_read_b128 v[20:23], v73 offset:50448
 s_waitcnt lgkmcnt(0)
 v_pk_add_f32 v[8:9], v[8:9], v[16:17]
 v_pk_add_f32 v[10:11], v[10:11], v[18:19]
 v_pk_add_f32 v[12:13], v[12:13], v[20:21]
 v_pk_add_f32 v[14:15], v[14:15], v[22:23]
 ds_read_b128 v[16:19], v73 offset:52736
 ds_read_b128 v[20:23], v73 offset:52752
 s_waitcnt lgkmcnt(0)
 v_pk_add_f32 v[8:9], v[8:9], v[16:17]
 v_pk_add_f32 v[10:11], v[10:11], v[18:19]
 v_pk_add_f32 v[12:13], v[12:13], v[20:21]
 v_pk_add_f32 v[14:15], v[14:15], v[22:23]
 ds_read_b128 v[16:19], v73 offset:55040
 ds_read_b128 v[20:23], v73 offset:55056
 s_waitcnt lgkmcnt(0)
 v_pk_add_f32 v[8:9], v[8:9], v[16:17]
 v_pk_add_f32 v[10:11], v[10:11], v[18:19]
 v_pk_add_f32 v[12:13], v[12:13], v[20:21]
 v_pk_add_f32 v[14:15], v[14:15], v[22:23]
 s_mov_b64 exec, -1
 s_waitcnt lgkmcnt(0)
 v_cvt_pk_bf16_f32 v40, v0, v1
 v_lshlrev_b32 v0, 16, v40
 v_and_b32 v1, s75, v40
 v_lshlrev_b32 v41, 16, v32
 v_and_b32 v42, s75, v32
 v_add_f32 v0, v0, v41
 v_add_f32 v1, v1, v42
 v_cvt_pk_bf16_f32 v44, v0, v1
 v_cvt_pk_bf16_f32 v40, v2, v3
 v_lshlrev_b32 v2, 16, v40
 v_and_b32 v3, s75, v40
 v_lshlrev_b32 v41, 16, v33
 v_and_b32 v42, s75, v33
 v_add_f32 v2, v2, v41
 v_add_f32 v3, v3, v42
 v_cvt_pk_bf16_f32 v45, v2, v3
 v_cvt_pk_bf16_f32 v40, v4, v5
 v_lshlrev_b32 v4, 16, v40
 v_and_b32 v5, s75, v40
 v_lshlrev_b32 v41, 16, v34
 v_and_b32 v42, s75, v34
 v_add_f32 v4, v4, v41
 v_add_f32 v5, v5, v42
 v_cvt_pk_bf16_f32 v46, v4, v5
 v_cvt_pk_bf16_f32 v40, v6, v7
 v_lshlrev_b32 v6, 16, v40
 v_and_b32 v7, s75, v40
 v_lshlrev_b32 v41, 16, v35
 v_and_b32 v42, s75, v35
 v_add_f32 v6, v6, v41
 v_add_f32 v7, v7, v42
 v_cvt_pk_bf16_f32 v47, v6, v7
 v_cvt_pk_bf16_f32 v40, v8, v9
 v_lshlrev_b32 v8, 16, v40
 v_and_b32 v9, s75, v40
 v_lshlrev_b32 v41, 16, v36
 v_and_b32 v42, s75, v36
 v_add_f32 v8, v8, v41
 v_add_f32 v9, v9, v42
 v_cvt_pk_bf16_f32 v48, v8, v9
 v_cvt_pk_bf16_f32 v40, v10, v11
 v_lshlrev_b32 v10, 16, v40
 v_and_b32 v11, s75, v40
 v_lshlrev_b32 v41, 16, v37
 v_and_b32 v42, s75, v37
 v_add_f32 v10, v10, v41
 v_add_f32 v11, v11, v42
 v_cvt_pk_bf16_f32 v49, v10, v11
 v_cvt_pk_bf16_f32 v40, v12, v13
 v_lshlrev_b32 v12, 16, v40
 v_and_b32 v13, s75, v40
 v_lshlrev_b32 v41, 16, v38
 v_and_b32 v42, s75, v38
 v_add_f32 v12, v12, v41
 v_add_f32 v13, v13, v42
 v_cvt_pk_bf16_f32 v50, v12, v13
 v_cvt_pk_bf16_f32 v40, v14, v15
 v_lshlrev_b32 v14, 16, v40
 v_and_b32 v15, s75, v40
 v_lshlrev_b32 v41, 16, v39
 v_and_b32 v42, s75, v39
 v_add_f32 v14, v14, v41
 v_add_f32 v15, v15, v42
 v_cvt_pk_bf16_f32 v51, v14, v15
 buffer_store_dwordx4 v[44:47], v69, s[56:59], s60 offen
 s_mov_b64 exec, 0xff
 buffer_store_dwordx4 v[48:51], v69, s[56:59], s60 offen offset:1024
 s_mov_b64 exec, -1
L165:
 s_add_u32 s64, s64, 3
 s_cmp_lt_u32 s64, 64
 s_cbranch_scc1 FF_LOOP155
 s_waitcnt vmcnt(0)
 s_endpgm
S_T1:
 v_and_b32 v100, 63, v0
 v_lshlrev_b32 v102, 4, v100
 s_lshl_b32 s67, s46, 6
 s_add_u32 s67, s67, 73400320
 s_mov_b32 s65, 0
 v_mov_b32 v6, 0
 v_mov_b32 v7, s65
 s_mov_b64 exec, 1
 buffer_store_dword v7, v6, s[4:7], s67 offen sc1
 s_mov_b64 exec, -1
 s_waitcnt vmcnt(0)
 s_barrier
 v_mov_b32 v6, 0
 s_cmp_eq_u32 s44, 0
 s_cbranch_scc0 L166
 v_mov_b32 v6, 0
 v_mov_b32 v7, 1
 s_mov_b64 exec, 1
 buffer_atomic_add v7, v6, s[8:11], 0 offen offset:112 sc1
 s_mov_b64 exec, -1
 s_waitcnt vmcnt(0)
L166:
 s_mov_b32 s48, s22
 s_mov_b32 s49, s23
 s_mov_b32 s50, 4718592
 s_mov_b32 s51, 0x20000
 s_mov_b32 s52, s24
 s_mov_b32 s53, s25
 s_mov_b32 s54, 4718592
 s_mov_b32 s55, 0x20000
 v_mov_b32 v1, v100
 v_lshrrev_b32 v6, 4, v1
 s_lshl_b32 s60, s44, 4
 v_add_u32 v6, s60, v6
 v_lshlrev_b32 v6, 13, v6
 v_and_b32 v7, 15, v1
 v_lshlrev_b32 v7, 4, v7
 v_add_u32 v6, v6, v7
 s_lshl_b32 s60, s46, 8
 v_add_u32 v0, s60, v6
 v_lshrrev_b32 v6, 5, v1
 v_lshlrev_b32 v6, 3, v6
 v_bfe_u32 v8, v1, 2, 2
 v_add_u32 v6, v6, v8
 v_lshlrev_b32 v6, 8, v6
 v_bfe_u32 v8, v1, 4, 1
 v_lshlrev_b32 v8, 5, v8
 v_add_u32 v6, v6, v8
 v_and_b32 v7, 3, v1
 v_lshlrev_b32 v7, 3, v7
 v_add_u32 v6, v6, v7
 s_lshl_b32 s60, s44, 6
 v_add_u32 v2, s60, v6
 s_lshl_b32 s64, s44, 12
 s_add_u32 m0, s64, 0
 s_mov_b32 s60, 0
 buffer_load_dwordx4 v0, s[48:51], s60 offen lds
 s_add_u32 m0, s64, 1024
 s_mov_b32 s60, 32768
 buffer_load_dwordx4 v0, s[48:51], s60 offen lds
 s_add_u32 m0, s64, 2048
 s_mov_b32 s60, 65536
 buffer_load_dwordx4 v0, s[48:51], s60 offen lds
 s_add_u32 m0, s64, 3072
 s_mov_b32 s60, 98304
 buffer_load_dwordx4 v0, s[48:51], s60 offen lds
 s_add_u32 m0, s64, 16384
 s_mov_b32 s60, 0
 buffer_load_dwordx4 v0, s[52:55], s60 offen lds
 s_add_u32 m0, s64, 17408
 s_mov_b32 s60, 32768
 buffer_load_dwordx4 v0, s[52:55], s60 offen lds
 s_add_u32 m0, s64, 18432
 s_mov_b32 s60, 65536
 buffer_load_dwordx4 v0, s[52:55], s60 offen lds
 s_add_u32 m0, s64, 19456
 s_mov_b32 s60, 98304
 buffer_load_dwordx4 v0, s[52:55], s60 offen lds
 s_add_u32 m0, s64, 32768
 s_mov_b32 s60, 524288
 buffer_load_dwordx4 v0, s[48:51], s60 offen lds
 s_add_u32 m0, s64, 33792
 s_mov_b32 s60, 557056
 buffer_load_dwordx4 v0, s[48:51], s60 offen lds
 s_add_u32 m0, s64, 34816
 s_mov_b32 s60, 589824
 buffer_load_dwordx4 v0, s[48:51], s60 offen lds
 s_add_u32 m0, s64, 35840
 s_mov_b32 s60, 622592
 buffer_load_dwordx4 v0, s[48:51], s60 offen lds
 s_add_u32 m0, s64, 49152
 s_mov_b32 s60, 524288
 buffer_load_dwordx4 v0, s[52:55], s60 offen lds
 s_add_u32 m0, s64, 50176
 s_mov_b32 s60, 557056
 buffer_load_dwordx4 v0, s[52:55], s60 offen lds
 s_add_u32 m0, s64, 51200
 s_mov_b32 s60, 589824
 buffer_load_dwordx4 v0, s[52:55], s60 offen lds
 s_add_u32 m0, s64, 52224
 s_mov_b32 s60, 622592
 buffer_load_dwordx4 v0, s[52:55], s60 offen lds
 s_add_u32 m0, s64, 65536
 s_mov_b32 s60, 1048576
 buffer_load_dwordx4 v0, s[48:51], s60 offen lds
 s_add_u32 m0, s64, 66560
 s_mov_b32 s60, 1081344
 buffer_load_dwordx4 v0, s[48:51], s60 offen lds
 s_add_u32 m0, s64, 67584
 s_mov_b32 s60, 1114112
 buffer_load_dwordx4 v0, s[48:51], s60 offen lds
 s_add_u32 m0, s64, 68608
 s_mov_b32 s60, 1146880
 buffer_load_dwordx4 v0, s[48:51], s60 offen lds
 s_add_u32 m0, s64, 81920
 s_mov_b32 s60, 1048576
 buffer_load_dwordx4 v0, s[52:55], s60 offen lds
 s_add_u32 m0, s64, 82944
 s_mov_b32 s60, 1081344
 buffer_load_dwordx4 v0, s[52:55], s60 offen lds
 s_add_u32 m0, s64, 83968
 s_mov_b32 s60, 1114112
 buffer_load_dwordx4 v0, s[52:55], s60 offen lds
 s_add_u32 m0, s64, 84992
 s_mov_b32 s60, 1146880
 buffer_load_dwordx4 v0, s[52:55], s60 offen lds
 s_add_u32 m0, s64, 98304
 s_mov_b32 s60, 1572864
 buffer_load_dwordx4 v0, s[48:51], s60 offen lds
 s_add_u32 m0, s64, 99328
 s_mov_b32 s60, 1605632
 buffer_load_dwordx4 v0, s[48:51], s60 offen lds
 s_add_u32 m0, s64, 100352
 s_mov_b32 s60, 1638400
 buffer_load_dwordx4 v0, s[48:51], s60 offen lds
 s_add_u32 m0, s64, 101376
 s_mov_b32 s60, 1671168
 buffer_load_dwordx4 v0, s[48:51], s60 offen lds
 s_add_u32 m0, s64, 114688
 s_mov_b32 s60, 1572864
 buffer_load_dwordx4 v0, s[52:55], s60 offen lds
 s_add_u32 m0, s64, 115712
 s_mov_b32 s60, 1605632
 buffer_load_dwordx4 v0, s[52:55], s60 offen lds
 s_add_u32 m0, s64, 116736
 s_mov_b32 s60, 1638400
 buffer_load_dwordx4 v0, s[52:55], s60 offen lds
 s_add_u32 m0, s64, 117760
 s_mov_b32 s60, 1671168
 buffer_load_dwordx4 v0, s[52:55], s60 offen lds
 s_add_u32 m0, s64, 131072
 s_mov_b32 s60, 2097152
 buffer_load_dwordx4 v0, s[48:51], s60 offen lds
 s_add_u32 m0, s64, 132096
 s_mov_b32 s60, 2129920
 buffer_load_dwordx4 v0, s[48:51], s60 offen lds
 s_add_u32 m0, s64, 133120
 s_mov_b32 s60, 2162688
 buffer_load_dwordx4 v0, s[48:51], s60 offen lds
 s_add_u32 m0, s64, 134144
 s_mov_b32 s60, 2195456
 buffer_load_dwordx4 v0, s[48:51], s60 offen lds
 s_waitcnt vmcnt(32)
 s_barrier
 v_add_u32 v3, 0, v2
 ds_read_b64_tr_b16 a[0:1], v3 offset:0
 ds_read_b64_tr_b16 a[2:3], v3 offset:1024
 ds_read_b64_tr_b16 a[4:5], v3 offset:4096
 ds_read_b64_tr_b16 a[6:7], v3 offset:5120
 ds_read_b64_tr_b16 a[8:9], v3 offset:8192
 ds_read_b64_tr_b16 a[10:11], v3 offset:9216
 ds_read_b64_tr_b16 a[12:13], v3 offset:12288
 ds_read_b64_tr_b16 a[14:15], v3 offset:13312
 s_waitcnt lgkmcnt(0)
 s_barrier
 s_add_u32 m0, s64, 0
 s_mov_b32 s60, 2097152
 buffer_load_dwordx4 v0, s[52:55], s60 offen lds
 s_add_u32 m0, s64, 1024
 s_mov_b32 s60, 2129920
 buffer_load_dwordx4 v0, s[52:55], s60 offen lds
 s_add_u32 m0, s64, 2048
 s_mov_b32 s60, 2162688
 buffer_load_dwordx4 v0, s[52:55], s60 offen lds
 s_add_u32 m0, s64, 3072
 s_mov_b32 s60, 2195456
 buffer_load_dwordx4 v0, s[52:55], s60 offen lds
 s_waitcnt vmcnt(32)
 s_barrier
 v_add_u32 v3, 16384, v2
 ds_read_b64_tr_b16 a[144:145], v3 offset:0
 ds_read_b64_tr_b16 a[146:147], v3 offset:1024
 ds_read_b64_tr_b16 a[148:149], v3 offset:4096
 ds_read_b64_tr_b16 a[150:151], v3 offset:5120
 ds_read_b64_tr_b16 a[152:153], v3 offset:8192
 ds_read_b64_tr_b16 a[154:155], v3 offset:9216
 ds_read_b64_tr_b16 a[156:157], v3 offset:12288
 ds_read_b64_tr_b16 a[158:159], v3 offset:13312
 s_waitcnt lgkmcnt(0)
 s_barrier
 s_add_u32 m0, s64, 16384
 s_mov_b32 s60, 2621440
 buffer_load_dwordx4 v0, s[48:51], s60 offen lds
 s_add_u32 m0, s64, 17408
 s_mov_b32 s60, 2654208
 buffer_load_dwordx4 v0, s[48:51], s60 offen lds
 s_add_u32 m0, s64, 18432
 s_mov_b32 s60, 2686976
 buffer_load_dwordx4 v0, s[48:51], s60 offen lds
 s_add_u32 m0, s64, 19456
 s_mov_b32 s60, 2719744
 buffer_load_dwordx4 v0, s[48:51], s60 offen lds
 s_waitcnt vmcnt(32)
 s_barrier
 v_add_u32 v3, 32768, v2
 ds_read_b64_tr_b16 a[16:17], v3 offset:0
 ds_read_b64_tr_b16 a[18:19], v3 offset:1024
 ds_read_b64_tr_b16 a[20:21], v3 offset:4096
 ds_read_b64_tr_b16 a[22:23], v3 offset:5120
 ds_read_b64_tr_b16 a[24:25], v3 offset:8192
 ds_read_b64_tr_b16 a[26:27], v3 offset:9216
 ds_read_b64_tr_b16 a[28:29], v3 offset:12288
 ds_read_b64_tr_b16 a[30:31], v3 offset:13312
 s_waitcnt lgkmcnt(0)
 s_barrier
 s_add_u32 m0, s64, 32768
 s_mov_b32 s60, 2621440
 buffer_load_dwordx4 v0, s[52:55], s60 offen lds
 s_add_u32 m0, s64, 33792
 s_mov_b32 s60, 2654208
 buffer_load_dwordx4 v0, s[52:55], s60 offen lds
 s_add_u32 m0, s64, 34816
 s_mov_b32 s60, 2686976
 buffer_load_dwordx4 v0, s[52:55], s60 offen lds
 s_add_u32 m0, s64, 35840
 s_mov_b32 s60, 2719744
 buffer_load_dwordx4 v0, s[52:55], s60 offen lds
 s_waitcnt vmcnt(32)
 s_barrier
 v_add_u32 v3, 49152, v2
 ds_read_b64_tr_b16 a[160:161], v3 offset:0
 ds_read_b64_tr_b16 a[162:163], v3 offset:1024
 ds_read_b64_tr_b16 a[164:165], v3 offset:4096
 ds_read_b64_tr_b16 a[166:167], v3 offset:5120
 ds_read_b64_tr_b16 a[168:169], v3 offset:8192
 ds_read_b64_tr_b16 a[170:171], v3 offset:9216
 ds_read_b64_tr_b16 a[172:173], v3 offset:12288
 ds_read_b64_tr_b16 a[174:175], v3 offset:13312
 s_waitcnt lgkmcnt(0)
 s_barrier
 s_add_u32 m0, s64, 49152
 s_mov_b32 s60, 3145728
 buffer_load_dwordx4 v0, s[48:51], s60 offen lds
 s_add_u32 m0, s64, 50176
 s_mov_b32 s60, 3178496
 buffer_load_dwordx4 v0, s[48:51], s60 offen lds
 s_add_u32 m0, s64, 51200
 s_mov_b32 s60, 3211264
 buffer_load_dwordx4 v0, s[48:51], s60 offen lds
 s_add_u32 m0, s64, 52224
 s_mov_b32 s60, 3244032
 buffer_load_dwordx4 v0, s[48:51], s60 offen lds
 s_waitcnt vmcnt(32)
 s_barrier
 v_add_u32 v3, 65536, v2
 ds_read_b64_tr_b16 a[32:33], v3 offset:0
 ds_read_b64_tr_b16 a[34:35], v3 offset:1024
 ds_read_b64_tr_b16 a[36:37], v3 offset:4096
 ds_read_b64_tr_b16 a[38:39], v3 offset:5120
 ds_read_b64_tr_b16 a[40:41], v3 offset:8192
 ds_read_b64_tr_b16 a[42:43], v3 offset:9216
 ds_read_b64_tr_b16 a[44:45], v3 offset:12288
 ds_read_b64_tr_b16 a[46:47], v3 offset:13312
 s_waitcnt lgkmcnt(0)
 s_barrier
 s_add_u32 m0, s64, 65536
 s_mov_b32 s60, 3145728
 buffer_load_dwordx4 v0, s[52:55], s60 offen lds
 s_add_u32 m0, s64, 66560
 s_mov_b32 s60, 3178496
 buffer_load_dwordx4 v0, s[52:55], s60 offen lds
 s_add_u32 m0, s64, 67584
 s_mov_b32 s60, 3211264
 buffer_load_dwordx4 v0, s[52:55], s60 offen lds
 s_add_u32 m0, s64, 68608
 s_mov_b32 s60, 3244032
 buffer_load_dwordx4 v0, s[52:55], s60 offen lds
 s_waitcnt vmcnt(32)
 s_barrier
 v_add_u32 v3, 81920, v2
 ds_read_b64_tr_b16 a[176:177], v3 offset:0
 ds_read_b64_tr_b16 a[178:179], v3 offset:1024
 ds_read_b64_tr_b16 a[180:181], v3 offset:4096
 ds_read_b64_tr_b16 a[182:183], v3 offset:5120
 ds_read_b64_tr_b16 a[184:185], v3 offset:8192
 ds_read_b64_tr_b16 a[186:187], v3 offset:9216
 ds_read_b64_tr_b16 a[188:189], v3 offset:12288
 ds_read_b64_tr_b16 a[190:191], v3 offset:13312
 s_waitcnt lgkmcnt(0)
 s_barrier
 s_add_u32 m0, s64, 81920
 s_mov_b32 s60, 3670016
 buffer_load_dwordx4 v0, s[48:51], s60 offen lds
 s_add_u32 m0, s64, 82944
 s_mov_b32 s60, 3702784
 buffer_load_dwordx4 v0, s[48:51], s60 offen lds
 s_add_u32 m0, s64, 83968
 s_mov_b32 s60, 3735552
 buffer_load_dwordx4 v0, s[48:51], s60 offen lds
 s_add_u32 m0, s64, 84992
 s_mov_b32 s60, 3768320
 buffer_load_dwordx4 v0, s[48:51], s60 offen lds
 s_waitcnt vmcnt(32)
 s_barrier
 v_add_u32 v3, 98304, v2
 ds_read_b64_tr_b16 a[48:49], v3 offset:0
 ds_read_b64_tr_b16 a[50:51], v3 offset:1024
 ds_read_b64_tr_b16 a[52:53], v3 offset:4096
 ds_read_b64_tr_b16 a[54:55], v3 offset:5120
 ds_read_b64_tr_b16 a[56:57], v3 offset:8192
 ds_read_b64_tr_b16 a[58:59], v3 offset:9216
 ds_read_b64_tr_b16 a[60:61], v3 offset:12288
 ds_read_b64_tr_b16 a[62:63], v3 offset:13312
 s_waitcnt lgkmcnt(0)
 s_barrier
 s_add_u32 m0, s64, 98304
 s_mov_b32 s60, 3670016
 buffer_load_dwordx4 v0, s[52:55], s60 offen lds
 s_add_u32 m0, s64, 99328
 s_mov_b32 s60, 3702784
 buffer_load_dwordx4 v0, s[52:55], s60 offen lds
 s_add_u32 m0, s64, 100352
 s_mov_b32 s60, 3735552
 buffer_load_dwordx4 v0, s[52:55], s60 offen lds
 s_add_u32 m0, s64, 101376
 s_mov_b32 s60, 3768320
 buffer_load_dwordx4 v0, s[52:55], s60 offen lds
 s_waitcnt vmcnt(32)
 s_barrier
 v_add_u32 v3, 114688, v2
 ds_read_b64_tr_b16 a[192:193], v3 offset:0
 ds_read_b64_tr_b16 a[194:195], v3 offset:1024
 ds_read_b64_tr_b16 a[196:197], v3 offset:4096
 ds_read_b64_tr_b16 a[198:199], v3 offset:5120
 ds_read_b64_tr_b16 a[200:201], v3 offset:8192
 ds_read_b64_tr_b16 a[202:203], v3 offset:9216
 ds_read_b64_tr_b16 a[204:205], v3 offset:12288
 ds_read_b64_tr_b16 a[206:207], v3 offset:13312
 s_waitcnt lgkmcnt(0)
 s_barrier
 s_add_u32 m0, s64, 114688
 s_mov_b32 s60, 4194304
 buffer_load_dwordx4 v0, s[48:51], s60 offen lds
 s_add_u32 m0, s64, 115712
 s_mov_b32 s60, 4227072
 buffer_load_dwordx4 v0, s[48:51], s60 offen lds
 s_add_u32 m0, s64, 116736
 s_mov_b32 s60, 4259840
 buffer_load_dwordx4 v0, s[48:51], s60 offen lds
 s_add_u32 m0, s64, 117760
 s_mov_b32 s60, 4292608
 buffer_load_dwordx4 v0, s[48:51], s60 offen lds
 s_waitcnt vmcnt(32)
 s_barrier
 v_add_u32 v3, 131072, v2
 ds_read_b64_tr_b16 a[64:65], v3 offset:0
 ds_read_b64_tr_b16 a[66:67], v3 offset:1024
 ds_read_b64_tr_b16 a[68:69], v3 offset:4096
 ds_read_b64_tr_b16 a[70:71], v3 offset:5120
 ds_read_b64_tr_b16 a[72:73], v3 offset:8192
 ds_read_b64_tr_b16 a[74:75], v3 offset:9216
 ds_read_b64_tr_b16 a[76:77], v3 offset:12288
 ds_read_b64_tr_b16 a[78:79], v3 offset:13312
 s_waitcnt lgkmcnt(0)
 s_barrier
 s_add_u32 m0, s64, 131072
 s_mov_b32 s60, 4194304
 buffer_load_dwordx4 v0, s[52:55], s60 offen lds
 s_add_u32 m0, s64, 132096
 s_mov_b32 s60, 4227072
 buffer_load_dwordx4 v0, s[52:55], s60 offen lds
 s_add_u32 m0, s64, 133120
 s_mov_b32 s60, 4259840
 buffer_load_dwordx4 v0, s[52:55], s60 offen lds
 s_add_u32 m0, s64, 134144
 s_mov_b32 s60, 4292608
 buffer_load_dwordx4 v0, s[52:55], s60 offen lds
 s_waitcnt vmcnt(32)
 s_barrier
 v_add_u32 v3, 0, v2
 ds_read_b64_tr_b16 a[208:209], v3 offset:0
 ds_read_b64_tr_b16 a[210:211], v3 offset:1024
 ds_read_b64_tr_b16 a[212:213], v3 offset:4096
 ds_read_b64_tr_b16 a[214:215], v3 offset:5120
 ds_read_b64_tr_b16 a[216:217], v3 offset:8192
 ds_read_b64_tr_b16 a[218:219], v3 offset:9216
 ds_read_b64_tr_b16 a[220:221], v3 offset:12288
 ds_read_b64_tr_b16 a[222:223], v3 offset:13312
 s_waitcnt lgkmcnt(0)
 s_barrier
 s_waitcnt vmcnt(28)
 s_barrier
 v_add_u32 v3, 16384, v2
 ds_read_b64_tr_b16 a[80:81], v3 offset:0
 ds_read_b64_tr_b16 a[82:83], v3 offset:1024
 ds_read_b64_tr_b16 a[84:85], v3 offset:4096
 ds_read_b64_tr_b16 a[86:87], v3 offset:5120
 ds_read_b64_tr_b16 a[88:89], v3 offset:8192
 ds_read_b64_tr_b16 a[90:91], v3 offset:9216
 ds_read_b64_tr_b16 a[92:93], v3 offset:12288
 ds_read_b64_tr_b16 a[94:95], v3 offset:13312
 s_waitcnt lgkmcnt(0)
 s_barrier
 s_waitcnt vmcnt(24)
 s_barrier
 v_add_u32 v3, 32768, v2
 ds_read_b64_tr_b16 a[224:225], v3 offset:0
 ds_read_b64_tr_b16 a[226:227], v3 offset:1024
 ds_read_b64_tr_b16 a[228:229], v3 offset:4096
 ds_read_b64_tr_b16 a[230:231], v3 offset:5120
 ds_read_b64_tr_b16 a[232:233], v3 offset:8192
 ds_read_b64_tr_b16 a[234:235], v3 offset:9216
 ds_read_b64_tr_b16 a[236:237], v3 offset:12288
 ds_read_b64_tr_b16 a[238:239], v3 offset:13312
 s_waitcnt lgkmcnt(0)
 s_barrier
 s_waitcnt vmcnt(20)
 s_barrier
 v_add_u32 v3, 49152, v2
 ds_read_b64_tr_b16 a[96:97], v3 offset:0
 ds_read_b64_tr_b16 a[98:99], v3 offset:1024
 ds_read_b64_tr_b16 a[100:101], v3 offset:4096
 ds_read_b64_tr_b16 a[102:103], v3 offset:5120
 ds_read_b64_tr_b16 a[104:105], v3 offset:8192
 ds_read_b64_tr_b16 a[106:107], v3 offset:9216
 ds_read_b64_tr_b16 a[108:109], v3 offset:12288
 ds_read_b64_tr_b16 a[110:111], v3 offset:13312
 s_waitcnt lgkmcnt(0)
 s_barrier
 s_waitcnt vmcnt(16)
 s_barrier
 v_add_u32 v3, 65536, v2
 ds_read_b64_tr_b16 a[240:241], v3 offset:0
 ds_read_b64_tr_b16 a[242:243], v3 offset:1024
 ds_read_b64_tr_b16 a[244:245], v3 offset:4096
 ds_read_b64_tr_b16 a[246:247], v3 offset:5120
 ds_read_b64_tr_b16 a[248:249], v3 offset:8192
 ds_read_b64_tr_b16 a[250:251], v3 offset:9216
 ds_read_b64_tr_b16 a[252:253], v3 offset:12288
 ds_read_b64_tr_b16 a[254:255], v3 offset:13312
 s_waitcnt lgkmcnt(0)
 s_barrier
 s_waitcnt vmcnt(12)
 s_barrier
 v_add_u32 v3, 81920, v2
 ds_read_b64_tr_b16 a[112:113], v3 offset:0
 ds_read_b64_tr_b16 a[114:115], v3 offset:1024
 ds_read_b64_tr_b16 a[116:117], v3 offset:4096
 ds_read_b64_tr_b16 a[118:119], v3 offset:5120
 ds_read_b64_tr_b16 a[120:121], v3 offset:8192
 ds_read_b64_tr_b16 a[122:123], v3 offset:9216
 ds_read_b64_tr_b16 a[124:125], v3 offset:12288
 ds_read_b64_tr_b16 a[126:127], v3 offset:13312
 s_waitcnt lgkmcnt(0)
 s_barrier
 s_waitcnt vmcnt(8)
 s_barrier
 v_add_u32 v3, 98304, v2
 ds_read_b64_tr_b16 v[224:225], v3 offset:0
 ds_read_b64_tr_b16 v[226:227], v3 offset:1024
 ds_read_b64_tr_b16 v[228:229], v3 offset:4096
 ds_read_b64_tr_b16 v[230:231], v3 offset:5120
 ds_read_b64_tr_b16 v[232:233], v3 offset:8192
 ds_read_b64_tr_b16 v[234:235], v3 offset:9216
 ds_read_b64_tr_b16 v[236:237], v3 offset:12288
 ds_read_b64_tr_b16 v[238:239], v3 offset:13312
 s_waitcnt lgkmcnt(0)
 s_barrier
 s_waitcnt vmcnt(4)
 s_barrier
 v_add_u32 v3, 114688, v2
 ds_read_b64_tr_b16 a[128:129], v3 offset:0
 ds_read_b64_tr_b16 a[130:131], v3 offset:1024
 ds_read_b64_tr_b16 a[132:133], v3 offset:4096
 ds_read_b64_tr_b16 a[134:135], v3 offset:5120
 ds_read_b64_tr_b16 a[136:137], v3 offset:8192
 ds_read_b64_tr_b16 a[138:139], v3 offset:9216
 ds_read_b64_tr_b16 a[140:141], v3 offset:12288
 ds_read_b64_tr_b16 a[142:143], v3 offset:13312
 s_waitcnt lgkmcnt(0)
 s_barrier
 s_waitcnt vmcnt(0)
 s_barrier
 v_add_u32 v3, 131072, v2
 ds_read_b64_tr_b16 v[240:241], v3 offset:0
 ds_read_b64_tr_b16 v[242:243], v3 offset:1024
 ds_read_b64_tr_b16 v[244:245], v3 offset:4096
 ds_read_b64_tr_b16 v[246:247], v3 offset:5120
 ds_read_b64_tr_b16 v[248:249], v3 offset:8192
 ds_read_b64_tr_b16 v[250:251], v3 offset:9216
 ds_read_b64_tr_b16 v[252:253], v3 offset:12288
 ds_read_b64_tr_b16 v[254:255], v3 offset:13312
 s_waitcnt lgkmcnt(0)
 s_barrier
 s_barrier
 v_mov_b32 v6, 0
L167:
 buffer_load_dword v7, v6, s[8:11], 0 offen offset:112 sc1
 s_waitcnt vmcnt(0)
 v_mov_b32 v6, 0x100
 v_cmp_ne_u32 vcc, v6, v7
 v_mov_b32 v6, 0
 s_cbranch_vccnz L167
 v_lshlrev_b32 v6, 2, v100
 s_mov_b32 s60, 73408512
L168:
 buffer_load_dword v7, v6, s[4:7], s60 offen sc1
 s_waitcnt vmcnt(0)
 v_cmp_ne_u32 vcc, 1, v7
 s_cbranch_vccnz L168
 v_and_b32 v1, 15, v100
 v_lshlrev_b32 v1, 4, v1
 v_bfe_u32 v2, v100, 4, 1
 v_lshlrev_b32 v2, 12, v2
 v_add_u32 v1, v1, v2
 v_lshrrev_b32 v2, 5, v100
 v_lshlrev_b32 v3, 9, v2
 v_add_u32 v1, v1, v3
 s_lshl_b32 s60, s44, 10
 v_add_u32 v103, s60, v1
 v_and_b32 v1, 15, v100
 v_lshlrev_b32 v1, 4, v1
 v_bfe_u32 v3, v100, 4, 1
 v_lshlrev_b32 v3, 10, v3
 v_add_u32 v1, v1, v3
 v_lshlrev_b32 v3, 8, v2
 v_add_u32 v1, v1, v3
 s_lshl_b32 s60, s44, 11
 s_add_u32 s60, s60, 8192
 v_add_u32 v104, s60, v1
 s_mov_b32 s62, 0
 s_mov_b32 s66, 0
 s_mul_i32 s71, s62, 36864
 s_mul_i32 s72, s44, 9216
 s_add_u32 s71, s71, s72
 s_add_u32 s71, s71, 0
 s_add_u32 s72, s72, s66
 s_add_u32 m0, s72, 0
 s_add_u32 s63, s71, 0
 buffer_load_dwordx4 v102, s[4:7], s63 offen sc1 lds
 s_add_u32 m0, s72, 1024
 s_add_u32 s63, s71, 1024
 buffer_load_dwordx4 v102, s[4:7], s63 offen sc1 lds
 s_add_u32 m0, s72, 2048
 s_add_u32 s63, s71, 2048
 buffer_load_dwordx4 v102, s[4:7], s63 offen sc1 lds
 s_add_u32 m0, s72, 3072
 s_add_u32 s63, s71, 3072
 buffer_load_dwordx4 v102, s[4:7], s63 offen sc1 lds
 s_add_u32 m0, s72, 4096
 s_add_u32 s63, s71, 4096
 buffer_load_dwordx4 v102, s[4:7], s63 offen sc1 lds
 s_add_u32 m0, s72, 5120
 s_add_u32 s63, s71, 5120
 buffer_load_dwordx4 v102, s[4:7], s63 offen sc1 lds
 s_add_u32 m0, s72, 6144
 s_add_u32 s63, s71, 6144
 buffer_load_dwordx4 v102, s[4:7], s63 offen sc1 lds
 s_add_u32 m0, s72, 7168
 s_add_u32 s63, s71, 7168
 buffer_load_dwordx4 v102, s[4:7], s63 offen sc1 lds
 s_add_u32 m0, s72, 8192
 s_add_u32 s63, s71, 8192
 buffer_load_dwordx4 v102, s[4:7], s63 offen sc1 lds
 s_mov_b32 s70, 20971520
 s_lshl_b32 s60, s46, 14
 s_add_u32 s70, s70, s60
 s_add_u32 s70, s70, 33030144
T1_LOOP169:
 s_waitcnt vmcnt(0)
 s_barrier
 s_add_u32 s69, s62, 1
 s_min_u32 s69, s69, 63
 s_xor_b32 s68, s66, 36864
 s_mul_i32 s71, s69, 36864
 s_mul_i32 s72, s44, 9216
 s_add_u32 s71, s71, s72
 s_add_u32 s71, s71, 0
 s_add_u32 s72, s72, s68
 v_add_u32 v101, s66, v102
 ds_read_b128 v[80:83], v101 offset:0
 ds_read_b128 v[84:87], v101 offset:1024
 ds_read_b128 v[88:91], v101 offset:2048
 s_waitcnt lgkmcnt(2)
 v_mfma_f32_32x32x16_bf16 v[0:15], a[0:3], v[80:83], 0
 buffer_store_dwordx4 v[64:67], v103, s[4:7], s70 offen offset:0 sc1
 v_mfma_f32_32x32x16_bf16 v[16:31], v[80:83], a[144:147], 0
 ds_read_b128 v[80:83], v101 offset:3072
 s_waitcnt lgkmcnt(2)
 v_mfma_f32_32x32x16_bf16 v[0:15], a[4:7], v[84:87], v[0:15]
 buffer_store_dwordx4 v[68:71], v103, s[4:7], s70 offen offset:256 sc1
 v_mfma_f32_32x32x16_bf16 v[16:31], v[84:87], a[148:151], v[16:31]
 ds_read_b128 v[84:87], v101 offset:4096
 s_waitcnt lgkmcnt(2)
 v_mfma_f32_32x32x16_bf16 v[0:15], a[8:11], v[88:91], v[0:15]
 buffer_store_dwordx4 v[72:75], v104, s[4:7], s70 offen offset:0 sc1
 v_mfma_f32_32x32x16_bf16 v[16:31], v[88:91], a[152:155], v[16:31]
 ds_read_b128 v[88:91], v101 offset:5120
 s_waitcnt lgkmcnt(2)
 v_mfma_f32_32x32x16_bf16 v[0:15], a[12:15], v[80:83], v[0:15]
 buffer_store_dwordx4 v[76:79], v104, s[4:7], s70 offen offset:512 sc1
 v_mfma_f32_32x32x16_bf16 v[16:31], v[80:83], a[156:159], v[16:31]
 ds_read_b128 v[80:83], v101 offset:6144
 s_waitcnt lgkmcnt(2)
 v_mfma_f32_32x32x16_bf16 v[0:15], a[16:19], v[84:87], v[0:15]
 s_add_u32 m0, s72, 0
 s_add_u32 s63, s71, 0
 buffer_load_dwordx4 v102, s[4:7], s63 offen sc1 lds
 v_mfma_f32_32x32x16_bf16 v[16:31], v[84:87], a[160:163], v[16:31]
 ds_read_b128 v[84:87], v101 offset:7168
 s_waitcnt lgkmcnt(2)
 v_mfma_f32_32x32x16_bf16 v[0:15], a[20:23], v[88:91], v[0:15]
 v_mfma_f32_32x32x16_bf16 v[16:31], v[88:91], a[164:167], v[16:31]
 ds_read_b128 v[88:91], v101 offset:8192
 s_waitcnt lgkmcnt(2)
 v_mfma_f32_32x32x16_bf16 v[0:15], a[24:27], v[80:83], v[0:15]
 s_add_u32 m0, s72, 1024
 s_add_u32 s63, s71, 1024
 buffer_load_dwordx4 v102, s[4:7], s63 offen sc1 lds
 v_mfma_f32_32x32x16_bf16 v[16:31], v[80:83], a[168:171], v[16:31]
 ds_read_b128 v[80:83], v101 offset:9216
 s_waitcnt lgkmcnt(2)
 v_mfma_f32_32x32x16_bf16 v[0:15], a[28:31], v[84:87], v[0:15]
 v_mfma_f32_32x32x16_bf16 v[16:31], v[84:87], a[172:175], v[16:31]
 ds_read_b128 v[84:87], v101 offset:10240
 s_waitcnt lgkmcnt(2)
 v_mfma_f32_32x32x16_bf16 v[0:15], a[32:35], v[88:91], v[0:15]
 s_add_u32 m0, s72, 2048
 s_add_u32 s63, s71, 2048
 buffer_load_dwordx4 v102, s[4:7], s63 offen sc1 lds
 v_mfma_f32_32x32x16_bf16 v[16:31], v[88:91], a[176:179], v[16:31]
 ds_read_b128 v[88:91], v101 offset:11264
 s_waitcnt lgkmcnt(2)
 v_mfma_f32_32x32x16_bf16 v[0:15], a[36:39], v[80:83], v[0:15]
 v_mfma_f32_32x32x16_bf16 v[16:31], v[80:83], a[180:183], v[16:31]
 ds_read_b128 v[80:83], v101 offset:12288
 s_waitcnt lgkmcnt(2)
 v_mfma_f32_32x32x16_bf16 v[0:15], a[40:43], v[84:87], v[0:15]
 s_add_u32 m0, s72, 3072
 s_add_u32 s63, s71, 3072
 buffer_load_dwordx4 v102, s[4:7], s63 offen sc1 lds
 v_mfma_f32_32x32x16_bf16 v[16:31], v[84:87], a[184:187], v[16:31]
 ds_read_b128 v[84:87], v101 offset:13312
 s_waitcnt lgkmcnt(2)
 v_mfma_f32_32x32x16_bf16 v[0:15], a[44:47], v[88:91], v[0:15]
 v_mfma_f32_32x32x16_bf16 v[16:31], v[88:91], a[188:191], v[16:31]
 ds_read_b128 v[88:91], v101 offset:14336
 s_waitcnt lgkmcnt(2)
 v_mfma_f32_32x32x16_bf16 v[0:15], a[48:51], v[80:83], v[0:15]
 s_add_u32 m0, s72, 4096
 s_add_u32 s63, s71, 4096
 buffer_load_dwordx4 v102, s[4:7], s63 offen sc1 lds
 v_mfma_f32_32x32x16_bf16 v[16:31], v[80:83], a[192:195], v[16:31]
 ds_read_b128 v[80:83], v101 offset:15360
 s_waitcnt lgkmcnt(2)
 v_mfma_f32_32x32x16_bf16 v[0:15], a[52:55], v[84:87], v[0:15]
 v_mfma_f32_32x32x16_bf16 v[16:31], v[84:87], a[196:199], v[16:31]
 ds_read_b128 v[84:87], v101 offset:16384
 s_waitcnt lgkmcnt(2)
 v_mfma_f32_32x32x16_bf16 v[0:15], a[56:59], v[88:91], v[0:15]
 s_add_u32 m0, s72, 5120
 s_add_u32 s63, s71, 5120
 buffer_load_dwordx4 v102, s[4:7], s63 offen sc1 lds
 v_mfma_f32_32x32x16_bf16 v[16:31], v[88:91], a[200:203], v[16:31]
 ds_read_b128 v[88:91], v101 offset:17408
 s_waitcnt lgkmcnt(2)
 v_mfma_f32_32x32x16_bf16 v[0:15], a[60:63], v[80:83], v[0:15]
 v_mfma_f32_32x32x16_bf16 v[16:31], v[80:83], a[204:207], v[16:31]
 ds_read_b128 v[80:83], v101 offset:18432
 s_waitcnt lgkmcnt(2)
 v_mfma_f32_32x32x16_bf16 v[0:15], a[64:67], v[84:87], v[0:15]
 s_add_u32 m0, s72, 6144
 s_add_u32 s63, s71, 6144
 buffer_load_dwordx4 v102, s[4:7], s63 offen sc1 lds
 v_mfma_f32_32x32x16_bf16 v[16:31], v[84:87], a[208:211], v[16:31]
 ds_read_b128 v[84:87], v101 offset:19456
 s_waitcnt lgkmcnt(2)
 v_mfma_f32_32x32x16_bf16 v[0:15], a[68:71], v[88:91], v[0:15]
 v_mfma_f32_32x32x16_bf16 v[16:31], v[88:91], a[212:215], v[16:31]
 ds_read_b128 v[88:91], v101 offset:20480
 s_waitcnt lgkmcnt(2)
 v_mfma_f32_32x32x16_bf16 v[0:15], a[72:75], v[80:83], v[0:15]
 s_add_u32 m0, s72, 7168
 s_add_u32 s63, s71, 7168
 buffer_load_dwordx4 v102, s[4:7], s63 offen sc1 lds
 v_mfma_f32_32x32x16_bf16 v[16:31], v[80:83], a[216:219], v[16:31]
 ds_read_b128 v[80:83], v101 offset:21504
 s_waitcnt lgkmcnt(2)
 v_mfma_f32_32x32x16_bf16 v[0:15], a[76:79], v[84:87], v[0:15]
 v_mfma_f32_32x32x16_bf16 v[16:31], v[84:87], a[220:223], v[16:31]
 ds_read_b128 v[84:87], v101 offset:22528
 s_waitcnt lgkmcnt(2)
 v_mfma_f32_32x32x16_bf16 v[0:15], a[80:83], v[88:91], v[0:15]
 s_add_u32 m0, s72, 8192
 s_add_u32 s63, s71, 8192
 buffer_load_dwordx4 v102, s[4:7], s63 offen sc1 lds
 v_mfma_f32_32x32x16_bf16 v[16:31], v[88:91], a[224:227], v[16:31]
 ds_read_b128 v[88:91], v101 offset:23552
 s_waitcnt lgkmcnt(2)
 v_mfma_f32_32x32x16_bf16 v[0:15], a[84:87], v[80:83], v[0:15]
 v_mfma_f32_32x32x16_bf16 v[16:31], v[80:83], a[228:231], v[16:31]
 ds_read_b128 v[80:83], v101 offset:24576
 s_waitcnt lgkmcnt(2)
 v_mfma_f32_32x32x16_bf16 v[0:15], a[88:91], v[84:87], v[0:15]
 v_mfma_f32_32x32x16_bf16 v[16:31], v[84:87], a[232:235], v[16:31]
 ds_read_b128 v[84:87], v101 offset:25600
 s_waitcnt lgkmcnt(2)
 v_mfma_f32_32x32x16_bf16 v[0:15], a[92:95], v[88:91], v[0:15]
 v_mfma_f32_32x32x16_bf16 v[16:31], v[88:91], a[236:239], v[16:31]
 ds_read_b128 v[88:91], v101 offset:26624
 s_waitcnt lgkmcnt(2)
 v_mfma_f32_32x32x16_bf16 v[0:15], a[96:99], v[80:83], v[0:15]
 v_mfma_f32_32x32x16_bf16 v[16:31], v[80:83], a[240:243], v[16:31]
 ds_read_b128 v[80:83], v101 offset:27648
 s_waitcnt lgkmcnt(2)
 v_mfma_f32_32x32x16_bf16 v[0:15], a[100:103], v[84:87], v[0:15]
 v_mfma_f32_32x32x16_bf16 v[16:31], v[84:87], a[244:247], v[16:31]
 ds_read_b128 v[84:87], v101 offset:28672
 s_waitcnt lgkmcnt(2)
 v_mfma_f32_32x32x16_bf16 v[0:15], a[104:107], v[88:91], v[0:15]
 v_mfma_f32_32x32x16_bf16 v[16:31], v[88:91], a[248:251], v[16:31]
 ds_read_b128 v[88:91], v101 offset:29696
 s_waitcnt lgkmcnt(2)
 v_mfma_f32_32x32x16_bf16 v[0:15], a[108:111], v[80:83], v[0:15]
 v_mfma_f32_32x32x16_bf16 v[16:31], v[80:83], a[252:255], v[16:31]
 ds_read_b128 v[80:83], v101 offset:30720
 s_waitcnt lgkmcnt(2)
 v_mfma_f32_32x32x16_bf16 v[0:15], a[112:115], v[84:87], v[0:15]
 v_mfma_f32_32x32x16_bf16 v[16:31], v[84:87], v[224:227], v[16:31]
 s_waitcnt vmcnt(9)
 s_barrier
 s_cmp_eq_u32 s44, 0
 s_cbranch_scc0 L170
 v_mov_b32 v96, 0
 v_mov_b32 v97, s65
 s_mov_b64 exec, 1
 buffer_store_dword v97, v96, s[4:7], s67 offen sc1
 s_mov_b64 exec, -1
L170:
 ds_read_b128 v[84:87], v101 offset:31744
 s_waitcnt lgkmcnt(2)
 v_mfma_f32_32x32x16_bf16 v[0:15], a[116:119], v[88:91], v[0:15]
 v_mfma_f32_32x32x16_bf16 v[16:31], v[88:91], v[228:231], v[16:31]
 ds_read_b128 v[88:91], v101 offset:32768
 s_waitcnt lgkmcnt(2)
 v_mfma_f32_32x32x16_bf16 v[0:15], a[120:123], v[80:83], v[0:15]
 v_mfma_f32_32x32x16_bf16 v[16:31], v[80:83], v[232:235], v[16:31]
 ds_read_b128 v[80:83], v101 offset:33792
 s_waitcnt lgkmcnt(2)
 v_mfma_f32_32x32x16_bf16 v[0:15], a[124:127], v[84:87], v[0:15]
 v_mfma_f32_32x32x16_bf16 v[16:31], v[84:87], v[236:239], v[16:31]
 ds_read_b128 v[84:87], v101 offset:34816
 s_waitcnt lgkmcnt(2)
 v_mfma_f32_32x32x16_bf16 v[0:15], a[128:131], v[88:91], v[0:15]
 v_mfma_f32_32x32x16_bf16 v[16:31], v[88:91], v[240:243], v[16:31]
 ds_read_b128 v[88:91], v101 offset:35840
 s_waitcnt lgkmcnt(2)
 v_mfma_f32_32x32x16_bf16 v[0:15], a[132:135], v[80:83], v[0:15]
 v_mfma_f32_32x32x16_bf16 v[16:31], v[80:83], v[244:247], v[16:31]
 s_waitcnt lgkmcnt(1)
 v_mfma_f32_32x32x16_bf16 v[0:15], a[136:139], v[84:87], v[0:15]
 v_mfma_f32_32x32x16_bf16 v[16:31], v[84:87], v[248:251], v[16:31]
 s_waitcnt lgkmcnt(0)
 v_mfma_f32_32x32x16_bf16 v[0:15], a[140:143], v[88:91], v[0:15]
 v_mfma_f32_32x32x16_bf16 v[16:31], v[88:91], v[252:255], v[16:31]
 s_lshl_b32 s60, s62, 5
 s_add_u32 s60, s60, s46
 s_lshl_b32 s70, s60, 14
 s_add_u32 s70, s70, 20971520
 s_nop 7
 s_nop 1
 v_cvt_pk_bf16_f32 v64, v0, v1
 v_cvt_pk_bf16_f32 v65, v2, v3
 v_cvt_pk_bf16_f32 v66, v4, v5
 v_cvt_pk_bf16_f32 v67, v6, v7
 v_cvt_pk_bf16_f32 v68, v8, v9
 v_cvt_pk_bf16_f32 v69, v10, v11
 v_cvt_pk_bf16_f32 v70, v12, v13
 v_cvt_pk_bf16_f32 v71, v14, v15
 v_cvt_pk_bf16_f32 v72, v16, v17
 v_cvt_pk_bf16_f32 v73, v18, v19
 v_cvt_pk_bf16_f32 v74, v24, v25
 v_cvt_pk_bf16_f32 v75, v26, v27
 v_cvt_pk_bf16_f32 v76, v20, v21
 v_cvt_pk_bf16_f32 v77, v22, v23
 v_cvt_pk_bf16_f32 v78, v28, v29
 v_cvt_pk_bf16_f32 v79, v30, v31
 s_add_u32 s65, s65, 1
 s_cmp_gt_u32 s65, 1
 s_cbranch_scc1 L171
 buffer_store_dwordx4 v[64:67], v103, s[4:7], s70 offen offset:0 sc1
 buffer_store_dwordx4 v[68:71], v103, s[4:7], s70 offen offset:256 sc1
 buffer_store_dwordx4 v[72:75], v104, s[4:7], s70 offen offset:0 sc1
 buffer_store_dwordx4 v[76:79], v104, s[4:7], s70 offen offset:512 sc1
 s_waitcnt vmcnt(0)
 s_barrier
 s_cmp_eq_u32 s44, 0
 s_cbranch_scc0 L171
 v_mov_b32 v96, 0
 v_mov_b32 v97, s65
 s_mov_b64 exec, 1
 buffer_store_dword v97, v96, s[4:7], s67 offen sc1
 s_mov_b64 exec, -1
L171:
 s_add_u32 s62, s62, 1
 s_xor_b32 s66, s66, 36864
 s_cmp_lt_u32 s62, 64
 s_cbranch_scc1 T1_LOOP169
 buffer_store_dwordx4 v[64:67], v103, s[4:7], s70 offen offset:0 sc1
 buffer_store_dwordx4 v[68:71], v103, s[4:7], s70 offen offset:256 sc1
 buffer_store_dwordx4 v[72:75], v104, s[4:7], s70 offen offset:0 sc1
 buffer_store_dwordx4 v[76:79], v104, s[4:7], s70 offen offset:512 sc1
 s_waitcnt vmcnt(0)
 s_barrier
 s_cmp_eq_u32 s44, 0
 s_cbranch_scc0 L172
 v_mov_b32 v96, 0
 v_mov_b32 v97, s65
 s_mov_b64 exec, 1
 buffer_store_dword v97, v96, s[4:7], s67 offen sc1
 s_mov_b64 exec, -1
L172:
 s_waitcnt vmcnt(0)
 s_endpgm
S_T2:
 s_sub_u32 s47, s45, 2
 v_and_b32 v220, 63, v0
 v_lshlrev_b32 v221, 4, v220
 s_lshl_b32 s64, s46, 1
 s_add_u32 s64, s64, s47
 s_lshl_b32 s60, s64, 2
 s_add_u32 s60, s60, 73408512
 s_mov_b32 s61, 0
 s_lshl_b32 s72, s47, 8
 s_add_u32 s72, s72, 73433088
 s_lshl_b32 s71, s46, 2
 s_add_u32 s71, s71, s72
 s_cmp_ge_u32 s47, 2
 s_cbranch_scc1 L173
 v_mov_b32 v6, 0
 v_mov_b32 v7, s61
 s_mov_b64 exec, 1
 buffer_store_dword v7, v6, s[4:7], s60 offen sc1
 s_mov_b64 exec, -1
L173:
 v_mov_b32 v6, 0
 v_mov_b32 v7, s61
 s_mov_b64 exec, 1
 buffer_store_dword v7, v6, s[4:7], s71 offen sc1
 s_mov_b64 exec, -1
 s_add_u32 s60, s71, 128
 s_mov_b32 s61, 0
 v_mov_b32 v6, 0
 v_mov_b32 v7, s61
 s_mov_b64 exec, 1
 buffer_store_dword v7, v6, s[4:7], s60 offen sc1
 s_mov_b64 exec, -1
 v_mul_u32_u24 v6, 3, v220
 v_add_u32 v6, s47, v6
 v_cmp_gt_u32 vcc, 64, v6
 v_lshlrev_b32 v6, 7, v6
 s_lshl_b32 s62, s46, 2
 s_add_u32 s60, s62, 73416704
 v_mov_b32 v7, 0
 s_and_b64 exec, exec, vcc
 buffer_store_dword v7, v6, s[4:7], s60 offen sc1
 s_mov_b64 exec, -1
 s_waitcnt vmcnt(0)
 s_barrier
 v_mov_b32 v6, 0
 s_cmp_eq_u32 s44, 0
 s_cbranch_scc0 L174
 v_mov_b32 v6, 0
 v_mov_b32 v7, 1
 s_mov_b64 exec, 1
 buffer_atomic_add v7, v6, s[8:11], 0 offen offset:112 sc1
 s_mov_b64 exec, -1
 s_waitcnt vmcnt(0)
L174:
 s_cmp_ge_u32 s47, 2
 s_cbranch_scc1 L175
 s_mov_b32 s12, s16
 s_mov_b32 s13, s17
 s_mov_b32 s14, 2359296
 s_mov_b32 s15, 0x20000
 v_lshrrev_b32 v120, 3, v220
 s_lshl_b32 s60, s44, 3
 v_add_u32 v120, s60, v120
 v_and_b32 v119, 7, v220
 v_mul_u32_u24 v118, 1152, v120
 v_lshlrev_b32 v117, 4, v119
 v_add_u32 v118, v118, v117
 s_mul_i32 s60, s64, 36864
 buffer_load_dwordx4 v[0:3], v118, s[12:15], s60 offen offset:0
 buffer_load_dwordx4 v[4:7], v118, s[12:15], s60 offen offset:128
 buffer_load_dwordx4 v[8:11], v118, s[12:15], s60 offen offset:256
 buffer_load_dwordx4 v[12:15], v118, s[12:15], s60 offen offset:384
 buffer_load_dwordx4 v[16:19], v118, s[12:15], s60 offen offset:512
 buffer_load_dwordx4 v[20:23], v118, s[12:15], s60 offen offset:640
 buffer_load_dwordx4 v[24:27], v118, s[12:15], s60 offen offset:768
 buffer_load_dwordx4 v[28:31], v118, s[12:15], s60 offen offset:896
 buffer_load_dwordx4 v[32:35], v118, s[12:15], s60 offen offset:1024
 v_lshrrev_b32 v117, 1, v119
 v_lshlrev_b32 v117, 10, v117
 v_and_b32 v116, 1, v119
 v_lshlrev_b32 v116, 9, v116
 v_add_u32 v117, v117, v116
 v_lshlrev_b32 v116, 4, v120
 v_add_u32 v117, v117, v116
 s_add_u32 s60, s60, 0
 s_mov_b32 s61, 0xffff0000
 s_waitcnt vmcnt(0)
 v_lshlrev_b32 v40, 16, v0
 v_and_b32 v41, s61, v0
 v_lshlrev_b32 v42, 16, v1
 v_and_b32 v43, s61, v1
 v_lshlrev_b32 v44, 16, v2
 v_and_b32 v45, s61, v2
 v_lshlrev_b32 v46, 16, v3
 v_and_b32 v47, s61, v3
 v_lshlrev_b32 v48, 16, v4
 v_and_b32 v49, s61, v4
 v_lshlrev_b32 v50, 16, v5
 v_and_b32 v51, s61, v5
 v_lshlrev_b32 v52, 16, v6
 v_and_b32 v53, s61, v6
 v_lshlrev_b32 v54, 16, v7
 v_and_b32 v55, s61, v7
 v_lshlrev_b32 v56, 16, v8
 v_and_b32 v57, s61, v8
 v_lshlrev_b32 v58, 16, v9
 v_and_b32 v59, s61, v9
 v_lshlrev_b32 v60, 16, v10
 v_and_b32 v61, s61, v10
 v_lshlrev_b32 v62, 16, v11
 v_and_b32 v63, s61, v11
 v_lshlrev_b32 v64, 16, v12
 v_and_b32 v65, s61, v12
 v_lshlrev_b32 v66, 16, v13
 v_and_b32 v67, s61, v13
 v_lshlrev_b32 v68, 16, v14
 v_and_b32 v69, s61, v14
 v_lshlrev_b32 v70, 16, v15
 v_and_b32 v71, s61, v15
 v_lshlrev_b32 v72, 16, v16
 v_and_b32 v73, s61, v16
 v_lshlrev_b32 v74, 16, v17
 v_and_b32 v75, s61, v17
 v_lshlrev_b32 v76, 16, v18
 v_and_b32 v77, s61, v18
 v_lshlrev_b32 v78, 16, v19
 v_and_b32 v79, s61, v19
 v_lshlrev_b32 v80, 16, v20
 v_and_b32 v81, s61, v20
 v_lshlrev_b32 v82, 16, v21
 v_and_b32 v83, s61, v21
 v_lshlrev_b32 v84, 16, v22
 v_and_b32 v85, s61, v22
 v_lshlrev_b32 v86, 16, v23
 v_and_b32 v87, s61, v23
 v_lshlrev_b32 v88, 16, v24
 v_and_b32 v89, s61, v24
 v_lshlrev_b32 v90, 16, v25
 v_and_b32 v91, s61, v25
 v_lshlrev_b32 v92, 16, v26
 v_and_b32 v93, s61, v26
 v_lshlrev_b32 v94, 16, v27
 v_and_b32 v95, s61, v27
 v_lshlrev_b32 v96, 16, v28
 v_and_b32 v97, s61, v28
 v_lshlrev_b32 v98, 16, v29
 v_and_b32 v99, s61, v29
 v_lshlrev_b32 v100, 16, v30
 v_and_b32 v101, s61, v30
 v_lshlrev_b32 v102, 16, v31
 v_and_b32 v103, s61, v31
 v_lshlrev_b32 v104, 16, v32
 v_and_b32 v105, s61, v32
 v_lshlrev_b32 v106, 16, v33
 v_and_b32 v107, s61, v33
 v_lshlrev_b32 v108, 16, v34
 v_and_b32 v109, s61, v34
 v_lshlrev_b32 v110, 16, v35
 v_and_b32 v111, s61, v35
 v_pk_add_f32 v[112:113], v[40:41], v[42:43]
 v_pk_add_f32 v[112:113], v[112:113], v[44:45]
 v_pk_add_f32 v[112:113], v[112:113], v[46:47]
 v_pk_add_f32 v[112:113], v[112:113], v[48:49]
 v_pk_add_f32 v[112:113], v[112:113], v[50:51]
 v_pk_add_f32 v[112:113], v[112:113], v[52:53]
 v_pk_add_f32 v[112:113], v[112:113], v[54:55]
 v_pk_add_f32 v[112:113], v[112:113], v[56:57]
 v_pk_add_f32 v[112:113], v[112:113], v[58:59]
 v_pk_add_f32 v[112:113], v[112:113], v[60:61]
 v_pk_add_f32 v[112:113], v[112:113], v[62:63]
 v_pk_add_f32 v[112:113], v[112:113], v[64:65]
 v_pk_add_f32 v[112:113], v[112:113], v[66:67]
 v_pk_add_f32 v[112:113], v[112:113], v[68:69]
 v_pk_add_f32 v[112:113], v[112:113], v[70:71]
 v_pk_add_f32 v[112:113], v[112:113], v[72:73]
 v_pk_add_f32 v[112:113], v[112:113], v[74:75]
 v_pk_add_f32 v[112:113], v[112:113], v[76:77]
 v_pk_add_f32 v[112:113], v[112:113], v[78:79]
 v_pk_add_f32 v[112:113], v[112:113], v[80:81]
 v_pk_add_f32 v[112:113], v[112:113], v[82:83]
 v_pk_add_f32 v[112:113], v[112:113], v[84:85]
 v_pk_add_f32 v[112:113], v[112:113], v[86:87]
 v_pk_add_f32 v[112:113], v[112:113], v[88:89]
 v_pk_add_f32 v[112:113], v[112:113], v[90:91]
 v_pk_add_f32 v[112:113], v[112:113], v[92:93]
 v_pk_add_f32 v[112:113], v[112:113], v[94:95]
 v_pk_add_f32 v[112:113], v[112:113], v[96:97]
 v_pk_add_f32 v[112:113], v[112:113], v[98:99]
 v_pk_add_f32 v[112:113], v[112:113], v[100:101]
 v_pk_add_f32 v[112:113], v[112:113], v[102:103]
 v_pk_add_f32 v[112:113], v[112:113], v[104:105]
 v_pk_add_f32 v[112:113], v[112:113], v[106:107]
 v_pk_add_f32 v[112:113], v[112:113], v[108:109]
 v_pk_add_f32 v[112:113], v[112:113], v[110:111]
 v_add_f32 v112, v112, v113
 s_nop 1
 v_add_f32_dpp v112, v112, v112 quad_perm:[1,0,3,2] row_mask:0xf bank_mask:0xf
 s_nop 1
 v_add_f32_dpp v112, v112, v112 quad_perm:[2,3,0,1] row_mask:0xf bank_mask:0xf
 s_nop 1
 v_add_f32_dpp v112, v112, v112 row_half_mirror row_mask:0xf bank_mask:0xf
 v_mul_f32 v112, 0x3ae38e39, v112
 v_mov_b32 v113, 0
 v_mov_b32 v114, 0
 v_sub_f32 v115, v40, v112
 v_sub_f32 v116, v41, v112
 v_fmac_f32 v113, v115, v115
 v_fmac_f32 v114, v116, v116
 v_sub_f32 v115, v42, v112
 v_sub_f32 v116, v43, v112
 v_fmac_f32 v113, v115, v115
 v_fmac_f32 v114, v116, v116
 v_sub_f32 v115, v44, v112
 v_sub_f32 v116, v45, v112
 v_fmac_f32 v113, v115, v115
 v_fmac_f32 v114, v116, v116
 v_sub_f32 v115, v46, v112
 v_sub_f32 v116, v47, v112
 v_fmac_f32 v113, v115, v115
 v_fmac_f32 v114, v116, v116
 v_sub_f32 v115, v48, v112
 v_sub_f32 v116, v49, v112
 v_fmac_f32 v113, v115, v115
 v_fmac_f32 v114, v116, v116
 v_sub_f32 v115, v50, v112
 v_sub_f32 v116, v51, v112
 v_fmac_f32 v113, v115, v115
 v_fmac_f32 v114, v116, v116
 v_sub_f32 v115, v52, v112
 v_sub_f32 v116, v53, v112
 v_fmac_f32 v113, v115, v115
 v_fmac_f32 v114, v116, v116
 v_sub_f32 v115, v54, v112
 v_sub_f32 v116, v55, v112
 v_fmac_f32 v113, v115, v115
 v_fmac_f32 v114, v116, v116
 v_sub_f32 v115, v56, v112
 v_sub_f32 v116, v57, v112
 v_fmac_f32 v113, v115, v115
 v_fmac_f32 v114, v116, v116
 v_sub_f32 v115, v58, v112
 v_sub_f32 v116, v59, v112
 v_fmac_f32 v113, v115, v115
 v_fmac_f32 v114, v116, v116
 v_sub_f32 v115, v60, v112
 v_sub_f32 v116, v61, v112
 v_fmac_f32 v113, v115, v115
 v_fmac_f32 v114, v116, v116
 v_sub_f32 v115, v62, v112
 v_sub_f32 v116, v63, v112
 v_fmac_f32 v113, v115, v115
 v_fmac_f32 v114, v116, v116
 v_sub_f32 v115, v64, v112
 v_sub_f32 v116, v65, v112
 v_fmac_f32 v113, v115, v115
 v_fmac_f32 v114, v116, v116
 v_sub_f32 v115, v66, v112
 v_sub_f32 v116, v67, v112
 v_fmac_f32 v113, v115, v115
 v_fmac_f32 v114, v116, v116
 v_sub_f32 v115, v68, v112
 v_sub_f32 v116, v69, v112
 v_fmac_f32 v113, v115, v115
 v_fmac_f32 v114, v116, v116
 v_sub_f32 v115, v70, v112
 v_sub_f32 v116, v71, v112
 v_fmac_f32 v113, v115, v115
 v_fmac_f32 v114, v116, v116
 v_sub_f32 v115, v72, v112
 v_sub_f32 v116, v73, v112
 v_fmac_f32 v113, v115, v115
 v_fmac_f32 v114, v116, v116
 v_sub_f32 v115, v74, v112
 v_sub_f32 v116, v75, v112
 v_fmac_f32 v113, v115, v115
 v_fmac_f32 v114, v116, v116
 v_sub_f32 v115, v76, v112
 v_sub_f32 v116, v77, v112
 v_fmac_f32 v113, v115, v115
 v_fmac_f32 v114, v116, v116
 v_sub_f32 v115, v78, v112
 v_sub_f32 v116, v79, v112
 v_fmac_f32 v113, v115, v115
 v_fmac_f32 v114, v116, v116
 v_sub_f32 v115, v80, v112
 v_sub_f32 v116, v81, v112
 v_fmac_f32 v113, v115, v115
 v_fmac_f32 v114, v116, v116
 v_sub_f32 v115, v82, v112
 v_sub_f32 v116, v83, v112
 v_fmac_f32 v113, v115, v115
 v_fmac_f32 v114, v116, v116
 v_sub_f32 v115, v84, v112
 v_sub_f32 v116, v85, v112
 v_fmac_f32 v113, v115, v115
 v_fmac_f32 v114, v116, v116
 v_sub_f32 v115, v86, v112
 v_sub_f32 v116, v87, v112
 v_fmac_f32 v113, v115, v115
 v_fmac_f32 v114, v116, v116
 v_sub_f32 v115, v88, v112
 v_sub_f32 v116, v89, v112
 v_fmac_f32 v113, v115, v115
 v_fmac_f32 v114, v116, v116
 v_sub_f32 v115, v90, v112
 v_sub_f32 v116, v91, v112
 v_fmac_f32 v113, v115, v115
 v_fmac_f32 v114, v116, v116
 v_sub_f32 v115, v92, v112
 v_sub_f32 v116, v93, v112
 v_fmac_f32 v113, v115, v115
 v_fmac_f32 v114, v116, v116
 v_sub_f32 v115, v94, v112
 v_sub_f32 v116, v95, v112
 v_fmac_f32 v113, v115, v115
 v_fmac_f32 v114, v116, v116
 v_sub_f32 v115, v96, v112
 v_sub_f32 v116, v97, v112
 v_fmac_f32 v113, v115, v115
 v_fmac_f32 v114, v116, v116
 v_sub_f32 v115, v98, v112
 v_sub_f32 v116, v99, v112
 v_fmac_f32 v113, v115, v115
 v_fmac_f32 v114, v116, v116
 v_sub_f32 v115, v100, v112
 v_sub_f32 v116, v101, v112
 v_fmac_f32 v113, v115, v115
 v_fmac_f32 v114, v116, v116
 v_sub_f32 v115, v102, v112
 v_sub_f32 v116, v103, v112
 v_fmac_f32 v113, v115, v115
 v_fmac_f32 v114, v116, v116
 v_sub_f32 v115, v104, v112
 v_sub_f32 v116, v105, v112
 v_fmac_f32 v113, v115, v115
 v_fmac_f32 v114, v116, v116
 v_sub_f32 v115, v106, v112
 v_sub_f32 v116, v107, v112
 v_fmac_f32 v113, v115, v115
 v_fmac_f32 v114, v116, v116
 v_sub_f32 v115, v108, v112
 v_sub_f32 v116, v109, v112
 v_fmac_f32 v113, v115, v115
 v_fmac_f32 v114, v116, v116
 v_sub_f32 v115, v110, v112
 v_sub_f32 v116, v111, v112
 v_fmac_f32 v113, v115, v115
 v_fmac_f32 v114, v116, v116
 v_add_f32 v113, v113, v114
 s_nop 1
 v_add_f32_dpp v113, v113, v113 quad_perm:[1,0,3,2] row_mask:0xf bank_mask:0xf
 s_nop 1
 v_add_f32_dpp v113, v113, v113 quad_perm:[2,3,0,1] row_mask:0xf bank_mask:0xf
 s_nop 1
 v_add_f32_dpp v113, v113, v113 row_half_mirror row_mask:0xf bank_mask:0xf
 v_mul_f32 v113, 0x3ae38e39, v113
 v_cvt_pk_bf16_f32 v114, v112, v112
 v_lshlrev_b32 v112, 16, v114
 v_cvt_pk_bf16_f32 v114, v113, v113
 v_lshlrev_b32 v113, 16, v114
 v_add_f32 v113, 0x3727c5ac, v113
 v_cvt_pk_bf16_f32 v114, v113, v113
 v_lshlrev_b32 v113, 16, v114
 v_sqrt_f32 v113, v113
 s_nop 0
 v_cvt_pk_bf16_f32 v114, v113, v113
 v_lshlrev_b32 v113, 16, v114
 v_rcp_f32 v113, v113
 s_nop 0
 v_sub_f32 v40, v40, v112
 v_sub_f32 v41, v41, v112
 v_cvt_pk_bf16_f32 v114, v40, v41
 v_lshlrev_b32 v40, 16, v114
 v_and_b32 v41, s61, v114
 v_mul_f32 v40, v40, v113
 v_mul_f32 v41, v41, v113
 v_cvt_pk_bf16_f32 v0, v40, v41
 v_sub_f32 v42, v42, v112
 v_sub_f32 v43, v43, v112
 v_cvt_pk_bf16_f32 v114, v42, v43
 v_lshlrev_b32 v42, 16, v114
 v_and_b32 v43, s61, v114
 v_mul_f32 v42, v42, v113
 v_mul_f32 v43, v43, v113
 v_cvt_pk_bf16_f32 v1, v42, v43
 v_sub_f32 v44, v44, v112
 v_sub_f32 v45, v45, v112
 v_cvt_pk_bf16_f32 v114, v44, v45
 v_lshlrev_b32 v44, 16, v114
 v_and_b32 v45, s61, v114
 v_mul_f32 v44, v44, v113
 v_mul_f32 v45, v45, v113
 v_cvt_pk_bf16_f32 v2, v44, v45
 v_sub_f32 v46, v46, v112
 v_sub_f32 v47, v47, v112
 v_cvt_pk_bf16_f32 v114, v46, v47
 v_lshlrev_b32 v46, 16, v114
 v_and_b32 v47, s61, v114
 v_mul_f32 v46, v46, v113
 v_mul_f32 v47, v47, v113
 v_cvt_pk_bf16_f32 v3, v46, v47
 v_sub_f32 v48, v48, v112
 v_sub_f32 v49, v49, v112
 v_cvt_pk_bf16_f32 v114, v48, v49
 v_lshlrev_b32 v48, 16, v114
 v_and_b32 v49, s61, v114
 v_mul_f32 v48, v48, v113
 v_mul_f32 v49, v49, v113
 v_cvt_pk_bf16_f32 v4, v48, v49
 v_sub_f32 v50, v50, v112
 v_sub_f32 v51, v51, v112
 v_cvt_pk_bf16_f32 v114, v50, v51
 v_lshlrev_b32 v50, 16, v114
 v_and_b32 v51, s61, v114
 v_mul_f32 v50, v50, v113
 v_mul_f32 v51, v51, v113
 v_cvt_pk_bf16_f32 v5, v50, v51
 v_sub_f32 v52, v52, v112
 v_sub_f32 v53, v53, v112
 v_cvt_pk_bf16_f32 v114, v52, v53
 v_lshlrev_b32 v52, 16, v114
 v_and_b32 v53, s61, v114
 v_mul_f32 v52, v52, v113
 v_mul_f32 v53, v53, v113
 v_cvt_pk_bf16_f32 v6, v52, v53
 v_sub_f32 v54, v54, v112
 v_sub_f32 v55, v55, v112
 v_cvt_pk_bf16_f32 v114, v54, v55
 v_lshlrev_b32 v54, 16, v114
 v_and_b32 v55, s61, v114
 v_mul_f32 v54, v54, v113
 v_mul_f32 v55, v55, v113
 v_cvt_pk_bf16_f32 v7, v54, v55
 v_sub_f32 v56, v56, v112
 v_sub_f32 v57, v57, v112
 v_cvt_pk_bf16_f32 v114, v56, v57
 v_lshlrev_b32 v56, 16, v114
 v_and_b32 v57, s61, v114
 v_mul_f32 v56, v56, v113
 v_mul_f32 v57, v57, v113
 v_cvt_pk_bf16_f32 v8, v56, v57
 v_sub_f32 v58, v58, v112
 v_sub_f32 v59, v59, v112
 v_cvt_pk_bf16_f32 v114, v58, v59
 v_lshlrev_b32 v58, 16, v114
 v_and_b32 v59, s61, v114
 v_mul_f32 v58, v58, v113
 v_mul_f32 v59, v59, v113
 v_cvt_pk_bf16_f32 v9, v58, v59
 v_sub_f32 v60, v60, v112
 v_sub_f32 v61, v61, v112
 v_cvt_pk_bf16_f32 v114, v60, v61
 v_lshlrev_b32 v60, 16, v114
 v_and_b32 v61, s61, v114
 v_mul_f32 v60, v60, v113
 v_mul_f32 v61, v61, v113
 v_cvt_pk_bf16_f32 v10, v60, v61
 v_sub_f32 v62, v62, v112
 v_sub_f32 v63, v63, v112
 v_cvt_pk_bf16_f32 v114, v62, v63
 v_lshlrev_b32 v62, 16, v114
 v_and_b32 v63, s61, v114
 v_mul_f32 v62, v62, v113
 v_mul_f32 v63, v63, v113
 v_cvt_pk_bf16_f32 v11, v62, v63
 v_sub_f32 v64, v64, v112
 v_sub_f32 v65, v65, v112
 v_cvt_pk_bf16_f32 v114, v64, v65
 v_lshlrev_b32 v64, 16, v114
 v_and_b32 v65, s61, v114
 v_mul_f32 v64, v64, v113
 v_mul_f32 v65, v65, v113
 v_cvt_pk_bf16_f32 v12, v64, v65
 v_sub_f32 v66, v66, v112
 v_sub_f32 v67, v67, v112
 v_cvt_pk_bf16_f32 v114, v66, v67
 v_lshlrev_b32 v66, 16, v114
 v_and_b32 v67, s61, v114
 v_mul_f32 v66, v66, v113
 v_mul_f32 v67, v67, v113
 v_cvt_pk_bf16_f32 v13, v66, v67
 v_sub_f32 v68, v68, v112
 v_sub_f32 v69, v69, v112
 v_cvt_pk_bf16_f32 v114, v68, v69
 v_lshlrev_b32 v68, 16, v114
 v_and_b32 v69, s61, v114
 v_mul_f32 v68, v68, v113
 v_mul_f32 v69, v69, v113
 v_cvt_pk_bf16_f32 v14, v68, v69
 v_sub_f32 v70, v70, v112
 v_sub_f32 v71, v71, v112
 v_cvt_pk_bf16_f32 v114, v70, v71
 v_lshlrev_b32 v70, 16, v114
 v_and_b32 v71, s61, v114
 v_mul_f32 v70, v70, v113
 v_mul_f32 v71, v71, v113
 v_cvt_pk_bf16_f32 v15, v70, v71
 v_sub_f32 v72, v72, v112
 v_sub_f32 v73, v73, v112
 v_cvt_pk_bf16_f32 v114, v72, v73
 v_lshlrev_b32 v72, 16, v114
 v_and_b32 v73, s61, v114
 v_mul_f32 v72, v72, v113
 v_mul_f32 v73, v73, v113
 v_cvt_pk_bf16_f32 v16, v72, v73
 v_sub_f32 v74, v74, v112
 v_sub_f32 v75, v75, v112
 v_cvt_pk_bf16_f32 v114, v74, v75
 v_lshlrev_b32 v74, 16, v114
 v_and_b32 v75, s61, v114
 v_mul_f32 v74, v74, v113
 v_mul_f32 v75, v75, v113
 v_cvt_pk_bf16_f32 v17, v74, v75
 v_sub_f32 v76, v76, v112
 v_sub_f32 v77, v77, v112
 v_cvt_pk_bf16_f32 v114, v76, v77
 v_lshlrev_b32 v76, 16, v114
 v_and_b32 v77, s61, v114
 v_mul_f32 v76, v76, v113
 v_mul_f32 v77, v77, v113
 v_cvt_pk_bf16_f32 v18, v76, v77
 v_sub_f32 v78, v78, v112
 v_sub_f32 v79, v79, v112
 v_cvt_pk_bf16_f32 v114, v78, v79
 v_lshlrev_b32 v78, 16, v114
 v_and_b32 v79, s61, v114
 v_mul_f32 v78, v78, v113
 v_mul_f32 v79, v79, v113
 v_cvt_pk_bf16_f32 v19, v78, v79
 v_sub_f32 v80, v80, v112
 v_sub_f32 v81, v81, v112
 v_cvt_pk_bf16_f32 v114, v80, v81
 v_lshlrev_b32 v80, 16, v114
 v_and_b32 v81, s61, v114
 v_mul_f32 v80, v80, v113
 v_mul_f32 v81, v81, v113
 v_cvt_pk_bf16_f32 v20, v80, v81
 v_sub_f32 v82, v82, v112
 v_sub_f32 v83, v83, v112
 v_cvt_pk_bf16_f32 v114, v82, v83
 v_lshlrev_b32 v82, 16, v114
 v_and_b32 v83, s61, v114
 v_mul_f32 v82, v82, v113
 v_mul_f32 v83, v83, v113
 v_cvt_pk_bf16_f32 v21, v82, v83
 v_sub_f32 v84, v84, v112
 v_sub_f32 v85, v85, v112
 v_cvt_pk_bf16_f32 v114, v84, v85
 v_lshlrev_b32 v84, 16, v114
 v_and_b32 v85, s61, v114
 v_mul_f32 v84, v84, v113
 v_mul_f32 v85, v85, v113
 v_cvt_pk_bf16_f32 v22, v84, v85
 v_sub_f32 v86, v86, v112
 v_sub_f32 v87, v87, v112
 v_cvt_pk_bf16_f32 v114, v86, v87
 v_lshlrev_b32 v86, 16, v114
 v_and_b32 v87, s61, v114
 v_mul_f32 v86, v86, v113
 v_mul_f32 v87, v87, v113
 v_cvt_pk_bf16_f32 v23, v86, v87
 v_sub_f32 v88, v88, v112
 v_sub_f32 v89, v89, v112
 v_cvt_pk_bf16_f32 v114, v88, v89
 v_lshlrev_b32 v88, 16, v114
 v_and_b32 v89, s61, v114
 v_mul_f32 v88, v88, v113
 v_mul_f32 v89, v89, v113
 v_cvt_pk_bf16_f32 v24, v88, v89
 v_sub_f32 v90, v90, v112
 v_sub_f32 v91, v91, v112
 v_cvt_pk_bf16_f32 v114, v90, v91
 v_lshlrev_b32 v90, 16, v114
 v_and_b32 v91, s61, v114
 v_mul_f32 v90, v90, v113
 v_mul_f32 v91, v91, v113
 v_cvt_pk_bf16_f32 v25, v90, v91
 v_sub_f32 v92, v92, v112
 v_sub_f32 v93, v93, v112
 v_cvt_pk_bf16_f32 v114, v92, v93
 v_lshlrev_b32 v92, 16, v114
 v_and_b32 v93, s61, v114
 v_mul_f32 v92, v92, v113
 v_mul_f32 v93, v93, v113
 v_cvt_pk_bf16_f32 v26, v92, v93
 v_sub_f32 v94, v94, v112
 v_sub_f32 v95, v95, v112
 v_cvt_pk_bf16_f32 v114, v94, v95
 v_lshlrev_b32 v94, 16, v114
 v_and_b32 v95, s61, v114
 v_mul_f32 v94, v94, v113
 v_mul_f32 v95, v95, v113
 v_cvt_pk_bf16_f32 v27, v94, v95
 v_sub_f32 v96, v96, v112
 v_sub_f32 v97, v97, v112
 v_cvt_pk_bf16_f32 v114, v96, v97
 v_lshlrev_b32 v96, 16, v114
 v_and_b32 v97, s61, v114
 v_mul_f32 v96, v96, v113
 v_mul_f32 v97, v97, v113
 v_cvt_pk_bf16_f32 v28, v96, v97
 v_sub_f32 v98, v98, v112
 v_sub_f32 v99, v99, v112
 v_cvt_pk_bf16_f32 v114, v98, v99
 v_lshlrev_b32 v98, 16, v114
 v_and_b32 v99, s61, v114
 v_mul_f32 v98, v98, v113
 v_mul_f32 v99, v99, v113
 v_cvt_pk_bf16_f32 v29, v98, v99
 v_sub_f32 v100, v100, v112
 v_sub_f32 v101, v101, v112
 v_cvt_pk_bf16_f32 v114, v100, v101
 v_lshlrev_b32 v100, 16, v114
 v_and_b32 v101, s61, v114
 v_mul_f32 v100, v100, v113
 v_mul_f32 v101, v101, v113
 v_cvt_pk_bf16_f32 v30, v100, v101
 v_sub_f32 v102, v102, v112
 v_sub_f32 v103, v103, v112
 v_cvt_pk_bf16_f32 v114, v102, v103
 v_lshlrev_b32 v102, 16, v114
 v_and_b32 v103, s61, v114
 v_mul_f32 v102, v102, v113
 v_mul_f32 v103, v103, v113
 v_cvt_pk_bf16_f32 v31, v102, v103
 v_sub_f32 v104, v104, v112
 v_sub_f32 v105, v105, v112
 v_cvt_pk_bf16_f32 v114, v104, v105
 v_lshlrev_b32 v104, 16, v114
 v_and_b32 v105, s61, v114
 v_mul_f32 v104, v104, v113
 v_mul_f32 v105, v105, v113
 v_cvt_pk_bf16_f32 v32, v104, v105
 v_sub_f32 v106, v106, v112
 v_sub_f32 v107, v107, v112
 v_cvt_pk_bf16_f32 v114, v106, v107
 v_lshlrev_b32 v106, 16, v114
 v_and_b32 v107, s61, v114
 v_mul_f32 v106, v106, v113
 v_mul_f32 v107, v107, v113
 v_cvt_pk_bf16_f32 v33, v106, v107
 v_sub_f32 v108, v108, v112
 v_sub_f32 v109, v109, v112
 v_cvt_pk_bf16_f32 v114, v108, v109
 v_lshlrev_b32 v108, 16, v114
 v_and_b32 v109, s61, v114
 v_mul_f32 v108, v108, v113
 v_mul_f32 v109, v109, v113
 v_cvt_pk_bf16_f32 v34, v108, v109
 v_sub_f32 v110, v110, v112
 v_sub_f32 v111, v111, v112
 v_cvt_pk_bf16_f32 v114, v110, v111
 v_lshlrev_b32 v110, 16, v114
 v_and_b32 v111, s61, v114
 v_mul_f32 v110, v110, v113
 v_mul_f32 v111, v111, v113
 v_cvt_pk_bf16_f32 v35, v110, v111
 s_add_u32 s61, s60, 0
 buffer_store_dwordx4 v[0:3], v117, s[4:7], s61 offen sc1
 s_add_u32 s61, s60, 4096
 buffer_store_dwordx4 v[4:7], v117, s[4:7], s61 offen sc1
 s_add_u32 s61, s60, 8192
 buffer_store_dwordx4 v[8:11], v117, s[4:7], s61 offen sc1
 s_add_u32 s61, s60, 12288
 buffer_store_dwordx4 v[12:15], v117, s[4:7], s61 offen sc1
 s_add_u32 s61, s60, 16384
 buffer_store_dwordx4 v[16:19], v117, s[4:7], s61 offen sc1
 s_add_u32 s61, s60, 20480
 buffer_store_dwordx4 v[20:23], v117, s[4:7], s61 offen sc1
 s_add_u32 s61, s60, 24576
 buffer_store_dwordx4 v[24:27], v117, s[4:7], s61 offen sc1
 s_add_u32 s61, s60, 28672
 buffer_store_dwordx4 v[28:31], v117, s[4:7], s61 offen sc1
 s_add_u32 s61, s60, 32768
 buffer_store_dwordx4 v[32:35], v117, s[4:7], s61 offen sc1
 s_waitcnt vmcnt(0)
 s_barrier
 s_cmp_eq_u32 s44, 0
 s_cbranch_scc0 L176
 s_lshl_b32 s60, s64, 2
 s_add_u32 s60, s60, 73408512
 s_mov_b32 s61, 1
 v_mov_b32 v6, 0
 v_mov_b32 v7, s61
 s_mov_b64 exec, 1
 buffer_store_dword v7, v6, s[4:7], s60 offen sc1
 s_mov_b64 exec, -1
L176:
L175:
 s_mov_b32 s48, s26
 s_mov_b32 s49, s27
 s_mov_b32 s50, 4718592
 s_mov_b32 s51, 0x20000
 s_mov_b32 s52, s16
 s_mov_b32 s53, s17
 s_mov_b32 s54, 2359296
 s_mov_b32 s55, 0x20000
 s_mul_i32 s67, s44, 5
 s_cmp_eq_u32 s44, 3
 s_cselect_b32 s67, 14, s67
 s_cmp_lt_u32 s44, 2
 s_cselect_b32 s68, 5, 4
 s_mul_i32 s66, s44, 40960
 v_mul_u32_u24 v6, 3277, v220
 v_lshrrev_b32 v6, 16, v6
 v_mul_u32_u24 v8, 20, v6
 v_sub_u32 v8, v220, v8
 v_mul_u32_u24 v6, 1152, v6
 v_lshlrev_b32 v8, 4, v8
 v_add_u32 v6, v6, v8
 s_mul_i32 s60, s46, 147456
 s_lshl_b32 s61, s67, 6
 s_add_u32 s60, s60, s61
 v_add_u32 v0, s60, v6
 v_lshrrev_b32 v6, 5, v220
 v_lshlrev_b32 v6, 3, v6
 v_bfe_u32 v8, v220, 2, 2
 v_add_u32 v6, v6, v8
 v_mul_u32_u24 v6, 320, v6
 v_bfe_u32 v8, v220, 4, 1
 v_lshlrev_b32 v8, 5, v8
 v_add_u32 v6, v6, v8
 v_and_b32 v8, 3, v220
 v_lshlrev_b32 v8, 3, v8
 v_add_u32 v6, v6, v8
 v_add_u32 v2, s66, v6
 s_barrier
 s_mov_b32 exec_lo, -1
 s_mov_b32 exec_hi, 0x0fffffff
 s_add_u32 m0, s66, 0
 s_mov_b32 s60, 0
 buffer_load_dwordx4 v0, s[48:51], s60 offen lds
 s_add_u32 m0, s66, 960
 s_mov_b32 s60, 3456
 buffer_load_dwordx4 v0, s[48:51], s60 offen lds
 s_add_u32 m0, s66, 1920
 s_mov_b32 s60, 6912
 buffer_load_dwordx4 v0, s[48:51], s60 offen lds
 s_add_u32 m0, s66, 2880
 s_mov_b32 s60, 10368
 buffer_load_dwordx4 v0, s[48:51], s60 offen lds
 s_add_u32 m0, s66, 3840
 s_mov_b32 s60, 13824
 buffer_load_dwordx4 v0, s[48:51], s60 offen lds
 s_add_u32 m0, s66, 4800
 s_mov_b32 s60, 17280
 buffer_load_dwordx4 v0, s[48:51], s60 offen lds
 s_add_u32 m0, s66, 5760
 s_mov_b32 s60, 20736
 buffer_load_dwordx4 v0, s[48:51], s60 offen lds
 s_add_u32 m0, s66, 6720
 s_mov_b32 s60, 24192
 buffer_load_dwordx4 v0, s[48:51], s60 offen lds
 s_add_u32 m0, s66, 7680
 s_mov_b32 s60, 27648
 buffer_load_dwordx4 v0, s[48:51], s60 offen lds
 s_add_u32 m0, s66, 8640
 s_mov_b32 s60, 31104
 buffer_load_dwordx4 v0, s[48:51], s60 offen lds
 s_add_u32 m0, s66, 9600
 s_mov_b32 s60, 34560
 buffer_load_dwordx4 v0, s[48:51], s60 offen lds
 s_add_u32 m0, s66, 10560
 s_mov_b32 s60, 38016
 buffer_load_dwordx4 v0, s[48:51], s60 offen lds
 s_add_u32 m0, s66, 11520
 s_mov_b32 s60, 41472
 buffer_load_dwordx4 v0, s[48:51], s60 offen lds
 s_add_u32 m0, s66, 12480
 s_mov_b32 s60, 44928
 buffer_load_dwordx4 v0, s[48:51], s60 offen lds
 s_add_u32 m0, s66, 13440
 s_mov_b32 s60, 48384
 buffer_load_dwordx4 v0, s[48:51], s60 offen lds
 s_add_u32 m0, s66, 14400
 s_mov_b32 s60, 51840
 buffer_load_dwordx4 v0, s[48:51], s60 offen lds
 s_add_u32 m0, s66, 15360
 s_mov_b32 s60, 55296
 buffer_load_dwordx4 v0, s[48:51], s60 offen lds
 s_add_u32 m0, s66, 16320
 s_mov_b32 s60, 58752
 buffer_load_dwordx4 v0, s[48:51], s60 offen lds
 s_add_u32 m0, s66, 17280
 s_mov_b32 s60, 62208
 buffer_load_dwordx4 v0, s[48:51], s60 offen lds
 s_add_u32 m0, s66, 18240
 s_mov_b32 s60, 65664
 buffer_load_dwordx4 v0, s[48:51], s60 offen lds
 s_add_u32 m0, s66, 19200
 s_mov_b32 s60, 69120
 buffer_load_dwordx4 v0, s[48:51], s60 offen lds
 s_add_u32 m0, s66, 20160
 s_mov_b32 s60, 72576
 buffer_load_dwordx4 v0, s[48:51], s60 offen lds
 s_add_u32 m0, s66, 21120
 s_mov_b32 s60, 76032
 buffer_load_dwordx4 v0, s[48:51], s60 offen lds
 s_add_u32 m0, s66, 22080
 s_mov_b32 s60, 79488
 buffer_load_dwordx4 v0, s[48:51], s60 offen lds
 s_add_u32 m0, s66, 23040
 s_mov_b32 s60, 82944
 buffer_load_dwordx4 v0, s[48:51], s60 offen lds
 s_add_u32 m0, s66, 24000
 s_mov_b32 s60, 86400
 buffer_load_dwordx4 v0, s[48:51], s60 offen lds
 s_add_u32 m0, s66, 24960
 s_mov_b32 s60, 89856
 buffer_load_dwordx4 v0, s[48:51], s60 offen lds
 s_add_u32 m0, s66, 25920
 s_mov_b32 s60, 93312
 buffer_load_dwordx4 v0, s[48:51], s60 offen lds
 s_add_u32 m0, s66, 26880
 s_mov_b32 s60, 96768
 buffer_load_dwordx4 v0, s[48:51], s60 offen lds
 s_add_u32 m0, s66, 27840
 s_mov_b32 s60, 100224
 buffer_load_dwordx4 v0, s[48:51], s60 offen lds
 s_add_u32 m0, s66, 28800
 s_mov_b32 s60, 103680
 buffer_load_dwordx4 v0, s[48:51], s60 offen lds
 s_add_u32 m0, s66, 29760
 s_mov_b32 s60, 107136
 buffer_load_dwordx4 v0, s[48:51], s60 offen lds
 s_add_u32 m0, s66, 30720
 s_mov_b32 s60, 110592
 buffer_load_dwordx4 v0, s[48:51], s60 offen lds
 s_add_u32 m0, s66, 31680
 s_mov_b32 s60, 114048
 buffer_load_dwordx4 v0, s[48:51], s60 offen lds
 s_add_u32 m0, s66, 32640
 s_mov_b32 s60, 117504
 buffer_load_dwordx4 v0, s[48:51], s60 offen lds
 s_add_u32 m0, s66, 33600
 s_mov_b32 s60, 120960
 buffer_load_dwordx4 v0, s[48:51], s60 offen lds
 s_add_u32 m0, s66, 34560
 s_mov_b32 s60, 124416
 buffer_load_dwordx4 v0, s[48:51], s60 offen lds
 s_add_u32 m0, s66, 35520
 s_mov_b32 s60, 127872
 buffer_load_dwordx4 v0, s[48:51], s60 offen lds
 s_add_u32 m0, s66, 36480
 s_mov_b32 s60, 131328
 buffer_load_dwordx4 v0, s[48:51], s60 offen lds
 s_add_u32 m0, s66, 37440
 s_mov_b32 s60, 134784
 buffer_load_dwordx4 v0, s[48:51], s60 offen lds
 s_add_u32 m0, s66, 38400
 s_mov_b32 s60, 138240
 buffer_load_dwordx4 v0, s[48:51], s60 offen lds
 s_add_u32 m0, s66, 39360
 s_mov_b32 s60, 141696
 buffer_load_dwordx4 v0, s[48:51], s60 offen lds
 s_mov_b32 exec_hi, 0xff
 s_add_u32 m0, s66, 40320
 s_mov_b32 s60, 145152
 buffer_load_dwordx4 v0, s[48:51], s60 offen lds
 s_mov_b64 exec, -1
 s_waitcnt vmcnt(0)
 ds_read_b64_tr_b16 a[0:1], v2 offset:0
 ds_read_b64_tr_b16 a[2:3], v2 offset:1280
 ds_read_b64_tr_b16 a[4:5], v2 offset:5120
 ds_read_b64_tr_b16 a[6:7], v2 offset:6400
 ds_read_b64_tr_b16 a[8:9], v2 offset:10240
 ds_read_b64_tr_b16 a[10:11], v2 offset:11520
 ds_read_b64_tr_b16 a[12:13], v2 offset:15360
 ds_read_b64_tr_b16 a[14:15], v2 offset:16640
 ds_read_b64_tr_b16 a[16:17], v2 offset:20480
 ds_read_b64_tr_b16 a[18:19], v2 offset:21760
 ds_read_b64_tr_b16 a[20:21], v2 offset:25600
 ds_read_b64_tr_b16 a[22:23], v2 offset:26880
 ds_read_b64_tr_b16 a[24:25], v2 offset:30720
 ds_read_b64_tr_b16 a[26:27], v2 offset:32000
 ds_read_b64_tr_b16 a[28:29], v2 offset:35840
 ds_read_b64_tr_b16 a[30:31], v2 offset:37120
 s_waitcnt lgkmcnt(0)
 ds_read_b64_tr_b16 a[32:33], v2 offset:64
 ds_read_b64_tr_b16 a[34:35], v2 offset:1344
 ds_read_b64_tr_b16 a[36:37], v2 offset:5184
 ds_read_b64_tr_b16 a[38:39], v2 offset:6464
 ds_read_b64_tr_b16 a[40:41], v2 offset:10304
 ds_read_b64_tr_b16 a[42:43], v2 offset:11584
 ds_read_b64_tr_b16 a[44:45], v2 offset:15424
 ds_read_b64_tr_b16 a[46:47], v2 offset:16704
 ds_read_b64_tr_b16 a[48:49], v2 offset:20544
 ds_read_b64_tr_b16 a[50:51], v2 offset:21824
 ds_read_b64_tr_b16 a[52:53], v2 offset:25664
 ds_read_b64_tr_b16 a[54:55], v2 offset:26944
 ds_read_b64_tr_b16 a[56:57], v2 offset:30784
 ds_read_b64_tr_b16 a[58:59], v2 offset:32064
 ds_read_b64_tr_b16 a[60:61], v2 offset:35904
 ds_read_b64_tr_b16 a[62:63], v2 offset:37184
 s_waitcnt lgkmcnt(0)
 ds_read_b64_tr_b16 a[64:65], v2 offset:128
 ds_read_b64_tr_b16 a[66:67], v2 offset:1408
 ds_read_b64_tr_b16 a[68:69], v2 offset:5248
 ds_read_b64_tr_b16 a[70:71], v2 offset:6528
 ds_read_b64_tr_b16 a[72:73], v2 offset:10368
 ds_read_b64_tr_b16 a[74:75], v2 offset:11648
 ds_read_b64_tr_b16 a[76:77], v2 offset:15488
 ds_read_b64_tr_b16 a[78:79], v2 offset:16768
 ds_read_b64_tr_b16 a[80:81], v2 offset:20608
 ds_read_b64_tr_b16 a[82:83], v2 offset:21888
 ds_read_b64_tr_b16 a[84:85], v2 offset:25728
 ds_read_b64_tr_b16 a[86:87], v2 offset:27008
 ds_read_b64_tr_b16 a[88:89], v2 offset:30848
 ds_read_b64_tr_b16 a[90:91], v2 offset:32128
 ds_read_b64_tr_b16 a[92:93], v2 offset:35968
 ds_read_b64_tr_b16 a[94:95], v2 offset:37248
 s_waitcnt lgkmcnt(0)
 ds_read_b64_tr_b16 a[96:97], v2 offset:192
 ds_read_b64_tr_b16 a[98:99], v2 offset:1472
 ds_read_b64_tr_b16 a[100:101], v2 offset:5312
 ds_read_b64_tr_b16 a[102:103], v2 offset:6592
 ds_read_b64_tr_b16 a[104:105], v2 offset:10432
 ds_read_b64_tr_b16 a[106:107], v2 offset:11712
 ds_read_b64_tr_b16 a[108:109], v2 offset:15552
 ds_read_b64_tr_b16 a[110:111], v2 offset:16832
 ds_read_b64_tr_b16 a[112:113], v2 offset:20672
 ds_read_b64_tr_b16 a[114:115], v2 offset:21952
 ds_read_b64_tr_b16 a[116:117], v2 offset:25792
 ds_read_b64_tr_b16 a[118:119], v2 offset:27072
 ds_read_b64_tr_b16 a[120:121], v2 offset:30912
 ds_read_b64_tr_b16 a[122:123], v2 offset:32192
 ds_read_b64_tr_b16 a[124:125], v2 offset:36032
 ds_read_b64_tr_b16 a[126:127], v2 offset:37312
 s_waitcnt lgkmcnt(0)
 ds_read_b64_tr_b16 a[128:129], v2 offset:256
 ds_read_b64_tr_b16 a[130:131], v2 offset:1536
 ds_read_b64_tr_b16 a[132:133], v2 offset:5376
 ds_read_b64_tr_b16 a[134:135], v2 offset:6656
 ds_read_b64_tr_b16 a[136:137], v2 offset:10496
 ds_read_b64_tr_b16 a[138:139], v2 offset:11776
 ds_read_b64_tr_b16 a[140:141], v2 offset:15616
 ds_read_b64_tr_b16 a[142:143], v2 offset:16896
 ds_read_b64_tr_b16 a[144:145], v2 offset:20736
 ds_read_b64_tr_b16 a[146:147], v2 offset:22016
 ds_read_b64_tr_b16 a[148:149], v2 offset:25856
 ds_read_b64_tr_b16 a[150:151], v2 offset:27136
 ds_read_b64_tr_b16 a[152:153], v2 offset:30976
 ds_read_b64_tr_b16 a[154:155], v2 offset:32256
 ds_read_b64_tr_b16 a[156:157], v2 offset:36096
 ds_read_b64_tr_b16 a[158:159], v2 offset:37376
 s_waitcnt lgkmcnt(0)
 s_mov_b32 s24, s20
 s_mov_b32 s25, s21
 s_mov_b32 s26, 4718592
 s_mov_b32 s27, 0x20000
 s_barrier
 v_lshrrev_b32 v6, 2, v220
 v_lshlrev_b32 v6, 13, v6
 v_and_b32 v7, 3, v220
 v_lshlrev_b32 v8, 4, v7
 v_add_u32 v6, v6, v8
 s_lshl_b32 s60, s46, 8
 s_lshl_b32 s61, s44, 6
 s_add_u32 s60, s60, s61
 v_add_u32 v0, s60, v6
 v_lshrrev_b32 v6, 5, v220
 v_lshlrev_b32 v6, 3, v6
 v_bfe_u32 v8, v220, 2, 2
 v_add_u32 v6, v6, v8
 v_lshlrev_b32 v6, 6, v6
 v_bfe_u32 v8, v220, 4, 1
 v_lshlrev_b32 v8, 5, v8
 v_add_u32 v6, v6, v8
 v_lshlrev_b32 v7, 3, v7
 v_add_u32 v6, v6, v7
 s_mul_i32 s60, s44, 12288
 v_add_u32 v2, s60, v6
 s_add_u32 s61, s60, 62464
 v_add_u32 v217, s61, v221
 s_mov_b32 s66, s60
 s_add_u32 m0, s66, 0
 s_mov_b32 s60, 0
 buffer_load_dwordx4 v0, s[24:27], s60 offen lds
 s_add_u32 m0, s66, 1024
 s_mov_b32 s60, 131072
 buffer_load_dwordx4 v0, s[24:27], s60 offen lds
 s_add_u32 m0, s66, 2048
 s_mov_b32 s60, 262144
 buffer_load_dwordx4 v0, s[24:27], s60 offen lds
 s_add_u32 m0, s66, 3072
 s_mov_b32 s60, 393216
 buffer_load_dwordx4 v0, s[24:27], s60 offen lds
 s_add_u32 m0, s66, 4096
 s_mov_b32 s60, 524288
 buffer_load_dwordx4 v0, s[24:27], s60 offen lds
 s_add_u32 m0, s66, 5120
 s_mov_b32 s60, 655360
 buffer_load_dwordx4 v0, s[24:27], s60 offen lds
 s_add_u32 m0, s66, 6144
 s_mov_b32 s60, 786432
 buffer_load_dwordx4 v0, s[24:27], s60 offen lds
 s_add_u32 m0, s66, 7168
 s_mov_b32 s60, 917504
 buffer_load_dwordx4 v0, s[24:27], s60 offen lds
 s_add_u32 m0, s66, 8192
 s_mov_b32 s60, 1048576
 buffer_load_dwordx4 v0, s[24:27], s60 offen lds
 s_add_u32 m0, s66, 9216
 s_mov_b32 s60, 1179648
 buffer_load_dwordx4 v0, s[24:27], s60 offen lds
 s_add_u32 m0, s66, 10240
 s_mov_b32 s60, 1310720
 buffer_load_dwordx4 v0, s[24:27], s60 offen lds
 s_add_u32 m0, s66, 11264
 s_mov_b32 s60, 1441792
 buffer_load_dwordx4 v0, s[24:27], s60 offen lds
 s_waitcnt vmcnt(8)
 ds_read_b64_tr_b16 a[160:161], v2 offset:0
 ds_read_b64_tr_b16 a[162:163], v2 offset:256
 ds_read_b64_tr_b16 a[164:165], v2 offset:1024
 ds_read_b64_tr_b16 a[166:167], v2 offset:1280
 ds_read_b64_tr_b16 a[168:169], v2 offset:2048
 ds_read_b64_tr_b16 a[170:171], v2 offset:2304
 ds_read_b64_tr_b16 a[172:173], v2 offset:3072
 ds_read_b64_tr_b16 a[174:175], v2 offset:3328
 s_waitcnt lgkmcnt(0)
 s_add_u32 m0, s66, 0
 s_mov_b32 s60, 1572864
 buffer_load_dwordx4 v0, s[24:27], s60 offen lds
 s_add_u32 m0, s66, 1024
 s_mov_b32 s60, 1703936
 buffer_load_dwordx4 v0, s[24:27], s60 offen lds
 s_add_u32 m0, s66, 2048
 s_mov_b32 s60, 1835008
 buffer_load_dwordx4 v0, s[24:27], s60 offen lds
 s_add_u32 m0, s66, 3072
 s_mov_b32 s60, 1966080
 buffer_load_dwordx4 v0, s[24:27], s60 offen lds
 s_waitcnt vmcnt(8)
 ds_read_b64_tr_b16 a[176:177], v2 offset:4096
 ds_read_b64_tr_b16 a[178:179], v2 offset:4352
 ds_read_b64_tr_b16 a[180:181], v2 offset:5120
 ds_read_b64_tr_b16 a[182:183], v2 offset:5376
 ds_read_b64_tr_b16 a[184:185], v2 offset:6144
 ds_read_b64_tr_b16 a[186:187], v2 offset:6400
 ds_read_b64_tr_b16 a[188:189], v2 offset:7168
 ds_read_b64_tr_b16 a[190:191], v2 offset:7424
 s_waitcnt lgkmcnt(0)
 s_add_u32 m0, s66, 4096
 s_mov_b32 s60, 2097152
 buffer_load_dwordx4 v0, s[24:27], s60 offen lds
 s_add_u32 m0, s66, 5120
 s_mov_b32 s60, 2228224
 buffer_load_dwordx4 v0, s[24:27], s60 offen lds
 s_add_u32 m0, s66, 6144
 s_mov_b32 s60, 2359296
 buffer_load_dwordx4 v0, s[24:27], s60 offen lds
 s_add_u32 m0, s66, 7168
 s_mov_b32 s60, 2490368
 buffer_load_dwordx4 v0, s[24:27], s60 offen lds
 s_waitcnt vmcnt(8)
 ds_read_b64_tr_b16 a[192:193], v2 offset:8192
 ds_read_b64_tr_b16 a[194:195], v2 offset:8448
 ds_read_b64_tr_b16 a[196:197], v2 offset:9216
 ds_read_b64_tr_b16 a[198:199], v2 offset:9472
 ds_read_b64_tr_b16 a[200:201], v2 offset:10240
 ds_read_b64_tr_b16 a[202:203], v2 offset:10496
 ds_read_b64_tr_b16 a[204:205], v2 offset:11264
 ds_read_b64_tr_b16 a[206:207], v2 offset:11520
 s_waitcnt lgkmcnt(0)
 s_add_u32 m0, s66, 8192
 s_mov_b32 s60, 2621440
 buffer_load_dwordx4 v0, s[24:27], s60 offen lds
 s_add_u32 m0, s66, 9216
 s_mov_b32 s60, 2752512
 buffer_load_dwordx4 v0, s[24:27], s60 offen lds
 s_add_u32 m0, s66, 10240
 s_mov_b32 s60, 2883584
 buffer_load_dwordx4 v0, s[24:27], s60 offen lds
 s_add_u32 m0, s66, 11264
 s_mov_b32 s60, 3014656
 buffer_load_dwordx4 v0, s[24:27], s60 offen lds
 s_waitcnt vmcnt(8)
 ds_read_b64_tr_b16 a[208:209], v2 offset:0
 ds_read_b64_tr_b16 a[210:211], v2 offset:256
 ds_read_b64_tr_b16 a[212:213], v2 offset:1024
 ds_read_b64_tr_b16 a[214:215], v2 offset:1280
 ds_read_b64_tr_b16 a[216:217], v2 offset:2048
 ds_read_b64_tr_b16 a[218:219], v2 offset:2304
 ds_read_b64_tr_b16 a[220:221], v2 offset:3072
 ds_read_b64_tr_b16 a[222:223], v2 offset:3328
 s_waitcnt lgkmcnt(0)
 s_add_u32 m0, s66, 0
 s_mov_b32 s60, 3145728
 buffer_load_dwordx4 v0, s[24:27], s60 offen lds
 s_add_u32 m0, s66, 1024
 s_mov_b32 s60, 3276800
 buffer_load_dwordx4 v0, s[24:27], s60 offen lds
 s_add_u32 m0, s66, 2048
 s_mov_b32 s60, 3407872
 buffer_load_dwordx4 v0, s[24:27], s60 offen lds
 s_add_u32 m0, s66, 3072
 s_mov_b32 s60, 3538944
 buffer_load_dwordx4 v0, s[24:27], s60 offen lds
 s_waitcnt vmcnt(8)
 ds_read_b64_tr_b16 a[224:225], v2 offset:4096
 ds_read_b64_tr_b16 a[226:227], v2 offset:4352
 ds_read_b64_tr_b16 a[228:229], v2 offset:5120
 ds_read_b64_tr_b16 a[230:231], v2 offset:5376
 ds_read_b64_tr_b16 a[232:233], v2 offset:6144
 ds_read_b64_tr_b16 a[234:235], v2 offset:6400
 ds_read_b64_tr_b16 a[236:237], v2 offset:7168
 ds_read_b64_tr_b16 a[238:239], v2 offset:7424
 s_waitcnt lgkmcnt(0)
 s_add_u32 m0, s66, 4096
 s_mov_b32 s60, 3670016
 buffer_load_dwordx4 v0, s[24:27], s60 offen lds
 s_add_u32 m0, s66, 5120
 s_mov_b32 s60, 3801088
 buffer_load_dwordx4 v0, s[24:27], s60 offen lds
 s_add_u32 m0, s66, 6144
 s_mov_b32 s60, 3932160
 buffer_load_dwordx4 v0, s[24:27], s60 offen lds
 s_add_u32 m0, s66, 7168
 s_mov_b32 s60, 4063232
 buffer_load_dwordx4 v0, s[24:27], s60 offen lds
 s_waitcnt vmcnt(8)
 ds_read_b64_tr_b16 a[240:241], v2 offset:8192
 ds_read_b64_tr_b16 a[242:243], v2 offset:8448
 ds_read_b64_tr_b16 a[244:245], v2 offset:9216
 ds_read_b64_tr_b16 a[246:247], v2 offset:9472
 ds_read_b64_tr_b16 a[248:249], v2 offset:10240
 ds_read_b64_tr_b16 a[250:251], v2 offset:10496
 ds_read_b64_tr_b16 a[252:253], v2 offset:11264
 ds_read_b64_tr_b16 a[254:255], v2 offset:11520
 s_waitcnt lgkmcnt(0)
 s_add_u32 m0, s66, 8192
 s_mov_b32 s60, 4194304
 buffer_load_dwordx4 v0, s[24:27], s60 offen lds
 s_add_u32 m0, s66, 9216
 s_mov_b32 s60, 4325376
 buffer_load_dwordx4 v0, s[24:27], s60 offen lds
 s_add_u32 m0, s66, 10240
 s_mov_b32 s60, 4456448
 buffer_load_dwordx4 v0, s[24:27], s60 offen lds
 s_add_u32 m0, s66, 11264
 s_mov_b32 s60, 4587520
 buffer_load_dwordx4 v0, s[24:27], s60 offen lds
 s_waitcnt vmcnt(8)
 ds_read_b64_tr_b16 v[16:17], v2 offset:0
 ds_read_b64_tr_b16 v[18:19], v2 offset:256
 ds_read_b64_tr_b16 v[20:21], v2 offset:1024
 ds_read_b64_tr_b16 v[22:23], v2 offset:1280
 ds_read_b64_tr_b16 v[24:25], v2 offset:2048
 ds_read_b64_tr_b16 v[26:27], v2 offset:2304
 ds_read_b64_tr_b16 v[28:29], v2 offset:3072
 ds_read_b64_tr_b16 v[30:31], v2 offset:3328
 s_waitcnt lgkmcnt(0)
 ds_write_b128 v217, v[16:19] offset:0
 ds_write_b128 v217, v[20:23] offset:1024
 ds_write_b128 v217, v[24:27] offset:2048
 ds_write_b128 v217, v[28:31] offset:3072
 s_waitcnt lgkmcnt(0)
 s_waitcnt vmcnt(4)
 ds_read_b64_tr_b16 v[16:17], v2 offset:4096
 ds_read_b64_tr_b16 v[18:19], v2 offset:4352
 ds_read_b64_tr_b16 v[20:21], v2 offset:5120
 ds_read_b64_tr_b16 v[22:23], v2 offset:5376
 ds_read_b64_tr_b16 v[24:25], v2 offset:6144
 ds_read_b64_tr_b16 v[26:27], v2 offset:6400
 ds_read_b64_tr_b16 v[28:29], v2 offset:7168
 ds_read_b64_tr_b16 v[30:31], v2 offset:7424
 s_waitcnt lgkmcnt(0)
 ds_write_b128 v217, v[16:19] offset:4096
 ds_write_b128 v217, v[20:23] offset:5120
 ds_write_b128 v217, v[24:27] offset:6144
 ds_write_b128 v217, v[28:31] offset:7168
 s_waitcnt lgkmcnt(0)
 s_waitcnt vmcnt(0)
 ds_read_b64_tr_b16 v[16:17], v2 offset:8192
 ds_read_b64_tr_b16 v[18:19], v2 offset:8448
 ds_read_b64_tr_b16 v[20:21], v2 offset:9216
 ds_read_b64_tr_b16 v[22:23], v2 offset:9472
 ds_read_b64_tr_b16 v[24:25], v2 offset:10240
 ds_read_b64_tr_b16 v[26:27], v2 offset:10496
 ds_read_b64_tr_b16 v[28:29], v2 offset:11264
 ds_read_b64_tr_b16 v[30:31], v2 offset:11520
 s_waitcnt lgkmcnt(0)
 ds_write_b128 v217, v[16:19] offset:8192
 ds_write_b128 v217, v[20:23] offset:9216
 ds_write_b128 v217, v[24:27] offset:10240
 ds_write_b128 v217, v[28:31] offset:11264
 s_waitcnt lgkmcnt(0)
 s_barrier
 v_mov_b32 v6, 0
L177:
 buffer_load_dword v7, v6, s[8:11], 0 offen offset:112 sc1
 s_waitcnt vmcnt(0)
 v_mov_b32 v6, 0x100
 v_cmp_ne_u32 vcc, v6, v7
 v_mov_b32 v6, 0
 s_cbranch_vccnz L177
 v_and_b32 v6, 31, v220
 v_mul_u32_u24 v6, 1168, v6
 v_lshrrev_b32 v218, 5, v220
 v_lshlrev_b32 v218, 4, v218
 v_add_u32 v218, v218, v6
 v_add_u32 v218, 114688, v218
 v_lshrrev_b32 v6, 4, v220
 s_lshl_b32 s60, s44, 3
 v_add_u32 v6, s60, v6
 v_mul_u32_u24 v6, 1152, v6
 v_and_b32 v223, 15, v220
 v_lshlrev_b32 v223, 4, v223
 v_add_u32 v223, v223, v6
 s_mul_i32 s60, s46, 36864
 v_add_u32 v223, s60, v223
 v_lshrrev_b32 v6, 4, v220
 v_lshlrev_b32 v6, 7, v6
 v_bfe_u32 v224, v220, 2, 1
 v_lshlrev_b32 v224, 5, v224
 v_add_u32 v224, v224, v6
 v_and_b32 v6, 3, v220
 v_lshlrev_b32 v6, 2, v6
 v_add_u32 v224, v224, v6
 s_mul_i32 s60, s44, 2304
 v_add_u32 v224, s60, v224
 v_lshlrev_b32 v225, 5, v220
 v_and_b32 v6, 15, v220
 v_mov_b32 v9, 0x3f80
 v_subrev_u32 v7, 0, v6
 v_lshlrev_b32 v8, 4, v7
 v_cmp_gt_u32 vcc, 2, v7
 v_lshlrev_b32 v8, v8, v9
 s_nop 0
 v_cndmask_b32 v228, 0, v8, vcc
 v_subrev_u32 v7, 2, v6
 v_lshlrev_b32 v8, 4, v7
 v_cmp_gt_u32 vcc, 2, v7
 v_lshlrev_b32 v8, v8, v9
 s_nop 0
 v_cndmask_b32 v229, 0, v8, vcc
 v_subrev_u32 v7, 4, v6
 v_lshlrev_b32 v8, 4, v7
 v_cmp_gt_u32 vcc, 2, v7
 v_lshlrev_b32 v8, v8, v9
 s_nop 0
 v_cndmask_b32 v230, 0, v8, vcc
 v_subrev_u32 v7, 6, v6
 v_lshlrev_b32 v8, 4, v7
 v_cmp_gt_u32 vcc, 2, v7
 v_lshlrev_b32 v8, v8, v9
 s_nop 0
 v_cndmask_b32 v231, 0, v8, vcc
 s_and_b32 s60, s44, 1
 s_lshl_b32 s60, s60, 4
 v_and_b32 v6, 15, v220
 v_add_u32 v6, s60, v6
 v_lshrrev_b32 v7, 4, v220
 v_lshlrev_b32 v8, 2, v7
 v_sub_u32 v8, v6, v8
 v_cmp_le_i32 s[76:77], 0, v8
 v_cmp_le_i32 s[78:79], 1, v8
 v_cmp_le_i32 s[80:81], 2, v8
 v_cmp_le_i32 s[82:83], 3, v8
 v_cmp_le_i32 s[84:85], 16, v8
 v_cmp_le_i32 s[86:87], 17, v8
 v_cmp_le_i32 s[88:89], 18, v8
 v_cmp_le_i32 s[90:91], 19, v8
 v_lshlrev_b32 v6, 4, v6
 v_lshrrev_b32 v8, 1, v7
 v_lshlrev_b32 v8, 9, v8
 v_add_u32 v6, v6, v8
 v_and_b32 v8, 1, v7
 v_lshlrev_b32 v8, 3, v8
 v_add_u32 v6, v6, v8
 s_lshr_b32 s60, s44, 1
 s_lshl_b32 s60, s60, 12
 v_add_u32 v226, s60, v6
 v_cmp_gt_u32 vcc, 32, v220
 v_mov_b32 v6, 1.0
 v_mov_b32 v8, 0
 v_cndmask_b32 v227, v8, v6, vcc
 s_mov_b32 s92, -1
 s_mov_b32 s93, 0
 s_mov_b32 s94, 0x3db504f3
 s_mov_b32 s95, 0x3fb8aa3b
 s_mov_b32 s96, 0xffff0000
 s_mov_b32 s64, s47
 s_mov_b32 s65, 0
 s_mov_b32 s69, 0
 s_mov_b32 s97, 0
 s_mov_b32 s20, -1
 s_mov_b32 s21, 1
 v_lshlrev_b32 v6, 2, v220
 s_mov_b32 s60, 73408512
L178:
 buffer_load_dword v7, v6, s[4:7], s60 offen sc1
 s_waitcnt vmcnt(0)
 v_cmp_ne_u32 vcc, 1, v7
 s_cbranch_vccnz L178
 v_and_b32 v1, 15, v220
 v_lshlrev_b32 v1, 4, v1
 v_bfe_u32 v2, v220, 4, 1
 v_lshlrev_b32 v2, 12, v2
 v_add_u32 v1, v1, v2
 v_lshrrev_b32 v2, 5, v220
 v_lshlrev_b32 v3, 9, v2
 v_add_u32 v1, v1, v3
 s_lshl_b32 s60, s44, 10
 s_add_u32 s60, s60, 54272
 v_add_u32 v216, s60, v1
 s_cmp_lt_u32 s64, s69
 s_cbranch_scc1 L179
 s_lshl_b32 s60, s46, 6
 s_add_u32 s60, s60, 73400320
 v_mov_b32 v232, 0
L180:
 buffer_load_dword v233, v232, s[4:7], s60 offen sc1
 s_waitcnt vmcnt(0)
 v_readfirstlane_b32 s69, v233
 s_cmp_lt_u32 s64, s69
 s_cbranch_scc0 L180
L179:
 s_lshl_b32 s16, s64, 5
 s_add_u32 s16, s16, s46
 s_lshl_b32 s17, s16, 14
 s_add_u32 s17, s17, 20971520
 s_mul_i32 s22, s64, 36864
 s_mul_i32 s23, s44, 9216
 s_add_u32 s22, s22, s23
 s_add_u32 s22, s22, 0
 s_add_u32 s23, s23, 17408
 s_add_u32 s18, s17, 4096
 s_lshr_b32 s62, s44, 1
 s_lshl_b32 s62, s62, 12
 s_add_u32 s19, s17, s62
 s_add_u32 s19, s19, 8192
 s_add_u32 m0, s23, 0
 s_add_u32 s62, s22, 0
 buffer_load_dwordx4 v221, s[4:7], s62 offen sc1 lds
 s_add_u32 m0, s23, 1024
 s_add_u32 s62, s22, 1024
 buffer_load_dwordx4 v221, s[4:7], s62 offen sc1 lds
 s_add_u32 m0, s23, 2048
 s_add_u32 s62, s22, 2048
 buffer_load_dwordx4 v221, s[4:7], s62 offen sc1 lds
 s_add_u32 m0, s23, 3072
 s_add_u32 s62, s22, 3072
 buffer_load_dwordx4 v221, s[4:7], s62 offen sc1 lds
 s_add_u32 m0, s23, 4096
 s_add_u32 s62, s22, 4096
 buffer_load_dwordx4 v221, s[4:7], s62 offen sc1 lds
 s_add_u32 m0, s23, 5120
 s_add_u32 s62, s22, 5120
 buffer_load_dwordx4 v221, s[4:7], s62 offen sc1 lds
 s_add_u32 m0, s23, 6144
 s_add_u32 s62, s22, 6144
 buffer_load_dwordx4 v221, s[4:7], s62 offen sc1 lds
 s_add_u32 m0, s23, 7168
 s_add_u32 s62, s22, 7168
 buffer_load_dwordx4 v221, s[4:7], s62 offen sc1 lds
 s_add_u32 m0, s23, 8192
 s_add_u32 s62, s22, 8192
 buffer_load_dwordx4 v221, s[4:7], s62 offen sc1 lds
 buffer_load_dwordx4 v[16:19], v221, s[4:7], s17 offen offset:0 sc1
 buffer_load_dwordx4 v[20:23], v221, s[4:7], s17 offen offset:1024 sc1
 buffer_load_dwordx4 v[24:27], v221, s[4:7], s17 offen offset:2048 sc1
 buffer_load_dwordx4 v[28:31], v221, s[4:7], s17 offen offset:3072 sc1
 buffer_load_dwordx4 v[32:35], v221, s[4:7], s18 offen offset:0 sc1
 buffer_load_dwordx4 v[36:39], v221, s[4:7], s18 offen offset:1024 sc1
 buffer_load_dwordx4 v[40:43], v221, s[4:7], s18 offen offset:2048 sc1
 buffer_load_dwordx4 v[44:47], v221, s[4:7], s18 offen offset:3072 sc1
 buffer_load_dwordx4 v[64:67], v221, s[4:7], s19 offen offset:0 sc1
 buffer_load_dwordx4 v[68:71], v221, s[4:7], s19 offen offset:1024 sc1
 buffer_load_dwordx4 v[72:75], v221, s[4:7], s19 offen offset:2048 sc1
 buffer_load_dwordx4 v[76:79], v221, s[4:7], s19 offen offset:3072 sc1
 s_waitcnt vmcnt(0)
 s_barrier
 ds_read_b128 v[192:195], v221 offset:17408
 ds_read_b128 v[196:199], v221 offset:18432
 s_waitcnt lgkmcnt(1)
 v_mfma_f32_32x32x16_bf16 v[152:167], a[160:163], v[192:195], 0
 ds_read_b128 v[200:203], v221 offset:19456
 s_waitcnt lgkmcnt(1)
 v_mfma_f32_32x32x16_bf16 v[152:167], a[164:167], v[196:199], v[152:167]
 ds_read_b128 v[192:195], v221 offset:20480
 s_waitcnt lgkmcnt(1)
 v_mfma_f32_32x32x16_bf16 v[152:167], a[168:171], v[200:203], v[152:167]
 ds_read_b128 v[196:199], v221 offset:21504
 s_waitcnt lgkmcnt(1)
 v_mfma_f32_32x32x16_bf16 v[152:167], a[172:175], v[192:195], v[152:167]
 ds_read_b128 v[200:203], v221 offset:22528
 s_waitcnt lgkmcnt(1)
 v_mfma_f32_32x32x16_bf16 v[152:167], a[176:179], v[196:199], v[152:167]
 ds_read_b128 v[192:195], v221 offset:23552
 s_waitcnt lgkmcnt(1)
 v_mfma_f32_32x32x16_bf16 v[152:167], a[180:183], v[200:203], v[152:167]
 ds_read_b128 v[196:199], v221 offset:24576
 s_waitcnt lgkmcnt(1)
 v_mfma_f32_32x32x16_bf16 v[152:167], a[184:187], v[192:195], v[152:167]
 ds_read_b128 v[200:203], v221 offset:25600
 s_waitcnt lgkmcnt(1)
 v_mfma_f32_32x32x16_bf16 v[152:167], a[188:191], v[196:199], v[152:167]
 ds_read_b128 v[192:195], v221 offset:26624
 s_waitcnt lgkmcnt(1)
 v_mfma_f32_32x32x16_bf16 v[152:167], a[192:195], v[200:203], v[152:167]
 ds_read_b128 v[196:199], v221 offset:27648
 s_waitcnt lgkmcnt(1)
 v_mfma_f32_32x32x16_bf16 v[152:167], a[196:199], v[192:195], v[152:167]
 ds_read_b128 v[200:203], v221 offset:28672
 s_waitcnt lgkmcnt(1)
 v_mfma_f32_32x32x16_bf16 v[152:167], a[200:203], v[196:199], v[152:167]
 ds_read_b128 v[192:195], v221 offset:29696
 s_waitcnt lgkmcnt(1)
 v_mfma_f32_32x32x16_bf16 v[152:167], a[204:207], v[200:203], v[152:167]
 ds_read_b128 v[196:199], v221 offset:30720
 s_waitcnt lgkmcnt(1)
 v_mfma_f32_32x32x16_bf16 v[152:167], a[208:211], v[192:195], v[152:167]
 ds_read_b128 v[200:203], v221 offset:31744
 s_waitcnt lgkmcnt(1)
 v_mfma_f32_32x32x16_bf16 v[152:167], a[212:215], v[196:199], v[152:167]
 ds_read_b128 v[192:195], v221 offset:32768
 s_waitcnt lgkmcnt(1)
 v_mfma_f32_32x32x16_bf16 v[152:167], a[216:219], v[200:203], v[152:167]
 ds_read_b128 v[196:199], v221 offset:33792
 s_waitcnt lgkmcnt(1)
 v_mfma_f32_32x32x16_bf16 v[152:167], a[220:223], v[192:195], v[152:167]
 ds_read_b128 v[200:203], v221 offset:34816
 s_waitcnt lgkmcnt(1)
 v_mfma_f32_32x32x16_bf16 v[152:167], a[224:227], v[196:199], v[152:167]
 ds_read_b128 v[192:195], v221 offset:35840
 s_waitcnt lgkmcnt(1)
 v_mfma_f32_32x32x16_bf16 v[152:167], a[228:231], v[200:203], v[152:167]
 ds_read_b128 v[196:199], v221 offset:36864
 s_waitcnt lgkmcnt(1)
 v_mfma_f32_32x32x16_bf16 v[152:167], a[232:235], v[192:195], v[152:167]
 ds_read_b128 v[200:203], v221 offset:37888
 s_waitcnt lgkmcnt(1)
 v_mfma_f32_32x32x16_bf16 v[152:167], a[236:239], v[196:199], v[152:167]
 ds_read_b128 v[192:195], v221 offset:38912
 s_waitcnt lgkmcnt(1)
 v_mfma_f32_32x32x16_bf16 v[152:167], a[240:243], v[200:203], v[152:167]
 ds_read_b128 v[196:199], v221 offset:39936
 s_waitcnt lgkmcnt(1)
 v_mfma_f32_32x32x16_bf16 v[152:167], a[244:247], v[192:195], v[152:167]
 ds_read_b128 v[200:203], v221 offset:40960
 s_waitcnt lgkmcnt(1)
 v_mfma_f32_32x32x16_bf16 v[152:167], a[248:251], v[196:199], v[152:167]
 ds_read_b128 v[192:195], v221 offset:41984
 ds_read_b128 v[204:207], v217 offset:0
 s_waitcnt lgkmcnt(2)
 v_mfma_f32_32x32x16_bf16 v[152:167], a[252:255], v[200:203], v[152:167]
 ds_read_b128 v[196:199], v221 offset:43008
 ds_read_b128 v[232:235], v217 offset:1024
 s_waitcnt lgkmcnt(2)
 v_mfma_f32_32x32x16_bf16 v[152:167], v[204:207], v[192:195], v[152:167]
 ds_read_b128 v[200:203], v221 offset:44032
 ds_read_b128 v[204:207], v217 offset:2048
 s_waitcnt lgkmcnt(2)
 v_mfma_f32_32x32x16_bf16 v[152:167], v[232:235], v[196:199], v[152:167]
 ds_read_b128 v[192:195], v221 offset:45056
 ds_read_b128 v[232:235], v217 offset:3072
 s_waitcnt lgkmcnt(2)
 v_mfma_f32_32x32x16_bf16 v[152:167], v[204:207], v[200:203], v[152:167]
 ds_read_b128 v[196:199], v221 offset:46080
 ds_read_b128 v[204:207], v217 offset:4096
 s_waitcnt lgkmcnt(2)
 v_mfma_f32_32x32x16_bf16 v[152:167], v[232:235], v[192:195], v[152:167]
 ds_read_b128 v[200:203], v221 offset:47104
 ds_read_b128 v[232:235], v217 offset:5120
 s_waitcnt lgkmcnt(2)
 v_mfma_f32_32x32x16_bf16 v[152:167], v[204:207], v[196:199], v[152:167]
 ds_read_b128 v[192:195], v221 offset:48128
 ds_read_b128 v[204:207], v217 offset:6144
 s_waitcnt lgkmcnt(2)
 v_mfma_f32_32x32x16_bf16 v[152:167], v[232:235], v[200:203], v[152:167]
 ds_read_b128 v[196:199], v221 offset:49152
 ds_read_b128 v[232:235], v217 offset:7168
 s_waitcnt lgkmcnt(2)
 v_mfma_f32_32x32x16_bf16 v[152:167], v[204:207], v[192:195], v[152:167]
 ds_read_b128 v[200:203], v221 offset:50176
 ds_read_b128 v[204:207], v217 offset:8192
 s_waitcnt lgkmcnt(2)
 v_mfma_f32_32x32x16_bf16 v[152:167], v[232:235], v[196:199], v[152:167]
 ds_read_b128 v[192:195], v221 offset:51200
 ds_read_b128 v[232:235], v217 offset:9216
 s_waitcnt lgkmcnt(2)
 v_mfma_f32_32x32x16_bf16 v[152:167], v[204:207], v[200:203], v[152:167]
 ds_read_b128 v[196:199], v221 offset:52224
 ds_read_b128 v[204:207], v217 offset:10240
 s_waitcnt lgkmcnt(2)
 v_mfma_f32_32x32x16_bf16 v[152:167], v[232:235], v[192:195], v[152:167]
 ds_read_b128 v[200:203], v221 offset:53248
 ds_read_b128 v[232:235], v217 offset:11264
 s_waitcnt lgkmcnt(2)
 v_mfma_f32_32x32x16_bf16 v[152:167], v[204:207], v[196:199], v[152:167]
 s_waitcnt lgkmcnt(0)
 v_mfma_f32_32x32x16_bf16 v[152:167], v[232:235], v[200:203], v[152:167]
 s_nop 7
 s_nop 3
 v_cvt_pk_bf16_f32 v168, v152, v153
 v_cvt_pk_bf16_f32 v169, v154, v155
 v_cvt_pk_bf16_f32 v170, v156, v157
 v_cvt_pk_bf16_f32 v171, v158, v159
 ds_write_b128 v216, v[168:171] offset:0
 v_cvt_pk_bf16_f32 v172, v160, v161
 v_cvt_pk_bf16_f32 v173, v162, v163
 v_cvt_pk_bf16_f32 v174, v164, v165
 v_cvt_pk_bf16_f32 v175, v166, v167
 ds_write_b128 v216, v[172:175] offset:256
 s_waitcnt lgkmcnt(0)
 s_barrier
 s_and_b32 s60, s44, 1
 s_lshl_b32 s60, s60, 12
 v_add_u32 v232, s60, v221
 ds_read_b128 v[0:3], v232 offset:54272
 ds_read_b128 v[4:7], v232 offset:55296
 ds_read_b128 v[8:11], v232 offset:56320
 ds_read_b128 v[12:15], v232 offset:57344
T2_LOOP181:
 s_cmp_lt_u32 s64, s97
 s_cbranch_scc1 L182
 s_lshl_b32 s60, s46, 6
 s_add_u32 s60, s60, 73404416
 v_mov_b32 v232, 0
L183:
 buffer_load_dword v233, v232, s[4:7], s60 offen sc1
 s_waitcnt vmcnt(0)
 v_readfirstlane_b32 s97, v233
 s_cmp_eq_u32 s20, -1
 s_cbranch_scc1 L183n
 v_mov_b32 v234, 0
 v_mov_b32 v235, s21
 s_mov_b64 exec, 1
 buffer_store_dword v235, v234, s[4:7], s20 offen sc1
 s_mov_b64 exec, -1
 s_mov_b32 s20, -1
L183n:
 s_cmp_lt_u32 s64, s97
 s_cbranch_scc0 L183
L182:
 s_lshl_b32 s60, s64, 5
 s_add_u32 s60, s60, s46
 s_lshl_b32 s60, s60, 13
 s_add_u32 s60, s60, 54525952
 buffer_load_dwordx4 v[48:51], v221, s[4:7], s60 offen offset:0 sc1
 buffer_load_dwordx4 v[52:55], v221, s[4:7], s60 offen offset:1024 sc1
 buffer_load_dwordx4 v[56:59], v221, s[4:7], s60 offen offset:2048 sc1
 buffer_load_dwordx4 v[60:63], v221, s[4:7], s60 offen offset:3072 sc1
 s_lshr_b32 s61, s44, 1
 s_lshl_b32 s61, s61, 11
 s_add_u32 s60, s60, s61
 s_add_u32 s60, s60, 4096
 buffer_load_dwordx2 v[80:81], v221, s[4:7], s60 offen sc1
 buffer_load_dwordx2 v[82:83], v221, s[4:7], s60 offen offset:1024 sc1
 v_and_b32 v236, 31, v220
 v_lshlrev_b32 v236, 2, v236
 s_add_u32 s28, s72, 128
 buffer_load_dword v237, v236, s[4:7], s28 offen sc1
 s_cmp_eq_u32 s44, 0
 s_cbranch_scc0 L184
 s_lshl_b32 s60, s64, 5
 s_add_u32 s60, s60, s46
 s_mul_i32 s60, s60, 1152
 buffer_load_dwordx4 v[208:211], v221, s[52:55], s60 offen
 v_mov_b32 v212, 0
 v_mov_b32 v213, 0
 v_mov_b32 v214, 0
 v_mov_b32 v215, 0
 s_mov_b64 exec, 0xff
 buffer_load_dwordx4 v[212:215], v221, s[52:55], s60 offen offset:1024
 s_mov_b64 exec, -1
 s_waitcnt vmcnt(0)
 s_cmp_eq_u32 s20, -1
 s_cbranch_scc1 L184d
 v_mov_b32 v232, 0
 v_mov_b32 v233, s21
 s_mov_b64 exec, 1
 buffer_store_dword v233, v232, s[4:7], s20 offen sc1
 s_mov_b64 exec, -1
 s_mov_b32 s20, -1
 s_branch L184d
L184:
 s_waitcnt vmcnt(0)
L184d:
 v_cmp_gt_u32 vcc, s65, v237
 s_cbranch_vccz L186e
L186:
 buffer_load_dword v237, v236, s[4:7], s28 offen sc1
 s_waitcnt vmcnt(0)
 v_cmp_gt_u32 vcc, s65, v237
 s_cbranch_vccnz L186
L186e:
 s_waitcnt lgkmcnt(0)
 v_mfma_f32_16x16x32_bf16 v[88:91], v[16:19], v[0:3], 0
 v_mfma_f32_16x16x32_bf16 v[92:95], v[32:35], v[0:3], 0
 v_mfma_f32_16x16x32_bf16 v[84:87], v[48:51], v[0:3], 0
 v_mfma_f32_16x16x32_bf16 v[88:91], v[20:23], v[4:7], v[88:91]
 v_mfma_f32_16x16x32_bf16 v[92:95], v[36:39], v[4:7], v[92:95]
 v_mfma_f32_16x16x32_bf16 v[84:87], v[52:55], v[4:7], v[84:87]
 v_mfma_f32_16x16x32_bf16 v[88:91], v[24:27], v[8:11], v[88:91]
 v_mfma_f32_16x16x32_bf16 v[92:95], v[40:43], v[8:11], v[92:95]
 v_mfma_f32_16x16x32_bf16 v[84:87], v[56:59], v[8:11], v[84:87]
 v_mfma_f32_16x16x32_bf16 v[88:91], v[28:31], v[12:15], v[88:91]
 v_mfma_f32_16x16x32_bf16 v[92:95], v[44:47], v[12:15], v[92:95]
 v_mfma_f32_16x16x32_bf16 v[84:87], v[60:63], v[12:15], v[84:87]
 s_nop 7
 v_cvt_pk_bf16_f32 v232, v84, v85
 v_lshlrev_b32 v84, 16, v232
 v_and_b32 v85, s96, v232
 v_mul_f32 v84, s94, v84
 v_mul_f32 v85, s94, v85
 v_cvt_pk_bf16_f32 v232, v84, v85
 v_lshlrev_b32 v84, 16, v232
 v_and_b32 v85, s96, v232
 v_cvt_pk_bf16_f32 v232, v86, v87
 v_lshlrev_b32 v86, 16, v232
 v_and_b32 v87, s96, v232
 v_mul_f32 v86, s94, v86
 v_mul_f32 v87, s94, v87
 v_cvt_pk_bf16_f32 v232, v86, v87
 v_lshlrev_b32 v86, 16, v232
 v_and_b32 v87, s96, v232
 v_cvt_pk_bf16_f32 v232, v88, v89
 v_lshlrev_b32 v88, 16, v232
 v_and_b32 v89, s96, v232
 v_mul_f32 v88, s94, v88
 v_mul_f32 v89, s94, v89
 v_cvt_pk_bf16_f32 v232, v88, v89
 v_lshlrev_b32 v88, 16, v232
 v_and_b32 v89, s96, v232
 v_cvt_pk_bf16_f32 v232, v90, v91
 v_lshlrev_b32 v90, 16, v232
 v_and_b32 v91, s96, v232
 v_mul_f32 v90, s94, v90
 v_mul_f32 v91, s94, v91
 v_cvt_pk_bf16_f32 v232, v90, v91
 v_lshlrev_b32 v90, 16, v232
 v_and_b32 v91, s96, v232
 v_cvt_pk_bf16_f32 v232, v92, v93
 v_lshlrev_b32 v92, 16, v232
 v_and_b32 v93, s96, v232
 v_mul_f32 v92, s94, v92
 v_mul_f32 v93, s94, v93
 v_cvt_pk_bf16_f32 v232, v92, v93
 v_lshlrev_b32 v92, 16, v232
 v_and_b32 v93, s96, v232
 v_cvt_pk_bf16_f32 v232, v94, v95
 v_lshlrev_b32 v94, 16, v232
 v_and_b32 v95, s96, v232
 v_mul_f32 v94, s94, v94
 v_mul_f32 v95, s94, v95
 v_cvt_pk_bf16_f32 v232, v94, v95
 v_lshlrev_b32 v94, 16, v232
 v_and_b32 v95, s96, v232
 v_mov_b32 v233, 0xce6e6b28
 v_cndmask_b32 v88, v233, v88, s[76:77]
 v_cndmask_b32 v89, v233, v89, s[78:79]
 v_cndmask_b32 v90, v233, v90, s[80:81]
 v_cndmask_b32 v91, v233, v91, s[82:83]
 v_cndmask_b32 v92, v233, v92, s[84:85]
 v_cndmask_b32 v93, v233, v93, s[86:87]
 v_cndmask_b32 v94, v233, v94, s[88:89]
 v_cndmask_b32 v95, v233, v95, s[90:91]
 v_max3_f32 v232, v88, v89, v90
 v_max3_f32 v232, v232, v91, v92
 v_max3_f32 v233, v93, v94, v95
 v_max3_f32 v232, v232, v233, v84
 v_max3_f32 v232, v232, v85, v86
 v_max_f32 v232, v232, v87
 v_mov_b32 v233, v232
 s_nop 1
 v_permlane32_swap_b32 v232, v233
 v_max_f32 v232, v232, v233
 v_mov_b32 v233, v232
 s_nop 1
 v_permlane16_swap_b32 v232, v233
 v_max_f32 v232, v232, v233
 v_sub_f32 v84, v84, v232
 v_sub_f32 v85, v85, v232
 v_sub_f32 v86, v86, v232
 v_sub_f32 v87, v87, v232
 v_sub_f32 v88, v88, v232
 v_sub_f32 v89, v89, v232
 v_sub_f32 v90, v90, v232
 v_sub_f32 v91, v91, v232
 v_sub_f32 v92, v92, v232
 v_sub_f32 v93, v93, v232
 v_sub_f32 v94, v94, v232
 v_sub_f32 v95, v95, v232
 v_mul_f32 v84, s95, v84
 v_mul_f32 v85, s95, v85
 v_mul_f32 v86, s95, v86
 v_mul_f32 v87, s95, v87
 v_mul_f32 v88, s95, v88
 v_mul_f32 v89, s95, v89
 v_mul_f32 v90, s95, v90
 v_mul_f32 v91, s95, v91
 v_mul_f32 v92, s95, v92
 v_mul_f32 v93, s95, v93
 v_mul_f32 v94, s95, v94
 v_mul_f32 v95, s95, v95
 v_exp_f32 v84, v84
 v_exp_f32 v85, v85
 v_exp_f32 v86, v86
 v_exp_f32 v87, v87
 v_exp_f32 v88, v88
 v_exp_f32 v89, v89
 v_exp_f32 v90, v90
 v_exp_f32 v91, v91
 v_exp_f32 v92, v92
 v_exp_f32 v93, v93
 v_exp_f32 v94, v94
 v_exp_f32 v95, v95
 s_nop 0
 v_pk_add_f32 v[234:235], v[88:89], v[90:91]
 v_pk_add_f32 v[236:237], v[92:93], v[94:95]
 v_pk_add_f32 v[238:239], v[84:85], v[86:87]
 v_pk_add_f32 v[234:235], v[234:235], v[236:237]
 v_add_f32 v238, v238, v239
 v_add_f32 v234, v234, v235
 v_fma_f32 v234, v238, v227, v234
 v_mov_b32 v235, v234
 s_nop 1
 v_permlane32_swap_b32 v234, v235
 v_add_f32 v234, v234, v235
 v_mov_b32 v235, v234
 s_nop 1
 v_permlane16_swap_b32 v234, v235
 v_add_f32 v234, v234, v235
 v_rcp_f32 v235, v234
 s_nop 0
 v_mul_f32 v84, v84, v235
 v_mul_f32 v85, v85, v235
 v_mul_f32 v86, v86, v235
 v_mul_f32 v87, v87, v235
 v_mul_f32 v88, v88, v235
 v_mul_f32 v89, v89, v235
 v_mul_f32 v90, v90, v235
 v_mul_f32 v91, v91, v235
 v_mul_f32 v92, v92, v235
 v_mul_f32 v93, v93, v235
 v_mul_f32 v94, v94, v235
 v_mul_f32 v95, v95, v235
 v_cvt_pk_bf16_f32 v236, v84, v85
 v_cvt_pk_bf16_f32 v237, v86, v87
 v_cvt_pk_bf16_f32 v240, v88, v89
 v_cvt_pk_bf16_f32 v241, v90, v91
 v_cvt_pk_bf16_f32 v242, v92, v93
 v_cvt_pk_bf16_f32 v243, v94, v95
 v_cndmask_b32 v244, 0, v236, s[92:93]
 v_cndmask_b32 v245, 0, v237, s[92:93]
 v_cndmask_b32 v246, v236, 0, s[92:93]
 v_cndmask_b32 v247, v237, 0, s[92:93]
 s_nop 1
 v_mfma_f32_16x16x32_bf16 v[96:99], v[64:67], v[240:243], 0
 v_mfma_f32_16x16x32_bf16 v[100:103], v[68:71], v[240:243], 0
 v_mfma_f32_16x16x32_bf16 v[104:107], v[72:75], v[240:243], 0
 v_mfma_f32_16x16x32_bf16 v[108:111], v[76:79], v[240:243], 0
 v_mfma_f32_16x16x16_bf16 v[96:99], v[80:81], v[244:245], v[96:99]
 v_mfma_f32_16x16x16_bf16 v[100:103], v[80:81], v[246:247], v[100:103]
 v_mfma_f32_16x16x16_bf16 v[104:107], v[82:83], v[244:245], v[104:107]
 v_mfma_f32_16x16x16_bf16 v[108:111], v[82:83], v[246:247], v[108:111]
 s_nop 7
 v_cvt_pk_bf16_f32 v96, v96, v97
 v_cvt_pk_bf16_f32 v97, v98, v99
 ds_write_b64 v226, v[96:97] offset:0
 v_cvt_pk_bf16_f32 v100, v100, v101
 v_cvt_pk_bf16_f32 v101, v102, v103
 ds_write_b64 v226, v[100:101] offset:1024
 v_cvt_pk_bf16_f32 v104, v104, v105
 v_cvt_pk_bf16_f32 v105, v106, v107
 ds_write_b64 v226, v[104:105] offset:2048
 v_cvt_pk_bf16_f32 v108, v108, v109
 v_cvt_pk_bf16_f32 v109, v110, v111
 ds_write_b64 v226, v[108:109] offset:3072
 s_waitcnt lgkmcnt(0)
 s_barrier
 s_add_u32 s75, s64, 3
 s_cmp_ge_u32 s75, 64
 s_cbranch_scc1 L187
 s_cmp_lt_u32 s75, s69
 s_cbranch_scc1 L189
 s_lshl_b32 s60, s46, 6
 s_add_u32 s60, s60, 73400320
 v_mov_b32 v232, 0
L190:
 buffer_load_dword v233, v232, s[4:7], s60 offen sc1
 s_waitcnt vmcnt(0)
 v_readfirstlane_b32 s69, v233
 s_cmp_lt_u32 s75, s69
 s_cbranch_scc0 L190
L189:
 s_lshl_b32 s16, s75, 5
 s_add_u32 s16, s16, s46
 s_lshl_b32 s17, s16, 14
 s_add_u32 s17, s17, 20971520
 s_mul_i32 s22, s75, 36864
 s_mul_i32 s23, s44, 9216
 s_add_u32 s22, s22, s23
 s_add_u32 s22, s22, 0
 s_add_u32 s23, s23, 17408
 s_add_u32 s18, s17, 4096
 s_lshr_b32 s62, s44, 1
 s_lshl_b32 s62, s62, 12
 s_add_u32 s19, s17, s62
 s_add_u32 s19, s19, 8192
 ds_read_b128 v[192:195], v221 offset:0
 ds_read_b128 v[196:199], v221 offset:1024
 s_waitcnt lgkmcnt(1)
 v_mfma_f32_32x32x16_bf16 v[112:127], a[0:3], v[192:195], 0
 s_add_u32 m0, s23, 0
 s_add_u32 s62, s22, 0
 buffer_load_dwordx4 v221, s[4:7], s62 offen sc1 lds
 v_mfma_f32_32x32x16_bf16 v[128:143], a[32:35], v[192:195], 0
 s_add_u32 m0, s23, 1024
 s_add_u32 s62, s22, 1024
 buffer_load_dwordx4 v221, s[4:7], s62 offen sc1 lds
 v_mfma_f32_32x32x16_bf16 v[144:159], a[64:67], v[192:195], 0
 s_add_u32 m0, s23, 2048
 s_add_u32 s62, s22, 2048
 buffer_load_dwordx4 v221, s[4:7], s62 offen sc1 lds
 v_mfma_f32_32x32x16_bf16 v[160:175], a[96:99], v[192:195], 0
 s_cmp_eq_u32 s68, 4
 s_cbranch_scc1 L191
 v_mfma_f32_32x32x16_bf16 v[176:191], a[128:131], v[192:195], 0
L191:
 ds_read_b128 v[192:195], v221 offset:2048
 s_waitcnt lgkmcnt(1)
 v_mfma_f32_32x32x16_bf16 v[112:127], a[4:7], v[196:199], v[112:127]
 s_add_u32 m0, s23, 3072
 s_add_u32 s62, s22, 3072
 buffer_load_dwordx4 v221, s[4:7], s62 offen sc1 lds
 v_mfma_f32_32x32x16_bf16 v[128:143], a[36:39], v[196:199], v[128:143]
 s_add_u32 m0, s23, 4096
 s_add_u32 s62, s22, 4096
 buffer_load_dwordx4 v221, s[4:7], s62 offen sc1 lds
 v_mfma_f32_32x32x16_bf16 v[144:159], a[68:71], v[196:199], v[144:159]
 s_add_u32 m0, s23, 5120
 s_add_u32 s62, s22, 5120
 buffer_load_dwordx4 v221, s[4:7], s62 offen sc1 lds
 v_mfma_f32_32x32x16_bf16 v[160:175], a[100:103], v[196:199], v[160:175]
 s_cmp_eq_u32 s68, 4
 s_cbranch_scc1 L192
 v_mfma_f32_32x32x16_bf16 v[176:191], a[132:135], v[196:199], v[176:191]
L192:
 ds_read_b128 v[196:199], v221 offset:3072
 s_waitcnt lgkmcnt(1)
 v_mfma_f32_32x32x16_bf16 v[112:127], a[8:11], v[192:195], v[112:127]
 s_add_u32 m0, s23, 6144
 s_add_u32 s62, s22, 6144
 buffer_load_dwordx4 v221, s[4:7], s62 offen sc1 lds
 v_mfma_f32_32x32x16_bf16 v[128:143], a[40:43], v[192:195], v[128:143]
 s_add_u32 m0, s23, 7168
 s_add_u32 s62, s22, 7168
 buffer_load_dwordx4 v221, s[4:7], s62 offen sc1 lds
 v_mfma_f32_32x32x16_bf16 v[144:159], a[72:75], v[192:195], v[144:159]
 s_add_u32 m0, s23, 8192
 s_add_u32 s62, s22, 8192
 buffer_load_dwordx4 v221, s[4:7], s62 offen sc1 lds
 v_mfma_f32_32x32x16_bf16 v[160:175], a[104:107], v[192:195], v[160:175]
 s_cmp_eq_u32 s68, 4
 s_cbranch_scc1 L193
 v_mfma_f32_32x32x16_bf16 v[176:191], a[136:139], v[192:195], v[176:191]
L193:
 ds_read_b128 v[192:195], v221 offset:4096
 s_waitcnt lgkmcnt(1)
 v_mfma_f32_32x32x16_bf16 v[112:127], a[12:15], v[196:199], v[112:127]
 buffer_load_dwordx4 v[16:19], v221, s[4:7], s17 offen offset:0 sc1
 v_mfma_f32_32x32x16_bf16 v[128:143], a[44:47], v[196:199], v[128:143]
 buffer_load_dwordx4 v[20:23], v221, s[4:7], s17 offen offset:1024 sc1
 v_mfma_f32_32x32x16_bf16 v[144:159], a[76:79], v[196:199], v[144:159]
 buffer_load_dwordx4 v[24:27], v221, s[4:7], s17 offen offset:2048 sc1
 v_mfma_f32_32x32x16_bf16 v[160:175], a[108:111], v[196:199], v[160:175]
 s_cmp_eq_u32 s68, 4
 s_cbranch_scc1 L194
 v_mfma_f32_32x32x16_bf16 v[176:191], a[140:143], v[196:199], v[176:191]
L194:
 ds_read_b128 v[196:199], v221 offset:5120
 s_waitcnt lgkmcnt(1)
 v_mfma_f32_32x32x16_bf16 v[112:127], a[16:19], v[192:195], v[112:127]
 buffer_load_dwordx4 v[28:31], v221, s[4:7], s17 offen offset:3072 sc1
 v_mfma_f32_32x32x16_bf16 v[128:143], a[48:51], v[192:195], v[128:143]
 buffer_load_dwordx4 v[32:35], v221, s[4:7], s18 offen offset:0 sc1
 v_mfma_f32_32x32x16_bf16 v[144:159], a[80:83], v[192:195], v[144:159]
 buffer_load_dwordx4 v[36:39], v221, s[4:7], s18 offen offset:1024 sc1
 v_mfma_f32_32x32x16_bf16 v[160:175], a[112:115], v[192:195], v[160:175]
 s_cmp_eq_u32 s68, 4
 s_cbranch_scc1 L195
 v_mfma_f32_32x32x16_bf16 v[176:191], a[144:147], v[192:195], v[176:191]
L195:
 ds_read_b128 v[192:195], v221 offset:6144
 s_waitcnt lgkmcnt(1)
 v_mfma_f32_32x32x16_bf16 v[112:127], a[20:23], v[196:199], v[112:127]
 buffer_load_dwordx4 v[40:43], v221, s[4:7], s18 offen offset:2048 sc1
 v_mfma_f32_32x32x16_bf16 v[128:143], a[52:55], v[196:199], v[128:143]
 buffer_load_dwordx4 v[44:47], v221, s[4:7], s18 offen offset:3072 sc1
 v_mfma_f32_32x32x16_bf16 v[144:159], a[84:87], v[196:199], v[144:159]
 buffer_load_dwordx4 v[64:67], v221, s[4:7], s19 offen offset:0 sc1
 v_mfma_f32_32x32x16_bf16 v[160:175], a[116:119], v[196:199], v[160:175]
 s_cmp_eq_u32 s68, 4
 s_cbranch_scc1 L196
 v_mfma_f32_32x32x16_bf16 v[176:191], a[148:151], v[196:199], v[176:191]
L196:
 ds_read_b128 v[196:199], v221 offset:7168
 s_waitcnt lgkmcnt(1)
 v_mfma_f32_32x32x16_bf16 v[112:127], a[24:27], v[192:195], v[112:127]
 buffer_load_dwordx4 v[68:71], v221, s[4:7], s19 offen offset:1024 sc1
 v_mfma_f32_32x32x16_bf16 v[128:143], a[56:59], v[192:195], v[128:143]
 buffer_load_dwordx4 v[72:75], v221, s[4:7], s19 offen offset:2048 sc1
 v_mfma_f32_32x32x16_bf16 v[144:159], a[88:91], v[192:195], v[144:159]
 buffer_load_dwordx4 v[76:79], v221, s[4:7], s19 offen offset:3072 sc1
 v_mfma_f32_32x32x16_bf16 v[160:175], a[120:123], v[192:195], v[160:175]
 s_cmp_eq_u32 s68, 4
 s_cbranch_scc1 L197
 v_mfma_f32_32x32x16_bf16 v[176:191], a[152:155], v[192:195], v[176:191]
L197:
 s_waitcnt lgkmcnt(0)
 v_mfma_f32_32x32x16_bf16 v[112:127], a[28:31], v[196:199], v[112:127]
 v_mfma_f32_32x32x16_bf16 v[128:143], a[60:63], v[196:199], v[128:143]
 v_mfma_f32_32x32x16_bf16 v[144:159], a[92:95], v[196:199], v[144:159]
 v_mfma_f32_32x32x16_bf16 v[160:175], a[124:127], v[196:199], v[160:175]
 s_cmp_eq_u32 s68, 4
 s_cbranch_scc1 L198
 v_mfma_f32_32x32x16_bf16 v[176:191], a[156:159], v[196:199], v[176:191]
L198:
 s_branch L188
L187:
 ds_read_b128 v[192:195], v221 offset:0
 ds_read_b128 v[196:199], v221 offset:1024
 s_waitcnt lgkmcnt(1)
 v_mfma_f32_32x32x16_bf16 v[112:127], a[0:3], v[192:195], 0
 v_mfma_f32_32x32x16_bf16 v[128:143], a[32:35], v[192:195], 0
 v_mfma_f32_32x32x16_bf16 v[144:159], a[64:67], v[192:195], 0
 v_mfma_f32_32x32x16_bf16 v[160:175], a[96:99], v[192:195], 0
 s_cmp_eq_u32 s68, 4
 s_cbranch_scc1 L199
 v_mfma_f32_32x32x16_bf16 v[176:191], a[128:131], v[192:195], 0
L199:
 ds_read_b128 v[192:195], v221 offset:2048
 s_waitcnt lgkmcnt(1)
 v_mfma_f32_32x32x16_bf16 v[112:127], a[4:7], v[196:199], v[112:127]
 v_mfma_f32_32x32x16_bf16 v[128:143], a[36:39], v[196:199], v[128:143]
 v_mfma_f32_32x32x16_bf16 v[144:159], a[68:71], v[196:199], v[144:159]
 v_mfma_f32_32x32x16_bf16 v[160:175], a[100:103], v[196:199], v[160:175]
 s_cmp_eq_u32 s68, 4
 s_cbranch_scc1 L200
 v_mfma_f32_32x32x16_bf16 v[176:191], a[132:135], v[196:199], v[176:191]
L200:
 ds_read_b128 v[196:199], v221 offset:3072
 s_waitcnt lgkmcnt(1)
 v_mfma_f32_32x32x16_bf16 v[112:127], a[8:11], v[192:195], v[112:127]
 v_mfma_f32_32x32x16_bf16 v[128:143], a[40:43], v[192:195], v[128:143]
 v_mfma_f32_32x32x16_bf16 v[144:159], a[72:75], v[192:195], v[144:159]
 v_mfma_f32_32x32x16_bf16 v[160:175], a[104:107], v[192:195], v[160:175]
 s_cmp_eq_u32 s68, 4
 s_cbranch_scc1 L201
 v_mfma_f32_32x32x16_bf16 v[176:191], a[136:139], v[192:195], v[176:191]
L201:
 ds_read_b128 v[192:195], v221 offset:4096
 s_waitcnt lgkmcnt(1)
 v_mfma_f32_32x32x16_bf16 v[112:127], a[12:15], v[196:199], v[112:127]
 v_mfma_f32_32x32x16_bf16 v[128:143], a[44:47], v[196:199], v[128:143]
 v_mfma_f32_32x32x16_bf16 v[144:159], a[76:79], v[196:199], v[144:159]
 v_mfma_f32_32x32x16_bf16 v[160:175], a[108:111], v[196:199], v[160:175]
 s_cmp_eq_u32 s68, 4
 s_cbranch_scc1 L202
 v_mfma_f32_32x32x16_bf16 v[176:191], a[140:143], v[196:199], v[176:191]
L202:
 ds_read_b128 v[196:199], v221 offset:5120
 s_waitcnt lgkmcnt(1)
 v_mfma_f32_32x32x16_bf16 v[112:127], a[16:19], v[192:195], v[112:127]
 v_mfma_f32_32x32x16_bf16 v[128:143], a[48:51], v[192:195], v[128:143]
 v_mfma_f32_32x32x16_bf16 v[144:159], a[80:83], v[192:195], v[144:159]
 v_mfma_f32_32x32x16_bf16 v[160:175], a[112:115], v[192:195], v[160:175]
 s_cmp_eq_u32 s68, 4
 s_cbranch_scc1 L203
 v_mfma_f32_32x32x16_bf16 v[176:191], a[144:147], v[192:195], v[176:191]
L203:
 ds_read_b128 v[192:195], v221 offset:6144
 s_waitcnt lgkmcnt(1)
 v_mfma_f32_32x32x16_bf16 v[112:127], a[20:23], v[196:199], v[112:127]
 v_mfma_f32_32x32x16_bf16 v[128:143], a[52:55], v[196:199], v[128:143]
 v_mfma_f32_32x32x16_bf16 v[144:159], a[84:87], v[196:199], v[144:159]
 v_mfma_f32_32x32x16_bf16 v[160:175], a[116:119], v[196:199], v[160:175]
 s_cmp_eq_u32 s68, 4
 s_cbranch_scc1 L204
 v_mfma_f32_32x32x16_bf16 v[176:191], a[148:151], v[196:199], v[176:191]
L204:
 ds_read_b128 v[196:199], v221 offset:7168
 s_waitcnt lgkmcnt(1)
 v_mfma_f32_32x32x16_bf16 v[112:127], a[24:27], v[192:195], v[112:127]
 v_mfma_f32_32x32x16_bf16 v[128:143], a[56:59], v[192:195], v[128:143]
 v_mfma_f32_32x32x16_bf16 v[144:159], a[88:91], v[192:195], v[144:159]
 v_mfma_f32_32x32x16_bf16 v[160:175], a[120:123], v[192:195], v[160:175]
 s_cmp_eq_u32 s68, 4
 s_cbranch_scc1 L205
 v_mfma_f32_32x32x16_bf16 v[176:191], a[152:155], v[192:195], v[176:191]
L205:
 s_waitcnt lgkmcnt(0)
 v_mfma_f32_32x32x16_bf16 v[112:127], a[28:31], v[196:199], v[112:127]
 v_mfma_f32_32x32x16_bf16 v[128:143], a[60:63], v[196:199], v[128:143]
 v_mfma_f32_32x32x16_bf16 v[144:159], a[92:95], v[196:199], v[144:159]
 v_mfma_f32_32x32x16_bf16 v[160:175], a[124:127], v[196:199], v[160:175]
 s_cmp_eq_u32 s68, 4
 s_cbranch_scc1 L206
 v_mfma_f32_32x32x16_bf16 v[176:191], a[156:159], v[196:199], v[176:191]
L206:
L188:
 s_and_b32 s60, s65, 0
 s_lshl_b32 s61, s47, 1
 s_add_u32 s60, s60, s61
 s_mul_i32 s70, s60, 1179648
 s_add_u32 s70, s70, 83886080
 s_lshl_b32 s60, s67, 6
 v_add_u32 v232, s60, v218
 s_nop 7
 v_cvt_pk_bf16_f32 v200, v112, v113
 v_cvt_pk_bf16_f32 v201, v114, v115
 v_cvt_pk_bf16_f32 v202, v116, v117
 v_cvt_pk_bf16_f32 v203, v118, v119
 ds_write_b128 v232, v[200:203] offset:0
 v_cvt_pk_bf16_f32 v204, v120, v121
 v_cvt_pk_bf16_f32 v205, v122, v123
 v_cvt_pk_bf16_f32 v206, v124, v125
 v_cvt_pk_bf16_f32 v207, v126, v127
 ds_write_b128 v232, v[204:207] offset:32
 v_add_u32 v232, 64, v232
 v_cvt_pk_bf16_f32 v200, v128, v129
 v_cvt_pk_bf16_f32 v201, v130, v131
 v_cvt_pk_bf16_f32 v202, v132, v133
 v_cvt_pk_bf16_f32 v203, v134, v135
 ds_write_b128 v232, v[200:203] offset:0
 v_cvt_pk_bf16_f32 v204, v136, v137
 v_cvt_pk_bf16_f32 v205, v138, v139
 v_cvt_pk_bf16_f32 v206, v140, v141
 v_cvt_pk_bf16_f32 v207, v142, v143
 ds_write_b128 v232, v[204:207] offset:32
 v_add_u32 v232, 64, v232
 v_cvt_pk_bf16_f32 v200, v144, v145
 v_cvt_pk_bf16_f32 v201, v146, v147
 v_cvt_pk_bf16_f32 v202, v148, v149
 v_cvt_pk_bf16_f32 v203, v150, v151
 ds_write_b128 v232, v[200:203] offset:0
 v_cvt_pk_bf16_f32 v204, v152, v153
 v_cvt_pk_bf16_f32 v205, v154, v155
 v_cvt_pk_bf16_f32 v206, v156, v157
 v_cvt_pk_bf16_f32 v207, v158, v159
 ds_write_b128 v232, v[204:207] offset:32
 v_add_u32 v232, 64, v232
 v_cvt_pk_bf16_f32 v200, v160, v161
 v_cvt_pk_bf16_f32 v201, v162, v163
 v_cvt_pk_bf16_f32 v202, v164, v165
 v_cvt_pk_bf16_f32 v203, v166, v167
 ds_write_b128 v232, v[200:203] offset:0
 v_cvt_pk_bf16_f32 v204, v168, v169
 v_cvt_pk_bf16_f32 v205, v170, v171
 v_cvt_pk_bf16_f32 v206, v172, v173
 v_cvt_pk_bf16_f32 v207, v174, v175
 ds_write_b128 v232, v[204:207] offset:32
 v_add_u32 v232, 64, v232
 s_cmp_eq_u32 s68, 4
 s_cbranch_scc1 L207
 v_cvt_pk_bf16_f32 v200, v176, v177
 v_cvt_pk_bf16_f32 v201, v178, v179
 v_cvt_pk_bf16_f32 v202, v180, v181
 v_cvt_pk_bf16_f32 v203, v182, v183
 ds_write_b128 v232, v[200:203] offset:0
 v_cvt_pk_bf16_f32 v204, v184, v185
 v_cvt_pk_bf16_f32 v205, v186, v187
 v_cvt_pk_bf16_f32 v206, v188, v189
 v_cvt_pk_bf16_f32 v207, v190, v191
 ds_write_b128 v232, v[204:207] offset:32
 v_add_u32 v232, 64, v232
L207:
 s_waitcnt lgkmcnt(0)
 s_barrier
 s_mul_i32 s60, s44, 9344
 s_add_u32 s60, s60, 114688
 v_add_u32 v148, s60, v221
 ds_read_b128 v[112:115], v148 offset:0
 ds_read_b128 v[116:119], v148 offset:1168
 ds_read_b128 v[120:123], v148 offset:2336
 ds_read_b128 v[124:127], v148 offset:3504
 ds_read_b128 v[128:131], v148 offset:4672
 ds_read_b128 v[132:135], v148 offset:5840
 ds_read_b128 v[136:139], v148 offset:7008
 ds_read_b128 v[140:143], v148 offset:8176
 v_lshrrev_b32 v149, 3, v220
 s_lshl_b32 s61, s44, 3
 v_add_u32 v149, s61, v149
 v_and_b32 v150, 7, v220
 v_lshlrev_b32 v150, 4, v150
 v_add_u32 v150, 1024, v150
 v_mul_u32_u24 v151, 1168, v149
 v_add_u32 v151, v151, v150
 v_add_u32 v151, 114688, v151
 ds_read_b128 v[144:147], v151
 v_mul_u32_u24 v149, 36864, v149
 v_add_u32 v150, v150, v149
 s_mul_i32 s60, s44, 294912
 s_mul_i32 s61, s46, 1152
 s_add_u32 s60, s60, s61
 s_add_u32 s60, s60, s70
 s_add_u32 s61, s61, s70
 s_waitcnt lgkmcnt(8)
 buffer_store_dwordx4 v[112:115], v221, s[4:7], s60 offen sc1
 s_add_u32 s60, s60, 36864
 s_waitcnt lgkmcnt(7)
 buffer_store_dwordx4 v[116:119], v221, s[4:7], s60 offen sc1
 s_add_u32 s60, s60, 36864
 s_waitcnt lgkmcnt(6)
 buffer_store_dwordx4 v[120:123], v221, s[4:7], s60 offen sc1
 s_add_u32 s60, s60, 36864
 s_waitcnt lgkmcnt(5)
 buffer_store_dwordx4 v[124:127], v221, s[4:7], s60 offen sc1
 s_add_u32 s60, s60, 36864
 s_waitcnt lgkmcnt(4)
 buffer_store_dwordx4 v[128:131], v221, s[4:7], s60 offen sc1
 s_add_u32 s60, s60, 36864
 s_waitcnt lgkmcnt(3)
 buffer_store_dwordx4 v[132:135], v221, s[4:7], s60 offen sc1
 s_add_u32 s60, s60, 36864
 s_waitcnt lgkmcnt(2)
 buffer_store_dwordx4 v[136:139], v221, s[4:7], s60 offen sc1
 s_add_u32 s60, s60, 36864
 s_waitcnt lgkmcnt(1)
 buffer_store_dwordx4 v[140:143], v221, s[4:7], s60 offen sc1
 s_waitcnt lgkmcnt(0)
 buffer_store_dwordx4 v[144:147], v150, s[4:7], s61 offen sc1
 s_add_u32 s65, s65, 1
 s_waitcnt vmcnt(0)
 s_barrier
 s_cmp_eq_u32 s44, 0
 s_cbranch_scc0 L208
 v_mov_b32 v232, 0
 v_mov_b32 v233, s65
 s_mov_b64 exec, 1
 buffer_store_dword v233, v232, s[4:7], s71 offen sc1
 s_mov_b64 exec, -1
L208:
 v_and_b32 v232, 31, v220
 v_lshlrev_b32 v232, 2, v232
L209:
 buffer_load_dword v233, v232, s[4:7], s72 offen sc1
 s_waitcnt vmcnt(0)
 v_cmp_gt_u32 vcc, s65, v233
 s_cbranch_vccnz L209
 s_mov_b32 s73, s70
 s_add_u32 s74, s70, 4608
 buffer_load_dwordx4 v[112:115], v223, s[4:7], s73 offen offset:0 sc1
 buffer_load_dwordx4 v[116:119], v223, s[4:7], s74 offen offset:0 sc1
 buffer_load_dwordx4 v[120:123], v223, s[4:7], s73 offen offset:256 sc1
 buffer_load_dwordx4 v[124:127], v223, s[4:7], s74 offen offset:256 sc1
 buffer_load_dwordx4 v[128:131], v223, s[4:7], s73 offen offset:512 sc1
 buffer_load_dwordx4 v[132:135], v223, s[4:7], s74 offen offset:512 sc1
 buffer_load_dwordx4 v[136:139], v223, s[4:7], s73 offen offset:768 sc1
 buffer_load_dwordx4 v[140:143], v223, s[4:7], s74 offen offset:768 sc1
 buffer_load_dwordx4 v[144:147], v223, s[4:7], s73 offen offset:1024 sc1
 buffer_load_dwordx4 v[148:151], v223, s[4:7], s74 offen offset:1024 sc1
 s_waitcnt vmcnt(9)
 v_mfma_f32_16x16x32_bf16 v[152:155], v[112:115], v[228:231], 0
 s_waitcnt vmcnt(8)
 v_mfma_f32_16x16x32_bf16 v[152:155], v[116:119], v[228:231], v[152:155]
 s_waitcnt vmcnt(7)
 v_mfma_f32_16x16x32_bf16 v[156:159], v[120:123], v[228:231], 0
 s_waitcnt vmcnt(6)
 v_mfma_f32_16x16x32_bf16 v[156:159], v[124:127], v[228:231], v[156:159]
 s_waitcnt vmcnt(5)
 v_mfma_f32_16x16x32_bf16 v[160:163], v[128:131], v[228:231], 0
 s_waitcnt vmcnt(4)
 v_mfma_f32_16x16x32_bf16 v[160:163], v[132:135], v[228:231], v[160:163]
 s_waitcnt vmcnt(3)
 v_mfma_f32_16x16x32_bf16 v[164:167], v[136:139], v[228:231], 0
 s_waitcnt vmcnt(2)
 v_mfma_f32_16x16x32_bf16 v[164:167], v[140:143], v[228:231], v[164:167]
 s_waitcnt vmcnt(1)
 v_mfma_f32_16x16x32_bf16 v[168:171], v[144:147], v[228:231], 0
 s_waitcnt vmcnt(0)
 v_mfma_f32_16x16x32_bf16 v[168:171], v[148:151], v[228:231], v[168:171]
 s_nop 7
 s_mov_b32 exec_lo, 0x00ff00ff
 s_mov_b32 exec_hi, 0x00ff00ff
 ds_write_b32 v224, v152 offset:8192
 ds_write_b32 v224, v153 offset:8208
 ds_write_b32 v224, v154 offset:8256
 ds_write_b32 v224, v155 offset:8272
 ds_write_b32 v224, v156 offset:8704
 ds_write_b32 v224, v157 offset:8720
 ds_write_b32 v224, v158 offset:8768
 ds_write_b32 v224, v159 offset:8784
 ds_write_b32 v224, v160 offset:9216
 ds_write_b32 v224, v161 offset:9232
 ds_write_b32 v224, v162 offset:9280
 ds_write_b32 v224, v163 offset:9296
 ds_write_b32 v224, v164 offset:9728
 ds_write_b32 v224, v165 offset:9744
 ds_write_b32 v224, v166 offset:9792
 ds_write_b32 v224, v167 offset:9808
 s_mov_b32 exec_hi, 0
 ds_write_b32 v224, v168 offset:10240
 ds_write_b32 v224, v169 offset:10256
 ds_write_b32 v224, v170 offset:10304
 ds_write_b32 v224, v171 offset:10320
 s_mov_b64 exec, -1
 s_waitcnt lgkmcnt(0)
 s_barrier
 s_cmp_eq_u32 s44, 1
 s_cbranch_scc0 L210
 s_add_u32 s60, s71, 128
 v_mov_b32 v232, 0
 v_mov_b32 v233, s65
 s_mov_b64 exec, 1
 buffer_store_dword v233, v232, s[4:7], s60 offen sc1
 s_mov_b64 exec, -1
L210:
 s_cmp_eq_u32 s44, 0
 s_cbranch_scc0 L211
 s_lshl_b32 s60, s64, 5
 s_add_u32 s60, s60, s46
 s_mul_i32 s60, s60, 1152
 ds_read_b128 v[172:175], v225 offset:8192
 ds_read_b128 v[176:179], v225 offset:8208
 ds_read_b128 v[188:191], v225 offset:10496
 ds_read_b128 v[192:195], v225 offset:10512
 s_waitcnt lgkmcnt(0)
 v_pk_add_f32 v[172:173], v[172:173], v[188:189]
 v_pk_add_f32 v[174:175], v[174:175], v[190:191]
 v_pk_add_f32 v[176:177], v[176:177], v[192:193]
 v_pk_add_f32 v[178:179], v[178:179], v[194:195]
 ds_read_b128 v[188:191], v225 offset:12800
 ds_read_b128 v[192:195], v225 offset:12816
 s_waitcnt lgkmcnt(0)
 v_pk_add_f32 v[172:173], v[172:173], v[188:189]
 v_pk_add_f32 v[174:175], v[174:175], v[190:191]
 v_pk_add_f32 v[176:177], v[176:177], v[192:193]
 v_pk_add_f32 v[178:179], v[178:179], v[194:195]
 ds_read_b128 v[188:191], v225 offset:15104
 ds_read_b128 v[192:195], v225 offset:15120
 s_waitcnt lgkmcnt(0)
 v_pk_add_f32 v[172:173], v[172:173], v[188:189]
 v_pk_add_f32 v[174:175], v[174:175], v[190:191]
 v_pk_add_f32 v[176:177], v[176:177], v[192:193]
 v_pk_add_f32 v[178:179], v[178:179], v[194:195]
 v_mov_b32 v180, 0
 v_mov_b32 v181, 0
 v_mov_b32 v182, 0
 v_mov_b32 v183, 0
 v_mov_b32 v184, 0
 v_mov_b32 v185, 0
 v_mov_b32 v186, 0
 v_mov_b32 v187, 0
 s_mov_b64 exec, 0xff
 ds_read_b128 v[180:183], v225 offset:10240
 ds_read_b128 v[184:187], v225 offset:10256
 ds_read_b128 v[188:191], v225 offset:12544
 ds_read_b128 v[192:195], v225 offset:12560
 s_waitcnt lgkmcnt(0)
 v_pk_add_f32 v[180:181], v[180:181], v[188:189]
 v_pk_add_f32 v[182:183], v[182:183], v[190:191]
 v_pk_add_f32 v[184:185], v[184:185], v[192:193]
 v_pk_add_f32 v[186:187], v[186:187], v[194:195]
 ds_read_b128 v[188:191], v225 offset:14848
 ds_read_b128 v[192:195], v225 offset:14864
 s_waitcnt lgkmcnt(0)
 v_pk_add_f32 v[180:181], v[180:181], v[188:189]
 v_pk_add_f32 v[182:183], v[182:183], v[190:191]
 v_pk_add_f32 v[184:185], v[184:185], v[192:193]
 v_pk_add_f32 v[186:187], v[186:187], v[194:195]
 ds_read_b128 v[188:191], v225 offset:17152
 ds_read_b128 v[192:195], v225 offset:17168
 s_waitcnt lgkmcnt(0)
 v_pk_add_f32 v[180:181], v[180:181], v[188:189]
 v_pk_add_f32 v[182:183], v[182:183], v[190:191]
 v_pk_add_f32 v[184:185], v[184:185], v[192:193]
 v_pk_add_f32 v[186:187], v[186:187], v[194:195]
 s_mov_b64 exec, -1
 v_cvt_pk_bf16_f32 v204, v172, v173
 v_lshlrev_b32 v172, 16, v204
 v_and_b32 v173, s96, v204
 v_lshlrev_b32 v205, 16, v208
 v_and_b32 v206, s96, v208
 v_add_f32 v172, v172, v205
 v_add_f32 v173, v173, v206
 v_cvt_pk_bf16_f32 v120, v172, v173
 v_lshlrev_b32 v172, 16, v120
 v_and_b32 v173, s96, v120
 v_cvt_pk_bf16_f32 v204, v174, v175
 v_lshlrev_b32 v174, 16, v204
 v_and_b32 v175, s96, v204
 v_lshlrev_b32 v205, 16, v209
 v_and_b32 v206, s96, v209
 v_add_f32 v174, v174, v205
 v_add_f32 v175, v175, v206
 v_cvt_pk_bf16_f32 v121, v174, v175
 v_lshlrev_b32 v174, 16, v121
 v_and_b32 v175, s96, v121
 v_cvt_pk_bf16_f32 v204, v176, v177
 v_lshlrev_b32 v176, 16, v204
 v_and_b32 v177, s96, v204
 v_lshlrev_b32 v205, 16, v210
 v_and_b32 v206, s96, v210
 v_add_f32 v176, v176, v205
 v_add_f32 v177, v177, v206
 v_cvt_pk_bf16_f32 v122, v176, v177
 v_lshlrev_b32 v176, 16, v122
 v_and_b32 v177, s96, v122
 v_cvt_pk_bf16_f32 v204, v178, v179
 v_lshlrev_b32 v178, 16, v204
 v_and_b32 v179, s96, v204
 v_lshlrev_b32 v205, 16, v211
 v_and_b32 v206, s96, v211
 v_add_f32 v178, v178, v205
 v_add_f32 v179, v179, v206
 v_cvt_pk_bf16_f32 v123, v178, v179
 v_lshlrev_b32 v178, 16, v123
 v_and_b32 v179, s96, v123
 v_cvt_pk_bf16_f32 v204, v180, v181
 v_lshlrev_b32 v180, 16, v204
 v_and_b32 v181, s96, v204
 v_lshlrev_b32 v205, 16, v212
 v_and_b32 v206, s96, v212
 v_add_f32 v180, v180, v205
 v_add_f32 v181, v181, v206
 v_cvt_pk_bf16_f32 v124, v180, v181
 v_lshlrev_b32 v180, 16, v124
 v_and_b32 v181, s96, v124
 v_cvt_pk_bf16_f32 v204, v182, v183
 v_lshlrev_b32 v182, 16, v204
 v_and_b32 v183, s96, v204
 v_lshlrev_b32 v205, 16, v213
 v_and_b32 v206, s96, v213
 v_add_f32 v182, v182, v205
 v_add_f32 v183, v183, v206
 v_cvt_pk_bf16_f32 v125, v182, v183
 v_lshlrev_b32 v182, 16, v125
 v_and_b32 v183, s96, v125
 v_cvt_pk_bf16_f32 v204, v184, v185
 v_lshlrev_b32 v184, 16, v204
 v_and_b32 v185, s96, v204
 v_lshlrev_b32 v205, 16, v214
 v_and_b32 v206, s96, v214
 v_add_f32 v184, v184, v205
 v_add_f32 v185, v185, v206
 v_cvt_pk_bf16_f32 v126, v184, v185
 v_lshlrev_b32 v184, 16, v126
 v_and_b32 v185, s96, v126
 v_cvt_pk_bf16_f32 v204, v186, v187
 v_lshlrev_b32 v186, 16, v204
 v_and_b32 v187, s96, v204
 v_lshlrev_b32 v205, 16, v215
 v_and_b32 v206, s96, v215
 v_add_f32 v186, v186, v205
 v_add_f32 v187, v187, v206
 v_cvt_pk_bf16_f32 v127, v186, v187
 v_lshlrev_b32 v186, 16, v127
 v_and_b32 v187, s96, v127
 s_add_u32 s61, s60, 75497472
 buffer_store_dwordx4 v[120:123], v221, s[4:7], s61 offen sc1
 s_mov_b64 exec, 0xff
 buffer_store_dwordx4 v[124:127], v221, s[4:7], s61 offen offset:1024 sc1
 s_mov_b64 exec, -1
 v_pk_add_f32 v[204:205], v[172:173], v[174:175]
 v_pk_add_f32 v[204:205], v[204:205], v[176:177]
 v_pk_add_f32 v[204:205], v[204:205], v[178:179]
 v_pk_add_f32 v[204:205], v[204:205], v[180:181]
 v_pk_add_f32 v[204:205], v[204:205], v[182:183]
 v_pk_add_f32 v[204:205], v[204:205], v[184:185]
 v_pk_add_f32 v[204:205], v[204:205], v[186:187]
 v_add_f32 v204, v204, v205
 s_nop 1
 v_add_f32_dpp v204, v204, v204 quad_perm:[1,0,3,2] row_mask:0xf bank_mask:0xf
 s_nop 1
 v_add_f32_dpp v204, v204, v204 quad_perm:[2,3,0,1] row_mask:0xf bank_mask:0xf
 s_nop 1
 v_add_f32_dpp v204, v204, v204 row_half_mirror row_mask:0xf bank_mask:0xf
 s_nop 1
 v_add_f32_dpp v204, v204, v204 row_ror:8 row_mask:0xf bank_mask:0xf
 v_mov_b32 v205, v204
 s_nop 1
 v_permlane32_swap_b32 v204, v205
 v_add_f32 v204, v204, v205
 v_mov_b32 v205, v204
 s_nop 1
 v_permlane16_swap_b32 v204, v205
 v_add_f32 v204, v204, v205
 v_mul_f32 v204, 0x3ae38e39, v204
 v_mov_b32 v205, 0
 v_mov_b32 v206, 0
 v_sub_f32 v207, v172, v204
 v_fmac_f32 v205, v207, v207
 v_sub_f32 v207, v173, v204
 v_fmac_f32 v205, v207, v207
 v_sub_f32 v207, v174, v204
 v_fmac_f32 v205, v207, v207
 v_sub_f32 v207, v175, v204
 v_fmac_f32 v205, v207, v207
 v_sub_f32 v207, v176, v204
 v_fmac_f32 v205, v207, v207
 v_sub_f32 v207, v177, v204
 v_fmac_f32 v205, v207, v207
 v_sub_f32 v207, v178, v204
 v_fmac_f32 v205, v207, v207
 v_sub_f32 v207, v179, v204
 v_fmac_f32 v205, v207, v207
 v_sub_f32 v207, v180, v204
 v_fmac_f32 v206, v207, v207
 v_sub_f32 v207, v181, v204
 v_fmac_f32 v206, v207, v207
 v_sub_f32 v207, v182, v204
 v_fmac_f32 v206, v207, v207
 v_sub_f32 v207, v183, v204
 v_fmac_f32 v206, v207, v207
 v_sub_f32 v207, v184, v204
 v_fmac_f32 v206, v207, v207
 v_sub_f32 v207, v185, v204
 v_fmac_f32 v206, v207, v207
 v_sub_f32 v207, v186, v204
 v_fmac_f32 v206, v207, v207
 v_sub_f32 v207, v187, v204
 v_fmac_f32 v206, v207, v207
 v_cmp_gt_u32 vcc, 8, v220
 s_nop 1
 v_cndmask_b32 v206, 0, v206, vcc
 v_add_f32 v205, v205, v206
 s_nop 1
 v_add_f32_dpp v205, v205, v205 quad_perm:[1,0,3,2] row_mask:0xf bank_mask:0xf
 s_nop 1
 v_add_f32_dpp v205, v205, v205 quad_perm:[2,3,0,1] row_mask:0xf bank_mask:0xf
 s_nop 1
 v_add_f32_dpp v205, v205, v205 row_half_mirror row_mask:0xf bank_mask:0xf
 s_nop 1
 v_add_f32_dpp v205, v205, v205 row_ror:8 row_mask:0xf bank_mask:0xf
 v_mov_b32 v206, v205
 s_nop 1
 v_permlane32_swap_b32 v205, v206
 v_add_f32 v205, v205, v206
 v_mov_b32 v206, v205
 s_nop 1
 v_permlane16_swap_b32 v205, v206
 v_add_f32 v205, v205, v206
 v_mul_f32 v205, 0x3ae38e39, v205
 v_cvt_pk_bf16_f32 v206, v204, v204
 v_lshlrev_b32 v204, 16, v206
 v_cvt_pk_bf16_f32 v206, v205, v205
 v_lshlrev_b32 v205, 16, v206
 v_add_f32 v205, 0x3727c5ac, v205
 v_cvt_pk_bf16_f32 v206, v205, v205
 v_lshlrev_b32 v205, 16, v206
 v_sqrt_f32 v205, v205
 s_nop 0
 v_cvt_pk_bf16_f32 v206, v205, v205
 v_lshlrev_b32 v205, 16, v206
 v_rcp_f32 v205, v205
 s_nop 0
 v_sub_f32 v172, v172, v204
 v_sub_f32 v173, v173, v204
 v_cvt_pk_bf16_f32 v206, v172, v173
 v_lshlrev_b32 v172, 16, v206
 v_and_b32 v173, s96, v206
 v_mul_f32 v172, v172, v205
 v_mul_f32 v173, v173, v205
 v_cvt_pk_bf16_f32 v128, v172, v173
 v_sub_f32 v174, v174, v204
 v_sub_f32 v175, v175, v204
 v_cvt_pk_bf16_f32 v206, v174, v175
 v_lshlrev_b32 v174, 16, v206
 v_and_b32 v175, s96, v206
 v_mul_f32 v174, v174, v205
 v_mul_f32 v175, v175, v205
 v_cvt_pk_bf16_f32 v129, v174, v175
 v_sub_f32 v176, v176, v204
 v_sub_f32 v177, v177, v204
 v_cvt_pk_bf16_f32 v206, v176, v177
 v_lshlrev_b32 v176, 16, v206
 v_and_b32 v177, s96, v206
 v_mul_f32 v176, v176, v205
 v_mul_f32 v177, v177, v205
 v_cvt_pk_bf16_f32 v130, v176, v177
 v_sub_f32 v178, v178, v204
 v_sub_f32 v179, v179, v204
 v_cvt_pk_bf16_f32 v206, v178, v179
 v_lshlrev_b32 v178, 16, v206
 v_and_b32 v179, s96, v206
 v_mul_f32 v178, v178, v205
 v_mul_f32 v179, v179, v205
 v_cvt_pk_bf16_f32 v131, v178, v179
 v_sub_f32 v180, v180, v204
 v_sub_f32 v181, v181, v204
 v_cvt_pk_bf16_f32 v206, v180, v181
 v_lshlrev_b32 v180, 16, v206
 v_and_b32 v181, s96, v206
 v_mul_f32 v180, v180, v205
 v_mul_f32 v181, v181, v205
 v_cvt_pk_bf16_f32 v132, v180, v181
 v_sub_f32 v182, v182, v204
 v_sub_f32 v183, v183, v204
 v_cvt_pk_bf16_f32 v206, v182, v183
 v_lshlrev_b32 v182, 16, v206
 v_and_b32 v183, s96, v206
 v_mul_f32 v182, v182, v205
 v_mul_f32 v183, v183, v205
 v_cvt_pk_bf16_f32 v133, v182, v183
 v_sub_f32 v184, v184, v204
 v_sub_f32 v185, v185, v204
 v_cvt_pk_bf16_f32 v206, v184, v185
 v_lshlrev_b32 v184, 16, v206
 v_and_b32 v185, s96, v206
 v_mul_f32 v184, v184, v205
 v_mul_f32 v185, v185, v205
 v_cvt_pk_bf16_f32 v134, v184, v185
 v_sub_f32 v186, v186, v204
 v_sub_f32 v187, v187, v204
 v_cvt_pk_bf16_f32 v206, v186, v187
 v_lshlrev_b32 v186, 16, v206
 v_and_b32 v187, s96, v206
 v_mul_f32 v186, v186, v205
 v_mul_f32 v187, v187, v205
 v_cvt_pk_bf16_f32 v135, v186, v187
 v_lshrrev_b32 v204, 2, v220
 v_lshlrev_b32 v204, 11, v204
 v_and_b32 v205, 3, v220
 v_lshlrev_b32 v205, 8, v205
 v_add_u32 v204, v204, v205
 s_mul_i32 s61, s64, 36864
 s_lshr_b32 s62, s46, 4
 s_lshl_b32 s62, s62, 10
 s_add_u32 s61, s61, s62
 s_and_b32 s62, s46, 15
 s_lshl_b32 s62, s62, 4
 s_add_u32 s61, s61, s62
 s_add_u32 s61, s61, 79691776
 buffer_store_dwordx4 v[128:131], v204, s[4:7], s61 offen sc1
 s_add_u32 s61, s61, 32768
 s_mov_b64 exec, 0xff
 buffer_store_dwordx4 v[132:135], v204, s[4:7], s61 offen sc1
 s_mov_b64 exec, -1
 s_lshl_b32 s60, s64, 7
 s_lshl_b32 s61, s46, 2
 s_add_u32 s60, s60, s61
 s_add_u32 s20, s60, 73416704
L211:
 s_add_u32 s64, s64, 3
 s_cmp_lt_u32 s64, 64
 s_cbranch_scc0 L212
 s_waitcnt vmcnt(0)
 s_cmp_eq_u32 s20, -1
 s_cbranch_scc1 L213
 v_mov_b32 v232, 0
 v_mov_b32 v233, s21
 s_mov_b64 exec, 1
 buffer_store_dword v233, v232, s[4:7], s20 offen sc1
 s_mov_b64 exec, -1
 s_mov_b32 s20, -1
L213:
 s_barrier
 ds_read_b128 v[192:195], v221 offset:17408
 ds_read_b128 v[196:199], v221 offset:18432
 s_waitcnt lgkmcnt(1)
 v_mfma_f32_32x32x16_bf16 v[152:167], a[160:163], v[192:195], 0
 ds_read_b128 v[200:203], v221 offset:19456
 s_waitcnt lgkmcnt(1)
 v_mfma_f32_32x32x16_bf16 v[152:167], a[164:167], v[196:199], v[152:167]
 ds_read_b128 v[192:195], v221 offset:20480
 s_waitcnt lgkmcnt(1)
 v_mfma_f32_32x32x16_bf16 v[152:167], a[168:171], v[200:203], v[152:167]
 ds_read_b128 v[196:199], v221 offset:21504
 s_waitcnt lgkmcnt(1)
 v_mfma_f32_32x32x16_bf16 v[152:167], a[172:175], v[192:195], v[152:167]
 ds_read_b128 v[200:203], v221 offset:22528
 s_waitcnt lgkmcnt(1)
 v_mfma_f32_32x32x16_bf16 v[152:167], a[176:179], v[196:199], v[152:167]
 ds_read_b128 v[192:195], v221 offset:23552
 s_waitcnt lgkmcnt(1)
 v_mfma_f32_32x32x16_bf16 v[152:167], a[180:183], v[200:203], v[152:167]
 ds_read_b128 v[196:199], v221 offset:24576
 s_waitcnt lgkmcnt(1)
 v_mfma_f32_32x32x16_bf16 v[152:167], a[184:187], v[192:195], v[152:167]
 ds_read_b128 v[200:203], v221 offset:25600
 s_waitcnt lgkmcnt(1)
 v_mfma_f32_32x32x16_bf16 v[152:167], a[188:191], v[196:199], v[152:167]
 ds_read_b128 v[192:195], v221 offset:26624
 s_waitcnt lgkmcnt(1)
 v_mfma_f32_32x32x16_bf16 v[152:167], a[192:195], v[200:203], v[152:167]
 ds_read_b128 v[196:199], v221 offset:27648
 s_waitcnt lgkmcnt(1)
 v_mfma_f32_32x32x16_bf16 v[152:167], a[196:199], v[192:195], v[152:167]
 ds_read_b128 v[200:203], v221 offset:28672
 s_waitcnt lgkmcnt(1)
 v_mfma_f32_32x32x16_bf16 v[152:167], a[200:203], v[196:199], v[152:167]
 ds_read_b128 v[192:195], v221 offset:29696
 s_waitcnt lgkmcnt(1)
 v_mfma_f32_32x32x16_bf16 v[152:167], a[204:207], v[200:203], v[152:167]
 ds_read_b128 v[196:199], v221 offset:30720
 s_waitcnt lgkmcnt(1)
 v_mfma_f32_32x32x16_bf16 v[152:167], a[208:211], v[192:195], v[152:167]
 ds_read_b128 v[200:203], v221 offset:31744
 s_waitcnt lgkmcnt(1)
 v_mfma_f32_32x32x16_bf16 v[152:167], a[212:215], v[196:199], v[152:167]
 ds_read_b128 v[192:195], v221 offset:32768
 s_waitcnt lgkmcnt(1)
 v_mfma_f32_32x32x16_bf16 v[152:167], a[216:219], v[200:203], v[152:167]
 ds_read_b128 v[196:199], v221 offset:33792
 s_waitcnt lgkmcnt(1)
 v_mfma_f32_32x32x16_bf16 v[152:167], a[220:223], v[192:195], v[152:167]
 ds_read_b128 v[200:203], v221 offset:34816
 s_waitcnt lgkmcnt(1)
 v_mfma_f32_32x32x16_bf16 v[152:167], a[224:227], v[196:199], v[152:167]
 ds_read_b128 v[192:195], v221 offset:35840
 s_waitcnt lgkmcnt(1)
 v_mfma_f32_32x32x16_bf16 v[152:167], a[228:231], v[200:203], v[152:167]
 ds_read_b128 v[196:199], v221 offset:36864
 s_waitcnt lgkmcnt(1)
 v_mfma_f32_32x32x16_bf16 v[152:167], a[232:235], v[192:195], v[152:167]
 ds_read_b128 v[200:203], v221 offset:37888
 s_waitcnt lgkmcnt(1)
 v_mfma_f32_32x32x16_bf16 v[152:167], a[236:239], v[196:199], v[152:167]
 ds_read_b128 v[192:195], v221 offset:38912
 s_waitcnt lgkmcnt(1)
 v_mfma_f32_32x32x16_bf16 v[152:167], a[240:243], v[200:203], v[152:167]
 ds_read_b128 v[196:199], v221 offset:39936
 s_waitcnt lgkmcnt(1)
 v_mfma_f32_32x32x16_bf16 v[152:167], a[244:247], v[192:195], v[152:167]
 ds_read_b128 v[200:203], v221 offset:40960
 s_waitcnt lgkmcnt(1)
 v_mfma_f32_32x32x16_bf16 v[152:167], a[248:251], v[196:199], v[152:167]
 ds_read_b128 v[192:195], v221 offset:41984
 ds_read_b128 v[204:207], v217 offset:0
 s_waitcnt lgkmcnt(2)
 v_mfma_f32_32x32x16_bf16 v[152:167], a[252:255], v[200:203], v[152:167]
 ds_read_b128 v[196:199], v221 offset:43008
 ds_read_b128 v[232:235], v217 offset:1024
 s_waitcnt lgkmcnt(2)
 v_mfma_f32_32x32x16_bf16 v[152:167], v[204:207], v[192:195], v[152:167]
 ds_read_b128 v[200:203], v221 offset:44032
 ds_read_b128 v[204:207], v217 offset:2048
 s_waitcnt lgkmcnt(2)
 v_mfma_f32_32x32x16_bf16 v[152:167], v[232:235], v[196:199], v[152:167]
 ds_read_b128 v[192:195], v221 offset:45056
 ds_read_b128 v[232:235], v217 offset:3072
 s_waitcnt lgkmcnt(2)
 v_mfma_f32_32x32x16_bf16 v[152:167], v[204:207], v[200:203], v[152:167]
 ds_read_b128 v[196:199], v221 offset:46080
 ds_read_b128 v[204:207], v217 offset:4096
 s_waitcnt lgkmcnt(2)
 v_mfma_f32_32x32x16_bf16 v[152:167], v[232:235], v[192:195], v[152:167]
 ds_read_b128 v[200:203], v221 offset:47104
 ds_read_b128 v[232:235], v217 offset:5120
 s_waitcnt lgkmcnt(2)
 v_mfma_f32_32x32x16_bf16 v[152:167], v[204:207], v[196:199], v[152:167]
 ds_read_b128 v[192:195], v221 offset:48128
 ds_read_b128 v[204:207], v217 offset:6144
 s_waitcnt lgkmcnt(2)
 v_mfma_f32_32x32x16_bf16 v[152:167], v[232:235], v[200:203], v[152:167]
 ds_read_b128 v[196:199], v221 offset:49152
 ds_read_b128 v[232:235], v217 offset:7168
 s_waitcnt lgkmcnt(2)
 v_mfma_f32_32x32x16_bf16 v[152:167], v[204:207], v[192:195], v[152:167]
 ds_read_b128 v[200:203], v221 offset:50176
 ds_read_b128 v[204:207], v217 offset:8192
 s_waitcnt lgkmcnt(2)
 v_mfma_f32_32x32x16_bf16 v[152:167], v[232:235], v[196:199], v[152:167]
 ds_read_b128 v[192:195], v221 offset:51200
 ds_read_b128 v[232:235], v217 offset:9216
 s_waitcnt lgkmcnt(2)
 v_mfma_f32_32x32x16_bf16 v[152:167], v[204:207], v[200:203], v[152:167]
 ds_read_b128 v[196:199], v221 offset:52224
 ds_read_b128 v[204:207], v217 offset:10240
 s_waitcnt lgkmcnt(2)
 v_mfma_f32_32x32x16_bf16 v[152:167], v[232:235], v[192:195], v[152:167]
 ds_read_b128 v[200:203], v221 offset:53248
 ds_read_b128 v[232:235], v217 offset:11264
 s_waitcnt lgkmcnt(2)
 v_mfma_f32_32x32x16_bf16 v[152:167], v[204:207], v[196:199], v[152:167]
 s_waitcnt lgkmcnt(0)
 v_mfma_f32_32x32x16_bf16 v[152:167], v[232:235], v[200:203], v[152:167]
 s_nop 7
 s_nop 3
 v_cvt_pk_bf16_f32 v168, v152, v153
 v_cvt_pk_bf16_f32 v169, v154, v155
 v_cvt_pk_bf16_f32 v170, v156, v157
 v_cvt_pk_bf16_f32 v171, v158, v159
 ds_write_b128 v216, v[168:171] offset:0
 v_cvt_pk_bf16_f32 v172, v160, v161
 v_cvt_pk_bf16_f32 v173, v162, v163
 v_cvt_pk_bf16_f32 v174, v164, v165
 v_cvt_pk_bf16_f32 v175, v166, v167
 ds_write_b128 v216, v[172:175] offset:256
 s_waitcnt lgkmcnt(0)
 s_barrier
 s_and_b32 s60, s44, 1
 s_lshl_b32 s60, s60, 12
 v_add_u32 v232, s60, v221
 ds_read_b128 v[0:3], v232 offset:54272
 ds_read_b128 v[4:7], v232 offset:55296
 ds_read_b128 v[8:11], v232 offset:56320
 ds_read_b128 v[12:15], v232 offset:57344
 s_branch T2_LOOP181
L212:
 s_waitcnt vmcnt(0)
 s_cmp_eq_u32 s44, 0
 s_cbranch_scc0 L214
 v_mov_b32 v232, 0
 v_mov_b32 v233, s21
 s_mov_b64 exec, 1
 buffer_store_dword v233, v232, s[4:7], s20 offen sc1
 s_mov_b64 exec, -1
L214:
 s_waitcnt vmcnt(0)
 s_endpgm
S_CHAIN:
 v_and_b32 v1, 63, v0
 v_mov_b32 v61, v1
 v_and_b32 v2, 8, v1
 v_cmp_eq_u32 vcc, 0, v2
 v_mov_b32 v3, 0xeeee
 v_mov_b32 v4, 0x4444
 v_lshlrev_b32 v5, 4, v1
 v_cndmask_b32 v48, v3, v4, vcc
 v_add_u32 v49, 131072, v5
 s_lshl_b32 s92, s44, 12
 v_add_u32 v50, s92, v5
 s_lshl_b32 s60, s44, 11
 v_add_u32 v58, s60, v49
 v_mov_b32 v57, v5
 v_and_b32 v7, 15, v1
 v_bfe_u32 v8, v1, 4, 1
 v_lshrrev_b32 v9, 5, v1
 v_lshlrev_b32 v6, 11, v9
 v_lshlrev_b32 v10, 4, v7
 v_add_u32 v6, v6, v10
 v_lshlrev_b32 v10, 3, v8
 v_add_u32 v6, v6, v10
 s_lshl_b32 s60, s44, 9
 s_add_u32 s60, s60, 156672
 v_add_u32 v51, s60, v6
 v_lshlrev_b32 v6, 8, v8
 v_lshlrev_b32 v10, 6, v9
 v_add_u32 v6, v6, v10
 v_bfe_u32 v10, v1, 2, 2
 v_lshlrev_b32 v10, 4, v10
 v_add_u32 v6, v6, v10
 v_and_b32 v10, 1, v1
 v_lshlrev_b32 v10, 3, v10
 v_add_u32 v6, v6, v10
 v_add_u32 v52, 156672, v6
 v_lshlrev_b32 v6, 7, v9
 v_lshlrev_b32 v10, 4, v7
 v_add_u32 v6, v6, v10
 v_lshlrev_b32 v10, 3, v8
 v_add_u32 v6, v6, v10
 s_lshr_b32 s60, s44, 1
 s_lshl_b32 s60, s60, 10
 s_and_b32 s61, s44, 1
 s_lshl_b32 s61, s61, 9
 s_add_u32 s60, s60, s61
 s_add_u32 s60, s60, 160768
 v_add_u32 v53, s60, v6
 v_lshlrev_b32 v6, 8, v9
 v_lshlrev_b32 v10, 7, v8
 v_add_u32 v6, v6, v10
 v_and_b32 v10, 7, v1
 v_lshlrev_b32 v10, 4, v10
 v_add_u32 v6, v6, v10
 v_add_u32 v59, 131072, v6
 s_lshl_b32 s60, s46, 13
 s_lshl_b32 s61, s44, 10
 s_add_u32 s60, s60, s61
 s_add_u32 s60, s60, 54525952
 v_add_u32 v62, s60, v5
 s_mul_i32 s60, s46, 10240
 s_lshl_b32 s61, s44, 11
 s_add_u32 s60, s60, s61
 s_add_u32 s60, s60, 72351744
 v_add_u32 v54, s60, v5
 v_cmp_gt_u32 vcc, 32, v1
 v_mov_b32 v6, 1.0
 v_mov_b32 v10, 0
 v_cndmask_b32 v60, v10, v6, vcc
 s_mov_b32 s72, 0
 s_mov_b32 s60, s46
 s_cmp_eq_u32 s44, 0
 s_cselect_b32 s72, 1, 0
 s_cmp_eq_u32 s44, 1
 s_cbranch_scc0 L215
 s_cmp_lt_u32 s46, 8
 s_cbranch_scc0 L215
 s_mov_b32 s72, 2
 s_add_u32 s60, s46, 32
L215:
 v_lshrrev_b32 v6, 4, v1
 v_mul_u32_u24 v6, 10240, v6
 v_lshlrev_b32 v10, 4, v7
 v_add_u32 v6, v6, v10
 s_lshl_b32 s61, s60, 8
 s_add_u32 s61, s61, 72351744
 v_add_u32 v55, s61, v6
 s_mov_b32 s64, 0
 s_mov_b32 s65, 40960
 s_mov_b32 s66, 81920
 s_mov_b32 s67, 122880
 s_mov_b32 s68, 163840
 s_mov_b32 s69, 204800
 s_mov_b32 s70, 245760
 s_mov_b32 s71, 286720
 s_cmp_eq_u32 s72, 2
 s_cbranch_scc0 L216
 s_sub_u32 s61, s60, 32
 s_lshr_b32 s61, s61, 1
 s_mul_i32 s61, s61, 9
 s_add_u32 s61, s61, 8
 v_mov_b32 v10, s61
 s_mov_b32 s82, 0x000f000f
 s_branch L217
L216:
 s_lshr_b32 s61, s60, 3
 s_mul_i32 s61, s61, 9
 s_bfe_u32 s62, s60, 0x10002
 s_lshl_b32 s62, s62, 2
 s_add_u32 s61, s61, s62
 s_bfe_u32 s62, s60, 0x10001
 s_add_u32 s61, s61, s62
 v_bfe_u32 v10, v1, 2, 1
 v_lshlrev_b32 v10, 1, v10
 v_add_u32 v10, s61, v10
 s_mov_b32 s82, 0x00ff00ff
L217:
 s_mov_b32 s83, s82
 s_and_b32 s62, s60, 1
 s_lshl_b32 s62, s62, 2
 v_and_b32 v11, 3, v1
 v_add_u32 v11, s62, v11
 v_lshrrev_b32 v12, 2, v10
 v_lshlrev_b32 v12, 10, v12
 v_and_b32 v13, 3, v10
 v_lshlrev_b32 v13, 8, v13
 v_add_u32 v12, v12, v13
 v_lshlrev_b32 v13, 7, v9
 v_add_u32 v12, v12, v13
 v_lshlrev_b32 v13, 4, v11
 v_add_u32 v12, v12, v13
 v_lshlrev_b32 v13, 3, v8
 v_add_u32 v12, v12, v13
 v_add_u32 v56, 71303168, v12
 s_mov_b32 s80, 0x3e0293ee
 s_mov_b32 s81, 0xbe0293ee
 s_mov_b32 s84, 0x00ff00ff
 s_mov_b32 s85, 0x00ff00ff
 s_mov_b32 s86, -1
 s_mov_b32 s87, 0x003fffff
 s_mov_b32 s88, -1
 s_mov_b32 s89, 0
 s_mov_b32 s91, 8192
 v_lshlrev_b32 v6, 4, v0
 s_mul_i32 s62, s46, 10240
 s_add_u32 s63, s62, 72351744
 v_add_u32 v7, s63, v6
 s_mul_i32 s62, s46, 18432
 s_add_u32 s63, s62, 71303168
 v_add_u32 v9, s63, v6
 v_mov_b32 v12, 0
 v_mov_b32 v13, 0
 v_mov_b32 v14, 0
 v_mov_b32 v15, 0
 v_mov_b32 v16, -1
 v_mov_b32 v17, -1
 v_mov_b32 v18, -1
 v_mov_b32 v19, -1
 s_mov_b32 s63, 0
 buffer_store_dwordx4 v[12:15], v7, s[4:7], s63 offen sc1
 buffer_store_dwordx4 v[16:19], v9, s[4:7], s63 offen sc1
 s_mov_b32 s63, 4096
 buffer_store_dwordx4 v[12:15], v7, s[4:7], s63 offen sc1
 buffer_store_dwordx4 v[16:19], v9, s[4:7], s63 offen sc1
 s_mov_b32 s63, 8192
 buffer_store_dwordx4 v[16:19], v9, s[4:7], s63 offen sc1
 s_mov_b32 s63, 12288
 buffer_store_dwordx4 v[16:19], v9, s[4:7], s63 offen sc1
 s_cmp_ge_u32 s44, 2
 s_cbranch_scc1 L218
 s_mov_b32 s63, 8192
 buffer_store_dwordx4 v[12:15], v7, s[4:7], s63 offen sc1
 s_mov_b32 s63, 16384
 buffer_store_dwordx4 v[16:19], v9, s[4:7], s63 offen sc1
L218:
 s_mov_b32 s61, 0
 s_lshl_b32 s60, s46, 6
 s_add_u32 s60, s60, 73404416
 v_mov_b32 v11, s61
 s_mov_b64 exec, 1
 buffer_store_dword v11, v57, s[4:7], s60 offen sc1
 s_mov_b64 exec, -1
 s_mov_b32 s12, s20
 s_mov_b32 s13, s21
 s_mov_b32 s14, 4718592
 s_mov_b32 s15, 0x20000
 s_mov_b32 s48, s22
 s_mov_b32 s49, s23
 s_mov_b32 s50, 4718592
 s_mov_b32 s51, 0x20000
 s_mov_b32 s52, s24
 s_mov_b32 s53, s25
 s_mov_b32 s54, 4718592
 s_mov_b32 s55, 0x20000
 s_mov_b32 s56, s26
 s_mov_b32 s57, s27
 s_mov_b32 s58, 4718592
 s_mov_b32 s59, 0x20000
 v_mov_b32 v1, v61
 v_lshrrev_b32 v6, 4, v1
 s_lshl_b32 s60, s44, 4
 v_add_u32 v6, s60, v6
 v_lshlrev_b32 v6, 13, v6
 v_and_b32 v7, 15, v1
 v_lshlrev_b32 v7, 4, v7
 v_add_u32 v6, v6, v7
 s_lshl_b32 s60, s46, 8
 v_add_u32 v0, s60, v6
 s_mul_i32 s60, s46, 147456
 v_lshlrev_b32 v6, 4, v1
 v_add_u32 v2, s60, v6
 v_lshrrev_b32 v6, 2, v1
 v_lshlrev_b32 v6, 13, v6
 v_and_b32 v7, 3, v1
 v_lshlrev_b32 v8, 4, v7
 v_add_u32 v6, v6, v8
 s_lshl_b32 s60, s46, 8
 s_lshl_b32 s61, s44, 6
 s_add_u32 s60, s60, s61
 v_add_u32 v3, s60, v6
 v_lshlrev_b32 v7, 3, v7
 v_lshrrev_b32 v6, 5, v1
 v_lshlrev_b32 v6, 3, v6
 v_bfe_u32 v8, v1, 4, 1
 v_lshlrev_b32 v8, 2, v8
 v_add_u32 v6, v6, v8
 v_bfe_u32 v8, v1, 2, 1
 v_add_u32 v6, v6, v8
 v_bfe_u32 v9, v1, 3, 1
 v_lshlrev_b32 v8, 8, v6
 v_add_u32 v8, v8, v7
 s_lshl_b32 s60, s44, 6
 v_add_u32 v8, s60, v8
 v_lshlrev_b32 v10, 14, v9
 v_add_u32 v4, v10, v8
 v_lshlrev_b32 v10, 5, v9
 v_add_u32 v5, v10, v8
 v_lshlrev_b32 v8, 6, v6
 v_add_u32 v8, v8, v7
 v_add_u32 v8, v8, v10
 v_add_u32 v14, s92, v8
 v_mul_u32_u24 v8, 1152, v6
 v_add_u32 v8, v8, v7
 v_add_u32 v8, v8, v10
 s_mul_i32 s60, s44, 288
 v_add_u32 v12, s60, v8
 v_lshrrev_b32 v6, 5, v1
 v_lshlrev_b32 v6, 4, v6
 v_bfe_u32 v8, v1, 4, 1
 v_lshlrev_b32 v8, 2, v8
 v_add_u32 v6, v6, v8
 v_bfe_u32 v8, v1, 2, 1
 v_add_u32 v6, v6, v8
 v_lshlrev_b32 v8, 3, v9
 v_add_u32 v6, v6, v8
 v_mul_u32_u24 v8, 1152, v6
 v_add_u32 v8, v8, v7
 v_add_u32 v13, s60, v8
 s_lshl_b32 s93, s44, 12
 s_mul_i32 s63, s46, 7
 s_mul_i32 s62, s44, 9
 s_add_u32 s63, s63, s62
 s_mul_hi_u32 s62, s63, 0x71c71c8
 s_mul_i32 s62, s62, 36
 s_sub_u32 s63, s63, s62
 s_lshl_b32 s63, s63, 10
 v_lshrrev_b32 v6, 4, v1
 v_and_b32 v7, 15, v1
 v_and_b32 v8, 1, v6
 s_lshl_b32 s60, s44, 4
 v_add_u32 v6, s60, v6
 v_lshlrev_b32 v6, 13, v6
 s_lshl_b32 s60, s46, 8
 v_add_u32 v6, s60, v6
 v_add_u32 v10, 0, v8
 v_lshlrev_b32 v10, 1, v10
 v_sub_u32 v10, v7, v10
 v_and_b32 v10, 15, v10
 v_lshlrev_b32 v10, 4, v10
 v_add_u32 v32, v6, v10
 v_add_u32 v10, 4, v8
 v_lshlrev_b32 v10, 1, v10
 v_sub_u32 v10, v7, v10
 v_and_b32 v10, 15, v10
 v_lshlrev_b32 v10, 4, v10
 v_add_u32 v33, v6, v10
 v_add_u32 v10, 2, v8
 v_lshlrev_b32 v10, 1, v10
 v_sub_u32 v10, v7, v10
 v_and_b32 v10, 15, v10
 v_lshlrev_b32 v10, 4, v10
 v_add_u32 v34, v6, v10
 v_add_u32 v10, 6, v8
 v_lshlrev_b32 v10, 1, v10
 v_sub_u32 v10, v7, v10
 v_and_b32 v10, 15, v10
 v_lshlrev_b32 v10, 4, v10
 v_add_u32 v35, v6, v10
 v_bfe_u32 v6, v1, 2, 1
 v_bfe_u32 v7, v1, 4, 1
 v_lshlrev_b32 v7, 1, v7
 v_add_u32 v6, v6, v7
 v_lshlrev_b32 v7, 2, v9
 v_add_u32 v6, v6, v7
 s_lshl_b32 s60, s44, 1
 v_add_u32 v6, s60, v6
 v_lshrrev_b32 v7, 5, v1
 v_lshlrev_b32 v7, 3, v7
 v_bfe_u32 v8, v1, 4, 1
 v_lshlrev_b32 v8, 2, v8
 v_add_u32 v7, v7, v8
 v_bfe_u32 v8, v1, 2, 1
 v_add_u32 v7, v7, v8
 v_lshlrev_b32 v7, 8, v7
 v_lshlrev_b32 v8, 14, v9
 v_add_u32 v7, v7, v8
 v_and_b32 v8, 3, v1
 v_lshlrev_b32 v8, 3, v8
 v_add_u32 v7, v7, v8
 v_add_u32 v8, 0, v6
 v_and_b32 v8, 7, v8
 v_lshlrev_b32 v8, 5, v8
 v_add_u32 v36, v7, v8
 v_add_u32 v8, 1, v6
 v_and_b32 v8, 7, v8
 v_lshlrev_b32 v8, 5, v8
 v_add_u32 v37, v7, v8
 s_add_u32 s62, s63, 0
 s_sub_u32 s61, s62, 36864
 s_cmp_ge_u32 s62, 36864
 s_cselect_b32 s62, s61, s62
 s_add_u32 m0, s62, 0
 s_add_u32 s60, s62, 0
 buffer_load_dwordx4 v2, s[56:59], s60 offen lds
 s_add_u32 s62, s63, 1024
 s_sub_u32 s61, s62, 36864
 s_cmp_ge_u32 s62, 36864
 s_cselect_b32 s62, s61, s62
 s_add_u32 m0, s62, 0
 s_add_u32 s60, s62, 0
 buffer_load_dwordx4 v2, s[56:59], s60 offen lds
 s_add_u32 s62, s63, 2048
 s_sub_u32 s61, s62, 36864
 s_cmp_ge_u32 s62, 36864
 s_cselect_b32 s62, s61, s62
 s_add_u32 m0, s62, 0
 s_add_u32 s60, s62, 0
 buffer_load_dwordx4 v2, s[56:59], s60 offen lds
 s_add_u32 s62, s63, 3072
 s_sub_u32 s61, s62, 36864
 s_cmp_ge_u32 s62, 36864
 s_cselect_b32 s62, s61, s62
 s_add_u32 m0, s62, 0
 s_add_u32 s60, s62, 0
 buffer_load_dwordx4 v2, s[56:59], s60 offen lds
 s_add_u32 s62, s63, 4096
 s_sub_u32 s61, s62, 36864
 s_cmp_ge_u32 s62, 36864
 s_cselect_b32 s62, s61, s62
 s_add_u32 m0, s62, 0
 s_add_u32 s60, s62, 0
 buffer_load_dwordx4 v2, s[56:59], s60 offen lds
 s_add_u32 s62, s63, 5120
 s_sub_u32 s61, s62, 36864
 s_cmp_ge_u32 s62, 36864
 s_cselect_b32 s62, s61, s62
 s_add_u32 m0, s62, 0
 s_add_u32 s60, s62, 0
 buffer_load_dwordx4 v2, s[56:59], s60 offen lds
 s_add_u32 s62, s63, 6144
 s_sub_u32 s61, s62, 36864
 s_cmp_ge_u32 s62, 36864
 s_cselect_b32 s62, s61, s62
 s_add_u32 m0, s62, 0
 s_add_u32 s60, s62, 0
 buffer_load_dwordx4 v2, s[56:59], s60 offen lds
 s_add_u32 s62, s63, 7168
 s_sub_u32 s61, s62, 36864
 s_cmp_ge_u32 s62, 36864
 s_cselect_b32 s62, s61, s62
 s_add_u32 m0, s62, 0
 s_add_u32 s60, s62, 0
 buffer_load_dwordx4 v2, s[56:59], s60 offen lds
 s_add_u32 s62, s63, 8192
 s_sub_u32 s61, s62, 36864
 s_cmp_ge_u32 s62, 36864
 s_cselect_b32 s62, s61, s62
 s_add_u32 m0, s62, 0
 s_add_u32 s60, s62, 0
 buffer_load_dwordx4 v2, s[56:59], s60 offen lds
 s_add_u32 s62, s63, 0
 s_sub_u32 s61, s62, 36864
 s_cmp_ge_u32 s62, 36864
 s_cselect_b32 s62, s61, s62
 s_add_u32 m0, s62, 36864
 s_add_u32 s60, s62, 36864
 buffer_load_dwordx4 v2, s[56:59], s60 offen lds
 s_add_u32 s62, s63, 1024
 s_sub_u32 s61, s62, 36864
 s_cmp_ge_u32 s62, 36864
 s_cselect_b32 s62, s61, s62
 s_add_u32 m0, s62, 36864
 s_add_u32 s60, s62, 36864
 buffer_load_dwordx4 v2, s[56:59], s60 offen lds
 s_add_u32 s62, s63, 2048
 s_sub_u32 s61, s62, 36864
 s_cmp_ge_u32 s62, 36864
 s_cselect_b32 s62, s61, s62
 s_add_u32 m0, s62, 36864
 s_add_u32 s60, s62, 36864
 buffer_load_dwordx4 v2, s[56:59], s60 offen lds
 s_add_u32 s62, s63, 3072
 s_sub_u32 s61, s62, 36864
 s_cmp_ge_u32 s62, 36864
 s_cselect_b32 s62, s61, s62
 s_add_u32 m0, s62, 36864
 s_add_u32 s60, s62, 36864
 buffer_load_dwordx4 v2, s[56:59], s60 offen lds
 s_add_u32 s62, s63, 4096
 s_sub_u32 s61, s62, 36864
 s_cmp_ge_u32 s62, 36864
 s_cselect_b32 s62, s61, s62
 s_add_u32 m0, s62, 36864
 s_add_u32 s60, s62, 36864
 buffer_load_dwordx4 v2, s[56:59], s60 offen lds
 s_add_u32 s62, s63, 5120
 s_sub_u32 s61, s62, 36864
 s_cmp_ge_u32 s62, 36864
 s_cselect_b32 s62, s61, s62
 s_add_u32 m0, s62, 36864
 s_add_u32 s60, s62, 36864
 buffer_load_dwordx4 v2, s[56:59], s60 offen lds
 s_add_u32 s62, s63, 6144
 s_sub_u32 s61, s62, 36864
 s_cmp_ge_u32 s62, 36864
 s_cselect_b32 s62, s61, s62
 s_add_u32 m0, s62, 36864
 s_add_u32 s60, s62, 36864
 buffer_load_dwordx4 v2, s[56:59], s60 offen lds
 s_add_u32 s62, s63, 7168
 s_sub_u32 s61, s62, 36864
 s_cmp_ge_u32 s62, 36864
 s_cselect_b32 s62, s61, s62
 s_add_u32 m0, s62, 36864
 s_add_u32 s60, s62, 36864
 buffer_load_dwordx4 v2, s[56:59], s60 offen lds
 s_add_u32 s62, s63, 8192
 s_sub_u32 s61, s62, 36864
 s_cmp_ge_u32 s62, 36864
 s_cselect_b32 s62, s61, s62
 s_add_u32 m0, s62, 36864
 s_add_u32 s60, s62, 36864
 buffer_load_dwordx4 v2, s[56:59], s60 offen lds
 s_add_u32 s62, s63, 0
 s_sub_u32 s61, s62, 36864
 s_cmp_ge_u32 s62, 36864
 s_cselect_b32 s62, s61, s62
 s_add_u32 m0, s62, 73728
 s_add_u32 s60, s62, 73728
 buffer_load_dwordx4 v2, s[56:59], s60 offen lds
 s_add_u32 s62, s63, 1024
 s_sub_u32 s61, s62, 36864
 s_cmp_ge_u32 s62, 36864
 s_cselect_b32 s62, s61, s62
 s_add_u32 m0, s62, 73728
 s_add_u32 s60, s62, 73728
 buffer_load_dwordx4 v2, s[56:59], s60 offen lds
 s_add_u32 s62, s63, 2048
 s_sub_u32 s61, s62, 36864
 s_cmp_ge_u32 s62, 36864
 s_cselect_b32 s62, s61, s62
 s_add_u32 m0, s62, 73728
 s_add_u32 s60, s62, 73728
 buffer_load_dwordx4 v2, s[56:59], s60 offen lds
 s_add_u32 s62, s63, 3072
 s_sub_u32 s61, s62, 36864
 s_cmp_ge_u32 s62, 36864
 s_cselect_b32 s62, s61, s62
 s_add_u32 m0, s62, 73728
 s_add_u32 s60, s62, 73728
 buffer_load_dwordx4 v2, s[56:59], s60 offen lds
 s_add_u32 s62, s63, 4096
 s_sub_u32 s61, s62, 36864
 s_cmp_ge_u32 s62, 36864
 s_cselect_b32 s62, s61, s62
 s_add_u32 m0, s62, 73728
 s_add_u32 s60, s62, 73728
 buffer_load_dwordx4 v2, s[56:59], s60 offen lds
 s_add_u32 s62, s63, 5120
 s_sub_u32 s61, s62, 36864
 s_cmp_ge_u32 s62, 36864
 s_cselect_b32 s62, s61, s62
 s_add_u32 m0, s62, 73728
 s_add_u32 s60, s62, 73728
 buffer_load_dwordx4 v2, s[56:59], s60 offen lds
 s_add_u32 s62, s63, 6144
 s_sub_u32 s61, s62, 36864
 s_cmp_ge_u32 s62, 36864
 s_cselect_b32 s62, s61, s62
 s_add_u32 m0, s62, 73728
 s_add_u32 s60, s62, 73728
 buffer_load_dwordx4 v2, s[56:59], s60 offen lds
 s_add_u32 s62, s63, 7168
 s_sub_u32 s61, s62, 36864
 s_cmp_ge_u32 s62, 36864
 s_cselect_b32 s62, s61, s62
 s_add_u32 m0, s62, 73728
 s_add_u32 s60, s62, 73728
 buffer_load_dwordx4 v2, s[56:59], s60 offen lds
 s_add_u32 s62, s63, 8192
 s_sub_u32 s61, s62, 36864
 s_cmp_ge_u32 s62, 36864
 s_cselect_b32 s62, s61, s62
 s_add_u32 m0, s62, 73728
 s_add_u32 s60, s62, 73728
 buffer_load_dwordx4 v2, s[56:59], s60 offen lds
 s_add_u32 s62, s63, 0
 s_sub_u32 s61, s62, 36864
 s_cmp_ge_u32 s62, 36864
 s_cselect_b32 s62, s61, s62
 s_add_u32 m0, s62, 110592
 s_add_u32 s60, s62, 110592
 buffer_load_dwordx4 v2, s[56:59], s60 offen lds
 s_add_u32 s62, s63, 1024
 s_sub_u32 s61, s62, 36864
 s_cmp_ge_u32 s62, 36864
 s_cselect_b32 s62, s61, s62
 s_add_u32 m0, s62, 110592
 s_add_u32 s60, s62, 110592
 buffer_load_dwordx4 v2, s[56:59], s60 offen lds
 s_add_u32 s62, s63, 2048
 s_sub_u32 s61, s62, 36864
 s_cmp_ge_u32 s62, 36864
 s_cselect_b32 s62, s61, s62
 s_add_u32 m0, s62, 110592
 s_add_u32 s60, s62, 110592
 buffer_load_dwordx4 v2, s[56:59], s60 offen lds
 s_add_u32 s62, s63, 3072
 s_sub_u32 s61, s62, 36864
 s_cmp_ge_u32 s62, 36864
 s_cselect_b32 s62, s61, s62
 s_add_u32 m0, s62, 110592
 s_add_u32 s60, s62, 110592
 buffer_load_dwordx4 v2, s[56:59], s60 offen lds
 s_add_u32 s62, s63, 4096
 s_sub_u32 s61, s62, 36864
 s_cmp_ge_u32 s62, 36864
 s_cselect_b32 s62, s61, s62
 s_add_u32 m0, s62, 110592
 s_add_u32 s60, s62, 110592
 buffer_load_dwordx4 v2, s[56:59], s60 offen lds
 s_add_u32 s62, s63, 5120
 s_sub_u32 s61, s62, 36864
 s_cmp_ge_u32 s62, 36864
 s_cselect_b32 s62, s61, s62
 s_add_u32 m0, s62, 110592
 s_add_u32 s60, s62, 110592
 buffer_load_dwordx4 v2, s[56:59], s60 offen lds
 s_add_u32 s62, s63, 6144
 s_sub_u32 s61, s62, 36864
 s_cmp_ge_u32 s62, 36864
 s_cselect_b32 s62, s61, s62
 s_add_u32 m0, s62, 110592
 s_add_u32 s60, s62, 110592
 buffer_load_dwordx4 v2, s[56:59], s60 offen lds
 s_add_u32 s62, s63, 7168
 s_sub_u32 s61, s62, 36864
 s_cmp_ge_u32 s62, 36864
 s_cselect_b32 s62, s61, s62
 s_add_u32 m0, s62, 110592
 s_add_u32 s60, s62, 110592
 buffer_load_dwordx4 v2, s[56:59], s60 offen lds
 s_add_u32 s62, s63, 8192
 s_sub_u32 s61, s62, 36864
 s_cmp_ge_u32 s62, 36864
 s_cselect_b32 s62, s61, s62
 s_add_u32 m0, s62, 110592
 s_add_u32 s60, s62, 110592
 buffer_load_dwordx4 v2, s[56:59], s60 offen lds
 s_waitcnt vmcnt(27)
 s_barrier
 v_mov_b32 v40, 0
 v_mov_b32 v41, 0
 s_cmp_eq_u32 s44, 0
 s_cbranch_scc0 L219
 v_mov_b32 v40, 0
 v_mov_b32 v41, 1
 s_mov_b64 exec, 1
 buffer_atomic_add v41, v40, s[8:11], 0 offen offset:112 sc1
 s_mov_b64 exec, -1
L219:
 v_add_u32 v15, 0, v12
 ds_read_b64_tr_b16 v[64:65], v15 offset:0
 ds_read_b64_tr_b16 v[66:67], v15 offset:2304
 ds_read_b64_tr_b16 v[68:69], v15 offset:18432
 ds_read_b64_tr_b16 v[70:71], v15 offset:20736
 ds_read_b64_tr_b16 v[96:97], v15 offset:64
 ds_read_b64_tr_b16 v[98:99], v15 offset:2368
 ds_read_b64_tr_b16 v[100:101], v15 offset:18496
 ds_read_b64_tr_b16 v[102:103], v15 offset:20800
 ds_read_b64_tr_b16 v[128:129], v15 offset:128
 ds_read_b64_tr_b16 v[130:131], v15 offset:2432
 ds_read_b64_tr_b16 v[132:133], v15 offset:18560
 ds_read_b64_tr_b16 v[134:135], v15 offset:20864
 ds_read_b64_tr_b16 v[160:161], v15 offset:192
 ds_read_b64_tr_b16 v[162:163], v15 offset:2496
 ds_read_b64_tr_b16 v[164:165], v15 offset:18624
 ds_read_b64_tr_b16 v[166:167], v15 offset:20928
 v_add_u32 v15, 0, v13
 ds_read_b64_tr_b16 v[192:193], v15 offset:256
 ds_read_b64_tr_b16 v[194:195], v15 offset:2560
 s_waitcnt lgkmcnt(0)
 s_barrier
 s_add_u32 m0, s93, 0
 s_mov_b32 s60, 0
 buffer_load_dwordx4 v32, s[12:15], s60 offen lds
 s_add_u32 m0, s93, 1024
 s_mov_b32 s60, 32768
 buffer_load_dwordx4 v34, s[12:15], s60 offen lds
 s_add_u32 m0, s93, 2048
 s_mov_b32 s60, 65536
 buffer_load_dwordx4 v32, s[12:15], s60 offen lds
 s_add_u32 m0, s93, 3072
 s_mov_b32 s60, 98304
 buffer_load_dwordx4 v34, s[12:15], s60 offen lds
 s_add_u32 m0, s93, 16384
 s_mov_b32 s60, 0
 buffer_load_dwordx4 v33, s[48:51], s60 offen lds
 s_add_u32 m0, s93, 17408
 s_mov_b32 s60, 32768
 buffer_load_dwordx4 v35, s[48:51], s60 offen lds
 s_add_u32 m0, s93, 18432
 s_mov_b32 s60, 65536
 buffer_load_dwordx4 v33, s[48:51], s60 offen lds
 s_add_u32 m0, s93, 19456
 s_mov_b32 s60, 98304
 buffer_load_dwordx4 v35, s[48:51], s60 offen lds
 s_waitcnt vmcnt(26)
 s_barrier
 v_add_u32 v15, 36864, v12
 ds_read_b64_tr_b16 v[72:73], v15 offset:0
 ds_read_b64_tr_b16 v[74:75], v15 offset:2304
 ds_read_b64_tr_b16 v[76:77], v15 offset:18432
 ds_read_b64_tr_b16 v[78:79], v15 offset:20736
 ds_read_b64_tr_b16 v[104:105], v15 offset:64
 ds_read_b64_tr_b16 v[106:107], v15 offset:2368
 ds_read_b64_tr_b16 v[108:109], v15 offset:18496
 ds_read_b64_tr_b16 v[110:111], v15 offset:20800
 ds_read_b64_tr_b16 v[136:137], v15 offset:128
 ds_read_b64_tr_b16 v[138:139], v15 offset:2432
 ds_read_b64_tr_b16 v[140:141], v15 offset:18560
 ds_read_b64_tr_b16 v[142:143], v15 offset:20864
 ds_read_b64_tr_b16 v[168:169], v15 offset:192
 ds_read_b64_tr_b16 v[170:171], v15 offset:2496
 ds_read_b64_tr_b16 v[172:173], v15 offset:18624
 ds_read_b64_tr_b16 v[174:175], v15 offset:20928
 v_add_u32 v15, 36864, v13
 ds_read_b64_tr_b16 v[196:197], v15 offset:256
 ds_read_b64_tr_b16 v[198:199], v15 offset:2560
 s_waitcnt lgkmcnt(0)
 s_barrier
 s_add_u32 m0, s93, 36864
 s_mov_b32 s60, 524288
 buffer_load_dwordx4 v32, s[12:15], s60 offen lds
 s_add_u32 m0, s93, 37888
 s_mov_b32 s60, 557056
 buffer_load_dwordx4 v34, s[12:15], s60 offen lds
 s_add_u32 m0, s93, 38912
 s_mov_b32 s60, 589824
 buffer_load_dwordx4 v32, s[12:15], s60 offen lds
 s_add_u32 m0, s93, 39936
 s_mov_b32 s60, 622592
 buffer_load_dwordx4 v34, s[12:15], s60 offen lds
 s_add_u32 m0, s93, 53248
 s_mov_b32 s60, 524288
 buffer_load_dwordx4 v33, s[48:51], s60 offen lds
 s_add_u32 m0, s93, 54272
 s_mov_b32 s60, 557056
 buffer_load_dwordx4 v35, s[48:51], s60 offen lds
 s_add_u32 m0, s93, 55296
 s_mov_b32 s60, 589824
 buffer_load_dwordx4 v33, s[48:51], s60 offen lds
 s_add_u32 m0, s93, 56320
 s_mov_b32 s60, 622592
 buffer_load_dwordx4 v35, s[48:51], s60 offen lds
 s_waitcnt vmcnt(25)
 s_barrier
 v_add_u32 v15, 73728, v12
 ds_read_b64_tr_b16 v[80:81], v15 offset:0
 ds_read_b64_tr_b16 v[82:83], v15 offset:2304
 ds_read_b64_tr_b16 v[84:85], v15 offset:18432
 ds_read_b64_tr_b16 v[86:87], v15 offset:20736
 ds_read_b64_tr_b16 v[112:113], v15 offset:64
 ds_read_b64_tr_b16 v[114:115], v15 offset:2368
 ds_read_b64_tr_b16 v[116:117], v15 offset:18496
 ds_read_b64_tr_b16 v[118:119], v15 offset:20800
 ds_read_b64_tr_b16 v[144:145], v15 offset:128
 ds_read_b64_tr_b16 v[146:147], v15 offset:2432
 ds_read_b64_tr_b16 v[148:149], v15 offset:18560
 ds_read_b64_tr_b16 v[150:151], v15 offset:20864
 ds_read_b64_tr_b16 v[176:177], v15 offset:192
 ds_read_b64_tr_b16 v[178:179], v15 offset:2496
 ds_read_b64_tr_b16 v[180:181], v15 offset:18624
 ds_read_b64_tr_b16 v[182:183], v15 offset:20928
 v_add_u32 v15, 73728, v13
 ds_read_b64_tr_b16 v[200:201], v15 offset:256
 ds_read_b64_tr_b16 v[202:203], v15 offset:2560
 s_waitcnt lgkmcnt(0)
 s_barrier
 s_add_u32 m0, s93, 73728
 s_mov_b32 s60, 1048576
 buffer_load_dwordx4 v32, s[12:15], s60 offen lds
 s_add_u32 m0, s93, 74752
 s_mov_b32 s60, 1081344
 buffer_load_dwordx4 v34, s[12:15], s60 offen lds
 s_add_u32 m0, s93, 75776
 s_mov_b32 s60, 1114112
 buffer_load_dwordx4 v32, s[12:15], s60 offen lds
 s_add_u32 m0, s93, 76800
 s_mov_b32 s60, 1146880
 buffer_load_dwordx4 v34, s[12:15], s60 offen lds
 s_add_u32 m0, s93, 90112
 s_mov_b32 s60, 1048576
 buffer_load_dwordx4 v33, s[48:51], s60 offen lds
 s_add_u32 m0, s93, 91136
 s_mov_b32 s60, 1081344
 buffer_load_dwordx4 v35, s[48:51], s60 offen lds
 s_add_u32 m0, s93, 92160
 s_mov_b32 s60, 1114112
 buffer_load_dwordx4 v33, s[48:51], s60 offen lds
 s_add_u32 m0, s93, 93184
 s_mov_b32 s60, 1146880
 buffer_load_dwordx4 v35, s[48:51], s60 offen lds
 s_waitcnt vmcnt(24)
 s_barrier
 v_add_u32 v15, 110592, v12
 ds_read_b64_tr_b16 v[88:89], v15 offset:0
 ds_read_b64_tr_b16 v[90:91], v15 offset:2304
 ds_read_b64_tr_b16 v[92:93], v15 offset:18432
 ds_read_b64_tr_b16 v[94:95], v15 offset:20736
 ds_read_b64_tr_b16 v[120:121], v15 offset:64
 ds_read_b64_tr_b16 v[122:123], v15 offset:2368
 ds_read_b64_tr_b16 v[124:125], v15 offset:18496
 ds_read_b64_tr_b16 v[126:127], v15 offset:20800
 ds_read_b64_tr_b16 v[152:153], v15 offset:128
 ds_read_b64_tr_b16 v[154:155], v15 offset:2432
 ds_read_b64_tr_b16 v[156:157], v15 offset:18560
 ds_read_b64_tr_b16 v[158:159], v15 offset:20864
 ds_read_b64_tr_b16 v[184:185], v15 offset:192
 ds_read_b64_tr_b16 v[186:187], v15 offset:2496
 ds_read_b64_tr_b16 v[188:189], v15 offset:18624
 ds_read_b64_tr_b16 v[190:191], v15 offset:20928
 v_add_u32 v15, 110592, v13
 ds_read_b64_tr_b16 v[204:205], v15 offset:256
 ds_read_b64_tr_b16 v[206:207], v15 offset:2560
 s_waitcnt lgkmcnt(0)
 s_barrier
 s_add_u32 m0, s93, 110592
 s_mov_b32 s60, 1572864
 buffer_load_dwordx4 v32, s[12:15], s60 offen lds
 s_add_u32 m0, s93, 111616
 s_mov_b32 s60, 1605632
 buffer_load_dwordx4 v34, s[12:15], s60 offen lds
 s_add_u32 m0, s93, 112640
 s_mov_b32 s60, 1638400
 buffer_load_dwordx4 v32, s[12:15], s60 offen lds
 s_add_u32 m0, s93, 113664
 s_mov_b32 s60, 1671168
 buffer_load_dwordx4 v34, s[12:15], s60 offen lds
 s_add_u32 m0, s93, 126976
 s_mov_b32 s60, 1572864
 buffer_load_dwordx4 v33, s[48:51], s60 offen lds
 s_add_u32 m0, s93, 128000
 s_mov_b32 s60, 1605632
 buffer_load_dwordx4 v35, s[48:51], s60 offen lds
 s_add_u32 m0, s93, 129024
 s_mov_b32 s60, 1638400
 buffer_load_dwordx4 v33, s[48:51], s60 offen lds
 s_add_u32 m0, s93, 130048
 s_mov_b32 s60, 1671168
 buffer_load_dwordx4 v35, s[48:51], s60 offen lds
 s_waitcnt vmcnt(24)
 s_barrier
 s_cmp_eq_u32 s44, 0
 s_cbranch_scc0 L220
L220:
 v_add_u32 v38, 0, v36
 v_add_u32 v39, 0, v37
 ds_read_b64_tr_b16 v[224:225], v38 offset:0
 ds_read_b64_tr_b16 v[226:227], v38 offset:512
 ds_read_b64_tr_b16 v[228:229], v38 offset:4096
 ds_read_b64_tr_b16 v[230:231], v38 offset:4608
 ds_read_b64_tr_b16 v[232:233], v39 offset:0
 ds_read_b64_tr_b16 v[234:235], v39 offset:512
 ds_read_b64_tr_b16 v[236:237], v39 offset:4096
 ds_read_b64_tr_b16 v[238:239], v39 offset:4608
 ds_read_b64_tr_b16 v[240:241], v38 offset:8192
 ds_read_b64_tr_b16 v[242:243], v38 offset:8704
 ds_read_b64_tr_b16 v[244:245], v38 offset:12288
 ds_read_b64_tr_b16 v[246:247], v38 offset:12800
 ds_read_b64_tr_b16 v[248:249], v39 offset:8192
 ds_read_b64_tr_b16 v[250:251], v39 offset:8704
 ds_read_b64_tr_b16 v[252:253], v39 offset:12288
 ds_read_b64_tr_b16 v[254:255], v39 offset:12800
 s_waitcnt lgkmcnt(0)
 s_barrier
 s_add_u32 m0, s93, 0
 s_mov_b32 s60, 2097152
 buffer_load_dwordx4 v32, s[12:15], s60 offen lds
 s_add_u32 m0, s93, 1024
 s_mov_b32 s60, 2129920
 buffer_load_dwordx4 v34, s[12:15], s60 offen lds
 s_add_u32 m0, s93, 2048
 s_mov_b32 s60, 2162688
 buffer_load_dwordx4 v32, s[12:15], s60 offen lds
 s_add_u32 m0, s93, 3072
 s_mov_b32 s60, 2195456
 buffer_load_dwordx4 v34, s[12:15], s60 offen lds
 s_add_u32 m0, s93, 16384
 s_mov_b32 s60, 2097152
 buffer_load_dwordx4 v33, s[48:51], s60 offen lds
 s_add_u32 m0, s93, 17408
 s_mov_b32 s60, 2129920
 buffer_load_dwordx4 v35, s[48:51], s60 offen lds
 s_add_u32 m0, s93, 18432
 s_mov_b32 s60, 2162688
 buffer_load_dwordx4 v33, s[48:51], s60 offen lds
 s_add_u32 m0, s93, 19456
 s_mov_b32 s60, 2195456
 buffer_load_dwordx4 v35, s[48:51], s60 offen lds
 s_waitcnt vmcnt(24)
 s_barrier
 v_add_u32 v38, 36864, v36
 v_add_u32 v39, 36864, v37
 ds_read_b64_tr_b16 a[0:1], v38 offset:0
 ds_read_b64_tr_b16 a[2:3], v38 offset:512
 ds_read_b64_tr_b16 a[4:5], v38 offset:4096
 ds_read_b64_tr_b16 a[6:7], v38 offset:4608
 ds_read_b64_tr_b16 a[8:9], v39 offset:0
 ds_read_b64_tr_b16 a[10:11], v39 offset:512
 ds_read_b64_tr_b16 a[12:13], v39 offset:4096
 ds_read_b64_tr_b16 a[14:15], v39 offset:4608
 ds_read_b64_tr_b16 a[16:17], v38 offset:8192
 ds_read_b64_tr_b16 a[18:19], v38 offset:8704
 ds_read_b64_tr_b16 a[20:21], v38 offset:12288
 ds_read_b64_tr_b16 a[22:23], v38 offset:12800
 ds_read_b64_tr_b16 a[24:25], v39 offset:8192
 ds_read_b64_tr_b16 a[26:27], v39 offset:8704
 ds_read_b64_tr_b16 a[28:29], v39 offset:12288
 ds_read_b64_tr_b16 a[30:31], v39 offset:12800
 s_waitcnt lgkmcnt(0)
 s_barrier
 s_add_u32 m0, s93, 36864
 s_mov_b32 s60, 2621440
 buffer_load_dwordx4 v32, s[12:15], s60 offen lds
 s_add_u32 m0, s93, 37888
 s_mov_b32 s60, 2654208
 buffer_load_dwordx4 v34, s[12:15], s60 offen lds
 s_add_u32 m0, s93, 38912
 s_mov_b32 s60, 2686976
 buffer_load_dwordx4 v32, s[12:15], s60 offen lds
 s_add_u32 m0, s93, 39936
 s_mov_b32 s60, 2719744
 buffer_load_dwordx4 v34, s[12:15], s60 offen lds
 s_add_u32 m0, s93, 53248
 s_mov_b32 s60, 2621440
 buffer_load_dwordx4 v33, s[48:51], s60 offen lds
 s_add_u32 m0, s93, 54272
 s_mov_b32 s60, 2654208
 buffer_load_dwordx4 v35, s[48:51], s60 offen lds
 s_add_u32 m0, s93, 55296
 s_mov_b32 s60, 2686976
 buffer_load_dwordx4 v33, s[48:51], s60 offen lds
 s_add_u32 m0, s93, 56320
 s_mov_b32 s60, 2719744
 buffer_load_dwordx4 v35, s[48:51], s60 offen lds
 s_waitcnt vmcnt(24)
 s_barrier
 v_add_u32 v38, 73728, v36
 v_add_u32 v39, 73728, v37
 ds_read_b64_tr_b16 a[32:33], v38 offset:0
 ds_read_b64_tr_b16 a[34:35], v38 offset:512
 ds_read_b64_tr_b16 a[36:37], v38 offset:4096
 ds_read_b64_tr_b16 a[38:39], v38 offset:4608
 ds_read_b64_tr_b16 a[40:41], v39 offset:0
 ds_read_b64_tr_b16 a[42:43], v39 offset:512
 ds_read_b64_tr_b16 a[44:45], v39 offset:4096
 ds_read_b64_tr_b16 a[46:47], v39 offset:4608
 ds_read_b64_tr_b16 a[48:49], v38 offset:8192
 ds_read_b64_tr_b16 a[50:51], v38 offset:8704
 ds_read_b64_tr_b16 a[52:53], v38 offset:12288
 ds_read_b64_tr_b16 a[54:55], v38 offset:12800
 ds_read_b64_tr_b16 a[56:57], v39 offset:8192
 ds_read_b64_tr_b16 a[58:59], v39 offset:8704
 ds_read_b64_tr_b16 a[60:61], v39 offset:12288
 ds_read_b64_tr_b16 a[62:63], v39 offset:12800
 s_waitcnt lgkmcnt(0)
 s_barrier
 s_add_u32 m0, s93, 73728
 s_mov_b32 s60, 3145728
 buffer_load_dwordx4 v32, s[12:15], s60 offen lds
 s_add_u32 m0, s93, 74752
 s_mov_b32 s60, 3178496
 buffer_load_dwordx4 v34, s[12:15], s60 offen lds
 s_add_u32 m0, s93, 75776
 s_mov_b32 s60, 3211264
 buffer_load_dwordx4 v32, s[12:15], s60 offen lds
 s_add_u32 m0, s93, 76800
 s_mov_b32 s60, 3244032
 buffer_load_dwordx4 v34, s[12:15], s60 offen lds
 s_add_u32 m0, s93, 90112
 s_mov_b32 s60, 3145728
 buffer_load_dwordx4 v33, s[48:51], s60 offen lds
 s_add_u32 m0, s93, 91136
 s_mov_b32 s60, 3178496
 buffer_load_dwordx4 v35, s[48:51], s60 offen lds
 s_add_u32 m0, s93, 92160
 s_mov_b32 s60, 3211264
 buffer_load_dwordx4 v33, s[48:51], s60 offen lds
 s_add_u32 m0, s93, 93184
 s_mov_b32 s60, 3244032
 buffer_load_dwordx4 v35, s[48:51], s60 offen lds
 s_waitcnt vmcnt(24)
 s_barrier
 v_add_u32 v38, 110592, v36
 v_add_u32 v39, 110592, v37
 ds_read_b64_tr_b16 a[64:65], v38 offset:0
 ds_read_b64_tr_b16 a[66:67], v38 offset:512
 ds_read_b64_tr_b16 a[68:69], v38 offset:4096
 ds_read_b64_tr_b16 a[70:71], v38 offset:4608
 ds_read_b64_tr_b16 a[72:73], v39 offset:0
 ds_read_b64_tr_b16 a[74:75], v39 offset:512
 ds_read_b64_tr_b16 a[76:77], v39 offset:4096
 ds_read_b64_tr_b16 a[78:79], v39 offset:4608
 ds_read_b64_tr_b16 a[80:81], v38 offset:8192
 ds_read_b64_tr_b16 a[82:83], v38 offset:8704
 ds_read_b64_tr_b16 a[84:85], v38 offset:12288
 ds_read_b64_tr_b16 a[86:87], v38 offset:12800
 ds_read_b64_tr_b16 a[88:89], v39 offset:8192
 ds_read_b64_tr_b16 a[90:91], v39 offset:8704
 ds_read_b64_tr_b16 a[92:93], v39 offset:12288
 ds_read_b64_tr_b16 a[94:95], v39 offset:12800
 s_waitcnt lgkmcnt(0)
 s_barrier
 s_add_u32 m0, s93, 110592
 s_mov_b32 s60, 3670016
 buffer_load_dwordx4 v32, s[12:15], s60 offen lds
 s_add_u32 m0, s93, 111616
 s_mov_b32 s60, 3702784
 buffer_load_dwordx4 v34, s[12:15], s60 offen lds
 s_add_u32 m0, s93, 112640
 s_mov_b32 s60, 3735552
 buffer_load_dwordx4 v32, s[12:15], s60 offen lds
 s_add_u32 m0, s93, 113664
 s_mov_b32 s60, 3768320
 buffer_load_dwordx4 v34, s[12:15], s60 offen lds
 s_add_u32 m0, s93, 126976
 s_mov_b32 s60, 3670016
 buffer_load_dwordx4 v33, s[48:51], s60 offen lds
 s_add_u32 m0, s93, 128000
 s_mov_b32 s60, 3702784
 buffer_load_dwordx4 v35, s[48:51], s60 offen lds
 s_add_u32 m0, s93, 129024
 s_mov_b32 s60, 3735552
 buffer_load_dwordx4 v33, s[48:51], s60 offen lds
 s_add_u32 m0, s93, 130048
 s_mov_b32 s60, 3768320
 buffer_load_dwordx4 v35, s[48:51], s60 offen lds
 s_waitcnt vmcnt(24)
 s_barrier
 v_add_u32 v38, 0, v36
 v_add_u32 v39, 0, v37
 ds_read_b64_tr_b16 a[96:97], v38 offset:0
 ds_read_b64_tr_b16 a[98:99], v38 offset:512
 ds_read_b64_tr_b16 a[100:101], v38 offset:4096
 ds_read_b64_tr_b16 a[102:103], v38 offset:4608
 ds_read_b64_tr_b16 a[104:105], v39 offset:0
 ds_read_b64_tr_b16 a[106:107], v39 offset:512
 ds_read_b64_tr_b16 a[108:109], v39 offset:4096
 ds_read_b64_tr_b16 a[110:111], v39 offset:4608
 ds_read_b64_tr_b16 a[112:113], v38 offset:8192
 ds_read_b64_tr_b16 a[114:115], v38 offset:8704
 ds_read_b64_tr_b16 a[116:117], v38 offset:12288
 ds_read_b64_tr_b16 a[118:119], v38 offset:12800
 ds_read_b64_tr_b16 a[120:121], v39 offset:8192
 ds_read_b64_tr_b16 a[122:123], v39 offset:8704
 ds_read_b64_tr_b16 a[124:125], v39 offset:12288
 ds_read_b64_tr_b16 a[126:127], v39 offset:12800
 s_waitcnt lgkmcnt(0)
 s_barrier
 s_add_u32 m0, s93, 0
 s_mov_b32 s60, 4194304
 buffer_load_dwordx4 v32, s[12:15], s60 offen lds
 s_add_u32 m0, s93, 1024
 s_mov_b32 s60, 4227072
 buffer_load_dwordx4 v34, s[12:15], s60 offen lds
 s_add_u32 m0, s93, 2048
 s_mov_b32 s60, 4259840
 buffer_load_dwordx4 v32, s[12:15], s60 offen lds
 s_add_u32 m0, s93, 3072
 s_mov_b32 s60, 4292608
 buffer_load_dwordx4 v34, s[12:15], s60 offen lds
 s_add_u32 m0, s93, 16384
 s_mov_b32 s60, 4194304
 buffer_load_dwordx4 v33, s[48:51], s60 offen lds
 s_add_u32 m0, s93, 17408
 s_mov_b32 s60, 4227072
 buffer_load_dwordx4 v35, s[48:51], s60 offen lds
 s_add_u32 m0, s93, 18432
 s_mov_b32 s60, 4259840
 buffer_load_dwordx4 v33, s[48:51], s60 offen lds
 s_add_u32 m0, s93, 19456
 s_mov_b32 s60, 4292608
 buffer_load_dwordx4 v35, s[48:51], s60 offen lds
 s_waitcnt vmcnt(24)
 s_barrier
 v_add_u32 v38, 36864, v36
 v_add_u32 v39, 36864, v37
 ds_read_b64_tr_b16 a[128:129], v38 offset:0
 ds_read_b64_tr_b16 a[130:131], v38 offset:512
 ds_read_b64_tr_b16 a[132:133], v38 offset:4096
 ds_read_b64_tr_b16 a[134:135], v38 offset:4608
 ds_read_b64_tr_b16 a[136:137], v39 offset:0
 ds_read_b64_tr_b16 a[138:139], v39 offset:512
 ds_read_b64_tr_b16 a[140:141], v39 offset:4096
 ds_read_b64_tr_b16 a[142:143], v39 offset:4608
 ds_read_b64_tr_b16 a[144:145], v38 offset:8192
 ds_read_b64_tr_b16 a[146:147], v38 offset:8704
 ds_read_b64_tr_b16 a[148:149], v38 offset:12288
 ds_read_b64_tr_b16 a[150:151], v38 offset:12800
 ds_read_b64_tr_b16 a[152:153], v39 offset:8192
 ds_read_b64_tr_b16 a[154:155], v39 offset:8704
 ds_read_b64_tr_b16 a[156:157], v39 offset:12288
 ds_read_b64_tr_b16 a[158:159], v39 offset:12800
 s_waitcnt lgkmcnt(0)
 s_barrier
 s_add_u32 m0, s93, 36864
 s_mov_b32 s60, 4194304
 buffer_load_dwordx4 v0, s[52:55], s60 offen lds
 s_add_u32 m0, s93, 37888
 s_mov_b32 s60, 4227072
 buffer_load_dwordx4 v0, s[52:55], s60 offen lds
 s_add_u32 m0, s93, 38912
 s_mov_b32 s60, 4259840
 buffer_load_dwordx4 v0, s[52:55], s60 offen lds
 s_add_u32 m0, s93, 39936
 s_mov_b32 s60, 4292608
 buffer_load_dwordx4 v0, s[52:55], s60 offen lds
 s_waitcnt vmcnt(20)
 s_barrier
 v_add_u32 v38, 73728, v36
 v_add_u32 v39, 73728, v37
 ds_read_b64_tr_b16 a[160:161], v38 offset:0
 ds_read_b64_tr_b16 a[162:163], v38 offset:512
 ds_read_b64_tr_b16 a[164:165], v38 offset:4096
 ds_read_b64_tr_b16 a[166:167], v38 offset:4608
 ds_read_b64_tr_b16 a[168:169], v39 offset:0
 ds_read_b64_tr_b16 a[170:171], v39 offset:512
 ds_read_b64_tr_b16 a[172:173], v39 offset:4096
 ds_read_b64_tr_b16 a[174:175], v39 offset:4608
 ds_read_b64_tr_b16 a[176:177], v38 offset:8192
 ds_read_b64_tr_b16 a[178:179], v38 offset:8704
 ds_read_b64_tr_b16 a[180:181], v38 offset:12288
 ds_read_b64_tr_b16 a[182:183], v38 offset:12800
 ds_read_b64_tr_b16 a[184:185], v39 offset:8192
 ds_read_b64_tr_b16 a[186:187], v39 offset:8704
 ds_read_b64_tr_b16 a[188:189], v39 offset:12288
 ds_read_b64_tr_b16 a[190:191], v39 offset:12800
 s_waitcnt lgkmcnt(0)
 s_barrier
 s_add_u32 m0, s93, 81920
 s_mov_b32 s60, 2621440
 buffer_load_dwordx4 v0, s[52:55], s60 offen lds
 s_add_u32 m0, s93, 82944
 s_mov_b32 s60, 2654208
 buffer_load_dwordx4 v0, s[52:55], s60 offen lds
 s_add_u32 m0, s93, 83968
 s_mov_b32 s60, 2686976
 buffer_load_dwordx4 v0, s[52:55], s60 offen lds
 s_add_u32 m0, s93, 84992
 s_mov_b32 s60, 2719744
 buffer_load_dwordx4 v0, s[52:55], s60 offen lds
 s_waitcnt vmcnt(16)
 s_barrier
 v_add_u32 v38, 110592, v36
 v_add_u32 v39, 110592, v37
 ds_read_b64_tr_b16 a[192:193], v38 offset:0
 ds_read_b64_tr_b16 a[194:195], v38 offset:512
 ds_read_b64_tr_b16 a[196:197], v38 offset:4096
 ds_read_b64_tr_b16 a[198:199], v38 offset:4608
 ds_read_b64_tr_b16 a[200:201], v39 offset:0
 ds_read_b64_tr_b16 a[202:203], v39 offset:512
 ds_read_b64_tr_b16 a[204:205], v39 offset:4096
 ds_read_b64_tr_b16 a[206:207], v39 offset:4608
 ds_read_b64_tr_b16 a[208:209], v38 offset:8192
 ds_read_b64_tr_b16 a[210:211], v38 offset:8704
 ds_read_b64_tr_b16 a[212:213], v38 offset:12288
 ds_read_b64_tr_b16 a[214:215], v38 offset:12800
 ds_read_b64_tr_b16 a[216:217], v39 offset:8192
 ds_read_b64_tr_b16 a[218:219], v39 offset:8704
 ds_read_b64_tr_b16 a[220:221], v39 offset:12288
 ds_read_b64_tr_b16 a[222:223], v39 offset:12800
 s_waitcnt lgkmcnt(0)
 s_barrier
 s_add_u32 m0, s93, 98304
 s_mov_b32 s60, 3145728
 buffer_load_dwordx4 v0, s[52:55], s60 offen lds
 s_add_u32 m0, s93, 99328
 s_mov_b32 s60, 3178496
 buffer_load_dwordx4 v0, s[52:55], s60 offen lds
 s_add_u32 m0, s93, 100352
 s_mov_b32 s60, 3211264
 buffer_load_dwordx4 v0, s[52:55], s60 offen lds
 s_add_u32 m0, s93, 101376
 s_mov_b32 s60, 3244032
 buffer_load_dwordx4 v0, s[52:55], s60 offen lds
 s_add_u32 m0, s93, 114688
 s_mov_b32 s60, 3670016
 buffer_load_dwordx4 v0, s[52:55], s60 offen lds
 s_add_u32 m0, s93, 115712
 s_mov_b32 s60, 3702784
 buffer_load_dwordx4 v0, s[52:55], s60 offen lds
 s_add_u32 m0, s93, 116736
 s_mov_b32 s60, 3735552
 buffer_load_dwordx4 v0, s[52:55], s60 offen lds
 s_add_u32 m0, s93, 117760
 s_mov_b32 s60, 3768320
 buffer_load_dwordx4 v0, s[52:55], s60 offen lds
 s_waitcnt vmcnt(16)
 s_barrier
 v_add_u32 v38, 0, v36
 v_add_u32 v39, 0, v37
 ds_read_b64_tr_b16 a[224:225], v38 offset:0
 ds_read_b64_tr_b16 a[226:227], v38 offset:512
 ds_read_b64_tr_b16 a[228:229], v38 offset:4096
 ds_read_b64_tr_b16 a[230:231], v38 offset:4608
 ds_read_b64_tr_b16 a[232:233], v39 offset:0
 ds_read_b64_tr_b16 a[234:235], v39 offset:512
 ds_read_b64_tr_b16 a[236:237], v39 offset:4096
 ds_read_b64_tr_b16 a[238:239], v39 offset:4608
 ds_read_b64_tr_b16 a[240:241], v38 offset:8192
 ds_read_b64_tr_b16 a[242:243], v38 offset:8704
 ds_read_b64_tr_b16 a[244:245], v38 offset:12288
 ds_read_b64_tr_b16 a[246:247], v38 offset:12800
 ds_read_b64_tr_b16 a[248:249], v39 offset:8192
 ds_read_b64_tr_b16 a[250:251], v39 offset:8704
 ds_read_b64_tr_b16 a[252:253], v39 offset:12288
 ds_read_b64_tr_b16 a[254:255], v39 offset:12800
 s_waitcnt lgkmcnt(0)
 s_barrier
 s_add_u32 m0, s93, 0
 s_mov_b32 s60, 0
 buffer_load_dwordx4 v0, s[52:55], s60 offen lds
 s_add_u32 m0, s93, 1024
 s_mov_b32 s60, 32768
 buffer_load_dwordx4 v0, s[52:55], s60 offen lds
 s_add_u32 m0, s93, 2048
 s_mov_b32 s60, 65536
 buffer_load_dwordx4 v0, s[52:55], s60 offen lds
 s_add_u32 m0, s93, 3072
 s_mov_b32 s60, 98304
 buffer_load_dwordx4 v0, s[52:55], s60 offen lds
 s_add_u32 m0, s93, 16384
 s_mov_b32 s60, 524288
 buffer_load_dwordx4 v0, s[52:55], s60 offen lds
 s_add_u32 m0, s93, 17408
 s_mov_b32 s60, 557056
 buffer_load_dwordx4 v0, s[52:55], s60 offen lds
 s_add_u32 m0, s93, 18432
 s_mov_b32 s60, 589824
 buffer_load_dwordx4 v0, s[52:55], s60 offen lds
 s_add_u32 m0, s93, 19456
 s_mov_b32 s60, 622592
 buffer_load_dwordx4 v0, s[52:55], s60 offen lds
 s_waitcnt vmcnt(20)
 s_barrier
 v_add_u32 v15, 36864, v5
 ds_read_b64_tr_b16 v[208:209], v15 offset:0
 ds_read_b64_tr_b16 v[210:211], v15 offset:512
 ds_read_b64_tr_b16 v[212:213], v15 offset:4096
 ds_read_b64_tr_b16 v[214:215], v15 offset:4608
 ds_read_b64_tr_b16 v[216:217], v15 offset:8192
 ds_read_b64_tr_b16 v[218:219], v15 offset:8704
 ds_read_b64_tr_b16 v[220:221], v15 offset:12288
 ds_read_b64_tr_b16 v[222:223], v15 offset:12800
 s_waitcnt lgkmcnt(0)
 s_barrier
 s_add_u32 m0, s93, 32768
 s_mov_b32 s60, 1048576
 buffer_load_dwordx4 v0, s[52:55], s60 offen lds
 s_add_u32 m0, s93, 33792
 s_mov_b32 s60, 1081344
 buffer_load_dwordx4 v0, s[52:55], s60 offen lds
 s_add_u32 m0, s93, 34816
 s_mov_b32 s60, 1114112
 buffer_load_dwordx4 v0, s[52:55], s60 offen lds
 s_add_u32 m0, s93, 35840
 s_mov_b32 s60, 1146880
 buffer_load_dwordx4 v0, s[52:55], s60 offen lds
 s_add_u32 m0, s93, 49152
 s_mov_b32 s60, 1572864
 buffer_load_dwordx4 v0, s[52:55], s60 offen lds
 s_add_u32 m0, s93, 50176
 s_mov_b32 s60, 1605632
 buffer_load_dwordx4 v0, s[52:55], s60 offen lds
 s_add_u32 m0, s93, 51200
 s_mov_b32 s60, 1638400
 buffer_load_dwordx4 v0, s[52:55], s60 offen lds
 s_add_u32 m0, s93, 52224
 s_mov_b32 s60, 1671168
 buffer_load_dwordx4 v0, s[52:55], s60 offen lds
 s_add_u32 m0, s93, 65536
 s_mov_b32 s60, 2097152
 buffer_load_dwordx4 v0, s[52:55], s60 offen lds
 s_add_u32 m0, s93, 66560
 s_mov_b32 s60, 2129920
 buffer_load_dwordx4 v0, s[52:55], s60 offen lds
 s_add_u32 m0, s93, 67584
 s_mov_b32 s60, 2162688
 buffer_load_dwordx4 v0, s[52:55], s60 offen lds
 s_add_u32 m0, s93, 68608
 s_mov_b32 s60, 2195456
 buffer_load_dwordx4 v0, s[52:55], s60 offen lds
 s_mov_b32 s12, s18
 s_mov_b32 s13, s19
 s_mov_b32 s14, 9216
 s_mov_b32 s15, 0x20000
 v_and_b32 v6, 7, v61
 v_mul_u32_u24 v6, 1152, v6
 v_lshrrev_b32 v7, 4, v61
 v_lshlrev_b32 v7, 5, v7
 v_add_u32 v6, v6, v7
 v_bfe_u32 v7, v61, 3, 1
 v_lshlrev_b32 v7, 4, v7
 v_add_u32 v6, v6, v7
 s_min_u32 s60, s44, 2
 s_mul_i32 s60, s60, 384
 buffer_load_dwordx4 v[40:43], v6, s[12:15], s60 offen
 buffer_load_dwordx4 v[44:47], v6, s[12:15], s60 offen offset:128
 buffer_load_dwordx4 v[8:11], v6, s[12:15], s60 offen offset:256
 s_waitcnt vmcnt(28)
 s_barrier
 v_add_u32 v15, 81920, v5
 ds_read_b64_tr_b16 v[16:17], v15 offset:0
 ds_read_b64_tr_b16 v[18:19], v15 offset:512
 ds_read_b64_tr_b16 v[20:21], v15 offset:4096
 ds_read_b64_tr_b16 v[22:23], v15 offset:4608
 ds_read_b64_tr_b16 v[24:25], v15 offset:8192
 ds_read_b64_tr_b16 v[26:27], v15 offset:8704
 ds_read_b64_tr_b16 v[28:29], v15 offset:12288
 ds_read_b64_tr_b16 v[30:31], v15 offset:12800
 s_waitcnt lgkmcnt(0)
 s_barrier
 v_add_u32 v15, 81920, v50
 ds_write_b128 v15, v[16:19] offset:0
 ds_write_b128 v15, v[20:23] offset:1024
 ds_write_b128 v15, v[24:27] offset:2048
 ds_write_b128 v15, v[28:31] offset:3072
 s_waitcnt vmcnt(24)
 s_barrier
 v_add_u32 v15, 98304, v5
 ds_read_b64_tr_b16 v[16:17], v15 offset:0
 ds_read_b64_tr_b16 v[18:19], v15 offset:512
 ds_read_b64_tr_b16 v[20:21], v15 offset:4096
 ds_read_b64_tr_b16 v[22:23], v15 offset:4608
 ds_read_b64_tr_b16 v[24:25], v15 offset:8192
 ds_read_b64_tr_b16 v[26:27], v15 offset:8704
 ds_read_b64_tr_b16 v[28:29], v15 offset:12288
 ds_read_b64_tr_b16 v[30:31], v15 offset:12800
 s_waitcnt lgkmcnt(0)
 s_barrier
 v_add_u32 v15, 98304, v50
 ds_write_b128 v15, v[16:19] offset:0
 ds_write_b128 v15, v[20:23] offset:1024
 ds_write_b128 v15, v[24:27] offset:2048
 ds_write_b128 v15, v[28:31] offset:3072
 s_waitcnt vmcnt(20)
 s_barrier
 v_add_u32 v15, 114688, v5
 ds_read_b64_tr_b16 v[16:17], v15 offset:0
 ds_read_b64_tr_b16 v[18:19], v15 offset:512
 ds_read_b64_tr_b16 v[20:21], v15 offset:4096
 ds_read_b64_tr_b16 v[22:23], v15 offset:4608
 ds_read_b64_tr_b16 v[24:25], v15 offset:8192
 ds_read_b64_tr_b16 v[26:27], v15 offset:8704
 ds_read_b64_tr_b16 v[28:29], v15 offset:12288
 ds_read_b64_tr_b16 v[30:31], v15 offset:12800
 s_waitcnt lgkmcnt(0)
 s_barrier
 v_add_u32 v15, 114688, v50
 ds_write_b128 v15, v[16:19] offset:0
 ds_write_b128 v15, v[20:23] offset:1024
 ds_write_b128 v15, v[24:27] offset:2048
 ds_write_b128 v15, v[28:31] offset:3072
 s_waitcnt vmcnt(16)
 s_barrier
 v_add_u32 v15, 0, v5
 ds_read_b64_tr_b16 v[16:17], v15 offset:0
 ds_read_b64_tr_b16 v[18:19], v15 offset:512
 ds_read_b64_tr_b16 v[20:21], v15 offset:4096
 ds_read_b64_tr_b16 v[22:23], v15 offset:4608
 ds_read_b64_tr_b16 v[24:25], v15 offset:8192
 ds_read_b64_tr_b16 v[26:27], v15 offset:8704
 ds_read_b64_tr_b16 v[28:29], v15 offset:12288
 ds_read_b64_tr_b16 v[30:31], v15 offset:12800
 s_waitcnt lgkmcnt(0)
 s_barrier
 v_add_u32 v15, 0, v50
 ds_write_b128 v15, v[16:19] offset:0
 ds_write_b128 v15, v[20:23] offset:1024
 ds_write_b128 v15, v[24:27] offset:2048
 ds_write_b128 v15, v[28:31] offset:3072
 s_waitcnt vmcnt(12)
 s_barrier
 v_add_u32 v15, 16384, v5
 ds_read_b64_tr_b16 v[16:17], v15 offset:0
 ds_read_b64_tr_b16 v[18:19], v15 offset:512
 ds_read_b64_tr_b16 v[20:21], v15 offset:4096
 ds_read_b64_tr_b16 v[22:23], v15 offset:4608
 ds_read_b64_tr_b16 v[24:25], v15 offset:8192
 ds_read_b64_tr_b16 v[26:27], v15 offset:8704
 ds_read_b64_tr_b16 v[28:29], v15 offset:12288
 ds_read_b64_tr_b16 v[30:31], v15 offset:12800
 s_waitcnt lgkmcnt(0)
 s_barrier
 v_add_u32 v15, 16384, v50
 ds_write_b128 v15, v[16:19] offset:0
 ds_write_b128 v15, v[20:23] offset:1024
 ds_write_b128 v15, v[24:27] offset:2048
 ds_write_b128 v15, v[28:31] offset:3072
 s_waitcnt vmcnt(8)
 s_barrier
 v_add_u32 v15, 32768, v5
 ds_read_b64_tr_b16 v[16:17], v15 offset:0
 ds_read_b64_tr_b16 v[18:19], v15 offset:512
 ds_read_b64_tr_b16 v[20:21], v15 offset:4096
 ds_read_b64_tr_b16 v[22:23], v15 offset:4608
 ds_read_b64_tr_b16 v[24:25], v15 offset:8192
 ds_read_b64_tr_b16 v[26:27], v15 offset:8704
 ds_read_b64_tr_b16 v[28:29], v15 offset:12288
 ds_read_b64_tr_b16 v[30:31], v15 offset:12800
 s_waitcnt lgkmcnt(0)
 s_barrier
 v_add_u32 v15, 32768, v50
 ds_write_b128 v15, v[16:19] offset:0
 ds_write_b128 v15, v[20:23] offset:1024
 ds_write_b128 v15, v[24:27] offset:2048
 ds_write_b128 v15, v[28:31] offset:3072
 s_waitcnt vmcnt(4)
 s_barrier
 v_add_u32 v15, 49152, v5
 ds_read_b64_tr_b16 v[16:17], v15 offset:0
 ds_read_b64_tr_b16 v[18:19], v15 offset:512
 ds_read_b64_tr_b16 v[20:21], v15 offset:4096
 ds_read_b64_tr_b16 v[22:23], v15 offset:4608
 ds_read_b64_tr_b16 v[24:25], v15 offset:8192
 ds_read_b64_tr_b16 v[26:27], v15 offset:8704
 ds_read_b64_tr_b16 v[28:29], v15 offset:12288
 ds_read_b64_tr_b16 v[30:31], v15 offset:12800
 s_waitcnt lgkmcnt(0)
 s_barrier
 v_add_u32 v15, 49152, v50
 ds_write_b128 v15, v[16:19] offset:0
 ds_write_b128 v15, v[20:23] offset:1024
 ds_write_b128 v15, v[24:27] offset:2048
 ds_write_b128 v15, v[28:31] offset:3072
 s_waitcnt vmcnt(0)
 s_barrier
 v_add_u32 v15, 65536, v5
 ds_read_b64_tr_b16 v[16:17], v15 offset:0
 ds_read_b64_tr_b16 v[18:19], v15 offset:512
 ds_read_b64_tr_b16 v[20:21], v15 offset:4096
 ds_read_b64_tr_b16 v[22:23], v15 offset:4608
 ds_read_b64_tr_b16 v[24:25], v15 offset:8192
 ds_read_b64_tr_b16 v[26:27], v15 offset:8704
 ds_read_b64_tr_b16 v[28:29], v15 offset:12288
 ds_read_b64_tr_b16 v[30:31], v15 offset:12800
 s_waitcnt lgkmcnt(0)
 s_barrier
 v_add_u32 v15, 65536, v50
 ds_write_b128 v15, v[16:19] offset:0
 ds_write_b128 v15, v[20:23] offset:1024
 ds_write_b128 v15, v[24:27] offset:2048
 ds_write_b128 v15, v[28:31] offset:3072
 s_waitcnt vmcnt(0) lgkmcnt(0)
 s_barrier
 s_cmp_eq_u32 s44, 3
 s_cbranch_scc1 L221
 v_min_u32 v40, -2, v40
 v_min_u32 v41, -2, v41
 v_min_u32 v42, -2, v42
 v_min_u32 v43, -2, v43
 v_min_u32 v44, -2, v44
 v_min_u32 v45, -2, v45
 v_min_u32 v46, -2, v46
 v_min_u32 v47, -2, v47
 v_min_u32 v8, -2, v8
 v_min_u32 v9, -2, v9
 v_min_u32 v10, -2, v10
 v_min_u32 v11, -2, v11
 s_mul_i32 s60, s44, 3072
 v_add_u32 v16, s60, v49
 ds_write_b128 v16, v[40:43] offset:0
 ds_write_b128 v16, v[44:47] offset:1024
 ds_write_b128 v16, v[8:11] offset:2048
L221:
 v_mov_b32 v6, 0
L222:
 buffer_load_dword v7, v6, s[8:11], 0 offen offset:112 sc1
 s_waitcnt vmcnt(0)
 v_mov_b32 v6, 0x100
 v_cmp_ne_u32 vcc, v6, v7
 v_mov_b32 v6, 0
 s_cbranch_vccnz L222
 s_mov_b32 s47, 0
 s_mov_b32 s78, 0
 s_cmp_eq_u32 s44, 3
 s_cbranch_scc0 L224
 s_mov_b32 s63, 0
 s_mov_b32 s74, 0
 s_cmp_lt_u32 s63, s78
 s_cbranch_scc1 L225
 s_lshl_b32 s60, s46, 6
 s_add_u32 s60, s60, 73400320
 v_mov_b32 v46, 0
L226:
 buffer_load_dword v47, v46, s[4:7], s60 offen sc1
 s_waitcnt vmcnt(0)
 v_readfirstlane_b32 s78, v47
 s_cmp_lt_u32 s63, s78
 s_cbranch_scc0 L226
L225:
 s_lshl_b32 s77, s63, 5
 s_add_u32 s77, s77, s46
 s_lshl_b32 s77, s77, 14
 s_add_u32 s77, s77, 20971520
 s_mov_b32 m0, 140288
 s_add_u32 s60, s77, 0
 buffer_load_dwordx4 v57, s[4:7], s60 offen offset:0 sc1 lds
 buffer_load_dwordx4 v57, s[4:7], s60 offen offset:1024 sc1 lds
 buffer_load_dwordx4 v57, s[4:7], s60 offen offset:2048 sc1 lds
 buffer_load_dwordx4 v57, s[4:7], s60 offen offset:3072 sc1 lds
 s_mov_b32 m0, 144384
 s_add_u32 s60, s77, 4096
 buffer_load_dwordx4 v57, s[4:7], s60 offen offset:0 sc1 lds
 buffer_load_dwordx4 v57, s[4:7], s60 offen offset:1024 sc1 lds
 buffer_load_dwordx4 v57, s[4:7], s60 offen offset:2048 sc1 lds
 buffer_load_dwordx4 v57, s[4:7], s60 offen offset:3072 sc1 lds
 s_mov_b32 m0, 148480
 s_add_u32 s60, s77, 8192
 buffer_load_dwordx4 v57, s[4:7], s60 offen offset:0 sc1 lds
 buffer_load_dwordx4 v57, s[4:7], s60 offen offset:1024 sc1 lds
 buffer_load_dwordx4 v57, s[4:7], s60 offen offset:2048 sc1 lds
 buffer_load_dwordx4 v57, s[4:7], s60 offen offset:3072 sc1 lds
 s_mov_b32 m0, 152576
 s_add_u32 s60, s77, 12288
 buffer_load_dwordx4 v57, s[4:7], s60 offen offset:0 sc1 lds
 buffer_load_dwordx4 v57, s[4:7], s60 offen offset:1024 sc1 lds
 buffer_load_dwordx4 v57, s[4:7], s60 offen offset:2048 sc1 lds
 buffer_load_dwordx4 v57, s[4:7], s60 offen offset:3072 sc1 lds
L224:
 v_pk_mov_b32 v[0:1], 0, 0
 v_pk_mov_b32 v[2:3], 0, 0
 v_pk_mov_b32 v[4:5], 0, 0
 v_pk_mov_b32 v[6:7], 0, 0
 v_pk_mov_b32 v[8:9], 0, 0
 v_pk_mov_b32 v[10:11], 0, 0
 s_waitcnt vmcnt(0) lgkmcnt(0)
 s_barrier
 s_mul_i32 s15, s46, 10240
 s_lshl_b32 s61, s44, 9
 s_add_u32 s15, s15, s61
 s_add_u32 s15, s15, 72359936
 s_lshl_b32 s14, s46, 6
 s_add_u32 s14, s14, 73404416
 s_lshl_b32 s61, s44, 2
 s_add_u32 s61, s61, 4
 s_add_u32 s61, s61, s14
 s_cmp_eq_u32 s44, 3
 s_cselect_b32 s14, s14, s61
 s_mov_b32 s86, -1
 s_mov_b32 s87, -1
 s_cmp_eq_u32 s44, 2
 s_cselect_b32 s86, 0x1ff, s86
 s_cselect_b32 s87, 0, s87
 s_cmp_eq_u32 s44, 3
 s_cselect_b32 s16, 1, 0
 s_mov_b32 s17, 0
 s_cselect_b32 s86, 0, s86
 s_cselect_b32 s87, 0, s87
 s_lshl_b32 s79, s47, 18
 s_add_u32 s60, s47, 1
 s_and_b32 s75, s60, 1
 s_mul_i32 s74, s60, 9216
 s_add_u32 s60, s47, 63
 s_and_b32 s60, s60, 63
 s_lshl_b32 s73, s60, 18
 s_add_u32 s76, s73, 4096
 s_sub_u32 s90, s47, 1
 s_max_i32 s90, s90, 0
 s_add_u32 s63, s47, 1
 s_min_u32 s63, s63, 62
 s_cmp_lt_u32 s63, s78
 s_cbranch_scc1 L229
 s_lshl_b32 s60, s46, 6
 s_add_u32 s60, s60, 73400320
 v_mov_b32 v46, 0
L230:
 buffer_load_dword v47, v46, s[4:7], s60 offen sc1
 s_waitcnt vmcnt(0)
 v_readfirstlane_b32 s78, v47
 s_cmp_lt_u32 s63, s78
 s_cbranch_scc0 L230
L229:
 s_lshl_b32 s13, s63, 5
 s_add_u32 s13, s13, s46
 s_lshl_b32 s13, s13, 14
 s_add_u32 s13, s13, 20971520
 s_mov_b32 s77, s13
 s_add_u32 s60, s13, 8192
 s_cmp_eq_u32 s44, 1
 s_cselect_b32 s13, s60, s13
 s_and_b32 s60, s46, 7
 s_mul_i32 s60, s60, 1152
 s_add_u32 s60, s60, s74
 s_add_u32 s60, s60, 71303168
 s_cmp_eq_u32 s44, 2
 s_cselect_b32 s13, s60, s13
 s_branch CH_TOP227x
CH_TOP227:
 s_barrier
CH_TOP227x:
 ds_read_b128 v[12:15], v59 offset:0
 ds_read_b128 v[24:27], v50 offset:0
 ds_read_b128 v[28:31], v50 offset:1024
 ds_read_b128 v[16:19], v59 offset:512
 ds_read_b128 v[32:35], v50 offset:2048
 ds_read_b128 v[36:39], v50 offset:3072
 s_waitcnt lgkmcnt(5)
 v_smfmac_f32_16x16x64_bf16 v[0:3], v[12:15], v[224:231], v48
 ds_read_b128 v[20:23], v59 offset:1024
 v_smfmac_f32_16x16x64_bf16 v[4:7], v[12:15], v[232:239], v48
 s_waitcnt lgkmcnt(4)
 v_smfmac_f32_16x16x64_bf16 v[8:11], v[12:15], v[24:31], v48
 ds_read_b128 v[24:27], v50 offset:16384
 ds_read_b128 v[28:31], v50 offset:17408
 v_mov_b32 v47, s90
 s_mov_b64 exec, s[16:17]
 buffer_store_dword v47, v57, s[4:7], s14 offen sc1
 s_mov_b64 exec, -1
 s_waitcnt lgkmcnt(5)
 v_smfmac_f32_16x16x64_bf16 v[0:3], v[16:19], v[240:247], v48
 ds_read_b128 v[12:15], v59 offset:1536
 v_smfmac_f32_16x16x64_bf16 v[4:7], v[16:19], v[248:255], v48
 s_waitcnt lgkmcnt(4)
 v_smfmac_f32_16x16x64_bf16 v[8:11], v[16:19], v[32:39], v48
 ds_read_b128 v[32:35], v50 offset:18432
 ds_read_b128 v[36:39], v50 offset:19456
 buffer_store_dwordx4 v[40:43], v62, s[4:7], s73 offen sc1
 s_waitcnt lgkmcnt(5)
 v_smfmac_f32_16x16x64_bf16 v[0:3], v[20:23], a[0:7], v48
 ds_read_b128 v[16:19], v59 offset:2048
 v_smfmac_f32_16x16x64_bf16 v[4:7], v[20:23], a[8:15], v48
 s_waitcnt lgkmcnt(4)
 v_smfmac_f32_16x16x64_bf16 v[8:11], v[20:23], v[24:31], v48
 ds_read_b128 v[24:27], v50 offset:32768
 ds_read_b128 v[28:31], v50 offset:33792
 buffer_store_dwordx2 v[44:45], v62, s[4:7], s76 offen sc1
 s_waitcnt lgkmcnt(5)
 v_smfmac_f32_16x16x64_bf16 v[0:3], v[12:15], a[16:23], v48
 ds_read_b128 v[20:23], v59 offset:2560
 v_smfmac_f32_16x16x64_bf16 v[4:7], v[12:15], a[24:31], v48
 s_waitcnt lgkmcnt(4)
 v_smfmac_f32_16x16x64_bf16 v[8:11], v[12:15], v[32:39], v48
 ds_read_b128 v[32:35], v50 offset:34816
 ds_read_b128 v[36:39], v50 offset:35840
 v_lshlrev_b32 v46, 3, v57
 s_mov_b64 exec, s[86:87]
 buffer_load_dword v63, v46, s[4:7], s13 offen sc1
 s_mov_b64 exec, -1
 s_waitcnt lgkmcnt(5)
 v_smfmac_f32_16x16x64_bf16 v[0:3], v[16:19], a[32:39], v48
 ds_read_b128 v[12:15], v59 offset:3072
 v_smfmac_f32_16x16x64_bf16 v[4:7], v[16:19], a[40:47], v48
 s_waitcnt lgkmcnt(4)
 v_smfmac_f32_16x16x64_bf16 v[8:11], v[16:19], v[24:31], v48
 ds_read_b128 v[24:27], v50 offset:49152
 ds_read_b128 v[28:31], v50 offset:50176
 s_waitcnt lgkmcnt(5)
 v_smfmac_f32_16x16x64_bf16 v[0:3], v[20:23], a[48:55], v48
 ds_read_b128 v[16:19], v59 offset:3584
 v_smfmac_f32_16x16x64_bf16 v[4:7], v[20:23], a[56:63], v48
 s_waitcnt lgkmcnt(4)
 v_smfmac_f32_16x16x64_bf16 v[8:11], v[20:23], v[32:39], v48
 ds_read_b128 v[32:35], v50 offset:51200
 ds_read_b128 v[36:39], v50 offset:52224
 s_waitcnt lgkmcnt(5)
 v_smfmac_f32_16x16x64_bf16 v[0:3], v[12:15], a[64:71], v48
 ds_read_b128 v[20:23], v59 offset:4096
 v_smfmac_f32_16x16x64_bf16 v[4:7], v[12:15], a[72:79], v48
 s_waitcnt lgkmcnt(4)
 v_smfmac_f32_16x16x64_bf16 v[8:11], v[12:15], v[24:31], v48
 v_add_u32 v50, 0x10000, v50
 ds_read_b128 v[24:27], v50 offset:0
 ds_read_b128 v[28:31], v50 offset:1024
 s_waitcnt lgkmcnt(5)
 v_smfmac_f32_16x16x64_bf16 v[0:3], v[16:19], a[80:87], v48
 ds_read_b128 v[12:15], v59 offset:4608
 v_smfmac_f32_16x16x64_bf16 v[4:7], v[16:19], a[88:95], v48
 s_waitcnt lgkmcnt(4)
 v_smfmac_f32_16x16x64_bf16 v[8:11], v[16:19], v[32:39], v48
 ds_read_b128 v[32:35], v50 offset:2048
 ds_read_b128 v[36:39], v50 offset:3072
 s_waitcnt lgkmcnt(5)
 v_smfmac_f32_16x16x64_bf16 v[0:3], v[20:23], a[96:103], v48
 ds_read_b128 v[16:19], v59 offset:5120
 v_smfmac_f32_16x16x64_bf16 v[4:7], v[20:23], a[104:111], v48
 s_waitcnt lgkmcnt(4)
 v_smfmac_f32_16x16x64_bf16 v[8:11], v[20:23], v[24:31], v48
 ds_read_b128 v[24:27], v50 offset:16384
 ds_read_b128 v[28:31], v50 offset:17408
 s_waitcnt lgkmcnt(5)
 v_smfmac_f32_16x16x64_bf16 v[0:3], v[12:15], a[112:119], v48
 ds_read_b128 v[20:23], v59 offset:5632
 v_smfmac_f32_16x16x64_bf16 v[4:7], v[12:15], a[120:127], v48
 s_waitcnt lgkmcnt(4)
 v_smfmac_f32_16x16x64_bf16 v[8:11], v[12:15], v[32:39], v48
 ds_read_b128 v[32:35], v50 offset:18432
 ds_read_b128 v[36:39], v50 offset:19456
 s_waitcnt lgkmcnt(5)
 v_smfmac_f32_16x16x64_bf16 v[0:3], v[16:19], a[128:135], v48
 ds_read_b128 v[12:15], v59 offset:6144
 v_smfmac_f32_16x16x64_bf16 v[4:7], v[16:19], a[136:143], v48
 s_waitcnt lgkmcnt(4)
 v_smfmac_f32_16x16x64_bf16 v[8:11], v[16:19], v[24:31], v48
 ds_read_b128 v[24:27], v50 offset:32768
 ds_read_b128 v[28:31], v50 offset:33792
 s_waitcnt lgkmcnt(5)
 v_smfmac_f32_16x16x64_bf16 v[0:3], v[20:23], a[144:151], v48
 ds_read_b128 v[16:19], v59 offset:6656
 v_smfmac_f32_16x16x64_bf16 v[4:7], v[20:23], a[152:159], v48
 s_waitcnt lgkmcnt(4)
 v_smfmac_f32_16x16x64_bf16 v[8:11], v[20:23], v[32:39], v48
 ds_read_b128 v[32:35], v50 offset:34816
 ds_read_b128 v[36:39], v50 offset:35840
 s_waitcnt lgkmcnt(5)
 v_smfmac_f32_16x16x64_bf16 v[0:3], v[12:15], a[160:167], v48
 ds_read_b128 v[20:23], v59 offset:7168
 v_smfmac_f32_16x16x64_bf16 v[4:7], v[12:15], a[168:175], v48
 s_waitcnt lgkmcnt(4)
 v_smfmac_f32_16x16x64_bf16 v[8:11], v[12:15], v[24:31], v48
 ds_read_b128 v[24:27], v50 offset:49152
 ds_read_b128 v[28:31], v50 offset:50176
 s_waitcnt lgkmcnt(5)
 v_smfmac_f32_16x16x64_bf16 v[0:3], v[16:19], a[176:183], v48
 ds_read_b128 v[12:15], v59 offset:7680
 v_smfmac_f32_16x16x64_bf16 v[4:7], v[16:19], a[184:191], v48
 s_waitcnt lgkmcnt(4)
 v_smfmac_f32_16x16x64_bf16 v[8:11], v[16:19], v[32:39], v48
 ds_read_b128 v[32:35], v50 offset:51200
 ds_read_b128 v[36:39], v50 offset:52224
 v_subrev_u32 v50, 0x10000, v50
 s_waitcnt lgkmcnt(5)
 v_smfmac_f32_16x16x64_bf16 v[0:3], v[20:23], a[192:199], v48
 ds_read_b128 v[16:19], v59 offset:8192
 v_smfmac_f32_16x16x64_bf16 v[4:7], v[20:23], a[200:207], v48
 s_waitcnt lgkmcnt(4)
 v_smfmac_f32_16x16x64_bf16 v[8:11], v[20:23], v[24:31], v48
 s_waitcnt lgkmcnt(3)
 v_smfmac_f32_16x16x64_bf16 v[0:3], v[12:15], a[208:215], v48
 ds_read_b128 v[20:23], v59 offset:8704
 v_smfmac_f32_16x16x64_bf16 v[4:7], v[12:15], a[216:223], v48
 s_waitcnt lgkmcnt(1)
 v_smfmac_f32_16x16x64_bf16 v[0:3], v[16:19], a[224:231], v48
 v_smfmac_f32_16x16x64_bf16 v[4:7], v[16:19], a[232:239], v48
 s_waitcnt lgkmcnt(0)
 v_smfmac_f32_16x16x64_bf16 v[0:3], v[20:23], a[240:247], v48
 v_smfmac_f32_16x16x64_bf16 v[4:7], v[20:23], a[248:255], v48
 s_waitcnt lgkmcnt(2)
 v_smfmac_f32_16x16x64_bf16 v[8:11], v[12:15], v[32:39], v48
 v_cvt_pk_bf16_f32 v0, v0, v1
 v_cvt_pk_bf16_f32 v1, v2, v3
 ds_write_b64 v51, v[0:1]
 ds_read_b128 v[32:35], v49 offset:9216
 ds_read_b128 v[36:39], v49 offset:13312
 v_smfmac_f32_16x16x64_bf16 v[8:11], v[16:19], v[208:215], v48
 v_cvt_pk_bf16_f32 v4, v4, v5
 v_cvt_pk_bf16_f32 v5, v6, v7
 ds_write_b64 v51, v[4:5] offset:256
 v_smfmac_f32_16x16x64_bf16 v[8:11], v[20:23], v[216:223], v48
 ds_read_b128 v[16:19], v49 offset:10240
 ds_read_b128 v[20:23], v49 offset:14336
 s_waitcnt lgkmcnt(2)
 s_barrier
 ds_read_b64_tr_b16 v[24:25], v52 offset:0
 ds_read_b64_tr_b16 v[26:27], v52 offset:128
 ds_read_b64_tr_b16 v[28:29], v52 offset:2048
 ds_read_b64_tr_b16 v[30:31], v52 offset:2176
 ds_read_b64_tr_b16 v[40:41], v52 offset:512
 ds_read_b64_tr_b16 v[42:43], v52 offset:640
 ds_read_b64_tr_b16 v[44:45], v52 offset:2560
 ds_read_b64_tr_b16 v[46:47], v52 offset:2688
 v_cvt_pk_bf16_f32 v8, v8, v9
 v_cvt_pk_bf16_f32 v9, v10, v11
 s_waitcnt lgkmcnt(4)
 v_mfma_f32_16x16x32_bf16 v[4:7], v[32:35], v[24:27], 0
 v_mfma_f32_16x16x32_bf16 v[12:15], v[36:39], v[24:27], 0
 v_mfma_f32_16x16x32_bf16 v[0:3], v[28:31], v[24:27], 0
 ds_read_b128 v[32:35], v49 offset:11264
 ds_read_b128 v[36:39], v49 offset:15360
 ds_read_b64_tr_b16 v[24:25], v52 offset:1024
 ds_read_b64_tr_b16 v[26:27], v52 offset:1152
 ds_read_b64_tr_b16 v[28:29], v52 offset:3072
 ds_read_b64_tr_b16 v[30:31], v52 offset:3200
 s_waitcnt lgkmcnt(6)
 v_mfma_f32_16x16x32_bf16 v[4:7], v[16:19], v[40:43], v[4:7]
 v_mfma_f32_16x16x32_bf16 v[12:15], v[20:23], v[40:43], v[12:15]
 v_mfma_f32_16x16x32_bf16 v[0:3], v[44:47], v[40:43], v[0:3]
 ds_read_b128 v[16:19], v49 offset:12288
 ds_read_b128 v[20:23], v49 offset:16384
 ds_read_b64_tr_b16 v[40:41], v52 offset:1536
 ds_read_b64_tr_b16 v[42:43], v52 offset:1664
 ds_read_b64_tr_b16 v[44:45], v52 offset:3584
 ds_read_b64_tr_b16 v[46:47], v52 offset:3712
 s_waitcnt lgkmcnt(6)
 v_mfma_f32_16x16x32_bf16 v[4:7], v[32:35], v[24:27], v[4:7]
 v_mfma_f32_16x16x32_bf16 v[12:15], v[36:39], v[24:27], v[12:15]
 v_mfma_f32_16x16x32_bf16 v[0:3], v[28:31], v[24:27], v[0:3]
 ds_read_b128 v[24:27], v58 offset:17408
 ds_read_b128 v[28:31], v58 offset:18432
 s_waitcnt lgkmcnt(2)
 v_mfma_f32_16x16x32_bf16 v[4:7], v[16:19], v[40:43], v[4:7]
 v_mfma_f32_16x16x32_bf16 v[12:15], v[20:23], v[40:43], v[12:15]
 v_mfma_f32_16x16x32_bf16 v[0:3], v[44:47], v[40:43], v[0:3]
 v_cndmask_b32 v16, 0, v8, s[88:89]
 v_cndmask_b32 v17, 0, v9, s[88:89]
 v_cndmask_b32 v18, v8, 0, s[88:89]
 v_cndmask_b32 v19, v9, 0, s[88:89]
 v_mov_b32 v10, v8
 v_mov_b32 v11, v9
 v_max3_f32 v32, v4, v5, v6
 v_max3_f32 v33, v12, v13, v14
 v_max3_f32 v32, v32, v7, v15
 v_max3_f32 v33, v33, v0, v1
 v_max3_f32 v32, v32, v2, v3
 v_max_f32 v32, v32, v33
 v_mov_b32 v33, v32
 s_nop 1
 v_permlane32_swap_b32 v32, v33
 v_max_f32 v32, v32, v33
 v_mov_b32 v33, v32
 s_nop 1
 v_permlane16_swap_b32 v32, v33
 v_max_f32 v32, v32, v33
 v_mul_f32 v33, s81, v32
 v_fma_f32 v0, v0, s80, v33
 v_fma_f32 v1, v1, s80, v33
 v_fma_f32 v2, v2, s80, v33
 v_fma_f32 v3, v3, s80, v33
 v_fma_f32 v4, v4, s80, v33
 v_fma_f32 v5, v5, s80, v33
 v_fma_f32 v6, v6, s80, v33
 v_fma_f32 v7, v7, s80, v33
 v_fma_f32 v12, v12, s80, v33
 v_fma_f32 v13, v13, s80, v33
 v_fma_f32 v14, v14, s80, v33
 v_fma_f32 v15, v15, s80, v33
 v_exp_f32 v0, v0
 v_exp_f32 v1, v1
 v_exp_f32 v2, v2
 v_exp_f32 v3, v3
 v_exp_f32 v4, v4
 v_exp_f32 v5, v5
 v_exp_f32 v6, v6
 v_exp_f32 v7, v7
 v_exp_f32 v12, v12
 v_exp_f32 v13, v13
 v_exp_f32 v14, v14
 v_exp_f32 v15, v15
 v_cvt_pk_bf16_f32 v36, v4, v5
 v_cvt_pk_bf16_f32 v37, v6, v7
 v_cvt_pk_bf16_f32 v38, v12, v13
 v_cvt_pk_bf16_f32 v39, v14, v15
 v_cvt_pk_bf16_f32 v34, v0, v1
 v_cvt_pk_bf16_f32 v35, v2, v3
 s_waitcnt lgkmcnt(0)
 v_mfma_f32_16x16x32_bf16 v[40:43], v[24:27], v[36:39], 0
 v_pk_add_f32 v[4:5], v[4:5], v[6:7]
 v_pk_add_f32 v[12:13], v[12:13], v[14:15]
 v_mfma_f32_16x16x32_bf16 v[44:47], v[28:31], v[36:39], 0
 v_pk_add_f32 v[0:1], v[0:1], v[2:3]
 v_pk_add_f32 v[4:5], v[4:5], v[12:13]
 v_mfma_f32_16x16x16_bf16 v[40:43], v[16:17], v[34:35], v[40:43]
 v_add_f32 v0, v0, v1
 v_add_f32 v4, v4, v5
 v_mfma_f32_16x16x16_bf16 v[44:47], v[18:19], v[34:35], v[44:47]
 v_fma_f32 v20, v0, v60, v4
 v_mov_b32 v21, v20
 v_pk_mov_b32 v[0:1], 0, 0
 v_pk_mov_b32 v[2:3], 0, 0
 v_permlane32_swap_b32 v20, v21
 v_add_f32 v20, v20, v21
 v_mov_b32 v21, v20
 v_pk_mov_b32 v[4:5], 0, 0
 v_pk_mov_b32 v[6:7], 0, 0
 v_permlane16_swap_b32 v20, v21
 v_add_f32 v20, v20, v21
 v_rcp_f32 v22, v20
 v_pk_mov_b32 v[8:9], 0, 0
 v_mov_b32 v23, v22
 v_pk_mul_f32 v[40:41], v[40:41], v[22:23]
 v_pk_mul_f32 v[42:43], v[42:43], v[22:23]
 v_pk_mul_f32 v[44:45], v[44:45], v[22:23]
 v_pk_mul_f32 v[46:47], v[46:47], v[22:23]
 v_cvt_pk_bf16_f32 v40, v40, v41
 v_cvt_pk_bf16_f32 v41, v42, v43
 v_cvt_pk_bf16_f32 v42, v44, v45
 v_cvt_pk_bf16_f32 v43, v46, v47
 s_mov_b64 exec, s[84:85]
 ds_write_b64 v53, v[40:41]
 ds_write_b64 v53, v[42:43] offset:256
 s_mov_b64 exec, -1
 v_mov_b32 v44, v10
 v_mov_b32 v45, v11
 v_pk_mov_b32 v[10:11], 0, 0
 v_pk_mov_b32 v[12:13], 0, 0
 v_pk_mov_b32 v[14:15], 0, 0
 v_pk_mov_b32 v[16:17], 0, 0
 v_pk_mov_b32 v[18:19], 0, 0
 v_and_b32 v46, 31, v61
 v_lshlrev_b32 v46, 4, v46
 v_lshrrev_b32 v47, 5, v61
 v_lshlrev_b32 v47, 3, v47
 v_add_u32 v46, v46, v47
 s_waitcnt lgkmcnt(0)
 s_barrier
 ds_read_b128 v[36:39], v49 offset:29696
 ds_read_b128 v[40:43], v49 offset:30720
 ds_read_b128 v[20:23], v59 offset:29696
 ds_read_b128 v[24:27], v59 offset:30208
 ds_read_b128 v[28:31], v59 offset:30720
 ds_read_b128 v[32:35], v59 offset:31232
 s_waitcnt lgkmcnt(5)
 v_smfmac_f32_16x16x64_bf16 v[16:19], v[36:39], v[192:199], v48
 s_waitcnt lgkmcnt(4)
 v_smfmac_f32_16x16x64_bf16 v[16:19], v[40:43], v[200:207], v48
 s_waitcnt lgkmcnt(3)
 v_smfmac_f32_16x16x64_bf16 v[0:3], v[20:23], v[64:71], v48
 v_smfmac_f32_16x16x64_bf16 v[4:7], v[20:23], v[96:103], v48
 s_waitcnt lgkmcnt(2)
 v_smfmac_f32_16x16x64_bf16 v[0:3], v[24:27], v[72:79], v48
 v_smfmac_f32_16x16x64_bf16 v[4:7], v[24:27], v[104:111], v48
 v_cvt_pk_bf16_f32 v16, v16, v17
 v_cvt_pk_bf16_f32 v17, v18, v19
 v_and_or_b32 v16, v16, -2, s75
 buffer_store_dwordx2 v[16:17], v46, s[4:7], s15 offen sc1
 s_waitcnt lgkmcnt(1)
 v_smfmac_f32_16x16x64_bf16 v[0:3], v[28:31], v[80:87], v48
 v_smfmac_f32_16x16x64_bf16 v[4:7], v[28:31], v[112:119], v48
 s_waitcnt lgkmcnt(0)
 v_smfmac_f32_16x16x64_bf16 v[0:3], v[32:35], v[88:95], v48
 v_smfmac_f32_16x16x64_bf16 v[4:7], v[32:35], v[120:127], v48
 v_smfmac_f32_16x16x64_bf16 v[8:11], v[20:23], v[128:135], v48
 v_smfmac_f32_16x16x64_bf16 v[12:15], v[20:23], v[160:167], v48
 v_smfmac_f32_16x16x64_bf16 v[8:11], v[24:27], v[136:143], v48
 v_smfmac_f32_16x16x64_bf16 v[12:15], v[24:27], v[168:175], v48
 v_cvt_pk_bf16_f32 v0, v0, v1
 v_cvt_pk_bf16_f32 v1, v2, v3
 v_cvt_pk_bf16_f32 v2, v4, v5
 v_cvt_pk_bf16_f32 v3, v6, v7
 v_and_or_b32 v0, v0, -2, s75
 buffer_store_dwordx4 v[0:3], v54, s[4:7], 0 offen offset:0 sc1
 v_smfmac_f32_16x16x64_bf16 v[8:11], v[28:31], v[144:151], v48
 v_smfmac_f32_16x16x64_bf16 v[12:15], v[28:31], v[176:183], v48
 v_smfmac_f32_16x16x64_bf16 v[8:11], v[32:35], v[152:159], v48
 v_smfmac_f32_16x16x64_bf16 v[12:15], v[32:35], v[184:191], v48
 s_nop 7
 v_cvt_pk_bf16_f32 v8, v8, v9
 v_cvt_pk_bf16_f32 v9, v10, v11
 v_cvt_pk_bf16_f32 v10, v12, v13
 v_cvt_pk_bf16_f32 v11, v14, v15
 v_and_or_b32 v8, v8, -2, s75
 buffer_store_dwordx4 v[8:11], v54, s[4:7], 0 offen offset:1024 sc1
 s_cmp_eq_u32 s44, 3
 s_cbranch_scc1 L231
 s_cmp_eq_u32 s72, 0
 s_cbranch_scc1 L234
 s_cmp_eq_u32 s72, 2
 s_cbranch_scc1 L233
 v_and_b32 v40, 15, v61
 v_mov_b32 v43, 0x3f80
 v_subrev_u32 v41, 0, v40
 v_lshlrev_b32 v42, 4, v41
 v_cmp_gt_u32 vcc, 2, v41
 v_lshlrev_b32 v42, v42, v43
 s_nop 0
 v_cndmask_b32 v32, 0, v42, vcc
 v_subrev_u32 v41, 2, v40
 v_lshlrev_b32 v42, 4, v41
 v_cmp_gt_u32 vcc, 2, v41
 v_lshlrev_b32 v42, v42, v43
 s_nop 0
 v_cndmask_b32 v33, 0, v42, vcc
 v_subrev_u32 v41, 4, v40
 v_lshlrev_b32 v42, 4, v41
 v_cmp_gt_u32 vcc, 2, v41
 v_lshlrev_b32 v42, v42, v43
 s_nop 0
 v_cndmask_b32 v34, 0, v42, vcc
 v_subrev_u32 v41, 6, v40
 v_lshlrev_b32 v42, 4, v41
 v_cmp_gt_u32 vcc, 2, v41
 v_lshlrev_b32 v42, v42, v43
 s_nop 0
 v_cndmask_b32 v35, 0, v42, vcc
 s_waitcnt vmcnt(0)
 buffer_load_dwordx4 v[0:3], v55, s[4:7], s64 offen sc1
 buffer_load_dwordx4 v[4:7], v55, s[4:7], s65 offen sc1
 buffer_load_dwordx4 v[8:11], v55, s[4:7], s66 offen sc1
 buffer_load_dwordx4 v[12:15], v55, s[4:7], s67 offen sc1
 buffer_load_dwordx4 v[16:19], v55, s[4:7], s68 offen sc1
 buffer_load_dwordx4 v[20:23], v55, s[4:7], s69 offen sc1
 buffer_load_dwordx4 v[24:27], v55, s[4:7], s70 offen sc1
 buffer_load_dwordx4 v[28:31], v55, s[4:7], s71 offen sc1
 s_barrier
 s_branch L236
L235:
 buffer_load_dwordx4 v[0:3], v55, s[4:7], s64 offen sc1
 buffer_load_dwordx4 v[4:7], v55, s[4:7], s65 offen sc1
 buffer_load_dwordx4 v[8:11], v55, s[4:7], s66 offen sc1
 buffer_load_dwordx4 v[12:15], v55, s[4:7], s67 offen sc1
 buffer_load_dwordx4 v[16:19], v55, s[4:7], s68 offen sc1
 buffer_load_dwordx4 v[20:23], v55, s[4:7], s69 offen sc1
 buffer_load_dwordx4 v[24:27], v55, s[4:7], s70 offen sc1
 buffer_load_dwordx4 v[28:31], v55, s[4:7], s71 offen sc1
L236:
 s_waitcnt vmcnt(7)
 v_mfma_f32_16x16x32_bf16 v[36:39], v[0:3], v[32:35], 0
 s_waitcnt vmcnt(6)
 v_mfma_f32_16x16x32_bf16 v[36:39], v[4:7], v[32:35], v[36:39]
 v_bitop3_b32 v47, v0, v4, s75 bitop3:0x7e
 v_mov_b32 v46, v47
 s_waitcnt vmcnt(5)
 v_mfma_f32_16x16x32_bf16 v[36:39], v[8:11], v[32:35], v[36:39]
 s_waitcnt vmcnt(4)
 v_mfma_f32_16x16x32_bf16 v[36:39], v[12:15], v[32:35], v[36:39]
 v_bitop3_b32 v47, v8, v12, s75 bitop3:0x7e
 v_or_b32 v46, v46, v47
 s_waitcnt vmcnt(3)
 v_mfma_f32_16x16x32_bf16 v[36:39], v[16:19], v[32:35], v[36:39]
 s_waitcnt vmcnt(2)
 v_mfma_f32_16x16x32_bf16 v[36:39], v[20:23], v[32:35], v[36:39]
 v_bitop3_b32 v47, v16, v20, s75 bitop3:0x7e
 v_or_b32 v46, v46, v47
 s_waitcnt vmcnt(1)
 v_mfma_f32_16x16x32_bf16 v[36:39], v[24:27], v[32:35], v[36:39]
 s_waitcnt vmcnt(0)
 v_mfma_f32_16x16x32_bf16 v[36:39], v[28:31], v[32:35], v[36:39]
 v_bitop3_b32 v47, v24, v28, s75 bitop3:0x7e
 v_or_b32 v46, v46, v47
 v_and_b32 v46, 1, v46
 v_cmp_ne_u32 vcc, 0, v46
 s_cbranch_vccnz L235
 s_nop 2
 v_cvt_pk_bf16_f32 v46, v36, v37
 v_cvt_pk_bf16_f32 v47, v38, v39
 v_min_u32 v46, -2, v46
 v_min_u32 v47, -2, v47
 s_mov_b64 exec, s[82:83]
 buffer_store_dwordx2 v[46:47], v56, s[4:7], s74 offen sc1
 s_mov_b64 exec, -1
 s_branch L232
L233:
 v_and_b32 v40, 15, v61
 v_mov_b32 v43, 0x3f80
 v_subrev_u32 v41, 0, v40
 v_lshlrev_b32 v42, 4, v41
 v_cmp_gt_u32 vcc, 2, v41
 v_lshlrev_b32 v42, v42, v43
 s_nop 0
 v_cndmask_b32 v32, 0, v42, vcc
 v_subrev_u32 v41, 2, v40
 v_lshlrev_b32 v42, 4, v41
 v_cmp_gt_u32 vcc, 2, v41
 v_lshlrev_b32 v42, v42, v43
 s_nop 0
 v_cndmask_b32 v33, 0, v42, vcc
 v_subrev_u32 v41, 0, v40
 v_lshlrev_b32 v42, 4, v41
 v_cmp_gt_u32 vcc, 2, v41
 v_lshlrev_b32 v42, v42, v43
 s_nop 0
 v_cndmask_b32 v34, 0, v42, vcc
 v_subrev_u32 v41, 2, v40
 v_lshlrev_b32 v42, 4, v41
 v_cmp_gt_u32 vcc, 2, v41
 v_lshlrev_b32 v42, v42, v43
 s_nop 0
 v_cndmask_b32 v35, 0, v42, vcc
 s_waitcnt vmcnt(0)
 buffer_load_dwordx4 v[0:3], v55, s[4:7], s64 offen sc1
 buffer_load_dwordx4 v[4:7], v55, s[4:7], s65 offen sc1
 buffer_load_dwordx4 v[8:11], v55, s[4:7], s66 offen sc1
 buffer_load_dwordx4 v[12:15], v55, s[4:7], s67 offen sc1
 buffer_load_dwordx4 v[16:19], v55, s[4:7], s68 offen sc1
 buffer_load_dwordx4 v[20:23], v55, s[4:7], s69 offen sc1
 buffer_load_dwordx4 v[24:27], v55, s[4:7], s70 offen sc1
 buffer_load_dwordx4 v[28:31], v55, s[4:7], s71 offen sc1
 s_barrier
 s_branch L238
L237:
 buffer_load_dwordx4 v[0:3], v55, s[4:7], s64 offen sc1
 buffer_load_dwordx4 v[4:7], v55, s[4:7], s65 offen sc1
 buffer_load_dwordx4 v[8:11], v55, s[4:7], s66 offen sc1
 buffer_load_dwordx4 v[12:15], v55, s[4:7], s67 offen sc1
 buffer_load_dwordx4 v[16:19], v55, s[4:7], s68 offen sc1
 buffer_load_dwordx4 v[20:23], v55, s[4:7], s69 offen sc1
 buffer_load_dwordx4 v[24:27], v55, s[4:7], s70 offen sc1
 buffer_load_dwordx4 v[28:31], v55, s[4:7], s71 offen sc1
L238:
 s_waitcnt vmcnt(7)
 v_mfma_f32_16x16x32_bf16 v[36:39], v[0:3], v[32:35], 0
 v_bitop3_b32 v47, v0, v2, s75 bitop3:0x7e
 v_mov_b32 v46, v47
 s_waitcnt vmcnt(6)
 v_mfma_f32_16x16x32_bf16 v[36:39], v[4:7], v[32:35], v[36:39]
 v_bitop3_b32 v47, v4, v6, s75 bitop3:0x7e
 v_or_b32 v46, v46, v47
 s_waitcnt vmcnt(5)
 v_mfma_f32_16x16x32_bf16 v[36:39], v[8:11], v[32:35], v[36:39]
 v_bitop3_b32 v47, v8, v10, s75 bitop3:0x7e
 v_or_b32 v46, v46, v47
 s_waitcnt vmcnt(4)
 v_mfma_f32_16x16x32_bf16 v[36:39], v[12:15], v[32:35], v[36:39]
 v_bitop3_b32 v47, v12, v14, s75 bitop3:0x7e
 v_or_b32 v46, v46, v47
 s_waitcnt vmcnt(3)
 v_mfma_f32_16x16x32_bf16 v[36:39], v[16:19], v[32:35], v[36:39]
 v_bitop3_b32 v47, v16, v18, s75 bitop3:0x7e
 v_or_b32 v46, v46, v47
 s_waitcnt vmcnt(2)
 v_mfma_f32_16x16x32_bf16 v[36:39], v[20:23], v[32:35], v[36:39]
 v_bitop3_b32 v47, v20, v22, s75 bitop3:0x7e
 v_or_b32 v46, v46, v47
 s_waitcnt vmcnt(1)
 v_mfma_f32_16x16x32_bf16 v[36:39], v[24:27], v[32:35], v[36:39]
 v_bitop3_b32 v47, v24, v26, s75 bitop3:0x7e
 v_or_b32 v46, v46, v47
 s_waitcnt vmcnt(0)
 v_mfma_f32_16x16x32_bf16 v[36:39], v[28:31], v[32:35], v[36:39]
 v_bitop3_b32 v47, v28, v30, s75 bitop3:0x7e
 v_or_b32 v46, v46, v47
 v_and_b32 v46, 1, v46
 v_cmp_ne_u32 vcc, 0, v46
 s_cbranch_vccnz L237
 s_nop 2
 v_cvt_pk_bf16_f32 v46, v36, v37
 v_cvt_pk_bf16_f32 v47, v38, v39
 v_min_u32 v46, -2, v46
 v_min_u32 v47, -2, v47
 s_mov_b64 exec, s[82:83]
 buffer_store_dwordx2 v[46:47], v56, s[4:7], s74 offen sc1
 s_mov_b64 exec, -1
 s_branch L232
L234:
 s_barrier
L232:
 s_lshl_b32 s60, s44, 9
 v_add_u32 v46, s60, v52
 ds_read_b64_tr_b16 v[40:41], v46 offset:2048
 ds_read_b64_tr_b16 v[42:43], v46 offset:2176
 s_barrier
 s_mul_i32 s61, s44, 3072
 s_add_u32 s12, s61, s74
 s_add_u32 s12, s12, 71303168
 v_add_u32 v36, s61, v49
 v_pk_mov_b32 v[0:1], 0, 0
 v_pk_mov_b32 v[2:3], 0, 0
 v_pk_mov_b32 v[4:5], 0, 0
 v_pk_mov_b32 v[6:7], 0, 0
 v_pk_mov_b32 v[8:9], 0, 0
 v_pk_mov_b32 v[10:11], 0, 0
 s_add_u32 s47, s47, 1
 s_lshl_b32 s79, s47, 18
 s_add_u32 s60, s47, 1
 s_and_b32 s75, s60, 1
 s_mul_i32 s74, s60, 9216
 s_add_u32 s60, s47, 63
 s_and_b32 s60, s60, 63
 s_lshl_b32 s73, s60, 18
 s_add_u32 s76, s73, 4096
 s_sub_u32 s90, s47, 1
 s_max_i32 s90, s90, 0
 s_add_u32 s63, s47, 1
 s_min_u32 s63, s63, 62
 s_cmp_lt_u32 s63, s78
 s_cbranch_scc1 L240
 s_lshl_b32 s60, s46, 6
 s_add_u32 s60, s60, 73400320
 v_mov_b32 v46, 0
L241:
 buffer_load_dword v47, v46, s[4:7], s60 offen sc1
 s_waitcnt vmcnt(0)
 v_readfirstlane_b32 s78, v47
 s_cmp_lt_u32 s63, s78
 s_cbranch_scc0 L241
L240:
 s_lshl_b32 s13, s63, 5
 s_add_u32 s13, s13, s46
 s_lshl_b32 s13, s13, 14
 s_add_u32 s13, s13, 20971520
 s_mov_b32 s77, s13
 s_add_u32 s60, s13, 8192
 s_cmp_eq_u32 s44, 1
 s_cselect_b32 s13, s60, s13
 s_and_b32 s60, s46, 7
 s_mul_i32 s60, s60, 1152
 s_add_u32 s60, s60, s74
 s_add_u32 s60, s60, 71303168
 s_cmp_eq_u32 s44, 2
 s_cselect_b32 s13, s60, s13
L239:
 buffer_load_dwordx4 v[12:15], v57, s[4:7], s12 offen offset:0 sc1
 buffer_load_dwordx4 v[16:19], v57, s[4:7], s12 offen offset:1024 sc1
 buffer_load_dwordx4 v[20:23], v57, s[4:7], s12 offen offset:2048 sc1
 s_waitcnt vmcnt(2)
 ds_write_b128 v36, v[12:15] offset:0
 s_waitcnt vmcnt(1)
 ds_write_b128 v36, v[16:19] offset:1024
 s_waitcnt vmcnt(0)
 ds_write_b128 v36, v[20:23] offset:2048
 v_max3_u32 v37, v12, v14, v16
 v_max3_u32 v38, v18, v20, v22
 v_max_u32 v37, v37, v38
 v_cmp_eq_u32 vcc, -1, v37
 s_cbranch_vccnz L239
 s_waitcnt lgkmcnt(0)
L242:
 s_cmp_eq_u32 s47, 63
 s_cbranch_scc0 CH_TOP227
 s_branch CH_LAST228
L231:
 s_barrier
 s_add_u32 s63, s47, 1
 s_cmp_ge_u32 s63, 63
 s_cbranch_scc1 L243
 s_mov_b32 m0, 140288
 s_add_u32 s60, s77, 0
 buffer_load_dwordx4 v57, s[4:7], s60 offen offset:0 sc1 lds
 buffer_load_dwordx4 v57, s[4:7], s60 offen offset:1024 sc1 lds
 buffer_load_dwordx4 v57, s[4:7], s60 offen offset:2048 sc1 lds
 buffer_load_dwordx4 v57, s[4:7], s60 offen offset:3072 sc1 lds
 s_mov_b32 m0, 144384
 s_add_u32 s60, s77, 4096
 buffer_load_dwordx4 v57, s[4:7], s60 offen offset:0 sc1 lds
 buffer_load_dwordx4 v57, s[4:7], s60 offen offset:1024 sc1 lds
 buffer_load_dwordx4 v57, s[4:7], s60 offen offset:2048 sc1 lds
 buffer_load_dwordx4 v57, s[4:7], s60 offen offset:3072 sc1 lds
 s_mov_b32 m0, 148480
 s_add_u32 s60, s77, 8192
 buffer_load_dwordx4 v57, s[4:7], s60 offen offset:0 sc1 lds
 buffer_load_dwordx4 v57, s[4:7], s60 offen offset:1024 sc1 lds
 buffer_load_dwordx4 v57, s[4:7], s60 offen offset:2048 sc1 lds
 buffer_load_dwordx4 v57, s[4:7], s60 offen offset:3072 sc1 lds
 s_mov_b32 m0, 152576
 s_add_u32 s60, s77, 12288
 buffer_load_dwordx4 v57, s[4:7], s60 offen offset:0 sc1 lds
 buffer_load_dwordx4 v57, s[4:7], s60 offen offset:1024 sc1 lds
 buffer_load_dwordx4 v57, s[4:7], s60 offen offset:2048 sc1 lds
 buffer_load_dwordx4 v57, s[4:7], s60 offen offset:3072 sc1 lds
L243:
 s_lshl_b32 s60, s44, 9
 v_add_u32 v46, s60, v52
 ds_read_b64_tr_b16 v[40:41], v46 offset:2048
 ds_read_b64_tr_b16 v[42:43], v46 offset:2176
 s_barrier
 v_pk_mov_b32 v[0:1], 0, 0
 v_pk_mov_b32 v[2:3], 0, 0
 v_pk_mov_b32 v[4:5], 0, 0
 v_pk_mov_b32 v[6:7], 0, 0
 v_pk_mov_b32 v[8:9], 0, 0
 v_pk_mov_b32 v[10:11], 0, 0
 s_add_u32 s47, s47, 1
 s_lshl_b32 s79, s47, 18
 s_add_u32 s60, s47, 1
 s_and_b32 s75, s60, 1
 s_mul_i32 s74, s60, 9216
 s_add_u32 s60, s47, 63
 s_and_b32 s60, s60, 63
 s_lshl_b32 s73, s60, 18
 s_add_u32 s76, s73, 4096
 s_sub_u32 s90, s47, 1
 s_max_i32 s90, s90, 0
 s_add_u32 s63, s47, 1
 s_min_u32 s63, s63, 62
 s_cmp_lt_u32 s63, s78
 s_cbranch_scc1 L244
 s_lshl_b32 s60, s46, 6
 s_add_u32 s60, s60, 73400320
 v_mov_b32 v46, 0
L245:
 buffer_load_dword v47, v46, s[4:7], s60 offen sc1
 s_waitcnt vmcnt(0)
 v_readfirstlane_b32 s78, v47
 s_cmp_lt_u32 s63, s78
 s_cbranch_scc0 L245
L244:
 s_lshl_b32 s13, s63, 5
 s_add_u32 s13, s13, s46
 s_lshl_b32 s13, s13, 14
 s_add_u32 s13, s13, 20971520
 s_mov_b32 s77, s13
 s_add_u32 s60, s13, 8192
 s_cmp_eq_u32 s44, 1
 s_cselect_b32 s13, s60, s13
 s_and_b32 s60, s46, 7
 s_mul_i32 s60, s60, 1152
 s_add_u32 s60, s60, s74
 s_add_u32 s60, s60, 71303168
 s_cmp_eq_u32 s44, 2
 s_cselect_b32 s13, s60, s13
 s_waitcnt vmcnt(0) lgkmcnt(0)
 s_branch L242
CH_LAST228:
 s_barrier
 ds_read_b128 v[12:15], v59 offset:0
 ds_read_b128 v[24:27], v50 offset:0
 ds_read_b128 v[28:31], v50 offset:1024
 ds_read_b128 v[16:19], v59 offset:512
 ds_read_b128 v[32:35], v50 offset:2048
 ds_read_b128 v[36:39], v50 offset:3072
 s_waitcnt lgkmcnt(5)
 v_smfmac_f32_16x16x64_bf16 v[0:3], v[12:15], v[224:231], v48
 ds_read_b128 v[20:23], v59 offset:1024
 v_smfmac_f32_16x16x64_bf16 v[4:7], v[12:15], v[232:239], v48
 s_waitcnt lgkmcnt(4)
 v_smfmac_f32_16x16x64_bf16 v[8:11], v[12:15], v[24:31], v48
 ds_read_b128 v[24:27], v50 offset:16384
 ds_read_b128 v[28:31], v50 offset:17408
 v_mov_b32 v47, s90
 s_mov_b64 exec, s[16:17]
 buffer_store_dword v47, v57, s[4:7], s14 offen sc1
 s_mov_b64 exec, -1
 s_waitcnt lgkmcnt(5)
 v_smfmac_f32_16x16x64_bf16 v[0:3], v[16:19], v[240:247], v48
 ds_read_b128 v[12:15], v59 offset:1536
 v_smfmac_f32_16x16x64_bf16 v[4:7], v[16:19], v[248:255], v48
 s_waitcnt lgkmcnt(4)
 v_smfmac_f32_16x16x64_bf16 v[8:11], v[16:19], v[32:39], v48
 ds_read_b128 v[32:35], v50 offset:18432
 ds_read_b128 v[36:39], v50 offset:19456
 buffer_store_dwordx4 v[40:43], v62, s[4:7], s73 offen sc1
 s_waitcnt lgkmcnt(5)
 v_smfmac_f32_16x16x64_bf16 v[0:3], v[20:23], a[0:7], v48
 ds_read_b128 v[16:19], v59 offset:2048
 v_smfmac_f32_16x16x64_bf16 v[4:7], v[20:23], a[8:15], v48
 s_waitcnt lgkmcnt(4)
 v_smfmac_f32_16x16x64_bf16 v[8:11], v[20:23], v[24:31], v48
 ds_read_b128 v[24:27], v50 offset:32768
 ds_read_b128 v[28:31], v50 offset:33792
 buffer_store_dwordx2 v[44:45], v62, s[4:7], s76 offen sc1
 s_waitcnt lgkmcnt(5)
 v_smfmac_f32_16x16x64_bf16 v[0:3], v[12:15], a[16:23], v48
 ds_read_b128 v[20:23], v59 offset:2560
 v_smfmac_f32_16x16x64_bf16 v[4:7], v[12:15], a[24:31], v48
 s_waitcnt lgkmcnt(4)
 v_smfmac_f32_16x16x64_bf16 v[8:11], v[12:15], v[32:39], v48
 ds_read_b128 v[32:35], v50 offset:34816
 ds_read_b128 v[36:39], v50 offset:35840
 v_lshlrev_b32 v46, 3, v57
 s_mov_b64 exec, s[86:87]
 buffer_load_dword v63, v46, s[4:7], s13 offen sc1
 s_mov_b64 exec, -1
 s_waitcnt lgkmcnt(5)
 v_smfmac_f32_16x16x64_bf16 v[0:3], v[16:19], a[32:39], v48
 ds_read_b128 v[12:15], v59 offset:3072
 v_smfmac_f32_16x16x64_bf16 v[4:7], v[16:19], a[40:47], v48
 s_waitcnt lgkmcnt(4)
 v_smfmac_f32_16x16x64_bf16 v[8:11], v[16:19], v[24:31], v48
 ds_read_b128 v[24:27], v50 offset:49152
 ds_read_b128 v[28:31], v50 offset:50176
 s_waitcnt lgkmcnt(5)
 v_smfmac_f32_16x16x64_bf16 v[0:3], v[20:23], a[48:55], v48
 ds_read_b128 v[16:19], v59 offset:3584
 v_smfmac_f32_16x16x64_bf16 v[4:7], v[20:23], a[56:63], v48
 s_waitcnt lgkmcnt(4)
 v_smfmac_f32_16x16x64_bf16 v[8:11], v[20:23], v[32:39], v48
 ds_read_b128 v[32:35], v50 offset:51200
 ds_read_b128 v[36:39], v50 offset:52224
 s_waitcnt lgkmcnt(5)
 v_smfmac_f32_16x16x64_bf16 v[0:3], v[12:15], a[64:71], v48
 ds_read_b128 v[20:23], v59 offset:4096
 v_smfmac_f32_16x16x64_bf16 v[4:7], v[12:15], a[72:79], v48
 s_waitcnt lgkmcnt(4)
 v_smfmac_f32_16x16x64_bf16 v[8:11], v[12:15], v[24:31], v48
 v_add_u32 v50, 0x10000, v50
 ds_read_b128 v[24:27], v50 offset:0
 ds_read_b128 v[28:31], v50 offset:1024
 s_waitcnt lgkmcnt(5)
 v_smfmac_f32_16x16x64_bf16 v[0:3], v[16:19], a[80:87], v48
 ds_read_b128 v[12:15], v59 offset:4608
 v_smfmac_f32_16x16x64_bf16 v[4:7], v[16:19], a[88:95], v48
 s_waitcnt lgkmcnt(4)
 v_smfmac_f32_16x16x64_bf16 v[8:11], v[16:19], v[32:39], v48
 ds_read_b128 v[32:35], v50 offset:2048
 ds_read_b128 v[36:39], v50 offset:3072
 s_waitcnt lgkmcnt(5)
 v_smfmac_f32_16x16x64_bf16 v[0:3], v[20:23], a[96:103], v48
 ds_read_b128 v[16:19], v59 offset:5120
 v_smfmac_f32_16x16x64_bf16 v[4:7], v[20:23], a[104:111], v48
 s_waitcnt lgkmcnt(4)
 v_smfmac_f32_16x16x64_bf16 v[8:11], v[20:23], v[24:31], v48
 ds_read_b128 v[24:27], v50 offset:16384
 ds_read_b128 v[28:31], v50 offset:17408
 s_waitcnt lgkmcnt(5)
 v_smfmac_f32_16x16x64_bf16 v[0:3], v[12:15], a[112:119], v48
 ds_read_b128 v[20:23], v59 offset:5632
 v_smfmac_f32_16x16x64_bf16 v[4:7], v[12:15], a[120:127], v48
 s_waitcnt lgkmcnt(4)
 v_smfmac_f32_16x16x64_bf16 v[8:11], v[12:15], v[32:39], v48
 ds_read_b128 v[32:35], v50 offset:18432
 ds_read_b128 v[36:39], v50 offset:19456
 s_waitcnt lgkmcnt(5)
 v_smfmac_f32_16x16x64_bf16 v[0:3], v[16:19], a[128:135], v48
 ds_read_b128 v[12:15], v59 offset:6144
 v_smfmac_f32_16x16x64_bf16 v[4:7], v[16:19], a[136:143], v48
 s_waitcnt lgkmcnt(4)
 v_smfmac_f32_16x16x64_bf16 v[8:11], v[16:19], v[24:31], v48
 ds_read_b128 v[24:27], v50 offset:32768
 ds_read_b128 v[28:31], v50 offset:33792
 s_waitcnt lgkmcnt(5)
 v_smfmac_f32_16x16x64_bf16 v[0:3], v[20:23], a[144:151], v48
 ds_read_b128 v[16:19], v59 offset:6656
 v_smfmac_f32_16x16x64_bf16 v[4:7], v[20:23], a[152:159], v48
 s_waitcnt lgkmcnt(4)
 v_smfmac_f32_16x16x64_bf16 v[8:11], v[20:23], v[32:39], v48
 ds_read_b128 v[32:35], v50 offset:34816
 ds_read_b128 v[36:39], v50 offset:35840
 s_waitcnt lgkmcnt(5)
 v_smfmac_f32_16x16x64_bf16 v[0:3], v[12:15], a[160:167], v48
 ds_read_b128 v[20:23], v59 offset:7168
 v_smfmac_f32_16x16x64_bf16 v[4:7], v[12:15], a[168:175], v48
 s_waitcnt lgkmcnt(4)
 v_smfmac_f32_16x16x64_bf16 v[8:11], v[12:15], v[24:31], v48
 ds_read_b128 v[24:27], v50 offset:49152
 ds_read_b128 v[28:31], v50 offset:50176
 s_waitcnt lgkmcnt(5)
 v_smfmac_f32_16x16x64_bf16 v[0:3], v[16:19], a[176:183], v48
 ds_read_b128 v[12:15], v59 offset:7680
 v_smfmac_f32_16x16x64_bf16 v[4:7], v[16:19], a[184:191], v48
 s_waitcnt lgkmcnt(4)
 v_smfmac_f32_16x16x64_bf16 v[8:11], v[16:19], v[32:39], v48
 ds_read_b128 v[32:35], v50 offset:51200
 ds_read_b128 v[36:39], v50 offset:52224
 v_subrev_u32 v50, 0x10000, v50
 s_waitcnt lgkmcnt(5)
 v_smfmac_f32_16x16x64_bf16 v[0:3], v[20:23], a[192:199], v48
 ds_read_b128 v[16:19], v59 offset:8192
 v_smfmac_f32_16x16x64_bf16 v[4:7], v[20:23], a[200:207], v48
 s_waitcnt lgkmcnt(4)
 v_smfmac_f32_16x16x64_bf16 v[8:11], v[20:23], v[24:31], v48
 s_waitcnt lgkmcnt(3)
 v_smfmac_f32_16x16x64_bf16 v[0:3], v[12:15], a[208:215], v48
 ds_read_b128 v[20:23], v59 offset:8704
 v_smfmac_f32_16x16x64_bf16 v[4:7], v[12:15], a[216:223], v48
 s_waitcnt lgkmcnt(1)
 v_smfmac_f32_16x16x64_bf16 v[0:3], v[16:19], a[224:231], v48
 v_smfmac_f32_16x16x64_bf16 v[4:7], v[16:19], a[232:239], v48
 s_waitcnt lgkmcnt(0)
 v_smfmac_f32_16x16x64_bf16 v[0:3], v[20:23], a[240:247], v48
 v_smfmac_f32_16x16x64_bf16 v[4:7], v[20:23], a[248:255], v48
 s_waitcnt lgkmcnt(2)
 v_smfmac_f32_16x16x64_bf16 v[8:11], v[12:15], v[32:39], v48
 v_cvt_pk_bf16_f32 v0, v0, v1
 v_cvt_pk_bf16_f32 v1, v2, v3
 ds_write_b64 v51, v[0:1]
 ds_read_b128 v[32:35], v49 offset:9216
 ds_read_b128 v[36:39], v49 offset:13312
 v_smfmac_f32_16x16x64_bf16 v[8:11], v[16:19], v[208:215], v48
 v_cvt_pk_bf16_f32 v4, v4, v5
 v_cvt_pk_bf16_f32 v5, v6, v7
 ds_write_b64 v51, v[4:5] offset:256
 v_smfmac_f32_16x16x64_bf16 v[8:11], v[20:23], v[216:223], v48
 ds_read_b128 v[16:19], v49 offset:10240
 ds_read_b128 v[20:23], v49 offset:14336
 s_waitcnt lgkmcnt(2)
 s_barrier
 s_nop 7
 v_cvt_pk_bf16_f32 v8, v8, v9
 v_cvt_pk_bf16_f32 v9, v10, v11
 s_lshl_b32 s60, s44, 9
 v_add_u32 v46, s60, v52
 ds_read_b64_tr_b16 v[40:41], v46 offset:2048
 ds_read_b64_tr_b16 v[42:43], v46 offset:2176
 s_waitcnt lgkmcnt(0)
 buffer_store_dwordx4 v[40:43], v62, s[4:7], s79 offen sc1
 s_add_u32 s60, s79, 4096
 buffer_store_dwordx2 v[8:9], v62, s[4:7], s60 offen sc1
 s_waitcnt vmcnt(0)
 s_barrier
 s_cmp_eq_u32 s44, 3
 s_cbranch_scc0 L246
 s_add_u32 s61, s47, 1
 s_lshl_b32 s60, s46, 6
 s_add_u32 s60, s60, 73404416
 v_mov_b32 v11, s61
 s_mov_b64 exec, 1
 buffer_store_dword v11, v57, s[4:7], s60 offen sc1
 s_mov_b64 exec, -1
L246:
 s_waitcnt vmcnt(0)
 s_endpgm
L_EXIT:
 s_endpgm

.section .rodata,"a"
.p2align 6
.amdhsa_kernel sequential_preLN__memory_aug_recurrent_mem_tr__glu_gated_swiglu__prompt_kernel
  .amdhsa_next_free_vgpr 512
  .amdhsa_next_free_sgpr 102
  .amdhsa_accum_offset 256
  .amdhsa_group_segment_fixed_size 0
  .amdhsa_kernarg_size 112
  .amdhsa_user_sgpr_count 2
  .amdhsa_user_sgpr_kernarg_segment_ptr 1
  .amdhsa_system_sgpr_workgroup_id_x 1
.end_amdhsa_kernel
```
